```python
import torch

def _softmax(x, axis=-1):
    return torch.softmax(x, dim=axis)

def _gelu(x):
    return torch.nn.functional.gelu(x, approximate='tanh')

def _silu(x):
    return torch.nn.functional.silu(x)

def _sigmoid(x):
    return torch.sigmoid(x)

def _layernorm(x, axis=-1, eps=1e-05):
    m = x.mean(dim=axis, keepdim=True)
    v = x.var(dim=axis, keepdim=True, unbiased=False)
    return (x - m) / torch.sqrt(v + eps)

def _scatter_add(tgt, idx, src, axis=0):
    return tgt.clone().index_add_(axis, idx, src)

def _segment_sum(src, seg, n):
    out = torch.zeros((n,) + src.shape[1:], dtype=src.dtype)
    return out.index_add_(0, seg, src)

def _pad(x, pw):
    flat = tuple((v for pair in reversed(pw) for v in pair))
    return torch.nn.functional.pad(x, flat)
kernel_name = 'interleave_layers__memory_aug_recurrent_mem_tr__glu_gated_geglu__prompt'

def setup_inputs():

    _w = lambda a: (lambda t: t.to(torch.bfloat16) if t.is_floating_point() else t)(torch.as_tensor(a))

    def _A_setup():
        B, S, Dm = (1, 2048, 576)
        H, Dh = (32, 128)
        M, seg = (8, 32)
        seg = min(seg, S)
        S = S // seg * seg
        return {'x': _w((lambda *s: torch.randn(*s, dtype=torch.bfloat16) * 0.05)(B, S, Dm)), 'mem0': _w((lambda *s: torch.randn(*s, dtype=torch.bfloat16) * 0.2)(B, M, Dm)), 'Wq': _w((lambda *s: torch.randn(*s, dtype=torch.bfloat16) * 1.6)(Dm, H, Dh) * Dm ** (-0.5)), 'Wk': _w((lambda *s: torch.randn(*s, dtype=torch.bfloat16) * 1.6)(Dm, H, Dh) * Dm ** (-0.5)), 'Wv': _w((lambda *s: torch.randn(*s, dtype=torch.bfloat16) * 0.2)(Dm, H, Dh) * Dm ** (-0.5)), 'Wo': _w((lambda *s: torch.randn(*s, dtype=torch.bfloat16) * 0.2)(H, Dh, Dm) * (H * Dh) ** (-0.5)), 'seg_len': seg}
    _A_in = _A_setup()

    def _B_setup():
        B, S, Dm, Df = (1, 2048, 576, 4608)
        return {'x': _w((lambda *s: torch.randn(*s, dtype=torch.bfloat16) * 0.05)(B, S, Dm)), 'w_gate': _w((lambda *s: torch.randn(*s, dtype=torch.bfloat16) * 0.4)(Dm, Df) * Dm ** (-0.5)), 'w_up': _w((lambda *s: torch.randn(*s, dtype=torch.bfloat16) * 0.4)(Dm, Df) * Dm ** (-0.5)), 'w_down': _w((lambda *s: torch.randn(*s, dtype=torch.bfloat16) * 0.4)(Df, Dm) * Df ** (-0.5))}
    _B_in = _B_setup()
    return {'A_x': _A_in['x'], 'A_mem0': _A_in['mem0'], 'A_Wq': _A_in['Wq'], 'A_Wk': _A_in['Wk'], 'A_Wv': _A_in['Wv'], 'A_Wo': _A_in['Wo'], 'A_seg_len': _A_in['seg_len'], 'B_x': _B_in['x'], 'B_w_gate': _B_in['w_gate'], 'B_w_up': _B_in['w_up'], 'B_w_down': _B_in['w_down']}

def reference(A_x, A_mem0, A_Wq, A_Wk, A_Wv, A_Wo, A_seg_len, B_x, B_w_gate, B_w_up, B_w_down):

    def _A_ref(x, mem0, Wq, Wk, Wv, Wo, seg_len):
        B, S, Dm = x.shape
        H, Dh = (Wq.shape[1], Wq.shape[2])
        M = mem0.shape[1]
        scale = Dh ** (-0.5)
        n_seg = S // seg_len
        L = M + seg_len
        idx = torch.arange(L)
        mask = (idx[:, None] < M) | (idx[:, None] >= idx[None, :])
        mem = mem0
        outs = []
        for s in range(n_seg):
            xs = x[:, s * seg_len:(s + 1) * seg_len, :].clone()
            h = torch.concatenate([mem, xs], axis=1)
            q = torch.einsum('btd,dhe->bhte', h, Wq)
            k = torch.einsum('btd,dhe->bhte', h, Wk)
            v = torch.einsum('btd,dhe->bhte', h, Wv)
            scores = torch.einsum('bhqe,bhke->bhqk', q, k) * scale
            scores = torch.where(mask[None, None], scores, -1000000000.0)
            p = _softmax(scores, axis=-1)
            o = torch.einsum('bhqk,bhke->bhqe', p, v)
            o = torch.einsum('bhte,hed->btd', o, Wo)
            mem = o[:, :M, :].clone()
            outs.append(o[:, M:, :])
        return torch.concatenate(outs, axis=1)

    def _B_ref(x, w_gate, w_up, w_down):
        g = torch.einsum('bsd,df->bsf', x, w_gate)
        u = torch.einsum('bsd,df->bsf', x, w_up)
        h = _gelu(g) * u
        return torch.einsum('bsf,fd->bsd', h, w_down)
    x = A_x
    x = x + _A_ref(_layernorm(x, axis=-1), A_mem0, A_Wq, A_Wk, A_Wv, A_Wo, A_seg_len)
    x = x + _B_ref(_layernorm(x, axis=-1), B_w_gate, B_w_up, B_w_down)
    x = x + _A_ref(_layernorm(x, axis=-1), A_mem0, A_Wq, A_Wk, A_Wv, A_Wo, A_seg_len)
    x = x + _B_ref(_layernorm(x, axis=-1), B_w_gate, B_w_up, B_w_down)
    return x
```

```asm
; @launch grid=(256,1,1) block=(256,1,1) lds=163840
.amdgcn_target "amdgcn-amd-amdhsa--gfx950"
.text
.globl interleave_layers__memory_aug_recurrent_mem_tr__glu_gated_geglu__prompt_kernel
.p2align 8
.type interleave_layers__memory_aug_recurrent_mem_tr__glu_gated_geglu__prompt_kernel,@function
interleave_layers__memory_aug_recurrent_mem_tr__glu_gated_geglu__prompt_kernel:
  s_cmp_ge_u32 s2, 256
  s_cbranch_scc1 L_end
  s_load_dwordx4 s[4:7], s[0:1], 96
  s_getreg_b32 s8, hwreg(HW_REG_XCC_ID)
  s_and_b32 s8, s8, 7
  v_lshrrev_b32 v1, 6, v0
  s_nop 0
  v_readfirstlane_b32 s9, v1
  v_and_b32 v63, 63, v0
  s_mov_b32 s100, 1048576
  s_waitcnt lgkmcnt(0)
  s_mov_b32 s12, s6
  s_and_b32 s13, s7, 0xffff
  s_mov_b32 s14, 0x10000000
  s_mov_b32 s15, 0x20000
  s_cmp_lg_u32 s9, 0
  s_cbranch_scc1 L_claimed
  s_mov_b64 exec, 1
  s_lshl_b32 s10, s8, 2
  v_mov_b32 v3, s10
  v_mov_b32 v4, 1
  global_atomic_add v5, v3, v4, s[4:5] sc0 sc1
  v_mov_b32 v3, 0
  s_waitcnt vmcnt(0)
  ds_write_b32 v3, v5
  s_mov_b64 exec, -1
L_claimed:
  s_waitcnt vmcnt(0) lgkmcnt(0)
  s_barrier
  v_mov_b32 v3, 0
  ds_read_b32 v5, v3
  s_waitcnt lgkmcnt(0)
  v_readfirstlane_b32 s10, v5
  s_nop 0
  s_and_b32 s10, s10, 31
  s_mov_b32 s3, s10
  s_barrier
  s_cmp_eq_u32 s8, 1
  s_cbranch_scc1 L_m1
  s_cmp_eq_u32 s8, 2
  s_cbranch_scc1 L_m2
  s_cmp_eq_u32 s8, 3
  s_cbranch_scc1 L_m3
  s_cmp_eq_u32 s8, 4
  s_cbranch_scc1 L_m4
  s_cmp_eq_u32 s8, 5
  s_cbranch_scc1 L_m5
  s_cmp_eq_u32 s8, 6
  s_cbranch_scc1 L_m6
  s_cmp_eq_u32 s8, 7
  s_cbranch_scc1 L_m7
L_m0:
  s_add_i32 s10, s3, 0
  s_mov_b32 s11, 0
  s_branch L_chain
L_m1:
  s_add_i32 s10, s3, 0
  s_mov_b32 s11, 0
  s_cmp_lt_u32 s3, 16
  s_cbranch_scc1 L_qkv
  s_add_i32 s10, s3, 0
  s_mov_b32 s11, 1
  s_branch L_u
L_m2:
  s_add_i32 s10, s3, 0
  s_mov_b32 s11, 0
  s_cmp_lt_u32 s3, 16
  s_cbranch_scc1 L_u
  s_add_i32 s10, s3, 0
  s_mov_b32 s11, 1
  s_branch L_qkv
L_m3:
  s_add_i32 s10, s3, 0
  s_mov_b32 s11, 1
  s_branch L_chain
L_m4:
  s_add_i32 s10, s3, 0
  s_mov_b32 s11, 0
  s_cmp_lt_u32 s3, 16
  s_cbranch_scc1 L_aw
  s_add_i32 s10, s3, 0
  s_mov_b32 s11, 0
  s_branch L_qkv
L_m5:
  s_add_i32 s10, s3, 0
  s_mov_b32 s11, 1
  s_cmp_lt_u32 s3, 16
  s_cbranch_scc1 L_aw
  s_add_i32 s10, s3, 0
  s_mov_b32 s11, 0
  s_branch L_u
L_m6:
  s_add_i32 s10, s3, 0
  s_mov_b32 s11, 1
  s_cmp_lt_u32 s3, 16
  s_cbranch_scc1 L_u
  s_add_i32 s10, s3, 0
  s_mov_b32 s11, 0
  s_branch L_down
L_m7:
  s_add_i32 s10, s3, 0
  s_mov_b32 s11, 1
  s_cmp_lt_u32 s3, 16
  s_cbranch_scc1 L_qkv
  s_add_i32 s10, s3, 0
  s_mov_b32 s11, 1
  s_branch L_down
L_chain:
  s_load_dwordx2 s[16:17], s[0:1], 16
  s_mov_b32 s18, 4718592
  s_mov_b32 s19, 0x20000
  s_waitcnt lgkmcnt(0)
  s_and_b32 s17, s17, 0xffff
  s_load_dwordx2 s[20:21], s[0:1], 24
  s_mov_b32 s22, 4718592
  s_mov_b32 s23, 0x20000
  s_waitcnt lgkmcnt(0)
  s_and_b32 s21, s21, 0xffff
  s_load_dwordx2 s[24:25], s[0:1], 32
  s_mov_b32 s26, 4718592
  s_mov_b32 s27, 0x20000
  s_waitcnt lgkmcnt(0)
  s_and_b32 s25, s25, 0xffff
  s_load_dwordx2 s[28:29], s[0:1], 40
  s_mov_b32 s30, 4718592
  s_mov_b32 s31, 0x20000
  s_waitcnt lgkmcnt(0)
  s_and_b32 s29, s29, 0xffff
  s_load_dwordx2 s[64:65], s[0:1], 8
  s_mov_b32 s66, 9216
  s_mov_b32 s67, 0x20000
  s_waitcnt lgkmcnt(0)
  s_and_b32 s65, s65, 0xffff
  v_lshlrev_b32 v0, 4, v63
  v_and_b32 v61, 7, v63
  v_lshrrev_b32 v60, 4, v63
  v_lshlrev_b32 v1, 4, v61
  v_lshl_add_u32 v1, v60, 8, v1
  v_bfe_u32 v62, v63, 3, 1
  v_lshl_add_u32 v1, v62, 28, v1
  v_lshrrev_b32 v62, 3, v63
  v_mul_u32_u24 v2, 9344, v62
  v_and_b32 v61, 7, v63
  v_lshl_add_u32 v2, v61, 4, v2
  v_and_b32 v60, 1, v60
  v_lshlrev_b32 v4, 4, v61
  v_lshl_add_u32 v4, v60, 3, v4
  s_add_u32 s62, s9, 1
  s_lshl_b32 s62, s62, 15
  v_add_u32 v3, s62, v0
  s_mov_b32 s52, 0x00ff00ff
  s_mov_b32 s53, 0x00ff00ff
  s_mov_b32 s54, 0xff00ff00
  s_mov_b32 s55, 0xff00ff00
  s_mov_b32 s56, 0x70
  s_mov_b32 s57, 0
  s_mov_b32 s58, 0x00ff00ff
  s_mov_b32 s59, 0
  s_mov_b32 s36, 0
  s_mov_b32 s37, -1
  s_mov_b32 s40, -1
  s_mov_b32 s41, 0xffff
  s_mov_b32 s60, 0x3e0293ee
  s_lshl_b32 s96, s11, 19
  s_add_u32 s96, s96, 1048576
  s_lshl_b32 s97, s11, 16
  s_add_u32 s97, s97, 2097152
  s_mul_i32 s33, s10, 9344
  s_add_u32 s33, s33, s96
  s_add_u32 s48, s33, 4096
  s_add_u32 s49, s33, 8192
  s_cmp_eq_u32 s9, 1
  s_cselect_b32 s63, 8, 40
  s_cmp_eq_u32 s9, 0
  s_cselect_b32 s63, 0, s63
  s_add_u32 s63, s63, s10
  s_lshl_b32 s63, s63, 7
  s_add_u32 s38, s63, s96
  s_add_u32 s39, s38, 74752
  s_add_u32 s34, s38, 149504
  s_add_u32 s35, s38, 224256
  s_lshr_b32 s68, s10, 4
  s_xor_b32 s68, s68, s9
  s_and_b32 s68, s68, 1
  s_cmp_ge_u32 s10, 24
  s_cselect_b32 s98, 1, 0
  s_cmp_eq_u32 s9, 0
  s_cselect_b32 s68, s98, s68
  s_mov_b32 s42, s97
  s_add_u32 s44, s63, s97
  s_add_u32 s43, s44, 0x8000
  v_and_b32 v60, 15, v63
  v_and_b32 v61, 1, v60
  v_lshlrev_b32 v61, 4, v61
  v_mov_b32 v62, 0x3f80
  v_lshlrev_b32 v62, v61, v62
  v_lshrrev_b32 v60, 1, v60
  v_cmp_eq_u32 vcc, 0, v60
  s_nop 1
  v_cndmask_b32 v8, 0, v62, vcc
  v_cmp_eq_u32 vcc, 1, v60
  s_nop 1
  v_cndmask_b32 v9, 0, v62, vcc
  v_cmp_eq_u32 vcc, 2, v60
  s_nop 1
  v_cndmask_b32 v10, 0, v62, vcc
  v_cmp_eq_u32 vcc, 3, v60
  s_nop 1
  v_cndmask_b32 v11, 0, v62, vcc
  v_mov_b32 v16, 1
  v_mov_b32 v20, -1
  v_mov_b32 v17, 1
  v_mov_b32 v21, -1
  v_mov_b32 v18, 1
  v_mov_b32 v22, -1
  v_mov_b32 v19, 1
  v_mov_b32 v23, -1
  s_mul_i32 s98, s9, 2304
  s_add_u32 s98, s98, s33
  buffer_store_dwordx4 v[16:19], v0, s[12:15], s98 offen
  buffer_store_dwordx4 v[16:19], v0, s[12:15], s98 offen offset:1024
  buffer_store_dwordx4 v[16:19], v0, s[12:15], s98 offen offset:1280
  s_cmp_lg_u32 s68, 0
  s_cbranch_scc1 L_ci_1
  s_add_u32 s98, s63, 0
  s_mov_b32 s99, 0
  s_bfe_u32 s95, s98, 0x10007
  s_lshl_b32 s95, s95, 6
  s_add_u32 s99, s99, s95
  s_bfe_u32 s95, s98, 0x20008
  s_lshl_b32 s95, s95, 4
  s_add_u32 s99, s99, s95
  s_lshr_b32 s98, s98, 10
  s_lshl_b32 s98, s98, 7
  s_add_u32 s98, s98, s99
  v_lshrrev_b32 v12, 4, v4
  v_mul_u32_u24 v12, 1152, v12
  v_and_b32 v13, 8, v4
  v_add_u32 v12, v12, v13
  buffer_load_dwordx2 v[24:25], v12, s[64:67], s98 offen
  s_add_u32 s98, s44, 0
  s_add_u32 s99, s43, 0
  s_mov_b64 exec, s[58:59]
  s_waitcnt vmcnt(0)
  buffer_store_dwordx2 v[24:25], v4, s[12:15], s98 offen
  buffer_store_dwordx2 v[20:21], v4, s[12:15], s99 offen
  s_mov_b64 exec, -1
  s_waitcnt vmcnt(0)
L_ci_1:
  s_lshl_b32 s51, s11, 5
  s_add_u32 s51, s51, s10
  s_mul_i32 s51, s51, 64
  s_add_u32 s51, s51, s9
  s_lshl_b32 s51, s51, 2
  s_add_u32 s69, s51, 315392
  s_mul_i32 s98, s11, 8192
  s_add_u32 s47, s51, s98
  s_add_u32 s47, s47, 282624
  s_add_u32 s101, s47, 8192
  v_mov_b32 v60, 0
  s_mov_b64 exec, 1
  buffer_store_dword v60, off, s[12:15], s69 sc1
  s_mov_b64 exec, -1
  s_waitcnt vmcnt(0)
  s_barrier
  s_cmp_lg_u32 s9, 0
  s_cbranch_scc1 L_arr_2
  s_mov_b64 exec, 1
  v_mov_b32 v60, 64
  v_mov_b32 v61, 1
  global_atomic_add v60, v61, s[4:5] sc1
  s_mov_b64 exec, -1
L_arr_2:
  v_lshrrev_b32 v60, 4, v63
  v_lshlrev_b32 v48, 9, v60
  v_bfe_u32 v60, v63, 2, 2
  v_lshl_add_u32 v48, v60, 6, v48
  v_and_b32 v60, 3, v63
  v_lshl_add_u32 v48, v60, 4, v48
  v_add_u32 v48, s62, v48
  v_bfe_u32 v60, v63, 3, 1
  v_lshlrev_b32 v49, 5, v60
  v_lshrrev_b32 v60, 4, v63
  v_lshl_add_u32 v49, v60, 1, v49
  v_bfe_u32 v60, v63, 2, 1
  v_add_u32 v49, v49, v60
  v_lshlrev_b32 v49, 13, v49
  v_and_b32 v60, 3, v63
  v_lshl_add_u32 v49, v60, 4, v49
  v_and_b32 v60, 1, v63
  v_lshlrev_b32 v60, 4, v60
  v_mov_b32 v61, 0x3f80
  v_lshlrev_b32 v61, v60, v61
  v_bfe_u32 v60, v63, 1, 3
  v_lshrrev_b32 v62, 4, v63
  v_lshlrev_b32 v62, 1, v62
  v_sub_u32 v60, v60, v62
  v_cmp_eq_u32 vcc, 0, v60
  s_nop 1
  v_cndmask_b32 v16, 0, v61, vcc
  v_cmp_eq_u32 vcc, 1, v60
  s_nop 1
  v_cndmask_b32 v17, 0, v61, vcc
  v_mov_b32 v18, v16
  v_mov_b32 v19, v17
  v_lshrrev_b32 v60, 1, v0
  ds_write_b64 v60, v[16:17] offset:32000
  v_lshrrev_b32 v60, 2, v63
  v_mul_u32_u24 v50, 1152, v60
  v_and_b32 v60, 3, v63
  v_lshl_add_u32 v50, v60, 4, v50
  s_and_b32 s98, s9, 1
  s_lshl_b32 s98, s98, 3
  v_add_u32 v51, s98, v48
  s_lshl_b32 s90, s10, 8
  s_lshl_b32 s98, s9, 6
  s_add_u32 s90, s90, s98
  s_mul_i32 s91, s10, 147456
  s_lshr_b32 s99, s9, 1
  s_lshl_b32 s99, s99, 6
  s_add_u32 s92, s91, s99
  s_add_u32 s91, s91, s98
  s_cmp_lg_u32 s9, 3
  s_cbranch_scc1 L_gw_3b
  s_cmp_lg_u32 s11, 0
  s_cbranch_scc1 L_gw_3a
  s_branch L_gw_3b
L_gw_3a:
  v_mov_b32 v60, 192
  s_mov_b64 exec, 1
L_wa_4:
  global_load_dword v61, v60, s[4:5] sc1
  s_waitcnt vmcnt(0)
  v_readfirstlane_b32 s98, v61
  s_nop 0
  s_cmp_ge_u32 s98, 32
  s_nop 1
  s_cbranch_scc1 L_wa_4d
  s_sleep 48
  s_sub_u32 s100, s100, 1
  s_cbranch_scc0 L_wa_4
  s_branch L_end
L_wa_4d:
  s_mov_b64 exec, -1
L_gw_3b:
  s_barrier
  s_add_u32 m0, s62, 0
  s_add_u32 s99, s90, 0
  buffer_load_dwordx4 v49, s[16:19], s99 offen  lds
  s_add_u32 m0, s62, 1024
  s_add_u32 s99, s90, 65536
  buffer_load_dwordx4 v49, s[16:19], s99 offen  lds
  s_add_u32 m0, s62, 2048
  s_add_u32 s99, s90, 131072
  buffer_load_dwordx4 v49, s[16:19], s99 offen  lds
  s_add_u32 m0, s62, 3072
  s_add_u32 s99, s90, 196608
  buffer_load_dwordx4 v49, s[16:19], s99 offen  lds
  s_add_u32 m0, s62, 4096
  s_add_u32 s99, s90, 0
  buffer_load_dwordx4 v49, s[20:23], s99 offen  lds
  s_add_u32 m0, s62, 5120
  s_add_u32 s99, s90, 65536
  buffer_load_dwordx4 v49, s[20:23], s99 offen  lds
  s_add_u32 m0, s62, 6144
  s_add_u32 s99, s90, 131072
  buffer_load_dwordx4 v49, s[20:23], s99 offen  lds
  s_add_u32 m0, s62, 7168
  s_add_u32 s99, s90, 196608
  buffer_load_dwordx4 v49, s[20:23], s99 offen  lds
  s_add_u32 m0, s62, 8192
  s_add_u32 s99, s90, 524288
  buffer_load_dwordx4 v49, s[16:19], s99 offen  lds
  s_add_u32 m0, s62, 9216
  s_add_u32 s99, s90, 589824
  buffer_load_dwordx4 v49, s[16:19], s99 offen  lds
  s_add_u32 m0, s62, 10240
  s_add_u32 s99, s90, 655360
  buffer_load_dwordx4 v49, s[16:19], s99 offen  lds
  s_add_u32 m0, s62, 11264
  s_add_u32 s99, s90, 720896
  buffer_load_dwordx4 v49, s[16:19], s99 offen  lds
  s_add_u32 m0, s62, 12288
  s_add_u32 s99, s90, 524288
  buffer_load_dwordx4 v49, s[20:23], s99 offen  lds
  s_add_u32 m0, s62, 13312
  s_add_u32 s99, s90, 589824
  buffer_load_dwordx4 v49, s[20:23], s99 offen  lds
  s_add_u32 m0, s62, 14336
  s_add_u32 s99, s90, 655360
  buffer_load_dwordx4 v49, s[20:23], s99 offen  lds
  s_add_u32 m0, s62, 15360
  s_add_u32 s99, s90, 720896
  buffer_load_dwordx4 v49, s[20:23], s99 offen  lds
  s_add_u32 m0, s62, 16384
  s_add_u32 s99, s90, 1048576
  buffer_load_dwordx4 v49, s[16:19], s99 offen  lds
  s_add_u32 m0, s62, 17408
  s_add_u32 s99, s90, 1114112
  buffer_load_dwordx4 v49, s[16:19], s99 offen  lds
  s_add_u32 m0, s62, 18432
  s_add_u32 s99, s90, 1179648
  buffer_load_dwordx4 v49, s[16:19], s99 offen  lds
  s_add_u32 m0, s62, 19456
  s_add_u32 s99, s90, 1245184
  buffer_load_dwordx4 v49, s[16:19], s99 offen  lds
  s_add_u32 m0, s62, 20480
  s_add_u32 s99, s90, 1048576
  buffer_load_dwordx4 v49, s[20:23], s99 offen  lds
  s_add_u32 m0, s62, 21504
  s_add_u32 s99, s90, 1114112
  buffer_load_dwordx4 v49, s[20:23], s99 offen  lds
  s_add_u32 m0, s62, 22528
  s_add_u32 s99, s90, 1179648
  buffer_load_dwordx4 v49, s[20:23], s99 offen  lds
  s_add_u32 m0, s62, 23552
  s_add_u32 s99, s90, 1245184
  buffer_load_dwordx4 v49, s[20:23], s99 offen  lds
  s_add_u32 m0, s62, 24576
  s_add_u32 s99, s90, 1572864
  buffer_load_dwordx4 v49, s[16:19], s99 offen  lds
  s_add_u32 m0, s62, 25600
  s_add_u32 s99, s90, 1638400
  buffer_load_dwordx4 v49, s[16:19], s99 offen  lds
  s_add_u32 m0, s62, 26624
  s_add_u32 s99, s90, 1703936
  buffer_load_dwordx4 v49, s[16:19], s99 offen  lds
  s_add_u32 m0, s62, 27648
  s_add_u32 s99, s90, 1769472
  buffer_load_dwordx4 v49, s[16:19], s99 offen  lds
  s_add_u32 m0, s62, 28672
  s_add_u32 s99, s90, 1572864
  buffer_load_dwordx4 v49, s[20:23], s99 offen  lds
  s_add_u32 m0, s62, 29696
  s_add_u32 s99, s90, 1638400
  buffer_load_dwordx4 v49, s[20:23], s99 offen  lds
  s_waitcnt vmcnt(28)
  ds_read_b64_tr_b16 a[0:1], v48 offset:0
  ds_read_b64_tr_b16 a[2:3], v48 offset:256
  ds_read_b64_tr_b16 a[8:9], v48 offset:8
  ds_read_b64_tr_b16 a[10:11], v48 offset:264
  s_add_u32 m0, s62, 30720
  s_add_u32 s99, s90, 1703936
  buffer_load_dwordx4 v49, s[20:23], s99 offen  lds
  s_add_u32 m0, s62, 31744
  s_add_u32 s99, s90, 1769472
  buffer_load_dwordx4 v49, s[20:23], s99 offen  lds
  s_waitcnt vmcnt(28)
  ds_read_b64_tr_b16 a[4:5], v48 offset:2048
  ds_read_b64_tr_b16 a[6:7], v48 offset:2304
  ds_read_b64_tr_b16 a[12:13], v48 offset:2056
  ds_read_b64_tr_b16 a[14:15], v48 offset:2312
  s_waitcnt lgkmcnt(4)
  s_add_u32 m0, s62, 0
  s_add_u32 s99, s90, 2097152
  buffer_load_dwordx4 v49, s[16:19], s99 offen  lds
  s_add_u32 m0, s62, 1024
  s_add_u32 s99, s90, 2162688
  buffer_load_dwordx4 v49, s[16:19], s99 offen  lds
  s_waitcnt vmcnt(28)
  ds_read_b64_tr_b16 a[16:17], v48 offset:4096
  ds_read_b64_tr_b16 a[18:19], v48 offset:4352
  ds_read_b64_tr_b16 a[24:25], v48 offset:4104
  ds_read_b64_tr_b16 a[26:27], v48 offset:4360
  s_waitcnt lgkmcnt(4)
  s_add_u32 m0, s62, 2048
  s_add_u32 s99, s90, 2228224
  buffer_load_dwordx4 v49, s[16:19], s99 offen  lds
  s_add_u32 m0, s62, 3072
  s_add_u32 s99, s90, 2293760
  buffer_load_dwordx4 v49, s[16:19], s99 offen  lds
  s_waitcnt vmcnt(28)
  ds_read_b64_tr_b16 a[20:21], v48 offset:6144
  ds_read_b64_tr_b16 a[22:23], v48 offset:6400
  ds_read_b64_tr_b16 a[28:29], v48 offset:6152
  ds_read_b64_tr_b16 a[30:31], v48 offset:6408
  s_waitcnt lgkmcnt(4)
  s_add_u32 m0, s62, 4096
  s_add_u32 s99, s90, 2097152
  buffer_load_dwordx4 v49, s[20:23], s99 offen  lds
  s_add_u32 m0, s62, 5120
  s_add_u32 s99, s90, 2162688
  buffer_load_dwordx4 v49, s[20:23], s99 offen  lds
  s_waitcnt vmcnt(28)
  ds_read_b64_tr_b16 a[32:33], v48 offset:8192
  ds_read_b64_tr_b16 a[34:35], v48 offset:8448
  ds_read_b64_tr_b16 a[40:41], v48 offset:8200
  ds_read_b64_tr_b16 a[42:43], v48 offset:8456
  s_waitcnt lgkmcnt(4)
  s_add_u32 m0, s62, 6144
  s_add_u32 s99, s90, 2228224
  buffer_load_dwordx4 v49, s[20:23], s99 offen  lds
  s_add_u32 m0, s62, 7168
  s_add_u32 s99, s90, 2293760
  buffer_load_dwordx4 v49, s[20:23], s99 offen  lds
  s_waitcnt vmcnt(28)
  ds_read_b64_tr_b16 a[36:37], v48 offset:10240
  ds_read_b64_tr_b16 a[38:39], v48 offset:10496
  ds_read_b64_tr_b16 a[44:45], v48 offset:10248
  ds_read_b64_tr_b16 a[46:47], v48 offset:10504
  s_waitcnt lgkmcnt(4)
  s_add_u32 m0, s62, 8192
  s_add_u32 s99, s90, 2621440
  buffer_load_dwordx4 v49, s[16:19], s99 offen  lds
  s_add_u32 m0, s62, 9216
  s_add_u32 s99, s90, 2686976
  buffer_load_dwordx4 v49, s[16:19], s99 offen  lds
  s_waitcnt vmcnt(28)
  ds_read_b64_tr_b16 a[48:49], v48 offset:12288
  ds_read_b64_tr_b16 a[50:51], v48 offset:12544
  ds_read_b64_tr_b16 a[56:57], v48 offset:12296
  ds_read_b64_tr_b16 a[58:59], v48 offset:12552
  s_waitcnt lgkmcnt(4)
  s_add_u32 m0, s62, 10240
  s_add_u32 s99, s90, 2752512
  buffer_load_dwordx4 v49, s[16:19], s99 offen  lds
  s_add_u32 m0, s62, 11264
  s_add_u32 s99, s90, 2818048
  buffer_load_dwordx4 v49, s[16:19], s99 offen  lds
  s_waitcnt vmcnt(28)
  ds_read_b64_tr_b16 a[52:53], v48 offset:14336
  ds_read_b64_tr_b16 a[54:55], v48 offset:14592
  ds_read_b64_tr_b16 a[60:61], v48 offset:14344
  ds_read_b64_tr_b16 a[62:63], v48 offset:14600
  s_waitcnt lgkmcnt(4)
  s_add_u32 m0, s62, 12288
  s_add_u32 s99, s90, 2621440
  buffer_load_dwordx4 v49, s[20:23], s99 offen  lds
  s_add_u32 m0, s62, 13312
  s_add_u32 s99, s90, 2686976
  buffer_load_dwordx4 v49, s[20:23], s99 offen  lds
  s_waitcnt vmcnt(28)
  ds_read_b64_tr_b16 a[64:65], v48 offset:16384
  ds_read_b64_tr_b16 a[66:67], v48 offset:16640
  ds_read_b64_tr_b16 a[72:73], v48 offset:16392
  ds_read_b64_tr_b16 a[74:75], v48 offset:16648
  s_waitcnt lgkmcnt(4)
  s_add_u32 m0, s62, 14336
  s_add_u32 s99, s90, 2752512
  buffer_load_dwordx4 v49, s[20:23], s99 offen  lds
  s_add_u32 m0, s62, 15360
  s_add_u32 s99, s90, 2818048
  buffer_load_dwordx4 v49, s[20:23], s99 offen  lds
  s_waitcnt vmcnt(28)
  ds_read_b64_tr_b16 a[68:69], v48 offset:18432
  ds_read_b64_tr_b16 a[70:71], v48 offset:18688
  ds_read_b64_tr_b16 a[76:77], v48 offset:18440
  ds_read_b64_tr_b16 a[78:79], v48 offset:18696
  s_waitcnt lgkmcnt(4)
  s_add_u32 m0, s62, 16384
  s_add_u32 s99, s90, 3145728
  buffer_load_dwordx4 v49, s[16:19], s99 offen  lds
  s_add_u32 m0, s62, 17408
  s_add_u32 s99, s90, 3211264
  buffer_load_dwordx4 v49, s[16:19], s99 offen  lds
  s_waitcnt vmcnt(28)
  ds_read_b64_tr_b16 a[80:81], v48 offset:20480
  ds_read_b64_tr_b16 a[82:83], v48 offset:20736
  ds_read_b64_tr_b16 a[88:89], v48 offset:20488
  ds_read_b64_tr_b16 a[90:91], v48 offset:20744
  s_waitcnt lgkmcnt(4)
  s_add_u32 m0, s62, 18432
  s_add_u32 s99, s90, 3276800
  buffer_load_dwordx4 v49, s[16:19], s99 offen  lds
  s_add_u32 m0, s62, 19456
  s_add_u32 s99, s90, 3342336
  buffer_load_dwordx4 v49, s[16:19], s99 offen  lds
  s_waitcnt vmcnt(28)
  ds_read_b64_tr_b16 a[84:85], v48 offset:22528
  ds_read_b64_tr_b16 a[86:87], v48 offset:22784
  ds_read_b64_tr_b16 a[92:93], v48 offset:22536
  ds_read_b64_tr_b16 a[94:95], v48 offset:22792
  s_waitcnt lgkmcnt(4)
  s_add_u32 m0, s62, 20480
  s_add_u32 s99, s90, 3145728
  buffer_load_dwordx4 v49, s[20:23], s99 offen  lds
  s_add_u32 m0, s62, 21504
  s_add_u32 s99, s90, 3211264
  buffer_load_dwordx4 v49, s[20:23], s99 offen  lds
  s_waitcnt vmcnt(28)
  ds_read_b64_tr_b16 a[96:97], v48 offset:24576
  ds_read_b64_tr_b16 a[98:99], v48 offset:24832
  ds_read_b64_tr_b16 a[104:105], v48 offset:24584
  ds_read_b64_tr_b16 a[106:107], v48 offset:24840
  s_waitcnt lgkmcnt(4)
  s_add_u32 m0, s62, 22528
  s_add_u32 s99, s90, 3276800
  buffer_load_dwordx4 v49, s[20:23], s99 offen  lds
  s_add_u32 m0, s62, 23552
  s_add_u32 s99, s90, 3342336
  buffer_load_dwordx4 v49, s[20:23], s99 offen  lds
  s_waitcnt vmcnt(28)
  ds_read_b64_tr_b16 a[100:101], v48 offset:26624
  ds_read_b64_tr_b16 a[102:103], v48 offset:26880
  ds_read_b64_tr_b16 a[108:109], v48 offset:26632
  ds_read_b64_tr_b16 a[110:111], v48 offset:26888
  s_waitcnt lgkmcnt(4)
  s_add_u32 m0, s62, 24576
  s_add_u32 s99, s90, 3670016
  buffer_load_dwordx4 v49, s[16:19], s99 offen  lds
  s_add_u32 m0, s62, 25600
  s_add_u32 s99, s90, 3735552
  buffer_load_dwordx4 v49, s[16:19], s99 offen  lds
  s_waitcnt vmcnt(28)
  ds_read_b64_tr_b16 a[112:113], v48 offset:28672
  ds_read_b64_tr_b16 a[114:115], v48 offset:28928
  ds_read_b64_tr_b16 a[120:121], v48 offset:28680
  ds_read_b64_tr_b16 a[122:123], v48 offset:28936
  s_waitcnt lgkmcnt(4)
  s_add_u32 m0, s62, 26624
  s_add_u32 s99, s90, 3801088
  buffer_load_dwordx4 v49, s[16:19], s99 offen  lds
  s_add_u32 m0, s62, 27648
  s_add_u32 s99, s90, 3866624
  buffer_load_dwordx4 v49, s[16:19], s99 offen  lds
  s_waitcnt vmcnt(28)
  ds_read_b64_tr_b16 a[116:117], v48 offset:30720
  ds_read_b64_tr_b16 a[118:119], v48 offset:30976
  ds_read_b64_tr_b16 a[124:125], v48 offset:30728
  ds_read_b64_tr_b16 a[126:127], v48 offset:30984
  s_waitcnt lgkmcnt(4)
  s_add_u32 m0, s62, 28672
  s_add_u32 s99, s90, 3670016
  buffer_load_dwordx4 v49, s[20:23], s99 offen  lds
  s_add_u32 m0, s62, 29696
  s_add_u32 s99, s90, 3735552
  buffer_load_dwordx4 v49, s[20:23], s99 offen  lds
  s_waitcnt vmcnt(28)
  ds_read_b64_tr_b16 a[128:129], v48 offset:0
  ds_read_b64_tr_b16 a[130:131], v48 offset:256
  ds_read_b64_tr_b16 a[136:137], v48 offset:8
  ds_read_b64_tr_b16 a[138:139], v48 offset:264
  s_waitcnt lgkmcnt(4)
  s_add_u32 m0, s62, 30720
  s_add_u32 s99, s90, 3801088
  buffer_load_dwordx4 v49, s[20:23], s99 offen  lds
  s_add_u32 m0, s62, 31744
  s_add_u32 s99, s90, 3866624
  buffer_load_dwordx4 v49, s[20:23], s99 offen  lds
  s_waitcnt vmcnt(28)
  ds_read_b64_tr_b16 a[132:133], v48 offset:2048
  ds_read_b64_tr_b16 a[134:135], v48 offset:2304
  ds_read_b64_tr_b16 a[140:141], v48 offset:2056
  ds_read_b64_tr_b16 a[142:143], v48 offset:2312
  s_waitcnt lgkmcnt(4)
  s_add_u32 m0, s62, 0
  s_add_u32 s99, s90, 4194304
  buffer_load_dwordx4 v49, s[16:19], s99 offen  lds
  s_add_u32 m0, s62, 1024
  s_add_u32 s99, s90, 4259840
  buffer_load_dwordx4 v49, s[16:19], s99 offen  lds
  s_waitcnt vmcnt(28)
  ds_read_b64_tr_b16 a[144:145], v48 offset:4096
  ds_read_b64_tr_b16 a[146:147], v48 offset:4352
  ds_read_b64_tr_b16 a[152:153], v48 offset:4104
  ds_read_b64_tr_b16 a[154:155], v48 offset:4360
  s_waitcnt lgkmcnt(4)
  s_add_u32 m0, s62, 2048
  s_add_u32 s99, s90, 4325376
  buffer_load_dwordx4 v49, s[16:19], s99 offen  lds
  s_add_u32 m0, s62, 3072
  s_add_u32 s99, s90, 4390912
  buffer_load_dwordx4 v49, s[16:19], s99 offen  lds
  s_waitcnt vmcnt(28)
  ds_read_b64_tr_b16 a[148:149], v48 offset:6144
  ds_read_b64_tr_b16 a[150:151], v48 offset:6400
  ds_read_b64_tr_b16 a[156:157], v48 offset:6152
  ds_read_b64_tr_b16 a[158:159], v48 offset:6408
  s_waitcnt lgkmcnt(4)
  s_add_u32 m0, s62, 4096
  s_add_u32 s99, s90, 4194304
  buffer_load_dwordx4 v49, s[20:23], s99 offen  lds
  s_add_u32 m0, s62, 5120
  s_add_u32 s99, s90, 4259840
  buffer_load_dwordx4 v49, s[20:23], s99 offen  lds
  s_waitcnt vmcnt(28)
  ds_read_b64_tr_b16 a[160:161], v48 offset:8192
  ds_read_b64_tr_b16 a[162:163], v48 offset:8448
  ds_read_b64_tr_b16 a[168:169], v48 offset:8200
  ds_read_b64_tr_b16 a[170:171], v48 offset:8456
  s_waitcnt lgkmcnt(4)
  s_add_u32 m0, s62, 6144
  s_add_u32 s99, s90, 4325376
  buffer_load_dwordx4 v49, s[20:23], s99 offen  lds
  s_add_u32 m0, s62, 7168
  s_add_u32 s99, s90, 4390912
  buffer_load_dwordx4 v49, s[20:23], s99 offen  lds
  s_waitcnt vmcnt(28)
  ds_read_b64_tr_b16 a[164:165], v48 offset:10240
  ds_read_b64_tr_b16 a[166:167], v48 offset:10496
  ds_read_b64_tr_b16 a[172:173], v48 offset:10248
  ds_read_b64_tr_b16 a[174:175], v48 offset:10504
  s_waitcnt lgkmcnt(4)
  s_add_u32 m0, s62, 8192
  s_add_u32 s99, s90, 2621440
  buffer_load_dwordx4 v49, s[24:27], s99 offen  lds
  s_add_u32 m0, s62, 9216
  s_add_u32 s99, s90, 2686976
  buffer_load_dwordx4 v49, s[24:27], s99 offen  lds
  s_waitcnt vmcnt(28)
  ds_read_b64_tr_b16 a[176:177], v48 offset:12288
  ds_read_b64_tr_b16 a[178:179], v48 offset:12544
  ds_read_b64_tr_b16 a[184:185], v48 offset:12296
  ds_read_b64_tr_b16 a[186:187], v48 offset:12552
  s_waitcnt lgkmcnt(4)
  s_add_u32 m0, s62, 10240
  s_add_u32 s99, s90, 2752512
  buffer_load_dwordx4 v49, s[24:27], s99 offen  lds
  s_add_u32 m0, s62, 11264
  s_add_u32 s99, s90, 2818048
  buffer_load_dwordx4 v49, s[24:27], s99 offen  lds
  s_waitcnt vmcnt(28)
  ds_read_b64_tr_b16 a[180:181], v48 offset:14336
  ds_read_b64_tr_b16 a[182:183], v48 offset:14592
  ds_read_b64_tr_b16 a[188:189], v48 offset:14344
  ds_read_b64_tr_b16 a[190:191], v48 offset:14600
  s_waitcnt lgkmcnt(4)
  s_add_u32 m0, s62, 12288
  s_add_u32 s99, s90, 3145728
  buffer_load_dwordx4 v49, s[24:27], s99 offen  lds
  s_add_u32 m0, s62, 13312
  s_add_u32 s99, s90, 3211264
  buffer_load_dwordx4 v49, s[24:27], s99 offen  lds
  s_waitcnt vmcnt(28)
  ds_read_b64_tr_b16 a[192:193], v48 offset:16384
  ds_read_b64_tr_b16 a[194:195], v48 offset:16640
  ds_read_b64_tr_b16 a[200:201], v48 offset:16392
  ds_read_b64_tr_b16 a[202:203], v48 offset:16648
  s_waitcnt lgkmcnt(4)
  s_add_u32 m0, s62, 14336
  s_add_u32 s99, s90, 3276800
  buffer_load_dwordx4 v49, s[24:27], s99 offen  lds
  s_add_u32 m0, s62, 15360
  s_add_u32 s99, s90, 3342336
  buffer_load_dwordx4 v49, s[24:27], s99 offen  lds
  s_waitcnt vmcnt(28)
  ds_read_b64_tr_b16 a[196:197], v48 offset:18432
  ds_read_b64_tr_b16 a[198:199], v48 offset:18688
  ds_read_b64_tr_b16 a[204:205], v48 offset:18440
  ds_read_b64_tr_b16 a[206:207], v48 offset:18696
  s_waitcnt lgkmcnt(4)
  s_add_u32 m0, s62, 16384
  s_add_u32 s99, s90, 3670016
  buffer_load_dwordx4 v49, s[24:27], s99 offen  lds
  s_add_u32 m0, s62, 17408
  s_add_u32 s99, s90, 3735552
  buffer_load_dwordx4 v49, s[24:27], s99 offen  lds
  s_waitcnt vmcnt(28)
  ds_read_b64_tr_b16 a[208:209], v48 offset:20480
  ds_read_b64_tr_b16 a[210:211], v48 offset:20736
  ds_read_b64_tr_b16 a[216:217], v48 offset:20488
  ds_read_b64_tr_b16 a[218:219], v48 offset:20744
  s_waitcnt lgkmcnt(4)
  s_add_u32 m0, s62, 18432
  s_add_u32 s99, s90, 3801088
  buffer_load_dwordx4 v49, s[24:27], s99 offen  lds
  s_add_u32 m0, s62, 19456
  s_add_u32 s99, s90, 3866624
  buffer_load_dwordx4 v49, s[24:27], s99 offen  lds
  s_waitcnt vmcnt(28)
  ds_read_b64_tr_b16 a[212:213], v48 offset:22528
  ds_read_b64_tr_b16 a[214:215], v48 offset:22784
  ds_read_b64_tr_b16 a[220:221], v48 offset:22536
  ds_read_b64_tr_b16 a[222:223], v48 offset:22792
  s_waitcnt lgkmcnt(4)
  s_add_u32 m0, s62, 20480
  s_add_u32 s99, s90, 4194304
  buffer_load_dwordx4 v49, s[24:27], s99 offen  lds
  s_add_u32 m0, s62, 21504
  s_add_u32 s99, s90, 4259840
  buffer_load_dwordx4 v49, s[24:27], s99 offen  lds
  s_waitcnt vmcnt(28)
  ds_read_b64_tr_b16 a[224:225], v48 offset:24576
  ds_read_b64_tr_b16 a[226:227], v48 offset:24832
  ds_read_b64_tr_b16 a[232:233], v48 offset:24584
  ds_read_b64_tr_b16 a[234:235], v48 offset:24840
  s_waitcnt lgkmcnt(4)
  s_add_u32 m0, s62, 22528
  s_add_u32 s99, s90, 4325376
  buffer_load_dwordx4 v49, s[24:27], s99 offen  lds
  s_add_u32 m0, s62, 23552
  s_add_u32 s99, s90, 4390912
  buffer_load_dwordx4 v49, s[24:27], s99 offen  lds
  s_waitcnt vmcnt(28)
  ds_read_b64_tr_b16 a[228:229], v48 offset:26624
  ds_read_b64_tr_b16 a[230:231], v48 offset:26880
  ds_read_b64_tr_b16 a[236:237], v48 offset:26632
  ds_read_b64_tr_b16 a[238:239], v48 offset:26888
  s_waitcnt lgkmcnt(4)
  s_add_u32 m0, s62, 24576
  s_add_u32 s99, s91, 0
  buffer_load_dwordx4 v50, s[28:31], s99 offen  lds
  s_add_u32 m0, s62, 25600
  s_add_u32 s99, s91, 18432
  buffer_load_dwordx4 v50, s[28:31], s99 offen  lds
  s_waitcnt vmcnt(28)
  ds_read_b64_tr_b16 a[240:241], v48 offset:28672
  ds_read_b64_tr_b16 a[242:243], v48 offset:28928
  ds_read_b64_tr_b16 a[248:249], v48 offset:28680
  ds_read_b64_tr_b16 a[250:251], v48 offset:28936
  s_waitcnt lgkmcnt(4)
  s_add_u32 m0, s62, 26624
  s_add_u32 s99, s91, 73728
  buffer_load_dwordx4 v50, s[28:31], s99 offen  lds
  s_add_u32 m0, s62, 27648
  s_add_u32 s99, s91, 92160
  buffer_load_dwordx4 v50, s[28:31], s99 offen  lds
  s_waitcnt vmcnt(28)
  ds_read_b64_tr_b16 a[244:245], v48 offset:30720
  ds_read_b64_tr_b16 a[246:247], v48 offset:30976
  ds_read_b64_tr_b16 a[252:253], v48 offset:30728
  ds_read_b64_tr_b16 a[254:255], v48 offset:30984
  s_waitcnt lgkmcnt(4)
  s_add_u32 m0, s62, 28672
  s_add_u32 s99, s91, 384
  buffer_load_dwordx4 v50, s[28:31], s99 offen  lds
  s_add_u32 m0, s62, 29696
  s_add_u32 s99, s91, 18816
  buffer_load_dwordx4 v50, s[28:31], s99 offen  lds
  s_waitcnt vmcnt(28)
  ds_read_b64_tr_b16 v[64:65], v48 offset:0
  ds_read_b64_tr_b16 v[66:67], v48 offset:256
  ds_read_b64_tr_b16 v[72:73], v48 offset:8
  ds_read_b64_tr_b16 v[74:75], v48 offset:264
  s_waitcnt lgkmcnt(4)
  s_add_u32 m0, s62, 30720
  s_add_u32 s99, s91, 74112
  buffer_load_dwordx4 v50, s[28:31], s99 offen  lds
  s_add_u32 m0, s62, 31744
  s_add_u32 s99, s91, 92544
  buffer_load_dwordx4 v50, s[28:31], s99 offen  lds
  s_waitcnt vmcnt(28)
  ds_read_b64_tr_b16 v[68:69], v48 offset:2048
  ds_read_b64_tr_b16 v[70:71], v48 offset:2304
  ds_read_b64_tr_b16 v[76:77], v48 offset:2056
  ds_read_b64_tr_b16 v[78:79], v48 offset:2312
  s_waitcnt lgkmcnt(4)
  s_add_u32 m0, s62, 0
  s_add_u32 s99, s91, 640
  buffer_load_dwordx4 v50, s[28:31], s99 offen  lds
  s_add_u32 m0, s62, 1024
  s_add_u32 s99, s91, 19072
  buffer_load_dwordx4 v50, s[28:31], s99 offen  lds
  s_waitcnt vmcnt(28)
  ds_read_b64_tr_b16 v[80:81], v48 offset:4096
  ds_read_b64_tr_b16 v[82:83], v48 offset:4352
  ds_read_b64_tr_b16 v[88:89], v48 offset:4104
  ds_read_b64_tr_b16 v[90:91], v48 offset:4360
  s_waitcnt lgkmcnt(4)
  s_add_u32 m0, s62, 2048
  s_add_u32 s99, s91, 74368
  buffer_load_dwordx4 v50, s[28:31], s99 offen  lds
  s_add_u32 m0, s62, 3072
  s_add_u32 s99, s91, 92800
  buffer_load_dwordx4 v50, s[28:31], s99 offen  lds
  s_waitcnt vmcnt(28)
  ds_read_b64_tr_b16 v[84:85], v48 offset:6144
  ds_read_b64_tr_b16 v[86:87], v48 offset:6400
  ds_read_b64_tr_b16 v[92:93], v48 offset:6152
  ds_read_b64_tr_b16 v[94:95], v48 offset:6408
  s_waitcnt lgkmcnt(4)
  s_add_u32 m0, s62, 4096
  s_add_u32 s99, s91, 896
  buffer_load_dwordx4 v50, s[28:31], s99 offen  lds
  s_add_u32 m0, s62, 5120
  s_add_u32 s99, s91, 19328
  buffer_load_dwordx4 v50, s[28:31], s99 offen  lds
  s_waitcnt vmcnt(28)
  ds_read_b64_tr_b16 v[96:97], v48 offset:8192
  ds_read_b64_tr_b16 v[98:99], v48 offset:8448
  ds_read_b64_tr_b16 v[104:105], v48 offset:8200
  ds_read_b64_tr_b16 v[106:107], v48 offset:8456
  s_waitcnt lgkmcnt(4)
  s_add_u32 m0, s62, 6144
  s_add_u32 s99, s91, 37760
  buffer_load_dwordx4 v50, s[28:31], s99 offen  lds
  s_add_u32 m0, s62, 7168
  s_add_u32 s99, s91, 56192
  buffer_load_dwordx4 v50, s[28:31], s99 offen  lds
  s_waitcnt vmcnt(28)
  ds_read_b64_tr_b16 v[100:101], v48 offset:10240
  ds_read_b64_tr_b16 v[102:103], v48 offset:10496
  ds_read_b64_tr_b16 v[108:109], v48 offset:10248
  ds_read_b64_tr_b16 v[110:111], v48 offset:10504
  s_waitcnt lgkmcnt(4)
  s_add_u32 m0, s62, 8192
  s_add_u32 s99, s91, 74624
  buffer_load_dwordx4 v50, s[28:31], s99 offen  lds
  s_add_u32 m0, s62, 9216
  s_add_u32 s99, s91, 93056
  buffer_load_dwordx4 v50, s[28:31], s99 offen  lds
  s_waitcnt vmcnt(28)
  ds_read_b64_tr_b16 v[112:113], v48 offset:12288
  ds_read_b64_tr_b16 v[114:115], v48 offset:12544
  ds_read_b64_tr_b16 v[120:121], v48 offset:12296
  ds_read_b64_tr_b16 v[122:123], v48 offset:12552
  s_waitcnt lgkmcnt(4)
  s_add_u32 m0, s62, 10240
  s_add_u32 s99, s91, 111488
  buffer_load_dwordx4 v50, s[28:31], s99 offen  lds
  s_add_u32 m0, s62, 11264
  s_add_u32 s99, s91, 129920
  buffer_load_dwordx4 v50, s[28:31], s99 offen  lds
  s_waitcnt vmcnt(28)
  ds_read_b64_tr_b16 v[116:117], v48 offset:14336
  ds_read_b64_tr_b16 v[118:119], v48 offset:14592
  ds_read_b64_tr_b16 v[124:125], v48 offset:14344
  ds_read_b64_tr_b16 v[126:127], v48 offset:14600
  s_waitcnt lgkmcnt(4)
  s_add_u32 m0, s62, 12288
  s_add_u32 s99, s92, 256
  buffer_load_dwordx4 v50, s[28:31], s99 offen  lds
  s_add_u32 m0, s62, 13312
  s_add_u32 s99, s92, 18688
  buffer_load_dwordx4 v50, s[28:31], s99 offen  lds
  s_waitcnt vmcnt(28)
  ds_read_b64_tr_b16 v[128:129], v48 offset:16384
  ds_read_b64_tr_b16 v[130:131], v48 offset:16640
  ds_read_b64_tr_b16 v[136:137], v48 offset:16392
  ds_read_b64_tr_b16 v[138:139], v48 offset:16648
  s_waitcnt lgkmcnt(4)
  s_add_u32 m0, s62, 14336
  s_add_u32 s99, s92, 37120
  buffer_load_dwordx4 v50, s[28:31], s99 offen  lds
  s_add_u32 m0, s62, 15360
  s_add_u32 s99, s92, 55552
  buffer_load_dwordx4 v50, s[28:31], s99 offen  lds
  s_waitcnt vmcnt(28)
  ds_read_b64_tr_b16 v[132:133], v48 offset:18432
  ds_read_b64_tr_b16 v[134:135], v48 offset:18688
  ds_read_b64_tr_b16 v[140:141], v48 offset:18440
  ds_read_b64_tr_b16 v[142:143], v48 offset:18696
  s_waitcnt lgkmcnt(4)
  s_add_u32 m0, s62, 16384
  s_add_u32 s99, s92, 73984
  buffer_load_dwordx4 v50, s[28:31], s99 offen  lds
  s_add_u32 m0, s62, 17408
  s_add_u32 s99, s92, 92416
  buffer_load_dwordx4 v50, s[28:31], s99 offen  lds
  s_waitcnt vmcnt(28)
  ds_read_b64_tr_b16 v[144:145], v48 offset:20480
  ds_read_b64_tr_b16 v[146:147], v48 offset:20736
  ds_read_b64_tr_b16 v[152:153], v48 offset:20488
  ds_read_b64_tr_b16 v[154:155], v48 offset:20744
  s_waitcnt lgkmcnt(4)
  s_add_u32 m0, s62, 18432
  s_add_u32 s99, s92, 110848
  buffer_load_dwordx4 v50, s[28:31], s99 offen  lds
  s_add_u32 m0, s62, 19456
  s_add_u32 s99, s92, 129280
  buffer_load_dwordx4 v50, s[28:31], s99 offen  lds
  s_waitcnt vmcnt(28)
  ds_read_b64_tr_b16 v[148:149], v48 offset:22528
  ds_read_b64_tr_b16 v[150:151], v48 offset:22784
  ds_read_b64_tr_b16 v[156:157], v48 offset:22536
  ds_read_b64_tr_b16 v[158:159], v48 offset:22792
  s_waitcnt lgkmcnt(4)
  s_add_u32 m0, s62, 20480
  s_add_u32 s99, s90, 0
  buffer_load_dwordx4 v49, s[24:27], s99 offen  lds
  s_add_u32 m0, s62, 21504
  s_add_u32 s99, s90, 65536
  buffer_load_dwordx4 v49, s[24:27], s99 offen  lds
  s_waitcnt vmcnt(28)
  ds_read_b64_tr_b16 v[160:161], v48 offset:24576
  ds_read_b64_tr_b16 v[162:163], v48 offset:24832
  ds_read_b64_tr_b16 v[164:165], v48 offset:24584
  ds_read_b64_tr_b16 v[166:167], v48 offset:24840
  s_waitcnt lgkmcnt(4)
  s_add_u32 m0, s62, 22528
  s_add_u32 s99, s90, 131072
  buffer_load_dwordx4 v49, s[24:27], s99 offen  lds
  s_add_u32 m0, s62, 23552
  s_add_u32 s99, s90, 196608
  buffer_load_dwordx4 v49, s[24:27], s99 offen  lds
  s_waitcnt vmcnt(28)
  ds_read_b64_tr_b16 v[168:169], v48 offset:26624
  ds_read_b64_tr_b16 v[170:171], v48 offset:26880
  ds_read_b64_tr_b16 v[172:173], v48 offset:26632
  ds_read_b64_tr_b16 v[174:175], v48 offset:26888
  s_waitcnt lgkmcnt(4)
  s_add_u32 m0, s62, 24576
  s_add_u32 s99, s90, 524288
  buffer_load_dwordx4 v49, s[24:27], s99 offen  lds
  s_add_u32 m0, s62, 25600
  s_add_u32 s99, s90, 589824
  buffer_load_dwordx4 v49, s[24:27], s99 offen  lds
  s_waitcnt vmcnt(28)
  ds_read_b64_tr_b16 v[176:177], v48 offset:28672
  ds_read_b64_tr_b16 v[178:179], v48 offset:28928
  ds_read_b64_tr_b16 v[180:181], v48 offset:28680
  ds_read_b64_tr_b16 v[182:183], v48 offset:28936
  s_waitcnt lgkmcnt(4)
  s_add_u32 m0, s62, 26624
  s_add_u32 s99, s90, 655360
  buffer_load_dwordx4 v49, s[24:27], s99 offen  lds
  s_add_u32 m0, s62, 27648
  s_add_u32 s99, s90, 720896
  buffer_load_dwordx4 v49, s[24:27], s99 offen  lds
  s_waitcnt vmcnt(28)
  ds_read_b64_tr_b16 v[184:185], v48 offset:30720
  ds_read_b64_tr_b16 v[186:187], v48 offset:30976
  ds_read_b64_tr_b16 v[188:189], v48 offset:30728
  ds_read_b64_tr_b16 v[190:191], v48 offset:30984
  s_waitcnt lgkmcnt(4)
  s_add_u32 m0, s62, 28672
  s_add_u32 s99, s90, 1048576
  buffer_load_dwordx4 v49, s[24:27], s99 offen  lds
  s_add_u32 m0, s62, 29696
  s_add_u32 s99, s90, 1114112
  buffer_load_dwordx4 v49, s[24:27], s99 offen  lds
  s_waitcnt vmcnt(28)
  ds_read_b64_tr_b16 v[192:193], v48 offset:0
  ds_read_b64_tr_b16 v[194:195], v48 offset:256
  ds_read_b64_tr_b16 v[196:197], v48 offset:8
  ds_read_b64_tr_b16 v[198:199], v48 offset:264
  s_waitcnt lgkmcnt(4)
  s_add_u32 m0, s62, 30720
  s_add_u32 s99, s90, 1179648
  buffer_load_dwordx4 v49, s[24:27], s99 offen  lds
  s_add_u32 m0, s62, 31744
  s_add_u32 s99, s90, 1245184
  buffer_load_dwordx4 v49, s[24:27], s99 offen  lds
  s_waitcnt vmcnt(28)
  ds_read_b64_tr_b16 v[200:201], v48 offset:2048
  ds_read_b64_tr_b16 v[202:203], v48 offset:2304
  ds_read_b64_tr_b16 v[204:205], v48 offset:2056
  ds_read_b64_tr_b16 v[206:207], v48 offset:2312
  s_waitcnt lgkmcnt(4)
  s_add_u32 m0, s62, 0
  s_add_u32 s99, s90, 1572864
  buffer_load_dwordx4 v49, s[24:27], s99 offen  lds
  s_add_u32 m0, s62, 1024
  s_add_u32 s99, s90, 1638400
  buffer_load_dwordx4 v49, s[24:27], s99 offen  lds
  s_waitcnt vmcnt(28)
  ds_read_b64_tr_b16 v[208:209], v48 offset:4096
  ds_read_b64_tr_b16 v[210:211], v48 offset:4352
  ds_read_b64_tr_b16 v[212:213], v48 offset:4104
  ds_read_b64_tr_b16 v[214:215], v48 offset:4360
  s_waitcnt lgkmcnt(4)
  s_add_u32 m0, s62, 2048
  s_add_u32 s99, s90, 1703936
  buffer_load_dwordx4 v49, s[24:27], s99 offen  lds
  s_add_u32 m0, s62, 3072
  s_add_u32 s99, s90, 1769472
  buffer_load_dwordx4 v49, s[24:27], s99 offen  lds
  s_waitcnt vmcnt(28)
  ds_read_b64_tr_b16 v[216:217], v48 offset:6144
  ds_read_b64_tr_b16 v[218:219], v48 offset:6400
  ds_read_b64_tr_b16 v[220:221], v48 offset:6152
  ds_read_b64_tr_b16 v[222:223], v48 offset:6408
  s_waitcnt lgkmcnt(4)
  s_add_u32 m0, s62, 4096
  s_add_u32 s99, s90, 2097152
  buffer_load_dwordx4 v49, s[24:27], s99 offen  lds
  s_add_u32 m0, s62, 5120
  s_add_u32 s99, s90, 2162688
  buffer_load_dwordx4 v49, s[24:27], s99 offen  lds
  s_waitcnt vmcnt(28)
  ds_read_b64_tr_b16 v[224:225], v48 offset:8192
  ds_read_b64_tr_b16 v[226:227], v48 offset:8448
  ds_read_b64_tr_b16 v[228:229], v48 offset:8200
  ds_read_b64_tr_b16 v[230:231], v48 offset:8456
  s_waitcnt lgkmcnt(4)
  s_add_u32 m0, s62, 6144
  s_add_u32 s99, s90, 2228224
  buffer_load_dwordx4 v49, s[24:27], s99 offen  lds
  s_add_u32 m0, s62, 7168
  s_add_u32 s99, s90, 2293760
  buffer_load_dwordx4 v49, s[24:27], s99 offen  lds
  s_waitcnt vmcnt(28)
  ds_read_b64_tr_b16 v[232:233], v48 offset:10240
  ds_read_b64_tr_b16 v[234:235], v48 offset:10496
  ds_read_b64_tr_b16 v[236:237], v48 offset:10248
  ds_read_b64_tr_b16 v[238:239], v48 offset:10504
  s_waitcnt lgkmcnt(4)
  s_add_u32 m0, s62, 8192
  s_add_u32 s99, s91, 36864
  buffer_load_dwordx4 v50, s[28:31], s99 offen  lds
  s_add_u32 m0, s62, 9216
  s_add_u32 s99, s91, 55296
  buffer_load_dwordx4 v50, s[28:31], s99 offen  lds
  s_waitcnt vmcnt(28)
  ds_read_b64_tr_b16 v[240:241], v51 offset:12288
  ds_read_b64_tr_b16 v[242:243], v51 offset:12544
  s_waitcnt lgkmcnt(2)
  s_add_u32 m0, s62, 10240
  s_add_u32 s99, s91, 110592
  buffer_load_dwordx4 v50, s[28:31], s99 offen  lds
  s_add_u32 m0, s62, 11264
  s_add_u32 s99, s91, 129024
  buffer_load_dwordx4 v50, s[28:31], s99 offen  lds
  s_waitcnt vmcnt(28)
  ds_read_b64_tr_b16 v[244:245], v51 offset:14336
  ds_read_b64_tr_b16 v[246:247], v51 offset:14592
  s_waitcnt lgkmcnt(2)
  s_add_u32 m0, s62, 12288
  s_add_u32 s99, s91, 37248
  buffer_load_dwordx4 v50, s[28:31], s99 offen  lds
  s_add_u32 m0, s62, 13312
  s_add_u32 s99, s91, 55680
  buffer_load_dwordx4 v50, s[28:31], s99 offen  lds
  s_waitcnt vmcnt(28)
  ds_read_b64_tr_b16 v[248:249], v51 offset:16384
  ds_read_b64_tr_b16 v[250:251], v51 offset:16640
  s_waitcnt lgkmcnt(2)
  s_add_u32 m0, s62, 14336
  s_add_u32 s99, s91, 110976
  buffer_load_dwordx4 v50, s[28:31], s99 offen  lds
  s_add_u32 m0, s62, 15360
  s_add_u32 s99, s91, 129408
  buffer_load_dwordx4 v50, s[28:31], s99 offen  lds
  s_waitcnt vmcnt(28)
  ds_read_b64_tr_b16 v[252:253], v51 offset:18432
  ds_read_b64_tr_b16 v[254:255], v51 offset:18688
  s_waitcnt lgkmcnt(2)
  s_add_u32 m0, s62, 16384
  s_add_u32 s99, s91, 37504
  buffer_load_dwordx4 v50, s[28:31], s99 offen  lds
  s_add_u32 m0, s62, 17408
  s_add_u32 s99, s91, 55936
  buffer_load_dwordx4 v50, s[28:31], s99 offen  lds
  s_waitcnt vmcnt(28)
  ds_read_b64_tr_b16 v[16:17], v48 offset:20480
  ds_read_b64_tr_b16 v[18:19], v48 offset:20736
  ds_read_b64_tr_b16 v[20:21], v48 offset:20488
  ds_read_b64_tr_b16 v[22:23], v48 offset:20744
  s_waitcnt lgkmcnt(0)
  ds_write_b128 v3, v[16:19] offset:20480
  ds_write_b128 v3, v[20:23] offset:21504
  s_add_u32 m0, s62, 18432
  s_add_u32 s99, s91, 111232
  buffer_load_dwordx4 v50, s[28:31], s99 offen  lds
  s_add_u32 m0, s62, 19456
  s_add_u32 s99, s91, 129664
  buffer_load_dwordx4 v50, s[28:31], s99 offen  lds
  s_waitcnt vmcnt(28)
  ds_read_b64_tr_b16 v[24:25], v48 offset:22528
  ds_read_b64_tr_b16 v[26:27], v48 offset:22784
  ds_read_b64_tr_b16 v[28:29], v48 offset:22536
  ds_read_b64_tr_b16 v[30:31], v48 offset:22792
  s_waitcnt lgkmcnt(0)
  ds_write_b128 v3, v[24:27] offset:22528
  ds_write_b128 v3, v[28:31] offset:23552
  s_waitcnt vmcnt(26)
  ds_read_b64_tr_b16 v[16:17], v48 offset:24576
  ds_read_b64_tr_b16 v[18:19], v48 offset:24832
  ds_read_b64_tr_b16 v[20:21], v48 offset:24584
  ds_read_b64_tr_b16 v[22:23], v48 offset:24840
  s_waitcnt lgkmcnt(0)
  ds_write_b128 v3, v[16:19] offset:24576
  ds_write_b128 v3, v[20:23] offset:25600
  s_waitcnt vmcnt(24)
  ds_read_b64_tr_b16 v[24:25], v48 offset:26624
  ds_read_b64_tr_b16 v[26:27], v48 offset:26880
  ds_read_b64_tr_b16 v[28:29], v48 offset:26632
  ds_read_b64_tr_b16 v[30:31], v48 offset:26888
  s_waitcnt lgkmcnt(0)
  ds_write_b128 v3, v[24:27] offset:26624
  ds_write_b128 v3, v[28:31] offset:27648
  s_waitcnt vmcnt(22)
  ds_read_b64_tr_b16 v[16:17], v48 offset:28672
  ds_read_b64_tr_b16 v[18:19], v48 offset:28928
  ds_read_b64_tr_b16 v[20:21], v48 offset:28680
  ds_read_b64_tr_b16 v[22:23], v48 offset:28936
  s_waitcnt lgkmcnt(0)
  ds_write_b128 v3, v[16:19] offset:28672
  ds_write_b128 v3, v[20:23] offset:29696
  s_waitcnt vmcnt(20)
  ds_read_b64_tr_b16 v[24:25], v48 offset:30720
  ds_read_b64_tr_b16 v[26:27], v48 offset:30976
  ds_read_b64_tr_b16 v[28:29], v48 offset:30728
  ds_read_b64_tr_b16 v[30:31], v48 offset:30984
  s_waitcnt lgkmcnt(0)
  ds_write_b128 v3, v[24:27] offset:30720
  ds_write_b128 v3, v[28:31] offset:31744
  s_waitcnt vmcnt(18)
  ds_read_b64_tr_b16 v[16:17], v48 offset:0
  ds_read_b64_tr_b16 v[18:19], v48 offset:256
  ds_read_b64_tr_b16 v[20:21], v48 offset:8
  ds_read_b64_tr_b16 v[22:23], v48 offset:264
  s_waitcnt lgkmcnt(0)
  ds_write_b128 v3, v[16:19] offset:0
  ds_write_b128 v3, v[20:23] offset:1024
  s_waitcnt vmcnt(16)
  ds_read_b64_tr_b16 v[24:25], v48 offset:2048
  ds_read_b64_tr_b16 v[26:27], v48 offset:2304
  ds_read_b64_tr_b16 v[28:29], v48 offset:2056
  ds_read_b64_tr_b16 v[30:31], v48 offset:2312
  s_waitcnt lgkmcnt(0)
  ds_write_b128 v3, v[24:27] offset:2048
  ds_write_b128 v3, v[28:31] offset:3072
  s_waitcnt vmcnt(14)
  ds_read_b64_tr_b16 v[16:17], v48 offset:4096
  ds_read_b64_tr_b16 v[18:19], v48 offset:4352
  ds_read_b64_tr_b16 v[20:21], v48 offset:4104
  ds_read_b64_tr_b16 v[22:23], v48 offset:4360
  s_waitcnt lgkmcnt(0)
  ds_write_b128 v3, v[16:19] offset:4096
  ds_write_b128 v3, v[20:23] offset:5120
  s_waitcnt vmcnt(12)
  ds_read_b64_tr_b16 v[24:25], v48 offset:6144
  ds_read_b64_tr_b16 v[26:27], v48 offset:6400
  ds_read_b64_tr_b16 v[28:29], v48 offset:6152
  ds_read_b64_tr_b16 v[30:31], v48 offset:6408
  s_waitcnt lgkmcnt(0)
  ds_write_b128 v3, v[24:27] offset:6144
  ds_write_b128 v3, v[28:31] offset:7168
  s_waitcnt vmcnt(10)
  ds_read_b64_tr_b16 v[16:17], v48 offset:8192
  ds_read_b64_tr_b16 v[18:19], v48 offset:8448
  ds_read_b64_tr_b16 v[20:21], v48 offset:8200
  ds_read_b64_tr_b16 v[22:23], v48 offset:8456
  s_waitcnt lgkmcnt(0)
  ds_write_b128 v3, v[16:19] offset:8192
  ds_write_b128 v3, v[20:23] offset:9216
  s_waitcnt vmcnt(8)
  ds_read_b64_tr_b16 v[24:25], v48 offset:10240
  ds_read_b64_tr_b16 v[26:27], v48 offset:10496
  ds_read_b64_tr_b16 v[28:29], v48 offset:10248
  ds_read_b64_tr_b16 v[30:31], v48 offset:10504
  s_waitcnt lgkmcnt(0)
  ds_write_b128 v3, v[24:27] offset:10240
  ds_write_b128 v3, v[28:31] offset:11264
  s_waitcnt vmcnt(6)
  ds_read_b64_tr_b16 v[16:17], v48 offset:12288
  ds_read_b64_tr_b16 v[18:19], v48 offset:12544
  ds_read_b64_tr_b16 v[20:21], v48 offset:12296
  ds_read_b64_tr_b16 v[22:23], v48 offset:12552
  s_waitcnt lgkmcnt(0)
  ds_write_b128 v3, v[16:19] offset:12288
  ds_write_b128 v3, v[20:23] offset:13312
  s_waitcnt vmcnt(4)
  ds_read_b64_tr_b16 v[24:25], v48 offset:14336
  ds_read_b64_tr_b16 v[26:27], v48 offset:14592
  ds_read_b64_tr_b16 v[28:29], v48 offset:14344
  ds_read_b64_tr_b16 v[30:31], v48 offset:14600
  s_waitcnt lgkmcnt(0)
  ds_write_b128 v3, v[24:27] offset:14336
  ds_write_b128 v3, v[28:31] offset:15360
  s_waitcnt vmcnt(2)
  ds_read_b64_tr_b16 v[16:17], v48 offset:16384
  ds_read_b64_tr_b16 v[18:19], v48 offset:16640
  ds_read_b64_tr_b16 v[20:21], v48 offset:16392
  ds_read_b64_tr_b16 v[22:23], v48 offset:16648
  s_waitcnt lgkmcnt(0)
  ds_write_b128 v3, v[16:19] offset:16384
  ds_write_b128 v3, v[20:23] offset:17408
  s_waitcnt vmcnt(0)
  ds_read_b64_tr_b16 v[24:25], v48 offset:18432
  ds_read_b64_tr_b16 v[26:27], v48 offset:18688
  ds_read_b64_tr_b16 v[28:29], v48 offset:18440
  ds_read_b64_tr_b16 v[30:31], v48 offset:18696
  s_waitcnt lgkmcnt(0)
  ds_write_b128 v3, v[24:27] offset:18432
  ds_write_b128 v3, v[28:31] offset:19456
  s_waitcnt lgkmcnt(0)
  s_or_b32 s98, s11, s9
  s_cbranch_scc1 L_gs_5
  s_mov_b64 exec, 1
  v_mov_b32 v60, 192
  v_mov_b32 v61, 1
  global_atomic_add v60, v61, s[4:5] sc1
  s_mov_b64 exec, -1
L_gs_5:
  v_mov_b32 v60, 64
  s_mov_b64 exec, 1
L_wa_6:
  global_load_dword v61, v60, s[4:5] sc1
  s_waitcnt vmcnt(0)
  v_readfirstlane_b32 s98, v61
  s_nop 0
  s_cmp_ge_u32 s98, 256
  s_nop 1
  s_cbranch_scc1 L_wa_6d
  s_sleep 8
  s_sub_u32 s100, s100, 1
  s_cbranch_scc0 L_wa_6
  s_branch L_end
L_wa_6d:
  s_mov_b64 exec, -1
  s_mov_b32 s32, 0
  s_mov_b32 s45, 0
  s_lshl_b32 s98, s11, 11
  s_add_u32 s98, s98, s10
  s_mul_i32 s46, s98, 24576
  s_lshl_b32 s99, s9, 12
  s_add_u32 s46, s46, s99
  s_add_u32 s46, s46, 37748736
  s_lshl_b32 s50, s98, 12
  s_lshl_b32 s99, s9, 10
  s_add_u32 s50, s50, s99
  s_add_u32 s50, s50, 20971520
  s_mov_b32 s91, s50
  s_mov_b32 s61, 0
  s_mov_b32 s90, 0
  s_setprio 3
  s_cmp_eq_u32 s9, 1
  s_cbranch_scc1 L_cst1
  s_cmp_eq_u32 s9, 2
  s_cbranch_scc1 L_cst2
  s_cmp_eq_u32 s9, 3
  s_cbranch_scc1 L_cst3
L_cst0:
  v_mov_b32 v16, 0
  v_mov_b32 v17, 31744
  ds_write_b32 v17, v16
  ds_write_b32 v17, v16 offset:4
  ds_read_b128 v[36:39], v3 offset:20480
  ds_read_b128 v[40:43], v3 offset:22528
  ds_read_b128 v[52:55], v3 offset:21504
  ds_read_b128 v[56:59], v3 offset:23552
  v_lshrrev_b32 v4, 1, v0
  ds_read_b64 v[4:5], v4 offset:32000
  v_mov_b32 v7, 0x4444
  v_mov_b32 v16, 0xeeee
  v_cndmask_b32 v7, v16, v7, s[52:53]
  v_mov_b64 v[16:17], 0
  v_mov_b64 v[18:19], 0
  v_mov_b64 v[20:21], 0
  v_mov_b64 v[22:23], 0
  v_mov_b64 v[24:25], 0
  v_mov_b64 v[26:27], 0
  v_mov_b64 v[28:29], 0
  v_mov_b64 v[30:31], 0
  v_mov_b64 v[44:45], 0
  v_mov_b64 v[46:47], 0
  v_mov_b64 v[48:49], 0
  v_mov_b64 v[50:51], 0
  s_add_u32 s96, s42, 0
  buffer_load_dwordx4 v[12:15], v0, s[12:15], s96 offen offset:0 sc1
  buffer_load_dwordx4 v[60:63], v0, s[12:15], s96 offen offset:1024 sc1
  buffer_load_dwordx4 v[32:35], v0, s[12:15], s96 offen offset:2048 sc1
L_g0c_7:
  s_waitcnt vmcnt(2)
  ds_write_b128 v0, v[12:15] offset:0
  v_max_u32 v6, v12, v14
  s_waitcnt vmcnt(1)
  ds_write_b128 v0, v[60:63] offset:1024
  v_max3_u32 v6, v6, v60, v62
  s_waitcnt vmcnt(0)
  v_max3_u32 v6, v6, v32, v34
  v_cmp_eq_u32 vcc, -1, v6
  ds_write_b128 v0, v[32:35] offset:2048
  s_cbranch_vccz L_g0d_9
  s_mov_b64 exec, vcc
  buffer_load_dwordx4 v[12:15], v0, s[12:15], s96 offen offset:0 sc1
  buffer_load_dwordx4 v[60:63], v0, s[12:15], s96 offen offset:1024 sc1
  buffer_load_dwordx4 v[32:35], v0, s[12:15], s96 offen offset:2048 sc1
  s_mov_b64 exec, -1
  s_sub_u32 s100, s100, 1
  s_cbranch_scc0 L_g0c_7
  s_branch L_end
L_g0d_9:
  s_waitcnt lgkmcnt(0)
  s_barrier
  ds_read_b128 v[32:35], v0 offset:0
  ds_read_b128 v[60:63], v0 offset:1024
L_cloop0:
  s_waitcnt lgkmcnt(1)
  v_smfmac_f32_16x16x64_bf16 v[44:47], v[32:35], v[36:43], v7
  ds_read_b128 v[36:39], v3 offset:24576
  ds_read_b128 v[40:43], v3 offset:26624
  s_add_u32 s98, s42, 5120
  buffer_load_dwordx4 v[12:15], v0, s[12:15], s98 offen sc1
  v_smfmac_f32_16x16x64_bf16 v[48:51], v[32:35], v[52:59], v7
  ds_read_b128 v[52:55], v3 offset:25600
  ds_read_b128 v[56:59], v3 offset:27648
  v_smfmac_f32_16x16x64_bf16 v[16:19], v[32:35], a[0:7], v7
  v_smfmac_f32_16x16x64_bf16 v[20:23], v[32:35], a[8:15], v7
  v_smfmac_f32_16x16x64_bf16 v[24:27], v[32:35], a[16:23], v7
  v_smfmac_f32_16x16x64_bf16 v[28:31], v[32:35], a[24:31], v7
  ds_read_b128 v[32:35], v0 offset:2048
  v_mov_b32 v6, s32
  s_mov_b64 exec, 1
  buffer_store_dword v6, off, s[12:15], s69 sc1
  s_mov_b64 exec, -1
  s_waitcnt lgkmcnt(3)
  v_smfmac_f32_16x16x64_bf16 v[44:47], v[60:63], v[36:43], v7
  ds_read_b128 v[36:39], v3 offset:28672
  ds_read_b128 v[40:43], v3 offset:30720
  s_waitcnt lgkmcnt(3)
  v_smfmac_f32_16x16x64_bf16 v[48:51], v[60:63], v[52:59], v7
  ds_read_b128 v[52:55], v3 offset:29696
  ds_read_b128 v[56:59], v3 offset:31744
  v_smfmac_f32_16x16x64_bf16 v[16:19], v[60:63], a[32:39], v7
  v_smfmac_f32_16x16x64_bf16 v[20:23], v[60:63], a[40:47], v7
  v_smfmac_f32_16x16x64_bf16 v[24:27], v[60:63], a[48:55], v7
  v_lshrrev_b32 v6, 2, v0
  ds_read_b32 v6, v6 offset:31744
  v_smfmac_f32_16x16x64_bf16 v[28:31], v[60:63], a[56:63], v7
  ds_read_b128 v[60:63], v0 offset:3072
  s_waitcnt lgkmcnt(4)
  v_smfmac_f32_16x16x64_bf16 v[44:47], v[32:35], v[36:43], v7
  ds_read_b128 v[36:39], v3 offset:0
  ds_read_b128 v[40:43], v3 offset:2048
  s_and_b32 s97, s90, 786432
  s_add_u32 s97, s97, s46
  s_waitcnt lgkmcnt(4)
  v_smfmac_f32_16x16x64_bf16 v[48:51], v[32:35], v[52:59], v7
  ds_read_b128 v[52:55], v3 offset:1024
  ds_read_b128 v[56:59], v3 offset:3072
  v_smfmac_f32_16x16x64_bf16 v[16:19], v[32:35], a[64:71], v7
  s_waitcnt lgkmcnt(5)
  v_readlane_b32 s98, v6, 0
  v_readlane_b32 s99, v6, 1
  s_nop 0
  s_min_u32 s98, s98, s99
  s_max_u32 s61, s61, s98
  v_smfmac_f32_16x16x64_bf16 v[20:23], v[32:35], a[72:79], v7
  v_smfmac_f32_16x16x64_bf16 v[24:27], v[32:35], a[80:87], v7
  s_and_b32 s98, s90, 1
  s_add_u32 s99, s32, s98
  s_min_u32 s99, s99, 63
  s_cmp_gt_u32 s61, s99
  s_cselect_b64 s[40:41], -1, 0
  v_smfmac_f32_16x16x64_bf16 v[28:31], v[32:35], a[88:95], v7
  ds_read_b128 v[32:35], v0 offset:4096
  s_cmp_eq_u32 s90, 0
  s_cbranch_scc1 L_kc_12
L_kc_12b:
  s_waitcnt lgkmcnt(3)
  v_smfmac_f32_16x16x64_bf16 v[44:47], v[60:63], v[36:43], v7
  ds_read_b128 v[36:39], v3 offset:4096
  ds_read_b128 v[40:43], v3 offset:6144
  s_waitcnt lgkmcnt(3)
  v_smfmac_f32_16x16x64_bf16 v[48:51], v[60:63], v[52:59], v7
  ds_read_b128 v[52:55], v3 offset:5120
  ds_read_b128 v[56:59], v3 offset:7168
  s_waitcnt vmcnt(1)
  ds_write_b128 v0, v[12:15] offset:5120
  v_cmp_eq_u32 vcc, -1, v12
  v_cmp_eq_u32 s[94:95], -1, v14
  v_smfmac_f32_16x16x64_bf16 v[16:19], v[60:63], a[96:103], v7
  v_smfmac_f32_16x16x64_bf16 v[20:23], v[60:63], a[104:111], v7
  s_or_b64 vcc, vcc, s[94:95]
  s_cbranch_scc1 L_gr_13
L_gb_14:
  v_smfmac_f32_16x16x64_bf16 v[24:27], v[60:63], a[112:119], v7
  v_smfmac_f32_16x16x64_bf16 v[28:31], v[60:63], a[120:127], v7
  s_waitcnt lgkmcnt(3)
  v_smfmac_f32_16x16x64_bf16 v[44:47], v[32:35], v[36:43], v7
  s_add_u32 s98, s32, 2
  s_min_u32 s98, s98, 64
  s_cmp_lt_u32 s61, s98
  s_cbranch_scc1 L_fp_15
L_fp_15b:
  s_waitcnt lgkmcnt(1)
  v_smfmac_f32_16x16x64_bf16 v[48:51], v[32:35], v[52:59], v7
  v_smfmac_f32_16x16x64_bf16 v[16:19], v[32:35], a[128:135], v7
  s_waitcnt lgkmcnt(0)
  s_barrier
  ds_read_b128 v[60:63], v0 offset:5120
  ds_read_b128 v[36:39], v0 offset:6144
  ds_read_b128 v[40:43], v0 offset:7168
  v_smfmac_f32_16x16x64_bf16 v[20:23], v[32:35], a[136:143], v7
  v_smfmac_f32_16x16x64_bf16 v[24:27], v[32:35], a[144:151], v7
  s_xor_b32 s42, s42, 0x8000
  v_smfmac_f32_16x16x64_bf16 v[28:31], v[32:35], a[152:159], v7
  ds_read_b128 v[32:35], v0 offset:8192
  s_waitcnt lgkmcnt(3)
  v_smfmac_f32_16x16x64_bf16 v[16:19], v[60:63], a[160:167], v7
  v_smfmac_f32_16x16x64_bf16 v[20:23], v[60:63], a[168:175], v7
  s_waitcnt lgkmcnt(2)
  v_smfmac_f32_16x16x64_bf16 v[16:19], v[36:39], a[192:199], v7
  v_smfmac_f32_16x16x64_bf16 v[20:23], v[36:39], a[200:207], v7
  s_cmp_eq_u32 s90, 0
  s_cbranch_scc1 L_csl_10
L_csb_11:
  ds_read_b128 v[12:15], v0 offset:15360
  ds_read_b128 v[52:55], v0 offset:16384
  s_and_b32 s40, s40, s90
  s_mov_b32 s41, s40
  s_waitcnt lgkmcnt(3)
  v_smfmac_f32_16x16x64_bf16 v[16:19], v[40:43], a[224:231], v7
  v_smfmac_f32_16x16x64_bf16 v[20:23], v[40:43], a[232:239], v7
  s_waitcnt lgkmcnt(2)
  v_smfmac_f32_16x16x64_bf16 v[16:19], v[32:35], v[64:71], v7
  v_smfmac_f32_16x16x64_bf16 v[20:23], v[32:35], v[72:79], v7
  v_smfmac_f32_16x16x64_bf16 v[24:27], v[60:63], a[176:183], v7
  s_waitcnt lgkmcnt(0)
  s_mov_b32 m0, 15360
  s_add_u32 s98, s97, 0
  s_mov_b64 exec, s[40:41]
  buffer_load_dwordx4 v0, s[12:15], s98 offen sc1 lds
  buffer_load_dwordx4 v0, s[12:15], s98 offen offset:1024 sc1 lds
  s_mov_b64 exec, -1
  v_smfmac_f32_16x16x64_bf16 v[28:31], v[60:63], a[184:191], v7
  s_nop 1
  v_permlane32_swap_b32 v16, v20
  v_smfmac_f32_16x16x64_bf16 v[24:27], v[36:39], a[208:215], v7
  v_permlane32_swap_b32 v17, v21
  v_smfmac_f32_16x16x64_bf16 v[28:31], v[36:39], a[216:223], v7
  v_permlane32_swap_b32 v18, v22
  v_smfmac_f32_16x16x64_bf16 v[24:27], v[40:43], a[240:247], v7
  v_permlane32_swap_b32 v19, v23
  v_smfmac_f32_16x16x64_bf16 v[28:31], v[40:43], a[248:255], v7
  v_add_f32 v16, v16, v20
  v_add_f32 v17, v17, v21
  v_add_f32 v18, v18, v22
  v_smfmac_f32_16x16x64_bf16 v[24:27], v[32:35], v[80:87], v7
  v_add_f32 v19, v19, v23
  v_cvt_pk_bf16_f32 v22, v16, v17
  v_cvt_pk_bf16_f32 v23, v18, v19
  v_smfmac_f32_16x16x64_bf16 v[28:31], v[32:35], v[88:95], v7
  s_nop 0
  v_mfma_f32_16x16x16_bf16 v[56:59], v[22:23], v[4:5], 0
  v_smfmac_f32_16x16x64_bf16 v[44:47], v[60:63], v[96:103], v7
  v_smfmac_f32_16x16x64_bf16 v[48:51], v[60:63], v[104:111], v7
  s_nop 3
  v_permlane32_swap_b32 v24, v28
  v_smfmac_f32_16x16x64_bf16 v[44:47], v[36:39], v[112:119], v7
  v_permlane32_swap_b32 v25, v29
  v_smfmac_f32_16x16x64_bf16 v[48:51], v[36:39], v[120:127], v7
  v_permlane32_swap_b32 v26, v30
  v_smfmac_f32_16x16x64_bf16 v[44:47], v[40:43], v[128:135], v7
  v_permlane32_swap_b32 v27, v31
  v_smfmac_f32_16x16x64_bf16 v[48:51], v[40:43], v[136:143], v7
  v_cvt_pk_bf16_f32 v16, v56, v57
  v_cvt_pk_bf16_f32 v17, v58, v59
  v_cvt_pk_bf16_f32 v20, v56, v57
  v_cvt_pk_bf16_f32 v21, v58, v59
  v_add_f32 v24, v24, v28
  v_add_f32 v25, v25, v29
  v_add_f32 v26, v26, v30
  v_smfmac_f32_16x16x64_bf16 v[44:47], v[32:35], v[144:151], v7
  v_add_f32 v27, v27, v31
  v_cvt_pk_bf16_f32 v24, v24, v25
  v_cvt_pk_bf16_f32 v25, v26, v27
  v_smfmac_f32_16x16x64_bf16 v[48:51], v[32:35], v[152:159], v7
  s_cmp_eq_u32 s90, 0
  s_cbranch_scc1 L_vw_16
L_vw_16b:
  v_mov_b32 v18, v16 row_ror:8 row_mask:0xf bank_mask:0xf
  v_mov_b32 v19, v17 row_ror:8 row_mask:0xf bank_mask:0xf
  v_mfma_f32_16x16x16_bf16 v[28:31], v[24:25], v[4:5], 0
  ds_read_b128 v[60:63], v0 offset:23552
  ds_read_b128 v[36:39], v0 offset:24576
  v_mfma_f32_16x16x32_bf16 v[12:15], v[12:15], v[16:19], 0
  v_mfma_f32_16x16x32_bf16 v[52:55], v[52:55], v[18:21], 0
  v_permlane32_swap_b32 v44, v48
  v_permlane32_swap_b32 v45, v49
  s_nop 1
  v_cvt_pk_bf16_f32 v24, v28, v29
  v_cvt_pk_bf16_f32 v25, v30, v31
  s_nop 1
  v_cndmask_b32 v12, v12, v52, s[54:55]
  v_cndmask_b32 v13, v13, v53, s[54:55]
  v_mov_b32 v26, v24 row_ror:8 row_mask:0xf bank_mask:0xf
  v_mov_b32 v27, v25 row_ror:8 row_mask:0xf bank_mask:0xf
  v_cndmask_b32 v14, v14, v54, s[54:55]
  v_cndmask_b32 v15, v15, v55, s[54:55]
  v_mfma_f32_16x16x32_bf16 v[28:31], v[24:27], v[16:19], 0
  ds_write_b128 v0, v[12:15] offset:9216
  v_permlane32_swap_b32 v46, v50
  v_permlane32_swap_b32 v47, v51
  v_add_f32 v44, v44, v48
  v_add_f32 v45, v45, v49
  v_add_f32 v46, v46, v50
  v_add_f32 v47, v47, v51
  v_cvt_pk_bf16_f32 v6, v44, v45
  v_cvt_pk_bf16_f32 v7, v46, v47
  ds_write_b128 v1, v[28:31] offset:13312
  v_mov_b32 v4, v24
  v_mov_b32 v5, v25
  v_bfe_u32 v56, v0, 7, 1
  v_lshrrev_b32 v57, 9, v0
  v_lshl_add_u32 v56, v57, 1, v56
  v_and_b32 v57, 0x170, v1
  v_lshl_add_u32 v56, v56, 2, v57
  v_add_u32 v56, 13312, v56
  v_add_u32 v57, 1024, v56
  s_cmp_eq_u32 s40, 0
  s_cbranch_scc1 L_cb_17
  s_waitcnt lgkmcnt(2)
  s_mov_b32 m0, 23552
  s_add_u32 s98, s46, 788480
  buffer_load_dwordx4 v0, s[12:15], s98 offen sc1 lds
  buffer_load_dwordx4 v0, s[12:15], s98 offen offset:1024 sc1 lds
L_cbb_18:
  s_waitcnt lgkmcnt(0)
  s_barrier
  ds_read_b128 v[52:55], v0 offset:10240
  ds_read_b128 v[16:19], v0 offset:11264
  ds_read_b128 v[20:23], v0 offset:12288
  ds_read2_b32 v[28:29], v56 offset0:0 offset1:32
  ds_read2_b32 v[30:31], v57 offset0:0 offset1:32
  v_mov_b32 v25, 0
  v_mov_b32 v26, 0
  s_mov_b32 s91, s50
  buffer_store_dwordx4 v[4:7], v0, s[12:15], s91 offen sc1
  s_waitcnt lgkmcnt(4)
  v_pk_add_f32 v[12:13], v[12:13], v[52:53]
  v_pk_add_f32 v[14:15], v[14:15], v[54:55]
  s_waitcnt lgkmcnt(3)
  v_pk_add_f32 v[12:13], v[12:13], v[16:17]
  v_pk_add_f32 v[14:15], v[14:15], v[18:19]
  s_waitcnt lgkmcnt(2)
  v_pk_add_f32 v[12:13], v[12:13], v[20:21]
  v_pk_add_f32 v[14:15], v[14:15], v[22:23]
  s_waitcnt lgkmcnt(0)
  v_pk_add_f32 v[28:29], v[28:29], v[30:31]
  v_max3_f32 v30, v12, v13, v14
  v_add_f32 v28, v28, v29
  v_max3_f32 v30, v30, v15, v28
  ds_read_b128 v[32:35], v3 offset:8192
  ds_read_b128 v[56:59], v3 offset:9216
  v_max_f32 v30, v30, v30 row_ror:8 row_mask:0xf bank_mask:0xf
  v_mov_b32 v31, v30
  ds_read_b128 v[40:43], v3 offset:10240
  s_nop 0
  v_permlane16_swap_b32 v30, v31
  v_max_f32 v30, v30, v31
  v_mov_b32 v31, v30
  s_nop 1
  v_permlane32_swap_b32 v30, v31
  v_max_f32 v30, v30, v31
  v_mul_f32 v30, s60, v30
  v_fma_f32 v28, v28, s60, -v30
  v_fma_f32 v12, v12, s60, -v30
  v_fma_f32 v13, v13, s60, -v30
  v_fma_f32 v14, v14, s60, -v30
  v_fma_f32 v15, v15, s60, -v30
  v_exp_f32 v28, v28
  v_exp_f32 v12, v12
  v_exp_f32 v13, v13
  v_exp_f32 v14, v14
  v_exp_f32 v15, v15
  v_mov_b32 v29, v28 row_ror:8 row_mask:0xf bank_mask:0xf
  v_cvt_pk_bf16_f32 v52, v12, v13
  v_cvt_pk_bf16_f32 v53, v14, v15
  v_cvt_pk_bf16_f32 v24, v28, v29
  v_cvt_pk_bf16_f32 v27, v28, v29
  v_mov_b32 v54, v52 row_ror:8 row_mask:0xf bank_mask:0xf
  v_mov_b32 v55, v53 row_ror:8 row_mask:0xf bank_mask:0xf
  v_permlane32_swap_b32 v24, v25
  v_permlane32_swap_b32 v26, v27
  v_mfma_f32_16x16x32_bf16 v[60:63], v[60:63], v[52:55], 0
  v_add_f32 v30, v12, v13
  v_add_f32 v31, v14, v15
  v_mfma_f32_16x16x32_bf16 v[36:39], v[36:39], v[52:55], 0
  v_add_f32 v30, v30, v28
  v_add_f32 v30, v30, v31
  s_barrier
  v_mfma_f32_16x16x16_bf16 v[60:63], v[6:7], v[24:25], v[60:63]
  v_add_f32 v30, v30, v30 row_ror:8 row_mask:0xf bank_mask:0xf
  v_mov_b32 v31, v30
  v_mfma_f32_16x16x16_bf16 v[36:39], v[6:7], v[26:27], v[36:39]
  s_nop 0
  v_permlane16_swap_b32 v30, v31
  v_add_f32 v30, v30, v31
  v_mov_b32 v31, v30
  ds_read_b128 v[12:15], v3 offset:11264
  s_nop 0
  v_permlane32_swap_b32 v30, v31
  v_add_f32 v30, v30, v31
  v_rcp_f32 v30, v30
  s_nop 0
  v_pk_mul_f32 v[60:61], v[60:61], v[30:31] op_sel_hi:[1,0]
  v_pk_mul_f32 v[62:63], v[62:63], v[30:31] op_sel_hi:[1,0]
  v_pk_mul_f32 v[36:37], v[36:37], v[30:31] op_sel_hi:[1,0]
  v_pk_mul_f32 v[38:39], v[38:39], v[30:31] op_sel_hi:[1,0]
  v_cvt_pk_bf16_f32 v60, v60, v61
  v_cvt_pk_bf16_f32 v61, v62, v63
  v_cvt_pk_bf16_f32 v62, v36, v37
  v_cvt_pk_bf16_f32 v63, v38, v39
  ds_write_b128 v1, v[60:63] offset:13312
  s_and_b32 s98, s32, 3
  s_cselect_b32 s98, 3, 64
  s_add_u32 s98, s98, s32
  s_min_u32 s98, s98, 64
  s_cmp_lt_u32 s61, s98
  s_cbranch_scc1 L_fp_19
L_fp_19b:
  s_cmp_eq_u32 s32, 63
  s_cbranch_scc1 L_cfin0
  s_waitcnt lgkmcnt(0)
  s_barrier
  ds_read_b128 v[36:39], v1 offset:13312
  ds_read_b128 v[28:31], v1 offset:13440
  ds_read_b128 v[24:27], v1 offset:14336
  ds_read_b128 v[60:63], v1 offset:14464
  s_waitcnt lgkmcnt(3)
  v_mfma_f32_16x16x32_bf16 v[44:47], v[160:163], v[36:39], 0
  v_mfma_f32_16x16x32_bf16 v[48:51], v[164:167], v[36:39], 0
  v_lshrrev_b32 v5, 5, v0
  v_and_b32 v5, 8, v5
  s_waitcnt lgkmcnt(2)
  v_mfma_f32_16x16x32_bf16 v[44:47], v[32:35], v[28:31], v[44:47]
  v_and_or_b32 v5, v0, s56, v5
  v_mov_b32 v6, -1
  v_mfma_f32_16x16x32_bf16 v[48:51], v[56:59], v[28:31], v[48:51]
  v_mov_b32 v7, -1
  ds_read_b128 v[32:35], v3 offset:12288
  ds_read_b128 v[56:59], v3 offset:13312
  s_waitcnt lgkmcnt(3)
  v_mfma_f32_16x16x32_bf16 v[44:47], v[168:171], v[24:27], v[44:47]
  v_mfma_f32_16x16x32_bf16 v[48:51], v[172:175], v[24:27], v[48:51]
  s_waitcnt lgkmcnt(2)
  v_mfma_f32_16x16x32_bf16 v[44:47], v[40:43], v[60:63], v[44:47]
  v_mfma_f32_16x16x32_bf16 v[48:51], v[12:15], v[60:63], v[48:51]
  ds_read_b128 v[40:43], v3 offset:14336
  ds_read_b128 v[12:15], v3 offset:15360
  v_mfma_f32_16x16x32_bf16 v[20:23], v[240:243], v[36:39], 0
  s_nop 1
  v_mfma_f32_16x16x32_bf16 v[20:23], v[244:247], v[28:31], v[20:23]
  s_nop 0
  v_cvt_pk_bf16_f32 v44, v44, v45
  v_cvt_pk_bf16_f32 v45, v46, v47
  v_mfma_f32_16x16x32_bf16 v[20:23], v[248:251], v[24:27], v[20:23]
  v_cvt_pk_bf16_f32 v46, v48, v49
  v_cvt_pk_bf16_f32 v47, v50, v51
  v_mfma_f32_16x16x32_bf16 v[20:23], v[252:255], v[60:63], v[20:23]
  v_bfi_b32 v44, 1, s45, v44
  v_bfi_b32 v46, 1, s45, v46
  buffer_store_dwordx4 v[44:47], v1, s[12:15], s33 offen offset:0
  v_mfma_f32_16x16x32_bf16 v[52:55], v[176:179], v[36:39], 0
  s_nop 1
  v_mfma_f32_16x16x32_bf16 v[16:19], v[180:183], v[36:39], 0
  s_waitcnt lgkmcnt(3)
  v_mfma_f32_16x16x32_bf16 v[52:55], v[32:35], v[28:31], v[52:55]
  v_cvt_pk_bf16_f32 v20, v20, v21
  v_cvt_pk_bf16_f32 v21, v22, v23
  s_waitcnt lgkmcnt(2)
  v_mfma_f32_16x16x32_bf16 v[16:19], v[56:59], v[28:31], v[16:19]
  v_bfi_b32 v20, 1, s45, v20
  buffer_store_dwordx2 v[20:21], v1, s[12:15], s33 offen offset:2048
  ds_read_b128 v[32:35], v3 offset:16384
  ds_read_b128 v[56:59], v3 offset:17408
  v_mfma_f32_16x16x32_bf16 v[52:55], v[184:187], v[24:27], v[52:55]
  v_mfma_f32_16x16x32_bf16 v[16:19], v[188:191], v[24:27], v[16:19]
  s_waitcnt lgkmcnt(3)
  v_mfma_f32_16x16x32_bf16 v[52:55], v[40:43], v[60:63], v[52:55]
  s_waitcnt lgkmcnt(2)
  v_mfma_f32_16x16x32_bf16 v[16:19], v[12:15], v[60:63], v[16:19]
  ds_read_b128 v[40:43], v3 offset:18432
  ds_read_b128 v[12:15], v3 offset:19456
  v_mfma_f32_16x16x32_bf16 v[44:47], v[192:195], v[36:39], 0
  s_nop 1
  v_mfma_f32_16x16x32_bf16 v[48:51], v[196:199], v[36:39], 0
  v_cvt_pk_bf16_f32 v52, v52, v53
  v_cvt_pk_bf16_f32 v53, v54, v55
  s_waitcnt lgkmcnt(3)
  v_mfma_f32_16x16x32_bf16 v[44:47], v[32:35], v[28:31], v[44:47]
  v_cvt_pk_bf16_f32 v54, v16, v17
  v_cvt_pk_bf16_f32 v55, v18, v19
  s_waitcnt lgkmcnt(2)
  v_mfma_f32_16x16x32_bf16 v[48:51], v[56:59], v[28:31], v[48:51]
  v_bfi_b32 v52, 1, s45, v52
  v_bfi_b32 v54, 1, s45, v54
  buffer_store_dwordx4 v[52:55], v1, s[12:15], s33 offen offset:3072
  v_mfma_f32_16x16x32_bf16 v[44:47], v[200:203], v[24:27], v[44:47]
  v_mfma_f32_16x16x32_bf16 v[48:51], v[204:207], v[24:27], v[48:51]
  s_waitcnt lgkmcnt(1)
  v_mfma_f32_16x16x32_bf16 v[44:47], v[40:43], v[60:63], v[44:47]
  s_waitcnt lgkmcnt(0)
  v_mfma_f32_16x16x32_bf16 v[48:51], v[12:15], v[60:63], v[48:51]
  s_cmp_lg_u32 s68, 0
  s_cbranch_scc1 L_nr_20
  v_mfma_f32_16x16x32_bf16 v[52:55], v[208:211], v[36:39], 0
  s_nop 1
  v_mfma_f32_16x16x32_bf16 v[16:19], v[212:215], v[36:39], 0
  v_cvt_pk_bf16_f32 v44, v44, v45
  v_cvt_pk_bf16_f32 v45, v46, v47
  v_mfma_f32_16x16x32_bf16 v[52:55], v[216:219], v[28:31], v[52:55]
  v_cvt_pk_bf16_f32 v46, v48, v49
  v_cvt_pk_bf16_f32 v47, v50, v51
  buffer_load_dwordx4 v[32:35], v2, s[12:15], s38 offen sc1
  v_mfma_f32_16x16x32_bf16 v[16:19], v[220:223], v[28:31], v[16:19]
  v_bfi_b32 v44, 1, s45, v44
  v_bfi_b32 v46, 1, s45, v46
  buffer_store_dwordx4 v[44:47], v1, s[12:15], s48 offen offset:1024
  buffer_load_dwordx4 v[56:59], v2, s[12:15], s39 offen sc1
  v_mfma_f32_16x16x32_bf16 v[52:55], v[224:227], v[24:27], v[52:55]
  buffer_load_dwordx4 v[40:43], v2, s[12:15], s34 offen sc1
  v_mfma_f32_16x16x32_bf16 v[16:19], v[228:231], v[24:27], v[16:19]
  buffer_load_dwordx4 v[12:15], v2, s[12:15], s35 offen sc1
  v_mfma_f32_16x16x32_bf16 v[52:55], v[232:235], v[60:63], v[52:55]
  v_mfma_f32_16x16x32_bf16 v[16:19], v[236:239], v[60:63], v[16:19]
  s_nop 6
  v_cvt_pk_bf16_f32 v52, v52, v53
  v_cvt_pk_bf16_f32 v53, v54, v55
  v_cvt_pk_bf16_f32 v54, v16, v17
  v_cvt_pk_bf16_f32 v55, v18, v19
  v_bfi_b32 v52, 1, s45, v52
  v_bfi_b32 v54, 1, s45, v54
  buffer_store_dwordx4 v[52:55], v1, s[12:15], s48 offen offset:3072
L_rc_22:
  s_waitcnt vmcnt(5)
  v_mfma_f32_16x16x32_bf16 v[20:23], v[8:11], v[32:35], 0
  v_bitop3_b32 v36, v32, v34, s45 bitop3:0x7e
  s_waitcnt vmcnt(3)
  v_mfma_f32_16x16x32_bf16 v[20:23], v[8:11], v[56:59], v[20:23]
  v_bitop3_b32 v37, v56, v58, s45 bitop3:0x7e
  s_waitcnt vmcnt(2)
  v_mfma_f32_16x16x32_bf16 v[20:23], v[8:11], v[40:43], v[20:23]
  v_bitop3_b32 v38, v40, v42, s45 bitop3:0x7e
  v_or3_b32 v36, v36, v37, v38
  s_waitcnt vmcnt(1)
  v_mfma_f32_16x16x32_bf16 v[20:23], v[8:11], v[12:15], v[20:23]
  v_bitop3_b32 v39, v12, v14, s45 bitop3:0x7e
  v_or_b32 v36, v36, v39
  v_and_b32 v36, 1, v36
  v_cmp_ne_u32 vcc, 0, v36
  s_nop 0
  s_cbranch_vccnz L_rr_23
  s_mov_b64 exec, s[58:59]
  buffer_store_dwordx2 v[6:7], v5, s[12:15], s44 offen
  s_mov_b64 exec, -1
  v_add_f32 v20, v20, v20 row_ror:8 row_mask:0xf bank_mask:0xf
  v_add_f32 v21, v21, v21 row_ror:8 row_mask:0xf bank_mask:0xf
  v_add_f32 v22, v22, v22 row_ror:8 row_mask:0xf bank_mask:0xf
  v_add_f32 v23, v23, v23 row_ror:8 row_mask:0xf bank_mask:0xf
  v_cvt_pk_bf16_f32 v20, v20, v21
  v_cvt_pk_bf16_f32 v21, v22, v23
  s_mov_b64 exec, s[58:59]
  buffer_store_dwordx2 v[20:21], v5, s[12:15], s43 offen
  s_mov_b64 exec, -1
  s_branch L_nj_21
L_nr_20:
  v_mfma_f32_16x16x32_bf16 v[52:55], v[208:211], v[36:39], 0
  s_nop 1
  v_mfma_f32_16x16x32_bf16 v[16:19], v[212:215], v[36:39], 0
  v_cvt_pk_bf16_f32 v44, v44, v45
  v_cvt_pk_bf16_f32 v45, v46, v47
  v_mfma_f32_16x16x32_bf16 v[52:55], v[216:219], v[28:31], v[52:55]
  v_cvt_pk_bf16_f32 v46, v48, v49
  v_cvt_pk_bf16_f32 v47, v50, v51
  v_mfma_f32_16x16x32_bf16 v[16:19], v[220:223], v[28:31], v[16:19]
  v_bfi_b32 v44, 1, s45, v44
  v_bfi_b32 v46, 1, s45, v46
  buffer_store_dwordx4 v[44:47], v1, s[12:15], s48 offen offset:1024
  v_mfma_f32_16x16x32_bf16 v[52:55], v[224:227], v[24:27], v[52:55]
  v_mfma_f32_16x16x32_bf16 v[16:19], v[228:231], v[24:27], v[16:19]
  v_mfma_f32_16x16x32_bf16 v[52:55], v[232:235], v[60:63], v[52:55]
  v_mfma_f32_16x16x32_bf16 v[16:19], v[236:239], v[60:63], v[16:19]
  s_nop 6
  v_cvt_pk_bf16_f32 v52, v52, v53
  v_cvt_pk_bf16_f32 v53, v54, v55
  v_cvt_pk_bf16_f32 v54, v16, v17
  v_cvt_pk_bf16_f32 v55, v18, v19
  v_bfi_b32 v52, 1, s45, v52
  v_bfi_b32 v54, 1, s45, v54
  buffer_store_dwordx4 v[52:55], v1, s[12:15], s48 offen offset:3072
  s_nop 15
  s_nop 15
  s_nop 15
  s_nop 15
  s_nop 10
L_nj_21:
  s_add_u32 s32, s32, 1
  s_xor_b32 s45, s45, 1
  s_add_u32 s50, s50, 131072
  s_xor_b32 s43, s43, 0x8000
  s_xor_b32 s44, s44, 0x8000
  s_add_u32 s46, s46, 786432
  ds_read_b128 v[36:39], v3 offset:20480
  ds_read_b128 v[40:43], v3 offset:22528
  ds_read_b128 v[52:55], v3 offset:21504
  ds_read_b128 v[56:59], v3 offset:23552
  v_lshrrev_b32 v4, 1, v0
  ds_read_b64 v[4:5], v4 offset:32000
  v_mov_b32 v7, 0x4444
  v_mov_b32 v16, 0xeeee
  v_cndmask_b32 v7, v16, v7, s[52:53]
  v_mov_b64 v[16:17], 0
  v_mov_b64 v[18:19], 0
  v_mov_b64 v[20:21], 0
  v_mov_b64 v[22:23], 0
  v_mov_b64 v[24:25], 0
  v_mov_b64 v[26:27], 0
  v_mov_b64 v[28:29], 0
  v_mov_b64 v[30:31], 0
  v_mov_b64 v[44:45], 0
  v_mov_b64 v[46:47], 0
  v_mov_b64 v[48:49], 0
  v_mov_b64 v[50:51], 0
  s_nop 9
  s_add_u32 s96, s42, 0
  buffer_load_dwordx4 v[12:15], v0, s[12:15], s96 offen offset:0 sc1
  buffer_load_dwordx4 v[60:63], v0, s[12:15], s96 offen offset:1024 sc1
  buffer_load_dwordx4 v[32:35], v0, s[12:15], s96 offen offset:2048 sc1
L_g0c_24:
  s_waitcnt vmcnt(2)
  ds_write_b128 v0, v[12:15] offset:0
  v_max_u32 v6, v12, v14
  s_waitcnt vmcnt(1)
  ds_write_b128 v0, v[60:63] offset:1024
  v_max3_u32 v6, v6, v60, v62
  s_waitcnt vmcnt(0)
  v_max3_u32 v6, v6, v32, v34
  v_cmp_eq_u32 vcc, -1, v6
  ds_write_b128 v0, v[32:35] offset:2048
  s_cbranch_vccz L_g0d_26
  s_mov_b64 exec, vcc
  buffer_load_dwordx4 v[12:15], v0, s[12:15], s96 offen offset:0 sc1
  buffer_load_dwordx4 v[60:63], v0, s[12:15], s96 offen offset:1024 sc1
  buffer_load_dwordx4 v[32:35], v0, s[12:15], s96 offen offset:2048 sc1
  s_mov_b64 exec, -1
  s_sub_u32 s100, s100, 1
  s_cbranch_scc0 L_g0c_24
  s_branch L_end
L_g0d_26:
  s_waitcnt lgkmcnt(0)
  s_barrier
  ds_read_b128 v[32:35], v0 offset:0
  ds_read_b128 v[60:63], v0 offset:1024
  s_branch L_cloop0
L_gr_13:
  s_sub_u32 s100, s100, 1
  s_cbranch_scc1 L_end
  s_add_u32 s98, s42, 5120
  s_mov_b64 exec, vcc
  buffer_load_dwordx4 v[12:15], v0, s[12:15], s98 offen sc1
  s_waitcnt vmcnt(0)
  ds_write_b128 v0, v[12:15] offset:5120
  v_cmp_eq_u32 vcc, -1, v12
  v_cmp_eq_u32 s[94:95], -1, v14
  s_mov_b64 exec, -1
  s_or_b64 vcc, vcc, s[94:95]
  s_nop 1
  s_cbranch_scc1 L_gr_13
  s_waitcnt lgkmcnt(0)
  s_branch L_gb_14
L_rr_23:
  s_mov_b64 exec, vcc
  buffer_load_dwordx4 v[32:35], v2, s[12:15], s38 offen sc1
  buffer_load_dwordx4 v[56:59], v2, s[12:15], s39 offen sc1
  buffer_load_dwordx4 v[40:43], v2, s[12:15], s34 offen sc1
  buffer_load_dwordx4 v[12:15], v2, s[12:15], s35 offen sc1
  s_mov_b64 exec, -1
  s_waitcnt vmcnt(0)
  s_sub_u32 s100, s100, 1
  s_cbranch_scc0 L_rc_22
  s_branch L_end
L_cfin0:
  s_branch L_cdone
L_vw_16:
  s_waitcnt vmcnt(0)
  s_branch L_vw_16b
L_fp_15:
  s_mov_b32 m0, 31744
  v_lshlrev_b32 v6, 9, v0
  s_mov_b64 exec, 3
  buffer_load_dword v6, s[12:15], s47 offen sc1 lds
  s_mov_b64 exec, -1
  s_branch L_fp_15b
L_fp_19:
  s_mov_b32 m0, 31744
  v_lshlrev_b32 v23, 9, v0
  s_mov_b64 exec, 3
  buffer_load_dword v23, s[12:15], s47 offen sc1 lds
  s_mov_b64 exec, -1
  s_branch L_fp_19b
L_kc_12:
  s_andn2_b32 s92, s40, s90
  s_mov_b32 s93, s92
  s_mov_b32 m0, 15360
  s_add_u32 s98, s97, 0
  s_mov_b64 exec, s[92:93]
  buffer_load_dwordx4 v0, s[12:15], s98 offen sc1 lds
  buffer_load_dwordx4 v0, s[12:15], s98 offen offset:1024 sc1 lds
  s_mov_b64 exec, -1
  s_mov_b32 m0, 23552
  s_add_u32 s98, s97, 2048
  s_mov_b64 exec, s[92:93]
  buffer_load_dwordx4 v0, s[12:15], s98 offen sc1 lds
  buffer_load_dwordx4 v0, s[12:15], s98 offen offset:1024 sc1 lds
  s_mov_b64 exec, -1
  s_branch L_kc_12b
L_csl_10:
  s_cmp_lg_u32 s40, 0
  s_cbranch_scc1 L_csl_10k
  s_add_u32 s99, s32, 1
  s_min_u32 s99, s99, 64
L_csp_27:
  s_mov_b64 exec, 1
  buffer_load_dword v6, off, s[12:15], s47 sc1
  buffer_load_dword v12, off, s[12:15], s101 sc1
  s_mov_b64 exec, -1
  s_waitcnt vmcnt(1)
  v_readfirstlane_b32 s61, v6
  s_waitcnt vmcnt(0)
  v_readfirstlane_b32 s98, v12
  s_nop 0
  s_min_u32 s61, s61, s98
  s_cmp_ge_u32 s61, s99
  s_nop 0
  s_cbranch_scc1 L_csp_27d
  s_sleep 1
  s_sub_u32 s100, s100, 1
  s_cbranch_scc0 L_csp_27
  s_branch L_end
L_csp_27d:
  s_mov_b32 m0, 15360
  s_add_u32 s98, s46, 0
  buffer_load_dwordx4 v0, s[12:15], s98 offen sc1 lds
  buffer_load_dwordx4 v0, s[12:15], s98 offen offset:1024 sc1 lds
  s_mov_b32 m0, 23552
  s_add_u32 s98, s46, 2048
  buffer_load_dwordx4 v0, s[12:15], s98 offen sc1 lds
  buffer_load_dwordx4 v0, s[12:15], s98 offen offset:1024 sc1 lds
L_csl_10k:
  s_waitcnt vmcnt(2)
  s_branch L_csb_11
L_cb_17:
  v_lshrrev_b32 v32, 2, v0
  ds_read_b32 v32, v32 offset:31744
  s_waitcnt lgkmcnt(0)
  v_readlane_b32 s98, v32, 0
  v_readlane_b32 s99, v32, 1
  s_nop 0
  s_min_u32 s98, s98, s99
  s_max_u32 s61, s61, s98
  s_add_u32 s99, s32, 2
  s_min_u32 s99, s99, 64
  s_cmp_ge_u32 s61, s99
  s_cselect_b64 s[40:41], -1, 0
  s_mov_b32 s90, s40
  s_mov_b32 m0, 15360
  s_add_u32 s98, s46, 786432
  s_mov_b64 exec, s[40:41]
  buffer_load_dwordx4 v0, s[12:15], s98 offen sc1 lds
  buffer_load_dwordx4 v0, s[12:15], s98 offen offset:1024 sc1 lds
  s_mov_b64 exec, -1
  s_mov_b32 m0, 23552
  s_add_u32 s98, s46, 788480
  s_mov_b64 exec, s[40:41]
  buffer_load_dwordx4 v0, s[12:15], s98 offen sc1 lds
  buffer_load_dwordx4 v0, s[12:15], s98 offen offset:1024 sc1 lds
  s_mov_b64 exec, -1
  s_branch L_cbb_18
L_cst1:
  v_mov_b32 v16, 0
  v_mov_b32 v17, 31808
  ds_write_b32 v17, v16
  ds_write_b32 v17, v16 offset:4
  ds_read_b128 v[36:39], v3 offset:20480
  ds_read_b128 v[40:43], v3 offset:22528
  ds_read_b128 v[52:55], v3 offset:21504
  ds_read_b128 v[56:59], v3 offset:23552
  v_lshrrev_b32 v4, 1, v0
  ds_read_b64 v[4:5], v4 offset:32000
  v_mov_b32 v7, 0x4444
  v_mov_b32 v16, 0xeeee
  v_cndmask_b32 v7, v16, v7, s[52:53]
  v_mov_b64 v[16:17], 0
  v_mov_b64 v[18:19], 0
  v_mov_b64 v[20:21], 0
  v_mov_b64 v[22:23], 0
  v_mov_b64 v[24:25], 0
  v_mov_b64 v[26:27], 0
  v_mov_b64 v[28:29], 0
  v_mov_b64 v[30:31], 0
  v_mov_b64 v[44:45], 0
  v_mov_b64 v[46:47], 0
  v_mov_b64 v[48:49], 0
  v_mov_b64 v[50:51], 0
  s_add_u32 s96, s42, 3072
  buffer_load_dwordx4 v[12:15], v0, s[12:15], s96 offen offset:0 sc1
  buffer_load_dwordx4 v[60:63], v0, s[12:15], s96 offen offset:1024 sc1
L_g0c_28:
  s_waitcnt vmcnt(1)
  ds_write_b128 v0, v[12:15] offset:3072
  v_max_u32 v6, v12, v14
  s_waitcnt vmcnt(0)
  v_max3_u32 v6, v6, v60, v62
  v_cmp_eq_u32 vcc, -1, v6
  ds_write_b128 v0, v[60:63] offset:4096
  s_cbranch_vccz L_g0d_30
  s_mov_b64 exec, vcc
  buffer_load_dwordx4 v[12:15], v0, s[12:15], s96 offen offset:0 sc1
  buffer_load_dwordx4 v[60:63], v0, s[12:15], s96 offen offset:1024 sc1
  s_mov_b64 exec, -1
  s_sub_u32 s100, s100, 1
  s_cbranch_scc0 L_g0c_28
  s_branch L_end
L_g0d_30:
  s_waitcnt lgkmcnt(0)
  s_barrier
  ds_read_b128 v[32:35], v0 offset:0
  ds_read_b128 v[60:63], v0 offset:1024
L_cloop1:
  s_waitcnt lgkmcnt(1)
  v_smfmac_f32_16x16x64_bf16 v[44:47], v[32:35], v[36:43], v7
  ds_read_b128 v[36:39], v3 offset:24576
  ds_read_b128 v[40:43], v3 offset:26624
  v_smfmac_f32_16x16x64_bf16 v[48:51], v[32:35], v[52:59], v7
  ds_read_b128 v[52:55], v3 offset:25600
  ds_read_b128 v[56:59], v3 offset:27648
  s_add_u32 s98, s42, 6144
  buffer_load_dwordx4 v[12:15], v0, s[12:15], s98 offen sc1
  v_smfmac_f32_16x16x64_bf16 v[16:19], v[32:35], a[0:7], v7
  v_smfmac_f32_16x16x64_bf16 v[20:23], v[32:35], a[8:15], v7
  v_smfmac_f32_16x16x64_bf16 v[24:27], v[32:35], a[16:23], v7
  v_smfmac_f32_16x16x64_bf16 v[28:31], v[32:35], a[24:31], v7
  ds_read_b128 v[32:35], v0 offset:2048
  s_waitcnt lgkmcnt(3)
  v_smfmac_f32_16x16x64_bf16 v[44:47], v[60:63], v[36:43], v7
  ds_read_b128 v[36:39], v3 offset:28672
  ds_read_b128 v[40:43], v3 offset:30720
  v_mov_b32 v6, s32
  s_mov_b64 exec, 1
  buffer_store_dword v6, off, s[12:15], s69 sc1
  s_mov_b64 exec, -1
  s_waitcnt lgkmcnt(3)
  v_smfmac_f32_16x16x64_bf16 v[48:51], v[60:63], v[52:59], v7
  ds_read_b128 v[52:55], v3 offset:29696
  ds_read_b128 v[56:59], v3 offset:31744
  v_smfmac_f32_16x16x64_bf16 v[16:19], v[60:63], a[32:39], v7
  v_smfmac_f32_16x16x64_bf16 v[20:23], v[60:63], a[40:47], v7
  v_smfmac_f32_16x16x64_bf16 v[24:27], v[60:63], a[48:55], v7
  v_lshrrev_b32 v6, 2, v0
  ds_read_b32 v6, v6 offset:31808
  v_smfmac_f32_16x16x64_bf16 v[28:31], v[60:63], a[56:63], v7
  ds_read_b128 v[60:63], v0 offset:3072
  s_waitcnt lgkmcnt(4)
  v_smfmac_f32_16x16x64_bf16 v[44:47], v[32:35], v[36:43], v7
  ds_read_b128 v[36:39], v3 offset:0
  ds_read_b128 v[40:43], v3 offset:2048
  s_and_b32 s97, s90, 786432
  s_add_u32 s97, s97, s46
  s_waitcnt lgkmcnt(4)
  v_smfmac_f32_16x16x64_bf16 v[48:51], v[32:35], v[52:59], v7
  ds_read_b128 v[52:55], v3 offset:1024
  ds_read_b128 v[56:59], v3 offset:3072
  v_smfmac_f32_16x16x64_bf16 v[16:19], v[32:35], a[64:71], v7
  s_waitcnt lgkmcnt(5)
  v_readlane_b32 s98, v6, 0
  v_readlane_b32 s99, v6, 1
  s_nop 0
  s_min_u32 s98, s98, s99
  s_max_u32 s61, s61, s98
  v_smfmac_f32_16x16x64_bf16 v[20:23], v[32:35], a[72:79], v7
  v_smfmac_f32_16x16x64_bf16 v[24:27], v[32:35], a[80:87], v7
  s_and_b32 s98, s90, 1
  s_add_u32 s99, s32, s98
  s_min_u32 s99, s99, 63
  s_cmp_gt_u32 s61, s99
  s_cselect_b64 s[40:41], -1, 0
  v_smfmac_f32_16x16x64_bf16 v[28:31], v[32:35], a[88:95], v7
  ds_read_b128 v[32:35], v0 offset:4096
  s_cmp_eq_u32 s90, 0
  s_cbranch_scc1 L_kc_33
L_kc_33b:
  s_waitcnt lgkmcnt(3)
  v_smfmac_f32_16x16x64_bf16 v[44:47], v[60:63], v[36:43], v7
  ds_read_b128 v[36:39], v3 offset:4096
  ds_read_b128 v[40:43], v3 offset:6144
  s_waitcnt lgkmcnt(3)
  v_smfmac_f32_16x16x64_bf16 v[48:51], v[60:63], v[52:59], v7
  ds_read_b128 v[52:55], v3 offset:5120
  ds_read_b128 v[56:59], v3 offset:7168
  v_smfmac_f32_16x16x64_bf16 v[16:19], v[60:63], a[96:103], v7
  s_waitcnt vmcnt(1)
  ds_write_b128 v0, v[12:15] offset:6144
  v_cmp_eq_u32 vcc, -1, v12
  v_cmp_eq_u32 s[94:95], -1, v14
  v_smfmac_f32_16x16x64_bf16 v[20:23], v[60:63], a[104:111], v7
  v_smfmac_f32_16x16x64_bf16 v[24:27], v[60:63], a[112:119], v7
  s_or_b64 vcc, vcc, s[94:95]
  s_cbranch_scc1 L_gr_34
L_gb_35:
  v_smfmac_f32_16x16x64_bf16 v[28:31], v[60:63], a[120:127], v7
  s_waitcnt lgkmcnt(3)
  v_smfmac_f32_16x16x64_bf16 v[44:47], v[32:35], v[36:43], v7
  s_waitcnt lgkmcnt(1)
  v_smfmac_f32_16x16x64_bf16 v[48:51], v[32:35], v[52:59], v7
  s_add_u32 s98, s32, 2
  s_min_u32 s98, s98, 64
  s_cmp_lt_u32 s61, s98
  s_cbranch_scc1 L_fp_36
L_fp_36b:
  v_smfmac_f32_16x16x64_bf16 v[16:19], v[32:35], a[128:135], v7
  s_waitcnt lgkmcnt(0)
  s_barrier
  ds_read_b128 v[60:63], v0 offset:5120
  ds_read_b128 v[36:39], v0 offset:6144
  ds_read_b128 v[40:43], v0 offset:7168
  v_smfmac_f32_16x16x64_bf16 v[20:23], v[32:35], a[136:143], v7
  v_smfmac_f32_16x16x64_bf16 v[24:27], v[32:35], a[144:151], v7
  s_xor_b32 s42, s42, 0x8000
  v_smfmac_f32_16x16x64_bf16 v[28:31], v[32:35], a[152:159], v7
  ds_read_b128 v[32:35], v0 offset:8192
  s_waitcnt lgkmcnt(3)
  v_smfmac_f32_16x16x64_bf16 v[16:19], v[60:63], a[160:167], v7
  v_smfmac_f32_16x16x64_bf16 v[20:23], v[60:63], a[168:175], v7
  s_waitcnt lgkmcnt(2)
  v_smfmac_f32_16x16x64_bf16 v[16:19], v[36:39], a[192:199], v7
  v_smfmac_f32_16x16x64_bf16 v[20:23], v[36:39], a[200:207], v7
  s_cmp_eq_u32 s90, 0
  s_cbranch_scc1 L_csl_31
L_csb_32:
  ds_read_b128 v[12:15], v0 offset:17408
  ds_read_b128 v[52:55], v0 offset:18432
  s_and_b32 s40, s40, s90
  s_mov_b32 s41, s40
  s_waitcnt lgkmcnt(3)
  v_smfmac_f32_16x16x64_bf16 v[16:19], v[40:43], a[224:231], v7
  v_smfmac_f32_16x16x64_bf16 v[20:23], v[40:43], a[232:239], v7
  s_waitcnt lgkmcnt(2)
  v_smfmac_f32_16x16x64_bf16 v[16:19], v[32:35], v[64:71], v7
  v_smfmac_f32_16x16x64_bf16 v[20:23], v[32:35], v[72:79], v7
  v_smfmac_f32_16x16x64_bf16 v[24:27], v[60:63], a[176:183], v7
  s_waitcnt lgkmcnt(0)
  s_mov_b32 m0, 17408
  s_add_u32 s98, s97, 0
  s_mov_b64 exec, s[40:41]
  buffer_load_dwordx4 v0, s[12:15], s98 offen sc1 lds
  buffer_load_dwordx4 v0, s[12:15], s98 offen offset:1024 sc1 lds
  s_mov_b64 exec, -1
  v_smfmac_f32_16x16x64_bf16 v[28:31], v[60:63], a[184:191], v7
  s_nop 1
  v_permlane32_swap_b32 v16, v20
  v_smfmac_f32_16x16x64_bf16 v[24:27], v[36:39], a[208:215], v7
  v_permlane32_swap_b32 v17, v21
  v_smfmac_f32_16x16x64_bf16 v[28:31], v[36:39], a[216:223], v7
  v_permlane32_swap_b32 v18, v22
  v_smfmac_f32_16x16x64_bf16 v[24:27], v[40:43], a[240:247], v7
  v_permlane32_swap_b32 v19, v23
  v_smfmac_f32_16x16x64_bf16 v[28:31], v[40:43], a[248:255], v7
  v_add_f32 v16, v16, v20
  v_add_f32 v17, v17, v21
  v_add_f32 v18, v18, v22
  v_smfmac_f32_16x16x64_bf16 v[24:27], v[32:35], v[80:87], v7
  v_add_f32 v19, v19, v23
  v_cvt_pk_bf16_f32 v22, v16, v17
  v_cvt_pk_bf16_f32 v23, v18, v19
  v_smfmac_f32_16x16x64_bf16 v[28:31], v[32:35], v[88:95], v7
  s_nop 0
  v_mfma_f32_16x16x16_bf16 v[56:59], v[22:23], v[4:5], 0
  v_smfmac_f32_16x16x64_bf16 v[44:47], v[60:63], v[96:103], v7
  v_smfmac_f32_16x16x64_bf16 v[48:51], v[60:63], v[104:111], v7
  s_nop 3
  v_permlane32_swap_b32 v24, v28
  v_smfmac_f32_16x16x64_bf16 v[44:47], v[36:39], v[112:119], v7
  v_permlane32_swap_b32 v25, v29
  v_smfmac_f32_16x16x64_bf16 v[48:51], v[36:39], v[120:127], v7
  v_permlane32_swap_b32 v26, v30
  v_smfmac_f32_16x16x64_bf16 v[44:47], v[40:43], v[128:135], v7
  v_permlane32_swap_b32 v27, v31
  v_smfmac_f32_16x16x64_bf16 v[48:51], v[40:43], v[136:143], v7
  v_cvt_pk_bf16_f32 v16, v56, v57
  v_cvt_pk_bf16_f32 v17, v58, v59
  v_cvt_pk_bf16_f32 v20, v56, v57
  v_cvt_pk_bf16_f32 v21, v58, v59
  v_add_f32 v24, v24, v28
  v_add_f32 v25, v25, v29
  v_add_f32 v26, v26, v30
  v_smfmac_f32_16x16x64_bf16 v[44:47], v[32:35], v[144:151], v7
  v_add_f32 v27, v27, v31
  v_cvt_pk_bf16_f32 v24, v24, v25
  v_cvt_pk_bf16_f32 v25, v26, v27
  v_smfmac_f32_16x16x64_bf16 v[48:51], v[32:35], v[152:159], v7
  s_cmp_eq_u32 s90, 0
  s_cbranch_scc1 L_vw_37
L_vw_37b:
  v_mov_b32 v18, v16 row_ror:8 row_mask:0xf bank_mask:0xf
  v_mov_b32 v19, v17 row_ror:8 row_mask:0xf bank_mask:0xf
  v_mfma_f32_16x16x16_bf16 v[28:31], v[24:25], v[4:5], 0
  ds_read_b128 v[60:63], v0 offset:25600
  ds_read_b128 v[36:39], v0 offset:26624
  v_mfma_f32_16x16x32_bf16 v[12:15], v[12:15], v[16:19], 0
  v_mfma_f32_16x16x32_bf16 v[52:55], v[52:55], v[18:21], 0
  v_permlane32_swap_b32 v44, v48
  v_permlane32_swap_b32 v45, v49
  s_nop 1
  v_cvt_pk_bf16_f32 v24, v28, v29
  v_cvt_pk_bf16_f32 v25, v30, v31
  s_nop 1
  v_cndmask_b32 v12, v12, v52, s[54:55]
  v_cndmask_b32 v13, v13, v53, s[54:55]
  v_mov_b32 v26, v24 row_ror:8 row_mask:0xf bank_mask:0xf
  v_mov_b32 v27, v25 row_ror:8 row_mask:0xf bank_mask:0xf
  v_cndmask_b32 v14, v14, v54, s[54:55]
  v_cndmask_b32 v15, v15, v55, s[54:55]
  v_mfma_f32_16x16x32_bf16 v[28:31], v[24:27], v[16:19], 0
  ds_write_b128 v0, v[12:15] offset:10240
  v_permlane32_swap_b32 v46, v50
  v_permlane32_swap_b32 v47, v51
  v_add_f32 v44, v44, v48
  v_add_f32 v45, v45, v49
  v_add_f32 v46, v46, v50
  v_add_f32 v47, v47, v51
  v_cvt_pk_bf16_f32 v6, v44, v45
  v_cvt_pk_bf16_f32 v7, v46, v47
  ds_write_b128 v1, v[28:31] offset:13440
  v_mov_b32 v4, v24
  v_mov_b32 v5, v25
  v_bfe_u32 v56, v0, 7, 1
  v_lshrrev_b32 v57, 9, v0
  v_lshl_add_u32 v56, v57, 1, v56
  v_and_b32 v57, 0x170, v1
  v_lshl_add_u32 v56, v56, 2, v57
  v_add_u32 v56, 13312, v56
  v_add_u32 v57, 1024, v56
  s_cmp_eq_u32 s40, 0
  s_cbranch_scc1 L_cb_38
  s_waitcnt lgkmcnt(2)
  s_mov_b32 m0, 25600
  s_add_u32 s98, s46, 788480
  buffer_load_dwordx4 v0, s[12:15], s98 offen sc1 lds
  buffer_load_dwordx4 v0, s[12:15], s98 offen offset:1024 sc1 lds
L_cbb_39:
  s_waitcnt lgkmcnt(0)
  s_barrier
  ds_read_b128 v[52:55], v0 offset:11264
  ds_read_b128 v[16:19], v0 offset:12288
  ds_read_b128 v[20:23], v0 offset:9216
  ds_read2_b32 v[28:29], v56 offset0:0 offset1:32
  ds_read2_b32 v[30:31], v57 offset0:0 offset1:32
  v_mov_b32 v25, 0
  v_mov_b32 v26, 0
  s_mov_b32 s91, s50
  buffer_store_dwordx4 v[4:7], v0, s[12:15], s91 offen sc1
  s_waitcnt lgkmcnt(4)
  v_pk_add_f32 v[12:13], v[12:13], v[52:53]
  v_pk_add_f32 v[14:15], v[14:15], v[54:55]
  s_waitcnt lgkmcnt(3)
  v_pk_add_f32 v[12:13], v[12:13], v[16:17]
  v_pk_add_f32 v[14:15], v[14:15], v[18:19]
  s_waitcnt lgkmcnt(2)
  v_pk_add_f32 v[12:13], v[12:13], v[20:21]
  v_pk_add_f32 v[14:15], v[14:15], v[22:23]
  s_waitcnt lgkmcnt(0)
  v_pk_add_f32 v[28:29], v[28:29], v[30:31]
  v_max3_f32 v30, v12, v13, v14
  v_add_f32 v28, v28, v29
  v_max3_f32 v30, v30, v15, v28
  ds_read_b128 v[32:35], v3 offset:8192
  ds_read_b128 v[56:59], v3 offset:9216
  v_max_f32 v30, v30, v30 row_ror:8 row_mask:0xf bank_mask:0xf
  v_mov_b32 v31, v30
  ds_read_b128 v[40:43], v3 offset:10240
  s_nop 0
  v_permlane16_swap_b32 v30, v31
  v_max_f32 v30, v30, v31
  v_mov_b32 v31, v30
  s_nop 1
  v_permlane32_swap_b32 v30, v31
  v_max_f32 v30, v30, v31
  v_mul_f32 v30, s60, v30
  v_fma_f32 v28, v28, s60, -v30
  v_fma_f32 v12, v12, s60, -v30
  v_fma_f32 v13, v13, s60, -v30
  v_fma_f32 v14, v14, s60, -v30
  v_fma_f32 v15, v15, s60, -v30
  v_exp_f32 v28, v28
  v_exp_f32 v12, v12
  v_exp_f32 v13, v13
  v_exp_f32 v14, v14
  v_exp_f32 v15, v15
  v_mov_b32 v29, v28 row_ror:8 row_mask:0xf bank_mask:0xf
  v_cvt_pk_bf16_f32 v52, v12, v13
  v_cvt_pk_bf16_f32 v53, v14, v15
  v_cvt_pk_bf16_f32 v24, v28, v29
  v_cvt_pk_bf16_f32 v27, v28, v29
  v_mov_b32 v54, v52 row_ror:8 row_mask:0xf bank_mask:0xf
  v_mov_b32 v55, v53 row_ror:8 row_mask:0xf bank_mask:0xf
  v_permlane32_swap_b32 v24, v25
  v_permlane32_swap_b32 v26, v27
  v_mfma_f32_16x16x32_bf16 v[60:63], v[60:63], v[52:55], 0
  v_add_f32 v30, v12, v13
  v_add_f32 v31, v14, v15
  v_mfma_f32_16x16x32_bf16 v[36:39], v[36:39], v[52:55], 0
  v_add_f32 v30, v30, v28
  v_add_f32 v30, v30, v31
  s_barrier
  v_mfma_f32_16x16x16_bf16 v[60:63], v[6:7], v[24:25], v[60:63]
  v_add_f32 v30, v30, v30 row_ror:8 row_mask:0xf bank_mask:0xf
  v_mov_b32 v31, v30
  v_mfma_f32_16x16x16_bf16 v[36:39], v[6:7], v[26:27], v[36:39]
  s_nop 0
  v_permlane16_swap_b32 v30, v31
  v_add_f32 v30, v30, v31
  v_mov_b32 v31, v30
  ds_read_b128 v[12:15], v3 offset:11264
  s_nop 0
  v_permlane32_swap_b32 v30, v31
  v_add_f32 v30, v30, v31
  v_rcp_f32 v30, v30
  s_nop 0
  v_pk_mul_f32 v[60:61], v[60:61], v[30:31] op_sel_hi:[1,0]
  v_pk_mul_f32 v[62:63], v[62:63], v[30:31] op_sel_hi:[1,0]
  v_pk_mul_f32 v[36:37], v[36:37], v[30:31] op_sel_hi:[1,0]
  v_pk_mul_f32 v[38:39], v[38:39], v[30:31] op_sel_hi:[1,0]
  v_cvt_pk_bf16_f32 v60, v60, v61
  v_cvt_pk_bf16_f32 v61, v62, v63
  v_cvt_pk_bf16_f32 v62, v36, v37
  v_cvt_pk_bf16_f32 v63, v38, v39
  ds_write_b128 v1, v[60:63] offset:13440
  s_and_b32 s98, s32, 3
  s_cselect_b32 s98, 3, 64
  s_add_u32 s98, s98, s32
  s_min_u32 s98, s98, 64
  s_cmp_lt_u32 s61, s98
  s_cbranch_scc1 L_fp_40
L_fp_40b:
  s_cmp_eq_u32 s32, 63
  s_cbranch_scc1 L_cfin1
  s_waitcnt lgkmcnt(0)
  s_barrier
  ds_read_b128 v[36:39], v1 offset:13312
  ds_read_b128 v[28:31], v1 offset:13440
  ds_read_b128 v[24:27], v1 offset:14336
  ds_read_b128 v[60:63], v1 offset:14464
  s_waitcnt lgkmcnt(3)
  v_mfma_f32_16x16x32_bf16 v[44:47], v[160:163], v[36:39], 0
  v_mfma_f32_16x16x32_bf16 v[48:51], v[164:167], v[36:39], 0
  v_lshrrev_b32 v5, 5, v0
  v_and_b32 v5, 8, v5
  s_waitcnt lgkmcnt(2)
  v_mfma_f32_16x16x32_bf16 v[44:47], v[32:35], v[28:31], v[44:47]
  v_and_or_b32 v5, v0, s56, v5
  v_mov_b32 v6, -1
  v_mfma_f32_16x16x32_bf16 v[48:51], v[56:59], v[28:31], v[48:51]
  v_mov_b32 v7, -1
  ds_read_b128 v[32:35], v3 offset:12288
  ds_read_b128 v[56:59], v3 offset:13312
  s_waitcnt lgkmcnt(3)
  v_mfma_f32_16x16x32_bf16 v[44:47], v[168:171], v[24:27], v[44:47]
  v_mfma_f32_16x16x32_bf16 v[48:51], v[172:175], v[24:27], v[48:51]
  s_waitcnt lgkmcnt(2)
  v_mfma_f32_16x16x32_bf16 v[44:47], v[40:43], v[60:63], v[44:47]
  v_mfma_f32_16x16x32_bf16 v[48:51], v[12:15], v[60:63], v[48:51]
  ds_read_b128 v[40:43], v3 offset:14336
  ds_read_b128 v[12:15], v3 offset:15360
  v_mfma_f32_16x16x32_bf16 v[20:23], v[240:243], v[36:39], 0
  s_nop 1
  v_mfma_f32_16x16x32_bf16 v[20:23], v[244:247], v[28:31], v[20:23]
  s_nop 0
  v_cvt_pk_bf16_f32 v44, v44, v45
  v_cvt_pk_bf16_f32 v45, v46, v47
  v_mfma_f32_16x16x32_bf16 v[20:23], v[248:251], v[24:27], v[20:23]
  v_cvt_pk_bf16_f32 v46, v48, v49
  v_cvt_pk_bf16_f32 v47, v50, v51
  v_mfma_f32_16x16x32_bf16 v[20:23], v[252:255], v[60:63], v[20:23]
  v_bfi_b32 v44, 1, s45, v44
  v_bfi_b32 v46, 1, s45, v46
  v_mfma_f32_16x16x32_bf16 v[52:55], v[176:179], v[36:39], 0
  buffer_store_dwordx4 v[44:47], v1, s[12:15], s33 offen offset:128
  s_nop 1
  v_mfma_f32_16x16x32_bf16 v[16:19], v[180:183], v[36:39], 0
  s_waitcnt lgkmcnt(3)
  v_mfma_f32_16x16x32_bf16 v[52:55], v[32:35], v[28:31], v[52:55]
  v_cvt_pk_bf16_f32 v20, v20, v21
  v_cvt_pk_bf16_f32 v21, v22, v23
  s_waitcnt lgkmcnt(2)
  v_mfma_f32_16x16x32_bf16 v[16:19], v[56:59], v[28:31], v[16:19]
  v_bfi_b32 v20, 1, s45, v20
  ds_read_b128 v[32:35], v3 offset:16384
  ds_read_b128 v[56:59], v3 offset:17408
  v_mfma_f32_16x16x32_bf16 v[52:55], v[184:187], v[24:27], v[52:55]
  buffer_store_dwordx2 v[20:21], v1, s[12:15], s33 offen offset:2056
  v_mfma_f32_16x16x32_bf16 v[16:19], v[188:191], v[24:27], v[16:19]
  s_waitcnt lgkmcnt(3)
  v_mfma_f32_16x16x32_bf16 v[52:55], v[40:43], v[60:63], v[52:55]
  s_waitcnt lgkmcnt(2)
  v_mfma_f32_16x16x32_bf16 v[16:19], v[12:15], v[60:63], v[16:19]
  ds_read_b128 v[40:43], v3 offset:18432
  ds_read_b128 v[12:15], v3 offset:19456
  v_mfma_f32_16x16x32_bf16 v[44:47], v[192:195], v[36:39], 0
  s_nop 1
  v_mfma_f32_16x16x32_bf16 v[48:51], v[196:199], v[36:39], 0
  v_cvt_pk_bf16_f32 v52, v52, v53
  v_cvt_pk_bf16_f32 v53, v54, v55
  s_waitcnt lgkmcnt(3)
  v_mfma_f32_16x16x32_bf16 v[44:47], v[32:35], v[28:31], v[44:47]
  v_cvt_pk_bf16_f32 v54, v16, v17
  v_cvt_pk_bf16_f32 v55, v18, v19
  s_waitcnt lgkmcnt(2)
  v_mfma_f32_16x16x32_bf16 v[48:51], v[56:59], v[28:31], v[48:51]
  v_bfi_b32 v52, 1, s45, v52
  v_bfi_b32 v54, 1, s45, v54
  v_mfma_f32_16x16x32_bf16 v[44:47], v[200:203], v[24:27], v[44:47]
  buffer_store_dwordx4 v[52:55], v1, s[12:15], s33 offen offset:3200
  v_mfma_f32_16x16x32_bf16 v[48:51], v[204:207], v[24:27], v[48:51]
  s_waitcnt lgkmcnt(1)
  v_mfma_f32_16x16x32_bf16 v[44:47], v[40:43], v[60:63], v[44:47]
  s_waitcnt lgkmcnt(0)
  v_mfma_f32_16x16x32_bf16 v[48:51], v[12:15], v[60:63], v[48:51]
  v_mfma_f32_16x16x32_bf16 v[52:55], v[208:211], v[36:39], 0
  s_nop 1
  v_mfma_f32_16x16x32_bf16 v[16:19], v[212:215], v[36:39], 0
  s_nop 1
  v_cvt_pk_bf16_f32 v44, v44, v45
  v_cvt_pk_bf16_f32 v45, v46, v47
  v_mfma_f32_16x16x32_bf16 v[52:55], v[216:219], v[28:31], v[52:55]
  v_cvt_pk_bf16_f32 v46, v48, v49
  v_cvt_pk_bf16_f32 v47, v50, v51
  v_mfma_f32_16x16x32_bf16 v[16:19], v[220:223], v[28:31], v[16:19]
  v_bfi_b32 v44, 1, s45, v44
  v_bfi_b32 v46, 1, s45, v46
  v_mfma_f32_16x16x32_bf16 v[52:55], v[224:227], v[24:27], v[52:55]
  buffer_store_dwordx4 v[44:47], v1, s[12:15], s48 offen offset:1152
  v_mfma_f32_16x16x32_bf16 v[16:19], v[228:231], v[24:27], v[16:19]
  v_mfma_f32_16x16x32_bf16 v[52:55], v[232:235], v[60:63], v[52:55]
  v_mfma_f32_16x16x32_bf16 v[16:19], v[236:239], v[60:63], v[16:19]
  s_nop 6
  v_cvt_pk_bf16_f32 v52, v52, v53
  v_cvt_pk_bf16_f32 v53, v54, v55
  v_cvt_pk_bf16_f32 v54, v16, v17
  v_cvt_pk_bf16_f32 v55, v18, v19
  v_bfi_b32 v52, 1, s45, v52
  v_bfi_b32 v54, 1, s45, v54
  buffer_store_dwordx4 v[52:55], v1, s[12:15], s48 offen offset:3200
  s_cmp_lg_u32 s68, 0
  s_cbranch_scc1 L_nr_41
  s_nop 15
  s_nop 8
  buffer_load_dwordx4 v[32:35], v2, s[12:15], s38 offen sc1
  buffer_load_dwordx4 v[56:59], v2, s[12:15], s39 offen sc1
  buffer_load_dwordx4 v[40:43], v2, s[12:15], s34 offen sc1
  buffer_load_dwordx4 v[12:15], v2, s[12:15], s35 offen sc1
L_rc_43:
  s_waitcnt vmcnt(3)
  v_mfma_f32_16x16x32_bf16 v[20:23], v[8:11], v[32:35], 0
  v_bitop3_b32 v36, v32, v34, s45 bitop3:0x7e
  s_waitcnt vmcnt(2)
  v_mfma_f32_16x16x32_bf16 v[20:23], v[8:11], v[56:59], v[20:23]
  v_bitop3_b32 v37, v56, v58, s45 bitop3:0x7e
  s_waitcnt vmcnt(1)
  v_mfma_f32_16x16x32_bf16 v[20:23], v[8:11], v[40:43], v[20:23]
  v_bitop3_b32 v38, v40, v42, s45 bitop3:0x7e
  v_or3_b32 v36, v36, v37, v38
  s_waitcnt vmcnt(0)
  v_mfma_f32_16x16x32_bf16 v[20:23], v[8:11], v[12:15], v[20:23]
  v_bitop3_b32 v39, v12, v14, s45 bitop3:0x7e
  v_or_b32 v36, v36, v39
  v_and_b32 v36, 1, v36
  v_cmp_ne_u32 vcc, 0, v36
  s_nop 0
  s_cbranch_vccnz L_rr_44
  s_mov_b64 exec, s[58:59]
  buffer_store_dwordx2 v[6:7], v5, s[12:15], s44 offen
  s_mov_b64 exec, -1
  v_add_f32 v20, v20, v20 row_ror:8 row_mask:0xf bank_mask:0xf
  v_add_f32 v21, v21, v21 row_ror:8 row_mask:0xf bank_mask:0xf
  v_add_f32 v22, v22, v22 row_ror:8 row_mask:0xf bank_mask:0xf
  v_add_f32 v23, v23, v23 row_ror:8 row_mask:0xf bank_mask:0xf
  v_cvt_pk_bf16_f32 v20, v20, v21
  v_cvt_pk_bf16_f32 v21, v22, v23
  s_mov_b64 exec, s[58:59]
  buffer_store_dwordx2 v[20:21], v5, s[12:15], s43 offen
  s_mov_b64 exec, -1
  s_branch L_nj_42
L_nr_41:
  s_nop 15
  s_nop 15
  s_nop 15
  s_nop 15
  s_nop 15
  s_nop 15
  s_nop 15
  s_nop 12
L_nj_42:
  s_add_u32 s32, s32, 1
  s_xor_b32 s45, s45, 1
  s_add_u32 s50, s50, 131072
  s_xor_b32 s43, s43, 0x8000
  s_xor_b32 s44, s44, 0x8000
  s_add_u32 s46, s46, 786432
  ds_read_b128 v[36:39], v3 offset:20480
  ds_read_b128 v[40:43], v3 offset:22528
  ds_read_b128 v[52:55], v3 offset:21504
  ds_read_b128 v[56:59], v3 offset:23552
  v_lshrrev_b32 v4, 1, v0
  ds_read_b64 v[4:5], v4 offset:32000
  v_mov_b32 v7, 0x4444
  v_mov_b32 v16, 0xeeee
  v_cndmask_b32 v7, v16, v7, s[52:53]
  v_mov_b64 v[16:17], 0
  v_mov_b64 v[18:19], 0
  v_mov_b64 v[20:21], 0
  v_mov_b64 v[22:23], 0
  v_mov_b64 v[24:25], 0
  v_mov_b64 v[26:27], 0
  v_mov_b64 v[28:29], 0
  v_mov_b64 v[30:31], 0
  v_mov_b64 v[44:45], 0
  v_mov_b64 v[46:47], 0
  v_mov_b64 v[48:49], 0
  v_mov_b64 v[50:51], 0
  s_nop 15
  s_nop 15
  s_nop 2
  s_add_u32 s96, s42, 3072
  buffer_load_dwordx4 v[12:15], v0, s[12:15], s96 offen offset:0 sc1
  buffer_load_dwordx4 v[60:63], v0, s[12:15], s96 offen offset:1024 sc1
L_g0c_45:
  s_waitcnt vmcnt(1)
  ds_write_b128 v0, v[12:15] offset:3072
  v_max_u32 v6, v12, v14
  s_waitcnt vmcnt(0)
  v_max3_u32 v6, v6, v60, v62
  v_cmp_eq_u32 vcc, -1, v6
  ds_write_b128 v0, v[60:63] offset:4096
  s_cbranch_vccz L_g0d_47
  s_mov_b64 exec, vcc
  buffer_load_dwordx4 v[12:15], v0, s[12:15], s96 offen offset:0 sc1
  buffer_load_dwordx4 v[60:63], v0, s[12:15], s96 offen offset:1024 sc1
  s_mov_b64 exec, -1
  s_sub_u32 s100, s100, 1
  s_cbranch_scc0 L_g0c_45
  s_branch L_end
L_g0d_47:
  s_waitcnt lgkmcnt(0)
  s_barrier
  ds_read_b128 v[32:35], v0 offset:0
  ds_read_b128 v[60:63], v0 offset:1024
  s_branch L_cloop1
L_gr_34:
  s_sub_u32 s100, s100, 1
  s_cbranch_scc1 L_end
  s_add_u32 s98, s42, 6144
  s_mov_b64 exec, vcc
  buffer_load_dwordx4 v[12:15], v0, s[12:15], s98 offen sc1
  s_waitcnt vmcnt(0)
  ds_write_b128 v0, v[12:15] offset:6144
  v_cmp_eq_u32 vcc, -1, v12
  v_cmp_eq_u32 s[94:95], -1, v14
  s_mov_b64 exec, -1
  s_or_b64 vcc, vcc, s[94:95]
  s_nop 1
  s_cbranch_scc1 L_gr_34
  s_waitcnt lgkmcnt(0)
  s_branch L_gb_35
L_rr_44:
  s_mov_b64 exec, vcc
  buffer_load_dwordx4 v[32:35], v2, s[12:15], s38 offen sc1
  buffer_load_dwordx4 v[56:59], v2, s[12:15], s39 offen sc1
  buffer_load_dwordx4 v[40:43], v2, s[12:15], s34 offen sc1
  buffer_load_dwordx4 v[12:15], v2, s[12:15], s35 offen sc1
  s_mov_b64 exec, -1
  s_waitcnt vmcnt(0)
  s_sub_u32 s100, s100, 1
  s_cbranch_scc0 L_rc_43
  s_branch L_end
L_cfin1:
  s_branch L_cdone
L_vw_37:
  s_waitcnt vmcnt(0)
  s_branch L_vw_37b
L_fp_36:
  s_mov_b32 m0, 31808
  v_lshlrev_b32 v6, 9, v0
  s_mov_b64 exec, 3
  buffer_load_dword v6, s[12:15], s47 offen sc1 lds
  s_mov_b64 exec, -1
  s_branch L_fp_36b
L_fp_40:
  s_mov_b32 m0, 31808
  v_lshlrev_b32 v23, 9, v0
  s_mov_b64 exec, 3
  buffer_load_dword v23, s[12:15], s47 offen sc1 lds
  s_mov_b64 exec, -1
  s_branch L_fp_40b
L_kc_33:
  s_andn2_b32 s92, s40, s90
  s_mov_b32 s93, s92
  s_mov_b32 m0, 17408
  s_add_u32 s98, s97, 0
  s_mov_b64 exec, s[92:93]
  buffer_load_dwordx4 v0, s[12:15], s98 offen sc1 lds
  buffer_load_dwordx4 v0, s[12:15], s98 offen offset:1024 sc1 lds
  s_mov_b64 exec, -1
  s_mov_b32 m0, 25600
  s_add_u32 s98, s97, 2048
  s_mov_b64 exec, s[92:93]
  buffer_load_dwordx4 v0, s[12:15], s98 offen sc1 lds
  buffer_load_dwordx4 v0, s[12:15], s98 offen offset:1024 sc1 lds
  s_mov_b64 exec, -1
  s_branch L_kc_33b
L_csl_31:
  s_cmp_lg_u32 s40, 0
  s_cbranch_scc1 L_csl_31k
  s_add_u32 s99, s32, 1
  s_min_u32 s99, s99, 64
L_csp_48:
  s_mov_b64 exec, 1
  buffer_load_dword v6, off, s[12:15], s47 sc1
  buffer_load_dword v12, off, s[12:15], s101 sc1
  s_mov_b64 exec, -1
  s_waitcnt vmcnt(1)
  v_readfirstlane_b32 s61, v6
  s_waitcnt vmcnt(0)
  v_readfirstlane_b32 s98, v12
  s_nop 0
  s_min_u32 s61, s61, s98
  s_cmp_ge_u32 s61, s99
  s_nop 0
  s_cbranch_scc1 L_csp_48d
  s_sleep 1
  s_sub_u32 s100, s100, 1
  s_cbranch_scc0 L_csp_48
  s_branch L_end
L_csp_48d:
  s_mov_b32 m0, 17408
  s_add_u32 s98, s46, 0
  buffer_load_dwordx4 v0, s[12:15], s98 offen sc1 lds
  buffer_load_dwordx4 v0, s[12:15], s98 offen offset:1024 sc1 lds
  s_mov_b32 m0, 25600
  s_add_u32 s98, s46, 2048
  buffer_load_dwordx4 v0, s[12:15], s98 offen sc1 lds
  buffer_load_dwordx4 v0, s[12:15], s98 offen offset:1024 sc1 lds
L_csl_31k:
  s_waitcnt vmcnt(2)
  s_branch L_csb_32
L_cb_38:
  v_lshrrev_b32 v32, 2, v0
  ds_read_b32 v32, v32 offset:31808
  s_waitcnt lgkmcnt(0)
  v_readlane_b32 s98, v32, 0
  v_readlane_b32 s99, v32, 1
  s_nop 0
  s_min_u32 s98, s98, s99
  s_max_u32 s61, s61, s98
  s_add_u32 s99, s32, 2
  s_min_u32 s99, s99, 64
  s_cmp_ge_u32 s61, s99
  s_cselect_b64 s[40:41], -1, 0
  s_mov_b32 s90, s40
  s_mov_b32 m0, 17408
  s_add_u32 s98, s46, 786432
  s_mov_b64 exec, s[40:41]
  buffer_load_dwordx4 v0, s[12:15], s98 offen sc1 lds
  buffer_load_dwordx4 v0, s[12:15], s98 offen offset:1024 sc1 lds
  s_mov_b64 exec, -1
  s_mov_b32 m0, 25600
  s_add_u32 s98, s46, 788480
  s_mov_b64 exec, s[40:41]
  buffer_load_dwordx4 v0, s[12:15], s98 offen sc1 lds
  buffer_load_dwordx4 v0, s[12:15], s98 offen offset:1024 sc1 lds
  s_mov_b64 exec, -1
  s_branch L_cbb_39
L_cst2:
  v_mov_b32 v16, 0
  v_mov_b32 v17, 31872
  ds_write_b32 v17, v16
  ds_write_b32 v17, v16 offset:4
  ds_read_b128 v[36:39], v3 offset:20480
  ds_read_b128 v[40:43], v3 offset:22528
  ds_read_b128 v[52:55], v3 offset:21504
  ds_read_b128 v[56:59], v3 offset:23552
  v_lshrrev_b32 v4, 1, v0
  ds_read_b64 v[4:5], v4 offset:32000
  v_mov_b32 v7, 0x4444
  v_mov_b32 v16, 0xeeee
  v_cndmask_b32 v7, v16, v7, s[52:53]
  v_mov_b64 v[16:17], 0
  v_mov_b64 v[18:19], 0
  v_mov_b64 v[20:21], 0
  v_mov_b64 v[22:23], 0
  v_mov_b64 v[24:25], 0
  v_mov_b64 v[26:27], 0
  v_mov_b64 v[28:29], 0
  v_mov_b64 v[30:31], 0
  v_mov_b64 v[44:45], 0
  v_mov_b64 v[46:47], 0
  v_mov_b64 v[48:49], 0
  v_mov_b64 v[50:51], 0
  s_barrier
  ds_read_b128 v[32:35], v0 offset:0
  ds_read_b128 v[60:63], v0 offset:1024
L_cloop2:
  s_waitcnt lgkmcnt(1)
  v_smfmac_f32_16x16x64_bf16 v[44:47], v[32:35], v[36:43], v7
  ds_read_b128 v[36:39], v3 offset:24576
  ds_read_b128 v[40:43], v3 offset:26624
  v_smfmac_f32_16x16x64_bf16 v[48:51], v[32:35], v[52:59], v7
  ds_read_b128 v[52:55], v3 offset:25600
  ds_read_b128 v[56:59], v3 offset:27648
  v_smfmac_f32_16x16x64_bf16 v[16:19], v[32:35], a[0:7], v7
  s_add_u32 s98, s42, 7168
  buffer_load_dwordx4 v[12:15], v0, s[12:15], s98 offen sc1
  v_smfmac_f32_16x16x64_bf16 v[20:23], v[32:35], a[8:15], v7
  v_smfmac_f32_16x16x64_bf16 v[24:27], v[32:35], a[16:23], v7
  v_smfmac_f32_16x16x64_bf16 v[28:31], v[32:35], a[24:31], v7
  ds_read_b128 v[32:35], v0 offset:2048
  s_waitcnt lgkmcnt(3)
  v_smfmac_f32_16x16x64_bf16 v[44:47], v[60:63], v[36:43], v7
  ds_read_b128 v[36:39], v3 offset:28672
  ds_read_b128 v[40:43], v3 offset:30720
  s_waitcnt lgkmcnt(3)
  v_smfmac_f32_16x16x64_bf16 v[48:51], v[60:63], v[52:59], v7
  ds_read_b128 v[52:55], v3 offset:29696
  ds_read_b128 v[56:59], v3 offset:31744
  v_mov_b32 v6, s32
  s_mov_b64 exec, 1
  buffer_store_dword v6, off, s[12:15], s69 sc1
  s_mov_b64 exec, -1
  v_smfmac_f32_16x16x64_bf16 v[16:19], v[60:63], a[32:39], v7
  v_smfmac_f32_16x16x64_bf16 v[20:23], v[60:63], a[40:47], v7
  v_smfmac_f32_16x16x64_bf16 v[24:27], v[60:63], a[48:55], v7
  v_lshrrev_b32 v6, 2, v0
  ds_read_b32 v6, v6 offset:31872
  v_smfmac_f32_16x16x64_bf16 v[28:31], v[60:63], a[56:63], v7
  ds_read_b128 v[60:63], v0 offset:3072
  s_waitcnt lgkmcnt(4)
  v_smfmac_f32_16x16x64_bf16 v[44:47], v[32:35], v[36:43], v7
  ds_read_b128 v[36:39], v3 offset:0
  ds_read_b128 v[40:43], v3 offset:2048
  s_and_b32 s97, s90, 786432
  s_add_u32 s97, s97, s46
  s_waitcnt lgkmcnt(4)
  v_smfmac_f32_16x16x64_bf16 v[48:51], v[32:35], v[52:59], v7
  ds_read_b128 v[52:55], v3 offset:1024
  ds_read_b128 v[56:59], v3 offset:3072
  v_smfmac_f32_16x16x64_bf16 v[16:19], v[32:35], a[64:71], v7
  s_waitcnt lgkmcnt(5)
  v_readlane_b32 s98, v6, 0
  v_readlane_b32 s99, v6, 1
  s_nop 0
  s_min_u32 s98, s98, s99
  s_max_u32 s61, s61, s98
  v_smfmac_f32_16x16x64_bf16 v[20:23], v[32:35], a[72:79], v7
  v_smfmac_f32_16x16x64_bf16 v[24:27], v[32:35], a[80:87], v7
  s_and_b32 s98, s90, 1
  s_add_u32 s99, s32, s98
  s_min_u32 s99, s99, 63
  s_cmp_gt_u32 s61, s99
  s_cselect_b64 s[40:41], -1, 0
  v_smfmac_f32_16x16x64_bf16 v[28:31], v[32:35], a[88:95], v7
  ds_read_b128 v[32:35], v0 offset:4096
  s_cmp_eq_u32 s90, 0
  s_cbranch_scc1 L_kc_51
L_kc_51b:
  s_waitcnt lgkmcnt(3)
  v_smfmac_f32_16x16x64_bf16 v[44:47], v[60:63], v[36:43], v7
  ds_read_b128 v[36:39], v3 offset:4096
  ds_read_b128 v[40:43], v3 offset:6144
  s_waitcnt lgkmcnt(3)
  v_smfmac_f32_16x16x64_bf16 v[48:51], v[60:63], v[52:59], v7
  ds_read_b128 v[52:55], v3 offset:5120
  ds_read_b128 v[56:59], v3 offset:7168
  v_smfmac_f32_16x16x64_bf16 v[16:19], v[60:63], a[96:103], v7
  s_waitcnt vmcnt(1)
  ds_write_b128 v0, v[12:15] offset:7168
  v_cmp_eq_u32 vcc, -1, v12
  v_cmp_eq_u32 s[94:95], -1, v14
  v_smfmac_f32_16x16x64_bf16 v[20:23], v[60:63], a[104:111], v7
  v_smfmac_f32_16x16x64_bf16 v[24:27], v[60:63], a[112:119], v7
  s_or_b64 vcc, vcc, s[94:95]
  s_cbranch_scc1 L_gr_52
L_gb_53:
  v_smfmac_f32_16x16x64_bf16 v[28:31], v[60:63], a[120:127], v7
  s_waitcnt lgkmcnt(3)
  v_smfmac_f32_16x16x64_bf16 v[44:47], v[32:35], v[36:43], v7
  s_add_u32 s98, s32, 2
  s_min_u32 s98, s98, 64
  s_cmp_lt_u32 s61, s98
  s_cbranch_scc1 L_fp_54
L_fp_54b:
  s_waitcnt lgkmcnt(1)
  v_smfmac_f32_16x16x64_bf16 v[48:51], v[32:35], v[52:59], v7
  v_smfmac_f32_16x16x64_bf16 v[16:19], v[32:35], a[128:135], v7
  s_waitcnt lgkmcnt(0)
  s_barrier
  ds_read_b128 v[60:63], v0 offset:5120
  ds_read_b128 v[36:39], v0 offset:6144
  ds_read_b128 v[40:43], v0 offset:7168
  v_smfmac_f32_16x16x64_bf16 v[20:23], v[32:35], a[136:143], v7
  v_smfmac_f32_16x16x64_bf16 v[24:27], v[32:35], a[144:151], v7
  s_xor_b32 s42, s42, 0x8000
  v_smfmac_f32_16x16x64_bf16 v[28:31], v[32:35], a[152:159], v7
  ds_read_b128 v[32:35], v0 offset:8192
  s_waitcnt lgkmcnt(3)
  v_smfmac_f32_16x16x64_bf16 v[16:19], v[60:63], a[160:167], v7
  v_smfmac_f32_16x16x64_bf16 v[20:23], v[60:63], a[168:175], v7
  s_waitcnt lgkmcnt(2)
  v_smfmac_f32_16x16x64_bf16 v[16:19], v[36:39], a[192:199], v7
  v_smfmac_f32_16x16x64_bf16 v[20:23], v[36:39], a[200:207], v7
  s_cmp_eq_u32 s90, 0
  s_cbranch_scc1 L_csl_49
L_csb_50:
  ds_read_b128 v[12:15], v0 offset:19456
  ds_read_b128 v[52:55], v0 offset:20480
  s_and_b32 s40, s40, s90
  s_mov_b32 s41, s40
  s_waitcnt lgkmcnt(3)
  v_smfmac_f32_16x16x64_bf16 v[16:19], v[40:43], a[224:231], v7
  v_smfmac_f32_16x16x64_bf16 v[20:23], v[40:43], a[232:239], v7
  s_waitcnt lgkmcnt(2)
  v_smfmac_f32_16x16x64_bf16 v[16:19], v[32:35], v[64:71], v7
  v_smfmac_f32_16x16x64_bf16 v[20:23], v[32:35], v[72:79], v7
  v_smfmac_f32_16x16x64_bf16 v[24:27], v[60:63], a[176:183], v7
  s_waitcnt lgkmcnt(0)
  s_mov_b32 m0, 19456
  s_add_u32 s98, s97, 0
  s_mov_b64 exec, s[40:41]
  buffer_load_dwordx4 v0, s[12:15], s98 offen sc1 lds
  buffer_load_dwordx4 v0, s[12:15], s98 offen offset:1024 sc1 lds
  s_mov_b64 exec, -1
  v_smfmac_f32_16x16x64_bf16 v[28:31], v[60:63], a[184:191], v7
  s_nop 1
  v_permlane32_swap_b32 v16, v20
  v_smfmac_f32_16x16x64_bf16 v[24:27], v[36:39], a[208:215], v7
  v_permlane32_swap_b32 v17, v21
  v_smfmac_f32_16x16x64_bf16 v[28:31], v[36:39], a[216:223], v7
  v_permlane32_swap_b32 v18, v22
  v_smfmac_f32_16x16x64_bf16 v[24:27], v[40:43], a[240:247], v7
  v_permlane32_swap_b32 v19, v23
  v_smfmac_f32_16x16x64_bf16 v[28:31], v[40:43], a[248:255], v7
  v_add_f32 v16, v16, v20
  v_add_f32 v17, v17, v21
  v_add_f32 v18, v18, v22
  v_smfmac_f32_16x16x64_bf16 v[24:27], v[32:35], v[80:87], v7
  v_add_f32 v19, v19, v23
  v_cvt_pk_bf16_f32 v22, v16, v17
  v_cvt_pk_bf16_f32 v23, v18, v19
  v_smfmac_f32_16x16x64_bf16 v[28:31], v[32:35], v[88:95], v7
  s_nop 0
  v_mfma_f32_16x16x16_bf16 v[56:59], v[22:23], v[4:5], 0
  v_smfmac_f32_16x16x64_bf16 v[44:47], v[60:63], v[96:103], v7
  v_smfmac_f32_16x16x64_bf16 v[48:51], v[60:63], v[104:111], v7
  s_nop 3
  v_permlane32_swap_b32 v24, v28
  v_smfmac_f32_16x16x64_bf16 v[44:47], v[36:39], v[112:119], v7
  v_permlane32_swap_b32 v25, v29
  v_smfmac_f32_16x16x64_bf16 v[48:51], v[36:39], v[120:127], v7
  v_permlane32_swap_b32 v26, v30
  v_smfmac_f32_16x16x64_bf16 v[44:47], v[40:43], v[128:135], v7
  v_permlane32_swap_b32 v27, v31
  v_smfmac_f32_16x16x64_bf16 v[48:51], v[40:43], v[136:143], v7
  v_cvt_pk_bf16_f32 v16, v56, v57
  v_cvt_pk_bf16_f32 v17, v58, v59
  v_cvt_pk_bf16_f32 v20, v56, v57
  v_cvt_pk_bf16_f32 v21, v58, v59
  v_add_f32 v24, v24, v28
  v_add_f32 v25, v25, v29
  v_add_f32 v26, v26, v30
  v_smfmac_f32_16x16x64_bf16 v[44:47], v[32:35], v[144:151], v7
  v_add_f32 v27, v27, v31
  v_cvt_pk_bf16_f32 v24, v24, v25
  v_cvt_pk_bf16_f32 v25, v26, v27
  v_smfmac_f32_16x16x64_bf16 v[48:51], v[32:35], v[152:159], v7
  s_cmp_eq_u32 s90, 0
  s_cbranch_scc1 L_vw_55
L_vw_55b:
  v_mov_b32 v18, v16 row_ror:8 row_mask:0xf bank_mask:0xf
  v_mov_b32 v19, v17 row_ror:8 row_mask:0xf bank_mask:0xf
  v_mfma_f32_16x16x16_bf16 v[28:31], v[24:25], v[4:5], 0
  ds_read_b128 v[60:63], v0 offset:27648
  ds_read_b128 v[36:39], v0 offset:28672
  v_mfma_f32_16x16x32_bf16 v[12:15], v[12:15], v[16:19], 0
  v_mfma_f32_16x16x32_bf16 v[52:55], v[52:55], v[18:21], 0
  v_permlane32_swap_b32 v44, v48
  v_permlane32_swap_b32 v45, v49
  s_nop 1
  v_cvt_pk_bf16_f32 v24, v28, v29
  v_cvt_pk_bf16_f32 v25, v30, v31
  s_nop 1
  v_cndmask_b32 v12, v12, v52, s[54:55]
  v_cndmask_b32 v13, v13, v53, s[54:55]
  v_mov_b32 v26, v24 row_ror:8 row_mask:0xf bank_mask:0xf
  v_mov_b32 v27, v25 row_ror:8 row_mask:0xf bank_mask:0xf
  v_cndmask_b32 v14, v14, v54, s[54:55]
  v_cndmask_b32 v15, v15, v55, s[54:55]
  v_mfma_f32_16x16x32_bf16 v[28:31], v[24:27], v[16:19], 0
  ds_write_b128 v0, v[12:15] offset:11264
  v_permlane32_swap_b32 v46, v50
  v_permlane32_swap_b32 v47, v51
  v_add_f32 v44, v44, v48
  v_add_f32 v45, v45, v49
  v_add_f32 v46, v46, v50
  v_add_f32 v47, v47, v51
  v_cvt_pk_bf16_f32 v6, v44, v45
  v_cvt_pk_bf16_f32 v7, v46, v47
  ds_write_b128 v1, v[28:31] offset:14336
  v_mov_b32 v4, v24
  v_mov_b32 v5, v25
  v_bfe_u32 v56, v0, 7, 1
  v_lshrrev_b32 v57, 9, v0
  v_lshl_add_u32 v56, v57, 1, v56
  v_and_b32 v57, 0x170, v1
  v_lshl_add_u32 v56, v56, 2, v57
  v_add_u32 v56, 13312, v56
  v_add_u32 v57, 1024, v56
  s_cmp_eq_u32 s40, 0
  s_cbranch_scc1 L_cb_56
  s_waitcnt lgkmcnt(2)
  s_mov_b32 m0, 27648
  s_add_u32 s98, s46, 788480
  buffer_load_dwordx4 v0, s[12:15], s98 offen sc1 lds
  buffer_load_dwordx4 v0, s[12:15], s98 offen offset:1024 sc1 lds
L_cbb_57:
  s_waitcnt lgkmcnt(0)
  s_barrier
  ds_read_b128 v[52:55], v0 offset:12288
  ds_read_b128 v[16:19], v0 offset:9216
  ds_read_b128 v[20:23], v0 offset:10240
  ds_read2_b32 v[28:29], v56 offset0:0 offset1:32
  ds_read2_b32 v[30:31], v57 offset0:0 offset1:32
  v_mov_b32 v25, 0
  v_mov_b32 v26, 0
  s_mov_b32 s91, s50
  buffer_store_dwordx4 v[4:7], v0, s[12:15], s91 offen sc1
  s_waitcnt lgkmcnt(4)
  v_pk_add_f32 v[12:13], v[12:13], v[52:53]
  v_pk_add_f32 v[14:15], v[14:15], v[54:55]
  s_waitcnt lgkmcnt(3)
  v_pk_add_f32 v[12:13], v[12:13], v[16:17]
  v_pk_add_f32 v[14:15], v[14:15], v[18:19]
  s_waitcnt lgkmcnt(2)
  v_pk_add_f32 v[12:13], v[12:13], v[20:21]
  v_pk_add_f32 v[14:15], v[14:15], v[22:23]
  s_waitcnt lgkmcnt(0)
  v_pk_add_f32 v[28:29], v[28:29], v[30:31]
  v_max3_f32 v30, v12, v13, v14
  v_add_f32 v28, v28, v29
  v_max3_f32 v30, v30, v15, v28
  ds_read_b128 v[32:35], v3 offset:8192
  ds_read_b128 v[56:59], v3 offset:9216
  v_max_f32 v30, v30, v30 row_ror:8 row_mask:0xf bank_mask:0xf
  v_mov_b32 v31, v30
  ds_read_b128 v[40:43], v3 offset:10240
  s_nop 0
  v_permlane16_swap_b32 v30, v31
  v_max_f32 v30, v30, v31
  v_mov_b32 v31, v30
  s_nop 1
  v_permlane32_swap_b32 v30, v31
  v_max_f32 v30, v30, v31
  v_mul_f32 v30, s60, v30
  v_fma_f32 v28, v28, s60, -v30
  v_fma_f32 v12, v12, s60, -v30
  v_fma_f32 v13, v13, s60, -v30
  v_fma_f32 v14, v14, s60, -v30
  v_fma_f32 v15, v15, s60, -v30
  v_exp_f32 v28, v28
  v_exp_f32 v12, v12
  v_exp_f32 v13, v13
  v_exp_f32 v14, v14
  v_exp_f32 v15, v15
  v_mov_b32 v29, v28 row_ror:8 row_mask:0xf bank_mask:0xf
  v_cvt_pk_bf16_f32 v52, v12, v13
  v_cvt_pk_bf16_f32 v53, v14, v15
  v_cvt_pk_bf16_f32 v24, v28, v29
  v_cvt_pk_bf16_f32 v27, v28, v29
  v_mov_b32 v54, v52 row_ror:8 row_mask:0xf bank_mask:0xf
  v_mov_b32 v55, v53 row_ror:8 row_mask:0xf bank_mask:0xf
  v_permlane32_swap_b32 v24, v25
  v_permlane32_swap_b32 v26, v27
  v_mfma_f32_16x16x32_bf16 v[60:63], v[60:63], v[52:55], 0
  v_add_f32 v30, v12, v13
  v_add_f32 v31, v14, v15
  v_mfma_f32_16x16x32_bf16 v[36:39], v[36:39], v[52:55], 0
  v_add_f32 v30, v30, v28
  v_add_f32 v30, v30, v31
  s_barrier
  v_mfma_f32_16x16x16_bf16 v[60:63], v[6:7], v[24:25], v[60:63]
  v_add_f32 v30, v30, v30 row_ror:8 row_mask:0xf bank_mask:0xf
  v_mov_b32 v31, v30
  v_mfma_f32_16x16x16_bf16 v[36:39], v[6:7], v[26:27], v[36:39]
  s_nop 0
  v_permlane16_swap_b32 v30, v31
  v_add_f32 v30, v30, v31
  v_mov_b32 v31, v30
  ds_read_b128 v[12:15], v3 offset:11264
  s_nop 0
  v_permlane32_swap_b32 v30, v31
  v_add_f32 v30, v30, v31
  v_rcp_f32 v30, v30
  s_nop 0
  v_pk_mul_f32 v[60:61], v[60:61], v[30:31] op_sel_hi:[1,0]
  v_pk_mul_f32 v[62:63], v[62:63], v[30:31] op_sel_hi:[1,0]
  v_pk_mul_f32 v[36:37], v[36:37], v[30:31] op_sel_hi:[1,0]
  v_pk_mul_f32 v[38:39], v[38:39], v[30:31] op_sel_hi:[1,0]
  v_cvt_pk_bf16_f32 v60, v60, v61
  v_cvt_pk_bf16_f32 v61, v62, v63
  v_cvt_pk_bf16_f32 v62, v36, v37
  v_cvt_pk_bf16_f32 v63, v38, v39
  ds_write_b128 v1, v[60:63] offset:14336
  s_and_b32 s98, s32, 3
  s_cselect_b32 s98, 3, 64
  s_add_u32 s98, s98, s32
  s_min_u32 s98, s98, 64
  s_cmp_lt_u32 s61, s98
  s_cbranch_scc1 L_fp_58
L_fp_58b:
  s_cmp_eq_u32 s32, 63
  s_cbranch_scc1 L_cfin2
  s_waitcnt lgkmcnt(0)
  s_barrier
  ds_read_b128 v[36:39], v1 offset:13312
  ds_read_b128 v[28:31], v1 offset:13440
  ds_read_b128 v[24:27], v1 offset:14336
  ds_read_b128 v[60:63], v1 offset:14464
  s_waitcnt lgkmcnt(3)
  v_mfma_f32_16x16x32_bf16 v[44:47], v[160:163], v[36:39], 0
  v_mfma_f32_16x16x32_bf16 v[48:51], v[164:167], v[36:39], 0
  v_lshrrev_b32 v5, 5, v0
  v_and_b32 v5, 8, v5
  s_waitcnt lgkmcnt(2)
  v_mfma_f32_16x16x32_bf16 v[44:47], v[32:35], v[28:31], v[44:47]
  v_and_or_b32 v5, v0, s56, v5
  v_mov_b32 v6, -1
  v_mfma_f32_16x16x32_bf16 v[48:51], v[56:59], v[28:31], v[48:51]
  v_mov_b32 v7, -1
  ds_read_b128 v[32:35], v3 offset:12288
  ds_read_b128 v[56:59], v3 offset:13312
  s_waitcnt lgkmcnt(3)
  v_mfma_f32_16x16x32_bf16 v[44:47], v[168:171], v[24:27], v[44:47]
  v_mfma_f32_16x16x32_bf16 v[48:51], v[172:175], v[24:27], v[48:51]
  s_waitcnt lgkmcnt(2)
  v_mfma_f32_16x16x32_bf16 v[44:47], v[40:43], v[60:63], v[44:47]
  v_mfma_f32_16x16x32_bf16 v[48:51], v[12:15], v[60:63], v[48:51]
  ds_read_b128 v[40:43], v3 offset:14336
  ds_read_b128 v[12:15], v3 offset:15360
  v_mfma_f32_16x16x32_bf16 v[20:23], v[240:243], v[36:39], 0
  s_nop 1
  v_mfma_f32_16x16x32_bf16 v[20:23], v[244:247], v[28:31], v[20:23]
  s_nop 0
  v_cvt_pk_bf16_f32 v44, v44, v45
  v_cvt_pk_bf16_f32 v45, v46, v47
  v_mfma_f32_16x16x32_bf16 v[20:23], v[248:251], v[24:27], v[20:23]
  v_cvt_pk_bf16_f32 v46, v48, v49
  v_cvt_pk_bf16_f32 v47, v50, v51
  v_mfma_f32_16x16x32_bf16 v[20:23], v[252:255], v[60:63], v[20:23]
  v_bfi_b32 v44, 1, s45, v44
  v_bfi_b32 v46, 1, s45, v46
  v_mfma_f32_16x16x32_bf16 v[52:55], v[176:179], v[36:39], 0
  buffer_store_dwordx4 v[44:47], v1, s[12:15], s33 offen offset:1024
  s_nop 1
  v_mfma_f32_16x16x32_bf16 v[16:19], v[180:183], v[36:39], 0
  s_waitcnt lgkmcnt(3)
  v_mfma_f32_16x16x32_bf16 v[52:55], v[32:35], v[28:31], v[52:55]
  v_cvt_pk_bf16_f32 v20, v20, v21
  v_cvt_pk_bf16_f32 v21, v22, v23
  s_waitcnt lgkmcnt(2)
  v_mfma_f32_16x16x32_bf16 v[16:19], v[56:59], v[28:31], v[16:19]
  v_bfi_b32 v20, 1, s45, v20
  ds_read_b128 v[32:35], v3 offset:16384
  ds_read_b128 v[56:59], v3 offset:17408
  v_mfma_f32_16x16x32_bf16 v[52:55], v[184:187], v[24:27], v[52:55]
  buffer_store_dwordx2 v[20:21], v1, s[12:15], s33 offen offset:2176
  v_mfma_f32_16x16x32_bf16 v[16:19], v[188:191], v[24:27], v[16:19]
  s_waitcnt lgkmcnt(3)
  v_mfma_f32_16x16x32_bf16 v[52:55], v[40:43], v[60:63], v[52:55]
  s_waitcnt lgkmcnt(2)
  v_mfma_f32_16x16x32_bf16 v[16:19], v[12:15], v[60:63], v[16:19]
  ds_read_b128 v[40:43], v3 offset:18432
  ds_read_b128 v[12:15], v3 offset:19456
  v_mfma_f32_16x16x32_bf16 v[44:47], v[192:195], v[36:39], 0
  s_nop 1
  v_mfma_f32_16x16x32_bf16 v[48:51], v[196:199], v[36:39], 0
  v_cvt_pk_bf16_f32 v52, v52, v53
  v_cvt_pk_bf16_f32 v53, v54, v55
  s_waitcnt lgkmcnt(3)
  v_mfma_f32_16x16x32_bf16 v[44:47], v[32:35], v[28:31], v[44:47]
  v_cvt_pk_bf16_f32 v54, v16, v17
  v_cvt_pk_bf16_f32 v55, v18, v19
  s_waitcnt lgkmcnt(2)
  v_mfma_f32_16x16x32_bf16 v[48:51], v[56:59], v[28:31], v[48:51]
  v_bfi_b32 v52, 1, s45, v52
  v_bfi_b32 v54, 1, s45, v54
  v_mfma_f32_16x16x32_bf16 v[44:47], v[200:203], v[24:27], v[44:47]
  buffer_store_dwordx4 v[52:55], v1, s[12:15], s48 offen offset:0
  v_mfma_f32_16x16x32_bf16 v[48:51], v[204:207], v[24:27], v[48:51]
  s_waitcnt lgkmcnt(1)
  v_mfma_f32_16x16x32_bf16 v[44:47], v[40:43], v[60:63], v[44:47]
  s_waitcnt lgkmcnt(0)
  v_mfma_f32_16x16x32_bf16 v[48:51], v[12:15], v[60:63], v[48:51]
  v_mfma_f32_16x16x32_bf16 v[52:55], v[208:211], v[36:39], 0
  s_nop 1
  v_mfma_f32_16x16x32_bf16 v[16:19], v[212:215], v[36:39], 0
  s_nop 1
  v_cvt_pk_bf16_f32 v44, v44, v45
  v_cvt_pk_bf16_f32 v45, v46, v47
  v_mfma_f32_16x16x32_bf16 v[52:55], v[216:219], v[28:31], v[52:55]
  v_cvt_pk_bf16_f32 v46, v48, v49
  v_cvt_pk_bf16_f32 v47, v50, v51
  v_mfma_f32_16x16x32_bf16 v[16:19], v[220:223], v[28:31], v[16:19]
  v_bfi_b32 v44, 1, s45, v44
  v_bfi_b32 v46, 1, s45, v46
  v_mfma_f32_16x16x32_bf16 v[52:55], v[224:227], v[24:27], v[52:55]
  buffer_store_dwordx4 v[44:47], v1, s[12:15], s48 offen offset:2048
  v_mfma_f32_16x16x32_bf16 v[16:19], v[228:231], v[24:27], v[16:19]
  v_mfma_f32_16x16x32_bf16 v[52:55], v[232:235], v[60:63], v[52:55]
  v_mfma_f32_16x16x32_bf16 v[16:19], v[236:239], v[60:63], v[16:19]
  s_nop 6
  v_cvt_pk_bf16_f32 v52, v52, v53
  v_cvt_pk_bf16_f32 v53, v54, v55
  v_cvt_pk_bf16_f32 v54, v16, v17
  v_cvt_pk_bf16_f32 v55, v18, v19
  v_bfi_b32 v52, 1, s45, v52
  v_bfi_b32 v54, 1, s45, v54
  buffer_store_dwordx4 v[52:55], v1, s[12:15], s49 offen offset:0
  s_cmp_lg_u32 s68, 0
  s_cbranch_scc1 L_nr_59
  s_nop 15
  s_nop 15
  s_nop 15
  s_nop 1
  buffer_load_dwordx4 v[32:35], v2, s[12:15], s38 offen sc1
  buffer_load_dwordx4 v[56:59], v2, s[12:15], s39 offen sc1
  buffer_load_dwordx4 v[40:43], v2, s[12:15], s34 offen sc1
  buffer_load_dwordx4 v[12:15], v2, s[12:15], s35 offen sc1
L_rc_61:
  s_waitcnt vmcnt(3)
  v_mfma_f32_16x16x32_bf16 v[20:23], v[8:11], v[32:35], 0
  v_bitop3_b32 v36, v32, v34, s45 bitop3:0x7e
  s_waitcnt vmcnt(2)
  v_mfma_f32_16x16x32_bf16 v[20:23], v[8:11], v[56:59], v[20:23]
  v_bitop3_b32 v37, v56, v58, s45 bitop3:0x7e
  s_waitcnt vmcnt(1)
  v_mfma_f32_16x16x32_bf16 v[20:23], v[8:11], v[40:43], v[20:23]
  v_bitop3_b32 v38, v40, v42, s45 bitop3:0x7e
  v_or3_b32 v36, v36, v37, v38
  s_waitcnt vmcnt(0)
  v_mfma_f32_16x16x32_bf16 v[20:23], v[8:11], v[12:15], v[20:23]
  v_bitop3_b32 v39, v12, v14, s45 bitop3:0x7e
  v_or_b32 v36, v36, v39
  v_and_b32 v36, 1, v36
  v_cmp_ne_u32 vcc, 0, v36
  s_nop 0
  s_cbranch_vccnz L_rr_62
  s_mov_b64 exec, s[58:59]
  buffer_store_dwordx2 v[6:7], v5, s[12:15], s44 offen
  s_mov_b64 exec, -1
  v_add_f32 v20, v20, v20 row_ror:8 row_mask:0xf bank_mask:0xf
  v_add_f32 v21, v21, v21 row_ror:8 row_mask:0xf bank_mask:0xf
  v_add_f32 v22, v22, v22 row_ror:8 row_mask:0xf bank_mask:0xf
  v_add_f32 v23, v23, v23 row_ror:8 row_mask:0xf bank_mask:0xf
  v_cvt_pk_bf16_f32 v20, v20, v21
  v_cvt_pk_bf16_f32 v21, v22, v23
  s_mov_b64 exec, s[58:59]
  buffer_store_dwordx2 v[20:21], v5, s[12:15], s43 offen
  s_mov_b64 exec, -1
L_nr_59:
  s_add_u32 s32, s32, 1
  s_xor_b32 s45, s45, 1
  s_add_u32 s50, s50, 131072
  s_xor_b32 s43, s43, 0x8000
  s_xor_b32 s44, s44, 0x8000
  s_add_u32 s46, s46, 786432
  ds_read_b128 v[36:39], v3 offset:20480
  ds_read_b128 v[40:43], v3 offset:22528
  ds_read_b128 v[52:55], v3 offset:21504
  ds_read_b128 v[56:59], v3 offset:23552
  v_lshrrev_b32 v4, 1, v0
  ds_read_b64 v[4:5], v4 offset:32000
  v_mov_b32 v7, 0x4444
  v_mov_b32 v16, 0xeeee
  v_cndmask_b32 v7, v16, v7, s[52:53]
  v_mov_b64 v[16:17], 0
  v_mov_b64 v[18:19], 0
  v_mov_b64 v[20:21], 0
  v_mov_b64 v[22:23], 0
  v_mov_b64 v[24:25], 0
  v_mov_b64 v[26:27], 0
  v_mov_b64 v[28:29], 0
  v_mov_b64 v[30:31], 0
  v_mov_b64 v[44:45], 0
  v_mov_b64 v[46:47], 0
  v_mov_b64 v[48:49], 0
  v_mov_b64 v[50:51], 0
  s_barrier
  ds_read_b128 v[32:35], v0 offset:0
  ds_read_b128 v[60:63], v0 offset:1024
  s_branch L_cloop2
L_gr_52:
  s_sub_u32 s100, s100, 1
  s_cbranch_scc1 L_end
  s_add_u32 s98, s42, 7168
  s_mov_b64 exec, vcc
  buffer_load_dwordx4 v[12:15], v0, s[12:15], s98 offen sc1
  s_waitcnt vmcnt(0)
  ds_write_b128 v0, v[12:15] offset:7168
  v_cmp_eq_u32 vcc, -1, v12
  v_cmp_eq_u32 s[94:95], -1, v14
  s_mov_b64 exec, -1
  s_or_b64 vcc, vcc, s[94:95]
  s_nop 1
  s_cbranch_scc1 L_gr_52
  s_waitcnt lgkmcnt(0)
  s_branch L_gb_53
L_rr_62:
  s_mov_b64 exec, vcc
  buffer_load_dwordx4 v[32:35], v2, s[12:15], s38 offen sc1
  buffer_load_dwordx4 v[56:59], v2, s[12:15], s39 offen sc1
  buffer_load_dwordx4 v[40:43], v2, s[12:15], s34 offen sc1
  buffer_load_dwordx4 v[12:15], v2, s[12:15], s35 offen sc1
  s_mov_b64 exec, -1
  s_waitcnt vmcnt(0)
  s_sub_u32 s100, s100, 1
  s_cbranch_scc0 L_rc_61
  s_branch L_end
L_cfin2:
  s_branch L_cdone
L_vw_55:
  s_waitcnt vmcnt(0)
  s_branch L_vw_55b
L_fp_54:
  s_mov_b32 m0, 31872
  v_lshlrev_b32 v6, 9, v0
  s_mov_b64 exec, 3
  buffer_load_dword v6, s[12:15], s47 offen sc1 lds
  s_mov_b64 exec, -1
  s_branch L_fp_54b
L_fp_58:
  s_mov_b32 m0, 31872
  v_lshlrev_b32 v23, 9, v0
  s_mov_b64 exec, 3
  buffer_load_dword v23, s[12:15], s47 offen sc1 lds
  s_mov_b64 exec, -1
  s_branch L_fp_58b
L_kc_51:
  s_andn2_b32 s92, s40, s90
  s_mov_b32 s93, s92
  s_mov_b32 m0, 19456
  s_add_u32 s98, s97, 0
  s_mov_b64 exec, s[92:93]
  buffer_load_dwordx4 v0, s[12:15], s98 offen sc1 lds
  buffer_load_dwordx4 v0, s[12:15], s98 offen offset:1024 sc1 lds
  s_mov_b64 exec, -1
  s_mov_b32 m0, 27648
  s_add_u32 s98, s97, 2048
  s_mov_b64 exec, s[92:93]
  buffer_load_dwordx4 v0, s[12:15], s98 offen sc1 lds
  buffer_load_dwordx4 v0, s[12:15], s98 offen offset:1024 sc1 lds
  s_mov_b64 exec, -1
  s_branch L_kc_51b
L_csl_49:
  s_cmp_lg_u32 s40, 0
  s_cbranch_scc1 L_csl_49k
  s_add_u32 s99, s32, 1
  s_min_u32 s99, s99, 64
L_csp_63:
  s_mov_b64 exec, 1
  buffer_load_dword v6, off, s[12:15], s47 sc1
  buffer_load_dword v12, off, s[12:15], s101 sc1
  s_mov_b64 exec, -1
  s_waitcnt vmcnt(1)
  v_readfirstlane_b32 s61, v6
  s_waitcnt vmcnt(0)
  v_readfirstlane_b32 s98, v12
  s_nop 0
  s_min_u32 s61, s61, s98
  s_cmp_ge_u32 s61, s99
  s_nop 0
  s_cbranch_scc1 L_csp_63d
  s_sleep 1
  s_sub_u32 s100, s100, 1
  s_cbranch_scc0 L_csp_63
  s_branch L_end
L_csp_63d:
  s_mov_b32 m0, 19456
  s_add_u32 s98, s46, 0
  buffer_load_dwordx4 v0, s[12:15], s98 offen sc1 lds
  buffer_load_dwordx4 v0, s[12:15], s98 offen offset:1024 sc1 lds
  s_mov_b32 m0, 27648
  s_add_u32 s98, s46, 2048
  buffer_load_dwordx4 v0, s[12:15], s98 offen sc1 lds
  buffer_load_dwordx4 v0, s[12:15], s98 offen offset:1024 sc1 lds
L_csl_49k:
  s_waitcnt vmcnt(2)
  s_branch L_csb_50
L_cb_56:
  v_lshrrev_b32 v32, 2, v0
  ds_read_b32 v32, v32 offset:31872
  s_waitcnt lgkmcnt(0)
  v_readlane_b32 s98, v32, 0
  v_readlane_b32 s99, v32, 1
  s_nop 0
  s_min_u32 s98, s98, s99
  s_max_u32 s61, s61, s98
  s_add_u32 s99, s32, 2
  s_min_u32 s99, s99, 64
  s_cmp_ge_u32 s61, s99
  s_cselect_b64 s[40:41], -1, 0
  s_mov_b32 s90, s40
  s_mov_b32 m0, 19456
  s_add_u32 s98, s46, 786432
  s_mov_b64 exec, s[40:41]
  buffer_load_dwordx4 v0, s[12:15], s98 offen sc1 lds
  buffer_load_dwordx4 v0, s[12:15], s98 offen offset:1024 sc1 lds
  s_mov_b64 exec, -1
  s_mov_b32 m0, 27648
  s_add_u32 s98, s46, 788480
  s_mov_b64 exec, s[40:41]
  buffer_load_dwordx4 v0, s[12:15], s98 offen sc1 lds
  buffer_load_dwordx4 v0, s[12:15], s98 offen offset:1024 sc1 lds
  s_mov_b64 exec, -1
  s_branch L_cbb_57
L_cst3:
  v_mov_b32 v16, 0
  v_mov_b32 v17, 31936
  ds_write_b32 v17, v16
  ds_write_b32 v17, v16 offset:4
  ds_read_b128 v[36:39], v3 offset:20480
  ds_read_b128 v[40:43], v3 offset:22528
  ds_read_b128 v[52:55], v3 offset:21504
  ds_read_b128 v[56:59], v3 offset:23552
  v_lshrrev_b32 v4, 1, v0
  ds_read_b64 v[4:5], v4 offset:32000
  v_mov_b32 v7, 0x4444
  v_mov_b32 v16, 0xeeee
  v_cndmask_b32 v7, v16, v7, s[52:53]
  v_mov_b64 v[16:17], 0
  v_mov_b64 v[18:19], 0
  v_mov_b64 v[20:21], 0
  v_mov_b64 v[22:23], 0
  v_mov_b64 v[24:25], 0
  v_mov_b64 v[26:27], 0
  v_mov_b64 v[28:29], 0
  v_mov_b64 v[30:31], 0
  v_mov_b64 v[44:45], 0
  v_mov_b64 v[46:47], 0
  v_mov_b64 v[48:49], 0
  v_mov_b64 v[50:51], 0
  s_barrier
  ds_read_b128 v[32:35], v0 offset:0
  ds_read_b128 v[60:63], v0 offset:1024
L_cloop3:
  s_waitcnt lgkmcnt(1)
  v_smfmac_f32_16x16x64_bf16 v[44:47], v[32:35], v[36:43], v7
  ds_read_b128 v[36:39], v3 offset:24576
  ds_read_b128 v[40:43], v3 offset:26624
  v_smfmac_f32_16x16x64_bf16 v[48:51], v[32:35], v[52:59], v7
  ds_read_b128 v[52:55], v3 offset:25600
  ds_read_b128 v[56:59], v3 offset:27648
  v_smfmac_f32_16x16x64_bf16 v[16:19], v[32:35], a[0:7], v7
  v_smfmac_f32_16x16x64_bf16 v[20:23], v[32:35], a[8:15], v7
  s_add_u32 s98, s42, 8192
  buffer_load_dwordx4 v[12:15], v0, s[12:15], s98 offen sc1
  v_smfmac_f32_16x16x64_bf16 v[24:27], v[32:35], a[16:23], v7
  v_smfmac_f32_16x16x64_bf16 v[28:31], v[32:35], a[24:31], v7
  ds_read_b128 v[32:35], v0 offset:2048
  s_waitcnt lgkmcnt(3)
  v_smfmac_f32_16x16x64_bf16 v[44:47], v[60:63], v[36:43], v7
  ds_read_b128 v[36:39], v3 offset:28672
  ds_read_b128 v[40:43], v3 offset:30720
  s_waitcnt lgkmcnt(3)
  v_smfmac_f32_16x16x64_bf16 v[48:51], v[60:63], v[52:59], v7
  ds_read_b128 v[52:55], v3 offset:29696
  ds_read_b128 v[56:59], v3 offset:31744
  v_smfmac_f32_16x16x64_bf16 v[16:19], v[60:63], a[32:39], v7
  v_mov_b32 v6, s32
  s_mov_b64 exec, 1
  buffer_store_dword v6, off, s[12:15], s69 sc1
  s_mov_b64 exec, -1
  v_smfmac_f32_16x16x64_bf16 v[20:23], v[60:63], a[40:47], v7
  v_smfmac_f32_16x16x64_bf16 v[24:27], v[60:63], a[48:55], v7
  v_lshrrev_b32 v6, 2, v0
  ds_read_b32 v6, v6 offset:31936
  v_smfmac_f32_16x16x64_bf16 v[28:31], v[60:63], a[56:63], v7
  ds_read_b128 v[60:63], v0 offset:3072
  s_waitcnt lgkmcnt(4)
  v_smfmac_f32_16x16x64_bf16 v[44:47], v[32:35], v[36:43], v7
  ds_read_b128 v[36:39], v3 offset:0
  ds_read_b128 v[40:43], v3 offset:2048
  s_and_b32 s97, s90, 786432
  s_add_u32 s97, s97, s46
  s_waitcnt lgkmcnt(4)
  v_smfmac_f32_16x16x64_bf16 v[48:51], v[32:35], v[52:59], v7
  ds_read_b128 v[52:55], v3 offset:1024
  ds_read_b128 v[56:59], v3 offset:3072
  v_smfmac_f32_16x16x64_bf16 v[16:19], v[32:35], a[64:71], v7
  s_waitcnt lgkmcnt(5)
  v_readlane_b32 s98, v6, 0
  v_readlane_b32 s99, v6, 1
  s_nop 0
  s_min_u32 s98, s98, s99
  s_max_u32 s61, s61, s98
  v_smfmac_f32_16x16x64_bf16 v[20:23], v[32:35], a[72:79], v7
  v_smfmac_f32_16x16x64_bf16 v[24:27], v[32:35], a[80:87], v7
  s_and_b32 s98, s90, 1
  s_add_u32 s99, s32, s98
  s_min_u32 s99, s99, 63
  s_cmp_gt_u32 s61, s99
  s_cselect_b64 s[40:41], -1, 0
  v_smfmac_f32_16x16x64_bf16 v[28:31], v[32:35], a[88:95], v7
  ds_read_b128 v[32:35], v0 offset:4096
  s_cmp_eq_u32 s90, 0
  s_cbranch_scc1 L_kc_66
L_kc_66b:
  s_waitcnt lgkmcnt(3)
  v_smfmac_f32_16x16x64_bf16 v[44:47], v[60:63], v[36:43], v7
  ds_read_b128 v[36:39], v3 offset:4096
  ds_read_b128 v[40:43], v3 offset:6144
  s_waitcnt lgkmcnt(3)
  v_smfmac_f32_16x16x64_bf16 v[48:51], v[60:63], v[52:59], v7
  ds_read_b128 v[52:55], v3 offset:5120
  ds_read_b128 v[56:59], v3 offset:7168
  v_smfmac_f32_16x16x64_bf16 v[16:19], v[60:63], a[96:103], v7
  v_smfmac_f32_16x16x64_bf16 v[20:23], v[60:63], a[104:111], v7
  s_waitcnt vmcnt(1)
  ds_write_b128 v0, v[12:15] offset:8192
  v_cmp_eq_u32 vcc, -1, v12
  v_cmp_eq_u32 s[94:95], -1, v14
  v_smfmac_f32_16x16x64_bf16 v[24:27], v[60:63], a[112:119], v7
  v_smfmac_f32_16x16x64_bf16 v[28:31], v[60:63], a[120:127], v7
  s_or_b64 vcc, vcc, s[94:95]
  s_cbranch_scc1 L_gr_67
L_gb_68:
  s_waitcnt lgkmcnt(3)
  v_smfmac_f32_16x16x64_bf16 v[44:47], v[32:35], v[36:43], v7
  s_waitcnt lgkmcnt(1)
  v_smfmac_f32_16x16x64_bf16 v[48:51], v[32:35], v[52:59], v7
  s_add_u32 s98, s32, 2
  s_min_u32 s98, s98, 64
  s_cmp_lt_u32 s61, s98
  s_cbranch_scc1 L_fp_69
L_fp_69b:
  v_smfmac_f32_16x16x64_bf16 v[16:19], v[32:35], a[128:135], v7
  s_waitcnt lgkmcnt(0)
  s_barrier
  ds_read_b128 v[60:63], v0 offset:5120
  ds_read_b128 v[36:39], v0 offset:6144
  ds_read_b128 v[40:43], v0 offset:7168
  v_smfmac_f32_16x16x64_bf16 v[20:23], v[32:35], a[136:143], v7
  v_smfmac_f32_16x16x64_bf16 v[24:27], v[32:35], a[144:151], v7
  s_xor_b32 s42, s42, 0x8000
  v_smfmac_f32_16x16x64_bf16 v[28:31], v[32:35], a[152:159], v7
  ds_read_b128 v[32:35], v0 offset:8192
  s_waitcnt lgkmcnt(3)
  v_smfmac_f32_16x16x64_bf16 v[16:19], v[60:63], a[160:167], v7
  v_smfmac_f32_16x16x64_bf16 v[20:23], v[60:63], a[168:175], v7
  s_waitcnt lgkmcnt(2)
  v_smfmac_f32_16x16x64_bf16 v[16:19], v[36:39], a[192:199], v7
  v_smfmac_f32_16x16x64_bf16 v[20:23], v[36:39], a[200:207], v7
  s_cmp_eq_u32 s90, 0
  s_cbranch_scc1 L_csl_64
L_csb_65:
  ds_read_b128 v[12:15], v0 offset:21504
  ds_read_b128 v[52:55], v0 offset:22528
  s_and_b32 s40, s40, s90
  s_mov_b32 s41, s40
  s_waitcnt lgkmcnt(3)
  v_smfmac_f32_16x16x64_bf16 v[16:19], v[40:43], a[224:231], v7
  v_smfmac_f32_16x16x64_bf16 v[20:23], v[40:43], a[232:239], v7
  s_waitcnt lgkmcnt(2)
  v_smfmac_f32_16x16x64_bf16 v[16:19], v[32:35], v[64:71], v7
  v_smfmac_f32_16x16x64_bf16 v[20:23], v[32:35], v[72:79], v7
  v_smfmac_f32_16x16x64_bf16 v[24:27], v[60:63], a[176:183], v7
  s_waitcnt lgkmcnt(0)
  s_mov_b32 m0, 21504
  s_add_u32 s98, s97, 0
  s_mov_b64 exec, s[40:41]
  buffer_load_dwordx4 v0, s[12:15], s98 offen sc1 lds
  buffer_load_dwordx4 v0, s[12:15], s98 offen offset:1024 sc1 lds
  s_mov_b64 exec, -1
  v_smfmac_f32_16x16x64_bf16 v[28:31], v[60:63], a[184:191], v7
  s_nop 1
  v_permlane32_swap_b32 v16, v20
  v_smfmac_f32_16x16x64_bf16 v[24:27], v[36:39], a[208:215], v7
  v_permlane32_swap_b32 v17, v21
  v_smfmac_f32_16x16x64_bf16 v[28:31], v[36:39], a[216:223], v7
  v_permlane32_swap_b32 v18, v22
  v_smfmac_f32_16x16x64_bf16 v[24:27], v[40:43], a[240:247], v7
  v_permlane32_swap_b32 v19, v23
  v_smfmac_f32_16x16x64_bf16 v[28:31], v[40:43], a[248:255], v7
  v_add_f32 v16, v16, v20
  v_add_f32 v17, v17, v21
  v_add_f32 v18, v18, v22
  v_smfmac_f32_16x16x64_bf16 v[24:27], v[32:35], v[80:87], v7
  v_add_f32 v19, v19, v23
  v_cvt_pk_bf16_f32 v22, v16, v17
  v_cvt_pk_bf16_f32 v23, v18, v19
  v_smfmac_f32_16x16x64_bf16 v[28:31], v[32:35], v[88:95], v7
  s_nop 0
  v_mfma_f32_16x16x16_bf16 v[56:59], v[22:23], v[4:5], 0
  v_smfmac_f32_16x16x64_bf16 v[44:47], v[60:63], v[96:103], v7
  v_smfmac_f32_16x16x64_bf16 v[48:51], v[60:63], v[104:111], v7
  s_nop 3
  v_permlane32_swap_b32 v24, v28
  v_smfmac_f32_16x16x64_bf16 v[44:47], v[36:39], v[112:119], v7
  v_permlane32_swap_b32 v25, v29
  v_smfmac_f32_16x16x64_bf16 v[48:51], v[36:39], v[120:127], v7
  v_permlane32_swap_b32 v26, v30
  v_smfmac_f32_16x16x64_bf16 v[44:47], v[40:43], v[128:135], v7
  v_permlane32_swap_b32 v27, v31
  v_smfmac_f32_16x16x64_bf16 v[48:51], v[40:43], v[136:143], v7
  v_cvt_pk_bf16_f32 v16, v56, v57
  v_cvt_pk_bf16_f32 v17, v58, v59
  v_cvt_pk_bf16_f32 v20, v56, v57
  v_cvt_pk_bf16_f32 v21, v58, v59
  v_add_f32 v24, v24, v28
  v_add_f32 v25, v25, v29
  v_add_f32 v26, v26, v30
  v_smfmac_f32_16x16x64_bf16 v[44:47], v[32:35], v[144:151], v7
  v_add_f32 v27, v27, v31
  v_cvt_pk_bf16_f32 v24, v24, v25
  v_cvt_pk_bf16_f32 v25, v26, v27
  v_smfmac_f32_16x16x64_bf16 v[48:51], v[32:35], v[152:159], v7
  s_cmp_eq_u32 s90, 0
  s_cbranch_scc1 L_vw_70
L_vw_70b:
  v_mov_b32 v18, v16 row_ror:8 row_mask:0xf bank_mask:0xf
  v_mov_b32 v19, v17 row_ror:8 row_mask:0xf bank_mask:0xf
  v_mfma_f32_16x16x16_bf16 v[28:31], v[24:25], v[4:5], 0
  ds_read_b128 v[60:63], v0 offset:29696
  ds_read_b128 v[36:39], v0 offset:30720
  v_mfma_f32_16x16x32_bf16 v[12:15], v[12:15], v[16:19], 0
  v_mfma_f32_16x16x32_bf16 v[52:55], v[52:55], v[18:21], 0
  v_permlane32_swap_b32 v44, v48
  v_permlane32_swap_b32 v45, v49
  s_nop 1
  v_cvt_pk_bf16_f32 v24, v28, v29
  v_cvt_pk_bf16_f32 v25, v30, v31
  s_nop 1
  v_cndmask_b32 v12, v12, v52, s[54:55]
  v_cndmask_b32 v13, v13, v53, s[54:55]
  v_mov_b32 v26, v24 row_ror:8 row_mask:0xf bank_mask:0xf
  v_mov_b32 v27, v25 row_ror:8 row_mask:0xf bank_mask:0xf
  v_cndmask_b32 v14, v14, v54, s[54:55]
  v_cndmask_b32 v15, v15, v55, s[54:55]
  v_mfma_f32_16x16x32_bf16 v[28:31], v[24:27], v[16:19], 0
  ds_write_b128 v0, v[12:15] offset:12288
  v_permlane32_swap_b32 v46, v50
  v_permlane32_swap_b32 v47, v51
  v_add_f32 v44, v44, v48
  v_add_f32 v45, v45, v49
  v_add_f32 v46, v46, v50
  v_add_f32 v47, v47, v51
  v_cvt_pk_bf16_f32 v6, v44, v45
  v_cvt_pk_bf16_f32 v7, v46, v47
  ds_write_b128 v1, v[28:31] offset:14464
  v_mov_b32 v4, v24
  v_mov_b32 v5, v25
  v_bfe_u32 v56, v0, 7, 1
  v_lshrrev_b32 v57, 9, v0
  v_lshl_add_u32 v56, v57, 1, v56
  v_and_b32 v57, 0x170, v1
  v_lshl_add_u32 v56, v56, 2, v57
  v_add_u32 v56, 13312, v56
  v_add_u32 v57, 1024, v56
  s_cmp_eq_u32 s40, 0
  s_cbranch_scc1 L_cb_71
  s_waitcnt lgkmcnt(2)
  s_mov_b32 m0, 29696
  s_add_u32 s98, s46, 788480
  buffer_load_dwordx4 v0, s[12:15], s98 offen sc1 lds
  buffer_load_dwordx4 v0, s[12:15], s98 offen offset:1024 sc1 lds
L_cbb_72:
  s_waitcnt lgkmcnt(0)
  s_barrier
  ds_read_b128 v[52:55], v0 offset:9216
  ds_read_b128 v[16:19], v0 offset:10240
  ds_read_b128 v[20:23], v0 offset:11264
  ds_read2_b32 v[28:29], v56 offset0:0 offset1:32
  ds_read2_b32 v[30:31], v57 offset0:0 offset1:32
  v_mov_b32 v25, 0
  v_mov_b32 v26, 0
  s_mov_b32 s91, s50
  buffer_store_dwordx4 v[4:7], v0, s[12:15], s91 offen sc1
  s_waitcnt lgkmcnt(4)
  v_pk_add_f32 v[12:13], v[12:13], v[52:53]
  v_pk_add_f32 v[14:15], v[14:15], v[54:55]
  s_waitcnt lgkmcnt(3)
  v_pk_add_f32 v[12:13], v[12:13], v[16:17]
  v_pk_add_f32 v[14:15], v[14:15], v[18:19]
  s_waitcnt lgkmcnt(2)
  v_pk_add_f32 v[12:13], v[12:13], v[20:21]
  v_pk_add_f32 v[14:15], v[14:15], v[22:23]
  s_waitcnt lgkmcnt(0)
  v_pk_add_f32 v[28:29], v[28:29], v[30:31]
  v_max3_f32 v30, v12, v13, v14
  v_add_f32 v28, v28, v29
  v_max3_f32 v30, v30, v15, v28
  ds_read_b128 v[32:35], v3 offset:8192
  ds_read_b128 v[56:59], v3 offset:9216
  v_max_f32 v30, v30, v30 row_ror:8 row_mask:0xf bank_mask:0xf
  v_mov_b32 v31, v30
  ds_read_b128 v[40:43], v3 offset:10240
  s_nop 0
  v_permlane16_swap_b32 v30, v31
  v_max_f32 v30, v30, v31
  v_mov_b32 v31, v30
  s_nop 1
  v_permlane32_swap_b32 v30, v31
  v_max_f32 v30, v30, v31
  v_mul_f32 v30, s60, v30
  v_fma_f32 v28, v28, s60, -v30
  v_fma_f32 v12, v12, s60, -v30
  v_fma_f32 v13, v13, s60, -v30
  v_fma_f32 v14, v14, s60, -v30
  v_fma_f32 v15, v15, s60, -v30
  v_exp_f32 v28, v28
  v_exp_f32 v12, v12
  v_exp_f32 v13, v13
  v_exp_f32 v14, v14
  v_exp_f32 v15, v15
  v_mov_b32 v29, v28 row_ror:8 row_mask:0xf bank_mask:0xf
  v_cvt_pk_bf16_f32 v52, v12, v13
  v_cvt_pk_bf16_f32 v53, v14, v15
  v_cvt_pk_bf16_f32 v24, v28, v29
  v_cvt_pk_bf16_f32 v27, v28, v29
  v_mov_b32 v54, v52 row_ror:8 row_mask:0xf bank_mask:0xf
  v_mov_b32 v55, v53 row_ror:8 row_mask:0xf bank_mask:0xf
  v_permlane32_swap_b32 v24, v25
  v_permlane32_swap_b32 v26, v27
  v_mfma_f32_16x16x32_bf16 v[60:63], v[60:63], v[52:55], 0
  v_add_f32 v30, v12, v13
  v_add_f32 v31, v14, v15
  v_mfma_f32_16x16x32_bf16 v[36:39], v[36:39], v[52:55], 0
  v_add_f32 v30, v30, v28
  v_add_f32 v30, v30, v31
  s_barrier
  v_mfma_f32_16x16x16_bf16 v[60:63], v[6:7], v[24:25], v[60:63]
  v_add_f32 v30, v30, v30 row_ror:8 row_mask:0xf bank_mask:0xf
  v_mov_b32 v31, v30
  v_mfma_f32_16x16x16_bf16 v[36:39], v[6:7], v[26:27], v[36:39]
  s_nop 0
  v_permlane16_swap_b32 v30, v31
  v_add_f32 v30, v30, v31
  v_mov_b32 v31, v30
  ds_read_b128 v[12:15], v3 offset:11264
  s_nop 0
  v_permlane32_swap_b32 v30, v31
  v_add_f32 v30, v30, v31
  v_rcp_f32 v30, v30
  s_nop 0
  v_pk_mul_f32 v[60:61], v[60:61], v[30:31] op_sel_hi:[1,0]
  v_pk_mul_f32 v[62:63], v[62:63], v[30:31] op_sel_hi:[1,0]
  v_pk_mul_f32 v[36:37], v[36:37], v[30:31] op_sel_hi:[1,0]
  v_pk_mul_f32 v[38:39], v[38:39], v[30:31] op_sel_hi:[1,0]
  v_cvt_pk_bf16_f32 v60, v60, v61
  v_cvt_pk_bf16_f32 v61, v62, v63
  v_cvt_pk_bf16_f32 v62, v36, v37
  v_cvt_pk_bf16_f32 v63, v38, v39
  ds_write_b128 v1, v[60:63] offset:14464
  s_and_b32 s98, s32, 3
  s_cselect_b32 s98, 3, 64
  s_add_u32 s98, s98, s32
  s_min_u32 s98, s98, 64
  s_cmp_lt_u32 s61, s98
  s_cbranch_scc1 L_fp_73
L_fp_73b:
  s_cmp_eq_u32 s32, 63
  s_cbranch_scc1 L_cfin3
  s_waitcnt lgkmcnt(0)
  s_barrier
  ds_read_b128 v[36:39], v1 offset:13312
  ds_read_b128 v[28:31], v1 offset:13440
  ds_read_b128 v[24:27], v1 offset:14336
  ds_read_b128 v[60:63], v1 offset:14464
  s_waitcnt lgkmcnt(3)
  v_mfma_f32_16x16x32_bf16 v[44:47], v[160:163], v[36:39], 0
  v_mfma_f32_16x16x32_bf16 v[48:51], v[164:167], v[36:39], 0
  v_lshrrev_b32 v5, 5, v0
  v_and_b32 v5, 8, v5
  s_waitcnt lgkmcnt(2)
  v_mfma_f32_16x16x32_bf16 v[44:47], v[32:35], v[28:31], v[44:47]
  v_and_or_b32 v5, v0, s56, v5
  v_mov_b32 v6, -1
  v_mfma_f32_16x16x32_bf16 v[48:51], v[56:59], v[28:31], v[48:51]
  v_mov_b32 v7, -1
  ds_read_b128 v[32:35], v3 offset:12288
  ds_read_b128 v[56:59], v3 offset:13312
  s_waitcnt lgkmcnt(3)
  v_mfma_f32_16x16x32_bf16 v[44:47], v[168:171], v[24:27], v[44:47]
  v_mfma_f32_16x16x32_bf16 v[48:51], v[172:175], v[24:27], v[48:51]
  s_waitcnt lgkmcnt(2)
  v_mfma_f32_16x16x32_bf16 v[44:47], v[40:43], v[60:63], v[44:47]
  v_mfma_f32_16x16x32_bf16 v[48:51], v[12:15], v[60:63], v[48:51]
  ds_read_b128 v[40:43], v3 offset:14336
  ds_read_b128 v[12:15], v3 offset:15360
  v_mfma_f32_16x16x32_bf16 v[20:23], v[240:243], v[36:39], 0
  s_nop 1
  v_mfma_f32_16x16x32_bf16 v[20:23], v[244:247], v[28:31], v[20:23]
  s_nop 0
  v_cvt_pk_bf16_f32 v44, v44, v45
  v_cvt_pk_bf16_f32 v45, v46, v47
  v_mfma_f32_16x16x32_bf16 v[20:23], v[248:251], v[24:27], v[20:23]
  v_cvt_pk_bf16_f32 v46, v48, v49
  v_cvt_pk_bf16_f32 v47, v50, v51
  v_mfma_f32_16x16x32_bf16 v[20:23], v[252:255], v[60:63], v[20:23]
  v_bfi_b32 v44, 1, s45, v44
  v_bfi_b32 v46, 1, s45, v46
  v_mfma_f32_16x16x32_bf16 v[52:55], v[176:179], v[36:39], 0
  s_nop 1
  v_mfma_f32_16x16x32_bf16 v[16:19], v[180:183], v[36:39], 0
  buffer_store_dwordx4 v[44:47], v1, s[12:15], s33 offen offset:1152
  s_waitcnt lgkmcnt(3)
  v_mfma_f32_16x16x32_bf16 v[52:55], v[32:35], v[28:31], v[52:55]
  v_cvt_pk_bf16_f32 v20, v20, v21
  v_cvt_pk_bf16_f32 v21, v22, v23
  s_waitcnt lgkmcnt(2)
  v_mfma_f32_16x16x32_bf16 v[16:19], v[56:59], v[28:31], v[16:19]
  v_bfi_b32 v20, 1, s45, v20
  ds_read_b128 v[32:35], v3 offset:16384
  ds_read_b128 v[56:59], v3 offset:17408
  v_mfma_f32_16x16x32_bf16 v[52:55], v[184:187], v[24:27], v[52:55]
  v_mfma_f32_16x16x32_bf16 v[16:19], v[188:191], v[24:27], v[16:19]
  buffer_store_dwordx2 v[20:21], v1, s[12:15], s33 offen offset:2184
  s_waitcnt lgkmcnt(3)
  v_mfma_f32_16x16x32_bf16 v[52:55], v[40:43], v[60:63], v[52:55]
  s_waitcnt lgkmcnt(2)
  v_mfma_f32_16x16x32_bf16 v[16:19], v[12:15], v[60:63], v[16:19]
  ds_read_b128 v[40:43], v3 offset:18432
  ds_read_b128 v[12:15], v3 offset:19456
  v_mfma_f32_16x16x32_bf16 v[44:47], v[192:195], v[36:39], 0
  s_nop 1
  v_mfma_f32_16x16x32_bf16 v[48:51], v[196:199], v[36:39], 0
  v_cvt_pk_bf16_f32 v52, v52, v53
  v_cvt_pk_bf16_f32 v53, v54, v55
  s_waitcnt lgkmcnt(3)
  v_mfma_f32_16x16x32_bf16 v[44:47], v[32:35], v[28:31], v[44:47]
  v_cvt_pk_bf16_f32 v54, v16, v17
  v_cvt_pk_bf16_f32 v55, v18, v19
  s_waitcnt lgkmcnt(2)
  v_mfma_f32_16x16x32_bf16 v[48:51], v[56:59], v[28:31], v[48:51]
  v_bfi_b32 v52, 1, s45, v52
  v_bfi_b32 v54, 1, s45, v54
  v_mfma_f32_16x16x32_bf16 v[44:47], v[200:203], v[24:27], v[44:47]
  v_mfma_f32_16x16x32_bf16 v[48:51], v[204:207], v[24:27], v[48:51]
  buffer_store_dwordx4 v[52:55], v1, s[12:15], s48 offen offset:128
  s_waitcnt lgkmcnt(1)
  v_mfma_f32_16x16x32_bf16 v[44:47], v[40:43], v[60:63], v[44:47]
  s_waitcnt lgkmcnt(0)
  v_mfma_f32_16x16x32_bf16 v[48:51], v[12:15], v[60:63], v[48:51]
  v_mfma_f32_16x16x32_bf16 v[52:55], v[208:211], v[36:39], 0
  s_nop 1
  v_mfma_f32_16x16x32_bf16 v[16:19], v[212:215], v[36:39], 0
  s_nop 1
  v_cvt_pk_bf16_f32 v44, v44, v45
  v_cvt_pk_bf16_f32 v45, v46, v47
  v_mfma_f32_16x16x32_bf16 v[52:55], v[216:219], v[28:31], v[52:55]
  v_cvt_pk_bf16_f32 v46, v48, v49
  v_cvt_pk_bf16_f32 v47, v50, v51
  v_mfma_f32_16x16x32_bf16 v[16:19], v[220:223], v[28:31], v[16:19]
  v_bfi_b32 v44, 1, s45, v44
  v_bfi_b32 v46, 1, s45, v46
  v_mfma_f32_16x16x32_bf16 v[52:55], v[224:227], v[24:27], v[52:55]
  v_mfma_f32_16x16x32_bf16 v[16:19], v[228:231], v[24:27], v[16:19]
  buffer_store_dwordx4 v[44:47], v1, s[12:15], s48 offen offset:2176
  v_mfma_f32_16x16x32_bf16 v[52:55], v[232:235], v[60:63], v[52:55]
  v_mfma_f32_16x16x32_bf16 v[16:19], v[236:239], v[60:63], v[16:19]
  s_nop 6
  v_cvt_pk_bf16_f32 v52, v52, v53
  v_cvt_pk_bf16_f32 v53, v54, v55
  v_cvt_pk_bf16_f32 v54, v16, v17
  v_cvt_pk_bf16_f32 v55, v18, v19
  v_bfi_b32 v52, 1, s45, v52
  v_bfi_b32 v54, 1, s45, v54
  buffer_store_dwordx4 v[52:55], v1, s[12:15], s49 offen offset:128
  s_cmp_lg_u32 s68, 0
  s_cbranch_scc1 L_nr_74
  s_nop 15
  s_nop 15
  s_nop 15
  s_nop 15
  s_nop 15
  s_nop 9
  buffer_load_dwordx4 v[32:35], v2, s[12:15], s38 offen sc1
  buffer_load_dwordx4 v[56:59], v2, s[12:15], s39 offen sc1
  buffer_load_dwordx4 v[40:43], v2, s[12:15], s34 offen sc1
  buffer_load_dwordx4 v[12:15], v2, s[12:15], s35 offen sc1
L_rc_76:
  s_waitcnt vmcnt(3)
  v_mfma_f32_16x16x32_bf16 v[20:23], v[8:11], v[32:35], 0
  v_bitop3_b32 v36, v32, v34, s45 bitop3:0x7e
  s_waitcnt vmcnt(2)
  v_mfma_f32_16x16x32_bf16 v[20:23], v[8:11], v[56:59], v[20:23]
  v_bitop3_b32 v37, v56, v58, s45 bitop3:0x7e
  s_waitcnt vmcnt(1)
  v_mfma_f32_16x16x32_bf16 v[20:23], v[8:11], v[40:43], v[20:23]
  v_bitop3_b32 v38, v40, v42, s45 bitop3:0x7e
  v_or3_b32 v36, v36, v37, v38
  s_waitcnt vmcnt(0)
  v_mfma_f32_16x16x32_bf16 v[20:23], v[8:11], v[12:15], v[20:23]
  v_bitop3_b32 v39, v12, v14, s45 bitop3:0x7e
  v_or_b32 v36, v36, v39
  v_and_b32 v36, 1, v36
  v_cmp_ne_u32 vcc, 0, v36
  s_nop 0
  s_cbranch_vccnz L_rr_77
  s_mov_b64 exec, s[58:59]
  buffer_store_dwordx2 v[6:7], v5, s[12:15], s44 offen
  s_mov_b64 exec, -1
  v_add_f32 v20, v20, v20 row_ror:8 row_mask:0xf bank_mask:0xf
  v_add_f32 v21, v21, v21 row_ror:8 row_mask:0xf bank_mask:0xf
  v_add_f32 v22, v22, v22 row_ror:8 row_mask:0xf bank_mask:0xf
  v_add_f32 v23, v23, v23 row_ror:8 row_mask:0xf bank_mask:0xf
  v_cvt_pk_bf16_f32 v20, v20, v21
  v_cvt_pk_bf16_f32 v21, v22, v23
  s_mov_b64 exec, s[58:59]
  buffer_store_dwordx2 v[20:21], v5, s[12:15], s43 offen
  s_mov_b64 exec, -1
L_nr_74:
  s_add_u32 s32, s32, 1
  s_xor_b32 s45, s45, 1
  s_add_u32 s50, s50, 131072
  s_xor_b32 s43, s43, 0x8000
  s_xor_b32 s44, s44, 0x8000
  s_add_u32 s46, s46, 786432
  ds_read_b128 v[36:39], v3 offset:20480
  ds_read_b128 v[40:43], v3 offset:22528
  ds_read_b128 v[52:55], v3 offset:21504
  ds_read_b128 v[56:59], v3 offset:23552
  v_lshrrev_b32 v4, 1, v0
  ds_read_b64 v[4:5], v4 offset:32000
  v_mov_b32 v7, 0x4444
  v_mov_b32 v16, 0xeeee
  v_cndmask_b32 v7, v16, v7, s[52:53]
  v_mov_b64 v[16:17], 0
  v_mov_b64 v[18:19], 0
  v_mov_b64 v[20:21], 0
  v_mov_b64 v[22:23], 0
  v_mov_b64 v[24:25], 0
  v_mov_b64 v[26:27], 0
  v_mov_b64 v[28:29], 0
  v_mov_b64 v[30:31], 0
  v_mov_b64 v[44:45], 0
  v_mov_b64 v[46:47], 0
  v_mov_b64 v[48:49], 0
  v_mov_b64 v[50:51], 0
  s_barrier
  ds_read_b128 v[32:35], v0 offset:0
  ds_read_b128 v[60:63], v0 offset:1024
  s_branch L_cloop3
L_gr_67:
  s_sub_u32 s100, s100, 1
  s_cbranch_scc1 L_end
  s_add_u32 s98, s42, 8192
  s_mov_b64 exec, vcc
  buffer_load_dwordx4 v[12:15], v0, s[12:15], s98 offen sc1
  s_waitcnt vmcnt(0)
  ds_write_b128 v0, v[12:15] offset:8192
  v_cmp_eq_u32 vcc, -1, v12
  v_cmp_eq_u32 s[94:95], -1, v14
  s_mov_b64 exec, -1
  s_or_b64 vcc, vcc, s[94:95]
  s_nop 1
  s_cbranch_scc1 L_gr_67
  s_waitcnt lgkmcnt(0)
  s_branch L_gb_68
L_rr_77:
  s_mov_b64 exec, vcc
  buffer_load_dwordx4 v[32:35], v2, s[12:15], s38 offen sc1
  buffer_load_dwordx4 v[56:59], v2, s[12:15], s39 offen sc1
  buffer_load_dwordx4 v[40:43], v2, s[12:15], s34 offen sc1
  buffer_load_dwordx4 v[12:15], v2, s[12:15], s35 offen sc1
  s_mov_b64 exec, -1
  s_waitcnt vmcnt(0)
  s_sub_u32 s100, s100, 1
  s_cbranch_scc0 L_rc_76
  s_branch L_end
L_cfin3:
  s_branch L_cdone
L_vw_70:
  s_waitcnt vmcnt(0)
  s_branch L_vw_70b
L_fp_69:
  s_mov_b32 m0, 31936
  v_lshlrev_b32 v6, 9, v0
  s_mov_b64 exec, 3
  buffer_load_dword v6, s[12:15], s47 offen sc1 lds
  s_mov_b64 exec, -1
  s_branch L_fp_69b
L_fp_73:
  s_mov_b32 m0, 31936
  v_lshlrev_b32 v23, 9, v0
  s_mov_b64 exec, 3
  buffer_load_dword v23, s[12:15], s47 offen sc1 lds
  s_mov_b64 exec, -1
  s_branch L_fp_73b
L_kc_66:
  s_andn2_b32 s92, s40, s90
  s_mov_b32 s93, s92
  s_mov_b32 m0, 21504
  s_add_u32 s98, s97, 0
  s_mov_b64 exec, s[92:93]
  buffer_load_dwordx4 v0, s[12:15], s98 offen sc1 lds
  buffer_load_dwordx4 v0, s[12:15], s98 offen offset:1024 sc1 lds
  s_mov_b64 exec, -1
  s_mov_b32 m0, 29696
  s_add_u32 s98, s97, 2048
  s_mov_b64 exec, s[92:93]
  buffer_load_dwordx4 v0, s[12:15], s98 offen sc1 lds
  buffer_load_dwordx4 v0, s[12:15], s98 offen offset:1024 sc1 lds
  s_mov_b64 exec, -1
  s_branch L_kc_66b
L_csl_64:
  s_cmp_lg_u32 s40, 0
  s_cbranch_scc1 L_csl_64k
  s_add_u32 s99, s32, 1
  s_min_u32 s99, s99, 64
L_csp_78:
  s_mov_b64 exec, 1
  buffer_load_dword v6, off, s[12:15], s47 sc1
  buffer_load_dword v12, off, s[12:15], s101 sc1
  s_mov_b64 exec, -1
  s_waitcnt vmcnt(1)
  v_readfirstlane_b32 s61, v6
  s_waitcnt vmcnt(0)
  v_readfirstlane_b32 s98, v12
  s_nop 0
  s_min_u32 s61, s61, s98
  s_cmp_ge_u32 s61, s99
  s_nop 0
  s_cbranch_scc1 L_csp_78d
  s_sleep 1
  s_sub_u32 s100, s100, 1
  s_cbranch_scc0 L_csp_78
  s_branch L_end
L_csp_78d:
  s_mov_b32 m0, 21504
  s_add_u32 s98, s46, 0
  buffer_load_dwordx4 v0, s[12:15], s98 offen sc1 lds
  buffer_load_dwordx4 v0, s[12:15], s98 offen offset:1024 sc1 lds
  s_mov_b32 m0, 29696
  s_add_u32 s98, s46, 2048
  buffer_load_dwordx4 v0, s[12:15], s98 offen sc1 lds
  buffer_load_dwordx4 v0, s[12:15], s98 offen offset:1024 sc1 lds
L_csl_64k:
  s_waitcnt vmcnt(2)
  s_branch L_csb_65
L_cb_71:
  v_lshrrev_b32 v32, 2, v0
  ds_read_b32 v32, v32 offset:31936
  s_waitcnt lgkmcnt(0)
  v_readlane_b32 s98, v32, 0
  v_readlane_b32 s99, v32, 1
  s_nop 0
  s_min_u32 s98, s98, s99
  s_max_u32 s61, s61, s98
  s_add_u32 s99, s32, 2
  s_min_u32 s99, s99, 64
  s_cmp_ge_u32 s61, s99
  s_cselect_b64 s[40:41], -1, 0
  s_mov_b32 s90, s40
  s_mov_b32 m0, 21504
  s_add_u32 s98, s46, 786432
  s_mov_b64 exec, s[40:41]
  buffer_load_dwordx4 v0, s[12:15], s98 offen sc1 lds
  buffer_load_dwordx4 v0, s[12:15], s98 offen offset:1024 sc1 lds
  s_mov_b64 exec, -1
  s_mov_b32 m0, 29696
  s_add_u32 s98, s46, 788480
  s_mov_b64 exec, s[40:41]
  buffer_load_dwordx4 v0, s[12:15], s98 offen sc1 lds
  buffer_load_dwordx4 v0, s[12:15], s98 offen offset:1024 sc1 lds
  s_mov_b64 exec, -1
  s_branch L_cbb_72
L_cdone:
  s_waitcnt vmcnt(0)
  v_mov_b32 v6, 64
  s_mov_b64 exec, 1
  buffer_store_dword v6, off, s[12:15], s69 sc1
  s_branch L_end
L_qkv:
  s_load_dwordx2 s[16:17], s[0:1], 16
  s_mov_b32 s18, 4718592
  s_mov_b32 s19, 0x20000
  s_waitcnt lgkmcnt(0)
  s_and_b32 s17, s17, 0xffff
  s_load_dwordx2 s[20:21], s[0:1], 24
  s_mov_b32 s22, 4718592
  s_mov_b32 s23, 0x20000
  s_waitcnt lgkmcnt(0)
  s_and_b32 s21, s21, 0xffff
  s_load_dwordx2 s[24:25], s[0:1], 32
  s_mov_b32 s26, 4718592
  s_mov_b32 s27, 0x20000
  s_waitcnt lgkmcnt(0)
  s_and_b32 s25, s25, 0xffff
  v_lshlrev_b32 v0, 4, v63
  v_lshlrev_b32 v1, 2, v63
  v_mov_b32 v2, v0
  v_lshrrev_b32 v60, 5, v63
  v_mul_u32_u24 v3, 18, v60
  v_bfe_u32 v60, v63, 4, 1
  v_add_u32 v3, v3, v60
  v_mul_u32_u24 v3, 1152, v3
  v_mul_u32_u24 v11, 256, v60
  v_and_b32 v60, 15, v63
  v_lshl_add_u32 v11, v60, 2, v11
  v_and_b32 v60, 15, v63
  v_lshl_add_u32 v3, v60, 3, v3
  v_add_u32 v3, 1024, v3
  s_mul_i32 s33, s11, 2654208
  s_mul_i32 s34, s9, 10368
  s_add_u32 s33, s33, s34
  s_add_u32 s33, s33, 8388608
  s_add_u32 s39, s34, 41472
  s_xor_b32 s39, s39, s34
  s_mul_i32 s36, s11, 1024
  s_add_u32 s36, s36, 262144
  s_mov_b32 s40, -1
  s_mov_b32 s41, 0
  s_mov_b32 s42, 41472
  s_lshl_b32 s51, s11, 5
  s_add_u32 s51, s51, s10
  s_mul_i32 s98, s51, 64
  s_add_u32 s98, s98, s9
  s_lshl_b32 s98, s98, 2
  s_add_u32 s50, s98, 282624
  s_mul_i32 s52, s10, 24576
  s_add_u32 s52, s52, 37748736
  s_lshl_b32 s98, s9, 11
  s_add_u32 s53, s52, s98
  s_add_u32 s53, s53, 16384
  s_lshl_b32 s98, s9, 12
  s_add_u32 s52, s52, s98
  s_add_u32 s54, s34, 8388608
  s_mov_b32 s46, s11
  s_add_u32 s47, s11, 64
  s_mov_b32 s36, 262144
  v_lshrrev_b32 v60, 5, v63
  v_mul_u32_u24 v60, 1024, v60
  v_add_u32 v11, v11, v60
  s_cmp_eq_u32 s9, 0
  s_cselect_b64 s[40:41], -1, 0
  s_cselect_b32 s98, 0, 8
  s_add_u32 s98, s98, 101376
  v_mov_b32 v1, s98
  s_mul_i32 s62, s9, 40960
  s_lshl_b32 s90, s10, 8
  s_lshl_b32 s98, s9, 6
  s_add_u32 s90, s90, s98
  s_mul_i32 s98, s9, 4608
  s_add_u32 s98, s98, 82944
  v_add_u32 v10, s98, v0
  v_and_b32 v60, 31, v63
  v_lshl_add_u32 v6, v60, 2, s98
  v_lshrrev_b32 v60, 4, v63
  v_lshl_add_u32 v7, v60, 4, s98
  s_add_u32 s37, s50, 0
  v_mov_b32 v5, s11
  s_mov_b64 exec, 1
  buffer_store_dword v5, off, s[12:15], s37 sc1
  s_mov_b64 exec, -1
  s_add_u32 s37, s50, 128
  v_mov_b32 v5, s11
  s_mov_b64 exec, 1
  buffer_store_dword v5, off, s[12:15], s37 sc1
  s_mov_b64 exec, -1
  s_add_u32 s37, s50, 16384
  v_mov_b32 v5, s11
  s_mov_b64 exec, 1
  buffer_store_dword v5, off, s[12:15], s37 sc1
  s_mov_b64 exec, -1
  s_add_u32 s37, s50, 16512
  v_mov_b32 v5, s11
  s_mov_b64 exec, 1
  buffer_store_dword v5, off, s[12:15], s37 sc1
  s_mov_b64 exec, -1
  s_waitcnt vmcnt(0)
  s_barrier
  s_cmp_lg_u32 s9, 0
  s_cbranch_scc1 L_arr_79
  s_mov_b64 exec, 1
  v_mov_b32 v60, 64
  v_mov_b32 v61, 1
  global_atomic_add v60, v61, s[4:5] sc1
  s_mov_b64 exec, -1
L_arr_79:
  v_lshrrev_b32 v60, 4, v63
  v_lshlrev_b32 v32, 9, v60
  v_bfe_u32 v60, v63, 2, 2
  v_lshl_add_u32 v32, v60, 6, v32
  v_and_b32 v60, 3, v63
  v_lshl_add_u32 v32, v60, 4, v32
  v_add_u32 v32, s62, v32
  v_lshrrev_b32 v60, 2, v63
  v_mul_u32_u24 v33, 8192, v60
  v_and_b32 v60, 3, v63
  v_lshl_add_u32 v33, v60, 4, v33
  s_add_u32 m0, s62, 0
  s_add_u32 s99, s90, 0
  buffer_load_dwordx4 v33, s[20:23], s99 offen  lds
  s_add_u32 m0, s62, 1024
  s_add_u32 s99, s90, 131072
  buffer_load_dwordx4 v33, s[20:23], s99 offen  lds
  s_add_u32 m0, s62, 2048
  s_add_u32 s99, s90, 262144
  buffer_load_dwordx4 v33, s[20:23], s99 offen  lds
  s_add_u32 m0, s62, 3072
  s_add_u32 s99, s90, 393216
  buffer_load_dwordx4 v33, s[20:23], s99 offen  lds
  s_add_u32 m0, s62, 4096
  s_add_u32 s99, s90, 524288
  buffer_load_dwordx4 v33, s[20:23], s99 offen  lds
  s_add_u32 m0, s62, 5120
  s_add_u32 s99, s90, 655360
  buffer_load_dwordx4 v33, s[20:23], s99 offen  lds
  s_add_u32 m0, s62, 6144
  s_add_u32 s99, s90, 786432
  buffer_load_dwordx4 v33, s[20:23], s99 offen  lds
  s_add_u32 m0, s62, 7168
  s_add_u32 s99, s90, 917504
  buffer_load_dwordx4 v33, s[20:23], s99 offen  lds
  s_add_u32 m0, s62, 8192
  s_add_u32 s99, s90, 1048576
  buffer_load_dwordx4 v33, s[20:23], s99 offen  lds
  s_add_u32 m0, s62, 9216
  s_add_u32 s99, s90, 1179648
  buffer_load_dwordx4 v33, s[20:23], s99 offen  lds
  s_add_u32 m0, s62, 10240
  s_add_u32 s99, s90, 1310720
  buffer_load_dwordx4 v33, s[20:23], s99 offen  lds
  s_add_u32 m0, s62, 11264
  s_add_u32 s99, s90, 1441792
  buffer_load_dwordx4 v33, s[20:23], s99 offen  lds
  s_add_u32 m0, s62, 12288
  s_add_u32 s99, s90, 1572864
  buffer_load_dwordx4 v33, s[20:23], s99 offen  lds
  s_add_u32 m0, s62, 13312
  s_add_u32 s99, s90, 1703936
  buffer_load_dwordx4 v33, s[20:23], s99 offen  lds
  s_add_u32 m0, s62, 14336
  s_add_u32 s99, s90, 1835008
  buffer_load_dwordx4 v33, s[20:23], s99 offen  lds
  s_add_u32 m0, s62, 15360
  s_add_u32 s99, s90, 1966080
  buffer_load_dwordx4 v33, s[20:23], s99 offen  lds
  s_add_u32 m0, s62, 16384
  s_add_u32 s99, s90, 2097152
  buffer_load_dwordx4 v33, s[20:23], s99 offen  lds
  s_add_u32 m0, s62, 17408
  s_add_u32 s99, s90, 2228224
  buffer_load_dwordx4 v33, s[20:23], s99 offen  lds
  s_add_u32 m0, s62, 18432
  s_add_u32 s99, s90, 2359296
  buffer_load_dwordx4 v33, s[20:23], s99 offen  lds
  s_add_u32 m0, s62, 19456
  s_add_u32 s99, s90, 2490368
  buffer_load_dwordx4 v33, s[20:23], s99 offen  lds
  s_add_u32 m0, s62, 20480
  s_add_u32 s99, s90, 2621440
  buffer_load_dwordx4 v33, s[20:23], s99 offen  lds
  s_add_u32 m0, s62, 21504
  s_add_u32 s99, s90, 2752512
  buffer_load_dwordx4 v33, s[20:23], s99 offen  lds
  s_add_u32 m0, s62, 22528
  s_add_u32 s99, s90, 2883584
  buffer_load_dwordx4 v33, s[20:23], s99 offen  lds
  s_add_u32 m0, s62, 23552
  s_add_u32 s99, s90, 3014656
  buffer_load_dwordx4 v33, s[20:23], s99 offen  lds
  s_add_u32 m0, s62, 24576
  s_add_u32 s99, s90, 3145728
  buffer_load_dwordx4 v33, s[20:23], s99 offen  lds
  s_add_u32 m0, s62, 25600
  s_add_u32 s99, s90, 3276800
  buffer_load_dwordx4 v33, s[20:23], s99 offen  lds
  s_add_u32 m0, s62, 26624
  s_add_u32 s99, s90, 3407872
  buffer_load_dwordx4 v33, s[20:23], s99 offen  lds
  s_add_u32 m0, s62, 27648
  s_add_u32 s99, s90, 3538944
  buffer_load_dwordx4 v33, s[20:23], s99 offen  lds
  s_add_u32 m0, s62, 28672
  s_add_u32 s99, s90, 3670016
  buffer_load_dwordx4 v33, s[20:23], s99 offen  lds
  s_add_u32 m0, s62, 29696
  s_add_u32 s99, s90, 3801088
  buffer_load_dwordx4 v33, s[20:23], s99 offen  lds
  s_add_u32 m0, s62, 30720
  s_add_u32 s99, s90, 3932160
  buffer_load_dwordx4 v33, s[20:23], s99 offen  lds
  s_add_u32 m0, s62, 31744
  s_add_u32 s99, s90, 4063232
  buffer_load_dwordx4 v33, s[20:23], s99 offen  lds
  s_add_u32 m0, s62, 32768
  s_add_u32 s99, s90, 4194304
  buffer_load_dwordx4 v33, s[20:23], s99 offen  lds
  s_add_u32 m0, s62, 33792
  s_add_u32 s99, s90, 4325376
  buffer_load_dwordx4 v33, s[20:23], s99 offen  lds
  s_add_u32 m0, s62, 34816
  s_add_u32 s99, s90, 4456448
  buffer_load_dwordx4 v33, s[20:23], s99 offen  lds
  s_add_u32 m0, s62, 35840
  s_add_u32 s99, s90, 4587520
  buffer_load_dwordx4 v33, s[20:23], s99 offen  lds
  s_add_u32 m0, s62, 36864
  s_add_u32 s99, s90, 0
  buffer_load_dwordx4 v33, s[24:27], s99 offen  lds
  s_add_u32 m0, s62, 37888
  s_add_u32 s99, s90, 131072
  buffer_load_dwordx4 v33, s[24:27], s99 offen  lds
  s_waitcnt vmcnt(36)
  ds_read_b64_tr_b16 a[0:1], v32 offset:0
  ds_read_b64_tr_b16 a[2:3], v32 offset:256
  ds_read_b64_tr_b16 a[4:5], v32 offset:8
  ds_read_b64_tr_b16 a[6:7], v32 offset:264
  s_add_u32 m0, s62, 38912
  s_add_u32 s99, s90, 262144
  buffer_load_dwordx4 v33, s[24:27], s99 offen  lds
  s_add_u32 m0, s62, 39936
  s_add_u32 s99, s90, 393216
  buffer_load_dwordx4 v33, s[24:27], s99 offen  lds
  s_waitcnt vmcnt(36)
  ds_read_b64_tr_b16 a[8:9], v32 offset:2048
  ds_read_b64_tr_b16 a[10:11], v32 offset:2304
  ds_read_b64_tr_b16 a[12:13], v32 offset:2056
  ds_read_b64_tr_b16 a[14:15], v32 offset:2312
  s_waitcnt lgkmcnt(4)
  s_add_u32 m0, s62, 0
  s_add_u32 s99, s90, 524288
  buffer_load_dwordx4 v33, s[24:27], s99 offen  lds
  s_add_u32 m0, s62, 1024
  s_add_u32 s99, s90, 655360
  buffer_load_dwordx4 v33, s[24:27], s99 offen  lds
  s_waitcnt vmcnt(36)
  ds_read_b64_tr_b16 a[16:17], v32 offset:4096
  ds_read_b64_tr_b16 a[18:19], v32 offset:4352
  ds_read_b64_tr_b16 a[20:21], v32 offset:4104
  ds_read_b64_tr_b16 a[22:23], v32 offset:4360
  s_waitcnt lgkmcnt(4)
  s_add_u32 m0, s62, 2048
  s_add_u32 s99, s90, 786432
  buffer_load_dwordx4 v33, s[24:27], s99 offen  lds
  s_add_u32 m0, s62, 3072
  s_add_u32 s99, s90, 917504
  buffer_load_dwordx4 v33, s[24:27], s99 offen  lds
  s_waitcnt vmcnt(36)
  ds_read_b64_tr_b16 a[24:25], v32 offset:6144
  ds_read_b64_tr_b16 a[26:27], v32 offset:6400
  ds_read_b64_tr_b16 a[28:29], v32 offset:6152
  ds_read_b64_tr_b16 a[30:31], v32 offset:6408
  s_waitcnt lgkmcnt(4)
  s_add_u32 m0, s62, 4096
  s_add_u32 s99, s90, 1048576
  buffer_load_dwordx4 v33, s[24:27], s99 offen  lds
  s_add_u32 m0, s62, 5120
  s_add_u32 s99, s90, 1179648
  buffer_load_dwordx4 v33, s[24:27], s99 offen  lds
  s_waitcnt vmcnt(36)
  ds_read_b64_tr_b16 a[32:33], v32 offset:8192
  ds_read_b64_tr_b16 a[34:35], v32 offset:8448
  ds_read_b64_tr_b16 a[36:37], v32 offset:8200
  ds_read_b64_tr_b16 a[38:39], v32 offset:8456
  s_waitcnt lgkmcnt(4)
  s_add_u32 m0, s62, 6144
  s_add_u32 s99, s90, 1310720
  buffer_load_dwordx4 v33, s[24:27], s99 offen  lds
  s_add_u32 m0, s62, 7168
  s_add_u32 s99, s90, 1441792
  buffer_load_dwordx4 v33, s[24:27], s99 offen  lds
  s_waitcnt vmcnt(36)
  ds_read_b64_tr_b16 a[40:41], v32 offset:10240
  ds_read_b64_tr_b16 a[42:43], v32 offset:10496
  ds_read_b64_tr_b16 a[44:45], v32 offset:10248
  ds_read_b64_tr_b16 a[46:47], v32 offset:10504
  s_waitcnt lgkmcnt(4)
  s_add_u32 m0, s62, 8192
  s_add_u32 s99, s90, 1572864
  buffer_load_dwordx4 v33, s[24:27], s99 offen  lds
  s_add_u32 m0, s62, 9216
  s_add_u32 s99, s90, 1703936
  buffer_load_dwordx4 v33, s[24:27], s99 offen  lds
  s_waitcnt vmcnt(36)
  ds_read_b64_tr_b16 a[48:49], v32 offset:12288
  ds_read_b64_tr_b16 a[50:51], v32 offset:12544
  ds_read_b64_tr_b16 a[52:53], v32 offset:12296
  ds_read_b64_tr_b16 a[54:55], v32 offset:12552
  s_waitcnt lgkmcnt(4)
  s_add_u32 m0, s62, 10240
  s_add_u32 s99, s90, 1835008
  buffer_load_dwordx4 v33, s[24:27], s99 offen  lds
  s_add_u32 m0, s62, 11264
  s_add_u32 s99, s90, 1966080
  buffer_load_dwordx4 v33, s[24:27], s99 offen  lds
  s_waitcnt vmcnt(36)
  ds_read_b64_tr_b16 a[56:57], v32 offset:14336
  ds_read_b64_tr_b16 a[58:59], v32 offset:14592
  ds_read_b64_tr_b16 a[60:61], v32 offset:14344
  ds_read_b64_tr_b16 a[62:63], v32 offset:14600
  s_waitcnt lgkmcnt(4)
  s_add_u32 m0, s62, 12288
  s_add_u32 s99, s90, 2097152
  buffer_load_dwordx4 v33, s[24:27], s99 offen  lds
  s_add_u32 m0, s62, 13312
  s_add_u32 s99, s90, 2228224
  buffer_load_dwordx4 v33, s[24:27], s99 offen  lds
  s_waitcnt vmcnt(36)
  ds_read_b64_tr_b16 a[64:65], v32 offset:16384
  ds_read_b64_tr_b16 a[66:67], v32 offset:16640
  ds_read_b64_tr_b16 a[68:69], v32 offset:16392
  ds_read_b64_tr_b16 a[70:71], v32 offset:16648
  s_waitcnt lgkmcnt(4)
  s_add_u32 m0, s62, 14336
  s_add_u32 s99, s90, 2359296
  buffer_load_dwordx4 v33, s[24:27], s99 offen  lds
  s_add_u32 m0, s62, 15360
  s_add_u32 s99, s90, 2490368
  buffer_load_dwordx4 v33, s[24:27], s99 offen  lds
  s_waitcnt vmcnt(36)
  ds_read_b64_tr_b16 a[72:73], v32 offset:18432
  ds_read_b64_tr_b16 a[74:75], v32 offset:18688
  ds_read_b64_tr_b16 a[76:77], v32 offset:18440
  ds_read_b64_tr_b16 a[78:79], v32 offset:18696
  s_waitcnt lgkmcnt(4)
  s_add_u32 m0, s62, 16384
  s_add_u32 s99, s90, 2621440
  buffer_load_dwordx4 v33, s[24:27], s99 offen  lds
  s_add_u32 m0, s62, 17408
  s_add_u32 s99, s90, 2752512
  buffer_load_dwordx4 v33, s[24:27], s99 offen  lds
  s_waitcnt vmcnt(36)
  ds_read_b64_tr_b16 a[80:81], v32 offset:20480
  ds_read_b64_tr_b16 a[82:83], v32 offset:20736
  ds_read_b64_tr_b16 a[84:85], v32 offset:20488
  ds_read_b64_tr_b16 a[86:87], v32 offset:20744
  s_waitcnt lgkmcnt(4)
  s_add_u32 m0, s62, 18432
  s_add_u32 s99, s90, 2883584
  buffer_load_dwordx4 v33, s[24:27], s99 offen  lds
  s_add_u32 m0, s62, 19456
  s_add_u32 s99, s90, 3014656
  buffer_load_dwordx4 v33, s[24:27], s99 offen  lds
  s_waitcnt vmcnt(36)
  ds_read_b64_tr_b16 a[88:89], v32 offset:22528
  ds_read_b64_tr_b16 a[90:91], v32 offset:22784
  ds_read_b64_tr_b16 a[92:93], v32 offset:22536
  ds_read_b64_tr_b16 a[94:95], v32 offset:22792
  s_waitcnt lgkmcnt(4)
  s_add_u32 m0, s62, 20480
  s_add_u32 s99, s90, 3145728
  buffer_load_dwordx4 v33, s[24:27], s99 offen  lds
  s_add_u32 m0, s62, 21504
  s_add_u32 s99, s90, 3276800
  buffer_load_dwordx4 v33, s[24:27], s99 offen  lds
  s_waitcnt vmcnt(36)
  ds_read_b64_tr_b16 a[96:97], v32 offset:24576
  ds_read_b64_tr_b16 a[98:99], v32 offset:24832
  ds_read_b64_tr_b16 a[100:101], v32 offset:24584
  ds_read_b64_tr_b16 a[102:103], v32 offset:24840
  s_waitcnt lgkmcnt(4)
  s_add_u32 m0, s62, 22528
  s_add_u32 s99, s90, 3407872
  buffer_load_dwordx4 v33, s[24:27], s99 offen  lds
  s_add_u32 m0, s62, 23552
  s_add_u32 s99, s90, 3538944
  buffer_load_dwordx4 v33, s[24:27], s99 offen  lds
  s_waitcnt vmcnt(36)
  ds_read_b64_tr_b16 a[104:105], v32 offset:26624
  ds_read_b64_tr_b16 a[106:107], v32 offset:26880
  ds_read_b64_tr_b16 a[108:109], v32 offset:26632
  ds_read_b64_tr_b16 a[110:111], v32 offset:26888
  s_waitcnt lgkmcnt(4)
  s_add_u32 m0, s62, 24576
  s_add_u32 s99, s90, 3670016
  buffer_load_dwordx4 v33, s[24:27], s99 offen  lds
  s_add_u32 m0, s62, 25600
  s_add_u32 s99, s90, 3801088
  buffer_load_dwordx4 v33, s[24:27], s99 offen  lds
  s_waitcnt vmcnt(36)
  ds_read_b64_tr_b16 a[112:113], v32 offset:28672
  ds_read_b64_tr_b16 a[114:115], v32 offset:28928
  ds_read_b64_tr_b16 a[116:117], v32 offset:28680
  ds_read_b64_tr_b16 a[118:119], v32 offset:28936
  s_waitcnt lgkmcnt(4)
  s_add_u32 m0, s62, 26624
  s_add_u32 s99, s90, 3932160
  buffer_load_dwordx4 v33, s[24:27], s99 offen  lds
  s_add_u32 m0, s62, 27648
  s_add_u32 s99, s90, 4063232
  buffer_load_dwordx4 v33, s[24:27], s99 offen  lds
  s_waitcnt vmcnt(36)
  ds_read_b64_tr_b16 a[120:121], v32 offset:30720
  ds_read_b64_tr_b16 a[122:123], v32 offset:30976
  ds_read_b64_tr_b16 a[124:125], v32 offset:30728
  ds_read_b64_tr_b16 a[126:127], v32 offset:30984
  s_waitcnt lgkmcnt(4)
  s_add_u32 m0, s62, 28672
  s_add_u32 s99, s90, 4194304
  buffer_load_dwordx4 v33, s[24:27], s99 offen  lds
  s_add_u32 m0, s62, 29696
  s_add_u32 s99, s90, 4325376
  buffer_load_dwordx4 v33, s[24:27], s99 offen  lds
  s_waitcnt vmcnt(36)
  ds_read_b64_tr_b16 a[128:129], v32 offset:32768
  ds_read_b64_tr_b16 a[130:131], v32 offset:33024
  ds_read_b64_tr_b16 a[132:133], v32 offset:32776
  ds_read_b64_tr_b16 a[134:135], v32 offset:33032
  s_waitcnt lgkmcnt(4)
  s_add_u32 m0, s62, 30720
  s_add_u32 s99, s90, 4456448
  buffer_load_dwordx4 v33, s[24:27], s99 offen  lds
  s_add_u32 m0, s62, 31744
  s_add_u32 s99, s90, 4587520
  buffer_load_dwordx4 v33, s[24:27], s99 offen  lds
  s_waitcnt vmcnt(36)
  ds_read_b64_tr_b16 a[136:137], v32 offset:34816
  ds_read_b64_tr_b16 a[138:139], v32 offset:35072
  ds_read_b64_tr_b16 a[140:141], v32 offset:34824
  ds_read_b64_tr_b16 a[142:143], v32 offset:35080
  s_waitcnt lgkmcnt(4)
  s_add_u32 m0, s62, 32768
  s_add_u32 s99, s90, 0
  buffer_load_dwordx4 v33, s[16:19], s99 offen  lds
  s_add_u32 m0, s62, 33792
  s_add_u32 s99, s90, 131072
  buffer_load_dwordx4 v33, s[16:19], s99 offen  lds
  s_waitcnt vmcnt(36)
  ds_read_b64_tr_b16 a[144:145], v32 offset:36864
  ds_read_b64_tr_b16 a[146:147], v32 offset:37120
  ds_read_b64_tr_b16 a[148:149], v32 offset:36872
  ds_read_b64_tr_b16 a[150:151], v32 offset:37128
  s_waitcnt lgkmcnt(4)
  s_add_u32 m0, s62, 34816
  s_add_u32 s99, s90, 262144
  buffer_load_dwordx4 v33, s[16:19], s99 offen  lds
  s_add_u32 m0, s62, 35840
  s_add_u32 s99, s90, 393216
  buffer_load_dwordx4 v33, s[16:19], s99 offen  lds
  s_waitcnt vmcnt(36)
  ds_read_b64_tr_b16 a[152:153], v32 offset:38912
  ds_read_b64_tr_b16 a[154:155], v32 offset:39168
  ds_read_b64_tr_b16 a[156:157], v32 offset:38920
  ds_read_b64_tr_b16 a[158:159], v32 offset:39176
  s_waitcnt lgkmcnt(4)
  s_add_u32 m0, s62, 36864
  s_add_u32 s99, s90, 524288
  buffer_load_dwordx4 v33, s[16:19], s99 offen  lds
  s_add_u32 m0, s62, 37888
  s_add_u32 s99, s90, 655360
  buffer_load_dwordx4 v33, s[16:19], s99 offen  lds
  s_waitcnt vmcnt(36)
  ds_read_b64_tr_b16 a[160:161], v32 offset:0
  ds_read_b64_tr_b16 a[162:163], v32 offset:256
  ds_read_b64_tr_b16 a[164:165], v32 offset:8
  ds_read_b64_tr_b16 a[166:167], v32 offset:264
  s_waitcnt lgkmcnt(4)
  s_add_u32 m0, s62, 38912
  s_add_u32 s99, s90, 786432
  buffer_load_dwordx4 v33, s[16:19], s99 offen  lds
  s_add_u32 m0, s62, 39936
  s_add_u32 s99, s90, 917504
  buffer_load_dwordx4 v33, s[16:19], s99 offen  lds
  s_waitcnt vmcnt(36)
  ds_read_b64_tr_b16 a[168:169], v32 offset:2048
  ds_read_b64_tr_b16 a[170:171], v32 offset:2304
  ds_read_b64_tr_b16 a[172:173], v32 offset:2056
  ds_read_b64_tr_b16 a[174:175], v32 offset:2312
  s_waitcnt lgkmcnt(4)
  s_add_u32 m0, s62, 0
  s_add_u32 s99, s90, 1048576
  buffer_load_dwordx4 v33, s[16:19], s99 offen  lds
  s_add_u32 m0, s62, 1024
  s_add_u32 s99, s90, 1179648
  buffer_load_dwordx4 v33, s[16:19], s99 offen  lds
  s_waitcnt vmcnt(36)
  ds_read_b64_tr_b16 a[176:177], v32 offset:4096
  ds_read_b64_tr_b16 a[178:179], v32 offset:4352
  ds_read_b64_tr_b16 a[180:181], v32 offset:4104
  ds_read_b64_tr_b16 a[182:183], v32 offset:4360
  s_waitcnt lgkmcnt(4)
  s_add_u32 m0, s62, 2048
  s_add_u32 s99, s90, 1310720
  buffer_load_dwordx4 v33, s[16:19], s99 offen  lds
  s_add_u32 m0, s62, 3072
  s_add_u32 s99, s90, 1441792
  buffer_load_dwordx4 v33, s[16:19], s99 offen  lds
  s_waitcnt vmcnt(36)
  ds_read_b64_tr_b16 a[184:185], v32 offset:6144
  ds_read_b64_tr_b16 a[186:187], v32 offset:6400
  ds_read_b64_tr_b16 a[188:189], v32 offset:6152
  ds_read_b64_tr_b16 a[190:191], v32 offset:6408
  s_waitcnt lgkmcnt(4)
  s_add_u32 m0, s62, 4096
  s_add_u32 s99, s90, 1572864
  buffer_load_dwordx4 v33, s[16:19], s99 offen  lds
  s_add_u32 m0, s62, 5120
  s_add_u32 s99, s90, 1703936
  buffer_load_dwordx4 v33, s[16:19], s99 offen  lds
  s_waitcnt vmcnt(36)
  ds_read_b64_tr_b16 a[192:193], v32 offset:8192
  ds_read_b64_tr_b16 a[194:195], v32 offset:8448
  ds_read_b64_tr_b16 a[196:197], v32 offset:8200
  ds_read_b64_tr_b16 a[198:199], v32 offset:8456
  s_waitcnt lgkmcnt(4)
  s_add_u32 m0, s62, 6144
  s_add_u32 s99, s90, 1835008
  buffer_load_dwordx4 v33, s[16:19], s99 offen  lds
  s_add_u32 m0, s62, 7168
  s_add_u32 s99, s90, 1966080
  buffer_load_dwordx4 v33, s[16:19], s99 offen  lds
  s_waitcnt vmcnt(36)
  ds_read_b64_tr_b16 a[200:201], v32 offset:10240
  ds_read_b64_tr_b16 a[202:203], v32 offset:10496
  ds_read_b64_tr_b16 a[204:205], v32 offset:10248
  ds_read_b64_tr_b16 a[206:207], v32 offset:10504
  s_waitcnt lgkmcnt(4)
  s_add_u32 m0, s62, 8192
  s_add_u32 s99, s90, 2097152
  buffer_load_dwordx4 v33, s[16:19], s99 offen  lds
  s_add_u32 m0, s62, 9216
  s_add_u32 s99, s90, 2228224
  buffer_load_dwordx4 v33, s[16:19], s99 offen  lds
  s_waitcnt vmcnt(36)
  ds_read_b64_tr_b16 a[208:209], v32 offset:12288
  ds_read_b64_tr_b16 a[210:211], v32 offset:12544
  ds_read_b64_tr_b16 a[212:213], v32 offset:12296
  ds_read_b64_tr_b16 a[214:215], v32 offset:12552
  s_waitcnt lgkmcnt(4)
  s_add_u32 m0, s62, 10240
  s_add_u32 s99, s90, 2359296
  buffer_load_dwordx4 v33, s[16:19], s99 offen  lds
  s_add_u32 m0, s62, 11264
  s_add_u32 s99, s90, 2490368
  buffer_load_dwordx4 v33, s[16:19], s99 offen  lds
  s_waitcnt vmcnt(36)
  ds_read_b64_tr_b16 a[216:217], v32 offset:14336
  ds_read_b64_tr_b16 a[218:219], v32 offset:14592
  ds_read_b64_tr_b16 a[220:221], v32 offset:14344
  ds_read_b64_tr_b16 a[222:223], v32 offset:14600
  s_waitcnt lgkmcnt(4)
  s_add_u32 m0, s62, 12288
  s_add_u32 s99, s90, 2621440
  buffer_load_dwordx4 v33, s[16:19], s99 offen  lds
  s_add_u32 m0, s62, 13312
  s_add_u32 s99, s90, 2752512
  buffer_load_dwordx4 v33, s[16:19], s99 offen  lds
  s_waitcnt vmcnt(36)
  ds_read_b64_tr_b16 a[224:225], v32 offset:16384
  ds_read_b64_tr_b16 a[226:227], v32 offset:16640
  ds_read_b64_tr_b16 a[228:229], v32 offset:16392
  ds_read_b64_tr_b16 a[230:231], v32 offset:16648
  s_waitcnt lgkmcnt(4)
  s_add_u32 m0, s62, 14336
  s_add_u32 s99, s90, 2883584
  buffer_load_dwordx4 v33, s[16:19], s99 offen  lds
  s_add_u32 m0, s62, 15360
  s_add_u32 s99, s90, 3014656
  buffer_load_dwordx4 v33, s[16:19], s99 offen  lds
  s_waitcnt vmcnt(36)
  ds_read_b64_tr_b16 a[232:233], v32 offset:18432
  ds_read_b64_tr_b16 a[234:235], v32 offset:18688
  ds_read_b64_tr_b16 a[236:237], v32 offset:18440
  ds_read_b64_tr_b16 a[238:239], v32 offset:18696
  s_waitcnt lgkmcnt(4)
  s_add_u32 m0, s62, 16384
  s_add_u32 s99, s90, 3145728
  buffer_load_dwordx4 v33, s[16:19], s99 offen  lds
  s_add_u32 m0, s62, 17408
  s_add_u32 s99, s90, 3276800
  buffer_load_dwordx4 v33, s[16:19], s99 offen  lds
  s_waitcnt vmcnt(36)
  ds_read_b64_tr_b16 a[240:241], v32 offset:20480
  ds_read_b64_tr_b16 a[242:243], v32 offset:20736
  ds_read_b64_tr_b16 a[244:245], v32 offset:20488
  ds_read_b64_tr_b16 a[246:247], v32 offset:20744
  s_waitcnt lgkmcnt(4)
  s_add_u32 m0, s62, 18432
  s_add_u32 s99, s90, 3407872
  buffer_load_dwordx4 v33, s[16:19], s99 offen  lds
  s_add_u32 m0, s62, 19456
  s_add_u32 s99, s90, 3538944
  buffer_load_dwordx4 v33, s[16:19], s99 offen  lds
  s_waitcnt vmcnt(36)
  ds_read_b64_tr_b16 a[248:249], v32 offset:22528
  ds_read_b64_tr_b16 a[250:251], v32 offset:22784
  ds_read_b64_tr_b16 a[252:253], v32 offset:22536
  ds_read_b64_tr_b16 a[254:255], v32 offset:22792
  s_waitcnt lgkmcnt(4)
  s_add_u32 m0, s62, 20480
  s_add_u32 s99, s90, 3670016
  buffer_load_dwordx4 v33, s[16:19], s99 offen  lds
  s_add_u32 m0, s62, 21504
  s_add_u32 s99, s90, 3801088
  buffer_load_dwordx4 v33, s[16:19], s99 offen  lds
  s_waitcnt vmcnt(36)
  ds_read_b64_tr_b16 v[80:81], v32 offset:24576
  ds_read_b64_tr_b16 v[82:83], v32 offset:24832
  ds_read_b64_tr_b16 v[84:85], v32 offset:24584
  ds_read_b64_tr_b16 v[86:87], v32 offset:24840
  s_waitcnt lgkmcnt(4)
  s_add_u32 m0, s62, 22528
  s_add_u32 s99, s90, 3932160
  buffer_load_dwordx4 v33, s[16:19], s99 offen  lds
  s_add_u32 m0, s62, 23552
  s_add_u32 s99, s90, 4063232
  buffer_load_dwordx4 v33, s[16:19], s99 offen  lds
  s_waitcnt vmcnt(36)
  ds_read_b64_tr_b16 v[88:89], v32 offset:26624
  ds_read_b64_tr_b16 v[90:91], v32 offset:26880
  ds_read_b64_tr_b16 v[92:93], v32 offset:26632
  ds_read_b64_tr_b16 v[94:95], v32 offset:26888
  s_waitcnt lgkmcnt(4)
  s_add_u32 m0, s62, 24576
  s_add_u32 s99, s90, 4194304
  buffer_load_dwordx4 v33, s[16:19], s99 offen  lds
  s_add_u32 m0, s62, 25600
  s_add_u32 s99, s90, 4325376
  buffer_load_dwordx4 v33, s[16:19], s99 offen  lds
  s_waitcnt vmcnt(36)
  ds_read_b64_tr_b16 v[96:97], v32 offset:28672
  ds_read_b64_tr_b16 v[98:99], v32 offset:28928
  ds_read_b64_tr_b16 v[100:101], v32 offset:28680
  ds_read_b64_tr_b16 v[102:103], v32 offset:28936
  s_waitcnt lgkmcnt(4)
  s_add_u32 m0, s62, 26624
  s_add_u32 s99, s90, 4456448
  buffer_load_dwordx4 v33, s[16:19], s99 offen  lds
  s_add_u32 m0, s62, 27648
  s_add_u32 s99, s90, 4587520
  buffer_load_dwordx4 v33, s[16:19], s99 offen  lds
  s_waitcnt vmcnt(36)
  ds_read_b64_tr_b16 v[104:105], v32 offset:30720
  ds_read_b64_tr_b16 v[106:107], v32 offset:30976
  ds_read_b64_tr_b16 v[108:109], v32 offset:30728
  ds_read_b64_tr_b16 v[110:111], v32 offset:30984
  s_waitcnt vmcnt(34)
  ds_read_b64_tr_b16 v[112:113], v32 offset:32768
  ds_read_b64_tr_b16 v[114:115], v32 offset:33024
  ds_read_b64_tr_b16 v[116:117], v32 offset:32776
  ds_read_b64_tr_b16 v[118:119], v32 offset:33032
  s_waitcnt vmcnt(32)
  ds_read_b64_tr_b16 v[120:121], v32 offset:34816
  ds_read_b64_tr_b16 v[122:123], v32 offset:35072
  ds_read_b64_tr_b16 v[124:125], v32 offset:34824
  ds_read_b64_tr_b16 v[126:127], v32 offset:35080
  s_waitcnt vmcnt(30)
  ds_read_b64_tr_b16 v[128:129], v32 offset:36864
  ds_read_b64_tr_b16 v[130:131], v32 offset:37120
  ds_read_b64_tr_b16 v[132:133], v32 offset:36872
  ds_read_b64_tr_b16 v[134:135], v32 offset:37128
  s_waitcnt vmcnt(28)
  ds_read_b64_tr_b16 v[136:137], v32 offset:38912
  ds_read_b64_tr_b16 v[138:139], v32 offset:39168
  ds_read_b64_tr_b16 v[140:141], v32 offset:38920
  ds_read_b64_tr_b16 v[142:143], v32 offset:39176
  s_waitcnt vmcnt(26)
  ds_read_b64_tr_b16 v[144:145], v32 offset:0
  ds_read_b64_tr_b16 v[146:147], v32 offset:256
  ds_read_b64_tr_b16 v[148:149], v32 offset:8
  ds_read_b64_tr_b16 v[150:151], v32 offset:264
  s_waitcnt vmcnt(24)
  ds_read_b64_tr_b16 v[152:153], v32 offset:2048
  ds_read_b64_tr_b16 v[154:155], v32 offset:2304
  ds_read_b64_tr_b16 v[156:157], v32 offset:2056
  ds_read_b64_tr_b16 v[158:159], v32 offset:2312
  s_waitcnt vmcnt(22)
  ds_read_b64_tr_b16 v[160:161], v32 offset:4096
  ds_read_b64_tr_b16 v[162:163], v32 offset:4352
  ds_read_b64_tr_b16 v[164:165], v32 offset:4104
  ds_read_b64_tr_b16 v[166:167], v32 offset:4360
  s_waitcnt vmcnt(20)
  ds_read_b64_tr_b16 v[168:169], v32 offset:6144
  ds_read_b64_tr_b16 v[170:171], v32 offset:6400
  ds_read_b64_tr_b16 v[172:173], v32 offset:6152
  ds_read_b64_tr_b16 v[174:175], v32 offset:6408
  s_waitcnt vmcnt(18)
  ds_read_b64_tr_b16 v[176:177], v32 offset:8192
  ds_read_b64_tr_b16 v[178:179], v32 offset:8448
  ds_read_b64_tr_b16 v[180:181], v32 offset:8200
  ds_read_b64_tr_b16 v[182:183], v32 offset:8456
  s_waitcnt vmcnt(16)
  ds_read_b64_tr_b16 v[184:185], v32 offset:10240
  ds_read_b64_tr_b16 v[186:187], v32 offset:10496
  ds_read_b64_tr_b16 v[188:189], v32 offset:10248
  ds_read_b64_tr_b16 v[190:191], v32 offset:10504
  s_waitcnt vmcnt(14)
  ds_read_b64_tr_b16 v[192:193], v32 offset:12288
  ds_read_b64_tr_b16 v[194:195], v32 offset:12544
  ds_read_b64_tr_b16 v[196:197], v32 offset:12296
  ds_read_b64_tr_b16 v[198:199], v32 offset:12552
  s_waitcnt vmcnt(12)
  ds_read_b64_tr_b16 v[200:201], v32 offset:14336
  ds_read_b64_tr_b16 v[202:203], v32 offset:14592
  ds_read_b64_tr_b16 v[204:205], v32 offset:14344
  ds_read_b64_tr_b16 v[206:207], v32 offset:14600
  s_waitcnt vmcnt(10)
  ds_read_b64_tr_b16 v[208:209], v32 offset:16384
  ds_read_b64_tr_b16 v[210:211], v32 offset:16640
  ds_read_b64_tr_b16 v[212:213], v32 offset:16392
  ds_read_b64_tr_b16 v[214:215], v32 offset:16648
  s_waitcnt vmcnt(8)
  ds_read_b64_tr_b16 v[216:217], v32 offset:18432
  ds_read_b64_tr_b16 v[218:219], v32 offset:18688
  ds_read_b64_tr_b16 v[220:221], v32 offset:18440
  ds_read_b64_tr_b16 v[222:223], v32 offset:18696
  s_waitcnt vmcnt(6)
  ds_read_b64_tr_b16 v[224:225], v32 offset:20480
  ds_read_b64_tr_b16 v[226:227], v32 offset:20736
  ds_read_b64_tr_b16 v[228:229], v32 offset:20488
  ds_read_b64_tr_b16 v[230:231], v32 offset:20744
  s_waitcnt vmcnt(4)
  ds_read_b64_tr_b16 v[232:233], v32 offset:22528
  ds_read_b64_tr_b16 v[234:235], v32 offset:22784
  ds_read_b64_tr_b16 v[236:237], v32 offset:22536
  ds_read_b64_tr_b16 v[238:239], v32 offset:22792
  s_waitcnt vmcnt(2)
  ds_read_b64_tr_b16 v[240:241], v32 offset:24576
  ds_read_b64_tr_b16 v[242:243], v32 offset:24832
  ds_read_b64_tr_b16 v[244:245], v32 offset:24584
  ds_read_b64_tr_b16 v[246:247], v32 offset:24840
  s_waitcnt vmcnt(0)
  ds_read_b64_tr_b16 v[248:249], v32 offset:26624
  ds_read_b64_tr_b16 v[250:251], v32 offset:26880
  ds_read_b64_tr_b16 v[252:253], v32 offset:26632
  ds_read_b64_tr_b16 v[254:255], v32 offset:26888
  s_or_b32 s98, s11, s9
  s_cbranch_scc1 L_gs_80
  s_mov_b64 exec, 1
  v_mov_b32 v60, 128
  v_mov_b32 v61, 1
  global_atomic_add v60, v61, s[4:5] sc1
  s_mov_b64 exec, -1
L_gs_80:
  s_waitcnt lgkmcnt(0)
  s_barrier
  v_mov_b32 v36, 0x3f803f80
  v_mov_b32 v37, 0x3f803f80
  v_mov_b32 v38, 0x3f803f80
  v_mov_b32 v39, 0x3f803f80
  s_nop 1
  v_mfma_f32_16x16x32_bf16 v[48:51], a[0:3], v[36:39], 0
  v_mfma_f32_16x16x32_bf16 v[52:55], a[4:7], v[36:39], 0
  v_mfma_f32_16x16x32_bf16 v[56:59], v[112:115], v[36:39], 0
  v_mfma_f32_16x16x32_bf16 v[60:63], v[116:119], v[36:39], 0
  v_mfma_f32_16x16x32_bf16 v[64:67], v[36:39], a[144:147], 0
  v_mfma_f32_16x16x32_bf16 v[68:71], v[36:39], a[148:151], 0
  v_mfma_f32_16x16x32_bf16 v[48:51], a[8:11], v[36:39], v[48:51]
  v_mfma_f32_16x16x32_bf16 v[52:55], a[12:15], v[36:39], v[52:55]
  v_mfma_f32_16x16x32_bf16 v[56:59], v[120:123], v[36:39], v[56:59]
  v_mfma_f32_16x16x32_bf16 v[60:63], v[124:127], v[36:39], v[60:63]
  v_mfma_f32_16x16x32_bf16 v[64:67], v[36:39], a[152:155], v[64:67]
  v_mfma_f32_16x16x32_bf16 v[68:71], v[36:39], a[156:159], v[68:71]
  v_mfma_f32_16x16x32_bf16 v[48:51], a[16:19], v[36:39], v[48:51]
  v_mfma_f32_16x16x32_bf16 v[52:55], a[20:23], v[36:39], v[52:55]
  v_mfma_f32_16x16x32_bf16 v[56:59], v[128:131], v[36:39], v[56:59]
  v_mfma_f32_16x16x32_bf16 v[60:63], v[132:135], v[36:39], v[60:63]
  v_mfma_f32_16x16x32_bf16 v[64:67], v[36:39], a[160:163], v[64:67]
  v_mfma_f32_16x16x32_bf16 v[68:71], v[36:39], a[164:167], v[68:71]
  v_mfma_f32_16x16x32_bf16 v[48:51], a[24:27], v[36:39], v[48:51]
  v_mfma_f32_16x16x32_bf16 v[52:55], a[28:31], v[36:39], v[52:55]
  v_mfma_f32_16x16x32_bf16 v[56:59], v[136:139], v[36:39], v[56:59]
  v_mfma_f32_16x16x32_bf16 v[60:63], v[140:143], v[36:39], v[60:63]
  v_mfma_f32_16x16x32_bf16 v[64:67], v[36:39], a[168:171], v[64:67]
  v_mfma_f32_16x16x32_bf16 v[68:71], v[36:39], a[172:175], v[68:71]
  v_mfma_f32_16x16x32_bf16 v[48:51], a[32:35], v[36:39], v[48:51]
  v_mfma_f32_16x16x32_bf16 v[52:55], a[36:39], v[36:39], v[52:55]
  v_mfma_f32_16x16x32_bf16 v[56:59], v[144:147], v[36:39], v[56:59]
  v_mfma_f32_16x16x32_bf16 v[60:63], v[148:151], v[36:39], v[60:63]
  v_mfma_f32_16x16x32_bf16 v[64:67], v[36:39], a[176:179], v[64:67]
  v_mfma_f32_16x16x32_bf16 v[68:71], v[36:39], a[180:183], v[68:71]
  v_mfma_f32_16x16x32_bf16 v[48:51], a[40:43], v[36:39], v[48:51]
  v_mfma_f32_16x16x32_bf16 v[52:55], a[44:47], v[36:39], v[52:55]
  v_mfma_f32_16x16x32_bf16 v[56:59], v[152:155], v[36:39], v[56:59]
  v_mfma_f32_16x16x32_bf16 v[60:63], v[156:159], v[36:39], v[60:63]
  v_mfma_f32_16x16x32_bf16 v[64:67], v[36:39], a[184:187], v[64:67]
  v_mfma_f32_16x16x32_bf16 v[68:71], v[36:39], a[188:191], v[68:71]
  v_mfma_f32_16x16x32_bf16 v[48:51], a[48:51], v[36:39], v[48:51]
  v_mfma_f32_16x16x32_bf16 v[52:55], a[52:55], v[36:39], v[52:55]
  v_mfma_f32_16x16x32_bf16 v[56:59], v[160:163], v[36:39], v[56:59]
  v_mfma_f32_16x16x32_bf16 v[60:63], v[164:167], v[36:39], v[60:63]
  v_mfma_f32_16x16x32_bf16 v[64:67], v[36:39], a[192:195], v[64:67]
  v_mfma_f32_16x16x32_bf16 v[68:71], v[36:39], a[196:199], v[68:71]
  v_mfma_f32_16x16x32_bf16 v[48:51], a[56:59], v[36:39], v[48:51]
  v_mfma_f32_16x16x32_bf16 v[52:55], a[60:63], v[36:39], v[52:55]
  v_mfma_f32_16x16x32_bf16 v[56:59], v[168:171], v[36:39], v[56:59]
  v_mfma_f32_16x16x32_bf16 v[60:63], v[172:175], v[36:39], v[60:63]
  v_mfma_f32_16x16x32_bf16 v[64:67], v[36:39], a[200:203], v[64:67]
  v_mfma_f32_16x16x32_bf16 v[68:71], v[36:39], a[204:207], v[68:71]
  v_mfma_f32_16x16x32_bf16 v[48:51], a[64:67], v[36:39], v[48:51]
  v_mfma_f32_16x16x32_bf16 v[52:55], a[68:71], v[36:39], v[52:55]
  v_mfma_f32_16x16x32_bf16 v[56:59], v[176:179], v[36:39], v[56:59]
  v_mfma_f32_16x16x32_bf16 v[60:63], v[180:183], v[36:39], v[60:63]
  v_mfma_f32_16x16x32_bf16 v[64:67], v[36:39], a[208:211], v[64:67]
  v_mfma_f32_16x16x32_bf16 v[68:71], v[36:39], a[212:215], v[68:71]
  v_mfma_f32_16x16x32_bf16 v[48:51], a[72:75], v[36:39], v[48:51]
  v_mfma_f32_16x16x32_bf16 v[52:55], a[76:79], v[36:39], v[52:55]
  v_mfma_f32_16x16x32_bf16 v[56:59], v[184:187], v[36:39], v[56:59]
  v_mfma_f32_16x16x32_bf16 v[60:63], v[188:191], v[36:39], v[60:63]
  v_mfma_f32_16x16x32_bf16 v[64:67], v[36:39], a[216:219], v[64:67]
  v_mfma_f32_16x16x32_bf16 v[68:71], v[36:39], a[220:223], v[68:71]
  v_mfma_f32_16x16x32_bf16 v[48:51], a[80:83], v[36:39], v[48:51]
  v_mfma_f32_16x16x32_bf16 v[52:55], a[84:87], v[36:39], v[52:55]
  v_mfma_f32_16x16x32_bf16 v[56:59], v[192:195], v[36:39], v[56:59]
  v_mfma_f32_16x16x32_bf16 v[60:63], v[196:199], v[36:39], v[60:63]
  v_mfma_f32_16x16x32_bf16 v[64:67], v[36:39], a[224:227], v[64:67]
  v_mfma_f32_16x16x32_bf16 v[68:71], v[36:39], a[228:231], v[68:71]
  v_mfma_f32_16x16x32_bf16 v[48:51], a[88:91], v[36:39], v[48:51]
  v_mfma_f32_16x16x32_bf16 v[52:55], a[92:95], v[36:39], v[52:55]
  v_mfma_f32_16x16x32_bf16 v[56:59], v[200:203], v[36:39], v[56:59]
  v_mfma_f32_16x16x32_bf16 v[60:63], v[204:207], v[36:39], v[60:63]
  v_mfma_f32_16x16x32_bf16 v[64:67], v[36:39], a[232:235], v[64:67]
  v_mfma_f32_16x16x32_bf16 v[68:71], v[36:39], a[236:239], v[68:71]
  v_mfma_f32_16x16x32_bf16 v[48:51], a[96:99], v[36:39], v[48:51]
  v_mfma_f32_16x16x32_bf16 v[52:55], a[100:103], v[36:39], v[52:55]
  v_mfma_f32_16x16x32_bf16 v[56:59], v[208:211], v[36:39], v[56:59]
  v_mfma_f32_16x16x32_bf16 v[60:63], v[212:215], v[36:39], v[60:63]
  v_mfma_f32_16x16x32_bf16 v[64:67], v[36:39], a[240:243], v[64:67]
  v_mfma_f32_16x16x32_bf16 v[68:71], v[36:39], a[244:247], v[68:71]
  v_mfma_f32_16x16x32_bf16 v[48:51], a[104:107], v[36:39], v[48:51]
  v_mfma_f32_16x16x32_bf16 v[52:55], a[108:111], v[36:39], v[52:55]
  v_mfma_f32_16x16x32_bf16 v[56:59], v[216:219], v[36:39], v[56:59]
  v_mfma_f32_16x16x32_bf16 v[60:63], v[220:223], v[36:39], v[60:63]
  v_mfma_f32_16x16x32_bf16 v[64:67], v[36:39], a[248:251], v[64:67]
  v_mfma_f32_16x16x32_bf16 v[68:71], v[36:39], a[252:255], v[68:71]
  v_mfma_f32_16x16x32_bf16 v[48:51], a[112:115], v[36:39], v[48:51]
  v_mfma_f32_16x16x32_bf16 v[52:55], a[116:119], v[36:39], v[52:55]
  v_mfma_f32_16x16x32_bf16 v[56:59], v[224:227], v[36:39], v[56:59]
  v_mfma_f32_16x16x32_bf16 v[60:63], v[228:231], v[36:39], v[60:63]
  v_mfma_f32_16x16x32_bf16 v[64:67], v[36:39], v[80:83], v[64:67]
  v_mfma_f32_16x16x32_bf16 v[68:71], v[36:39], v[84:87], v[68:71]
  v_mfma_f32_16x16x32_bf16 v[48:51], a[120:123], v[36:39], v[48:51]
  v_mfma_f32_16x16x32_bf16 v[52:55], a[124:127], v[36:39], v[52:55]
  v_mfma_f32_16x16x32_bf16 v[56:59], v[232:235], v[36:39], v[56:59]
  v_mfma_f32_16x16x32_bf16 v[60:63], v[236:239], v[36:39], v[60:63]
  v_mfma_f32_16x16x32_bf16 v[64:67], v[36:39], v[88:91], v[64:67]
  v_mfma_f32_16x16x32_bf16 v[68:71], v[36:39], v[92:95], v[68:71]
  v_mfma_f32_16x16x32_bf16 v[48:51], a[128:131], v[36:39], v[48:51]
  v_mfma_f32_16x16x32_bf16 v[52:55], a[132:135], v[36:39], v[52:55]
  v_mfma_f32_16x16x32_bf16 v[56:59], v[240:243], v[36:39], v[56:59]
  v_mfma_f32_16x16x32_bf16 v[60:63], v[244:247], v[36:39], v[60:63]
  v_mfma_f32_16x16x32_bf16 v[64:67], v[36:39], v[96:99], v[64:67]
  v_mfma_f32_16x16x32_bf16 v[68:71], v[36:39], v[100:103], v[68:71]
  v_mfma_f32_16x16x32_bf16 v[48:51], a[136:139], v[36:39], v[48:51]
  v_mfma_f32_16x16x32_bf16 v[52:55], a[140:143], v[36:39], v[52:55]
  v_mfma_f32_16x16x32_bf16 v[56:59], v[248:251], v[36:39], v[56:59]
  v_mfma_f32_16x16x32_bf16 v[60:63], v[252:255], v[36:39], v[60:63]
  v_mfma_f32_16x16x32_bf16 v[64:67], v[36:39], v[104:107], v[64:67]
  v_mfma_f32_16x16x32_bf16 v[68:71], v[36:39], v[108:111], v[68:71]
  s_nop 2
  ds_write_b128 v10, v[48:51] offset:256
  ds_write_b128 v10, v[52:55] offset:1280
  ds_write_b128 v10, v[56:59] offset:2304
  ds_write_b128 v10, v[60:63] offset:3328
  v_mov_b32 v8, v64
  v_mov_b32 v9, v68
  v_mov_b32 v60, 64
  s_mov_b64 exec, 1
L_wa_81:
  global_load_dword v61, v60, s[4:5] sc1
  s_waitcnt vmcnt(0)
  v_readfirstlane_b32 s98, v61
  s_nop 0
  s_cmp_ge_u32 s98, 256
  s_nop 1
  s_cbranch_scc1 L_wa_81d
  s_sleep 8
  s_sub_u32 s100, s100, 1
  s_cbranch_scc0 L_wa_81
  s_branch L_end
L_wa_81d:
  s_mov_b64 exec, -1
  s_mov_b32 s28, s12
  s_mov_b32 s29, s13
  s_mov_b32 s30, 0
  s_mov_b32 s31, 0x20000
  s_mov_b32 s32, 0
  s_add_u32 s55, s50, 128
  s_mov_b32 s56, s11
  v_mov_b32 v4, 0
  s_mov_b64 exec, s[40:41]
  buffer_load_dword v4, v11, s[12:15], s36 offen sc1
  s_mov_b64 exec, -1
L_ql_82:
  s_add_u32 s98, s46, 1
  s_waitcnt vmcnt(0)
  v_cmp_gt_u32 vcc, s98, v4
  s_cmp_lt_u32 s46, 64
  s_cselect_b32 s48, s46, -1
  s_cmp_eq_u32 vcc_lo, 0
  s_cselect_b32 s48, s48, -1
  s_sub_u32 s98, s47, 63
  v_cmp_gt_u32 vcc, s98, v4
  s_cmp_lt_u32 s47, 128
  s_cselect_b32 s99, s47, s48
  s_cmp_eq_u32 vcc_hi, 0
  s_cselect_b32 s48, s99, s48
  v_mov_b32 v4, s48
  ds_write_b32 v1, v4
  s_waitcnt lgkmcnt(0)
  s_barrier
  v_mov_b32 v4, 101376
  ds_read_b32 v4, v4
  s_waitcnt lgkmcnt(0)
  v_readfirstlane_b32 s48, v4
  s_nop 0
  s_cmp_lg_u32 s48, -1
  s_cselect_b32 s35, 1, 0
  s_cselect_b32 s44, -1, 0
  s_and_b32 s30, s44, s14
  s_mul_i32 s33, s48, 41472
  s_add_u32 s33, s33, s54
  s_add_u32 s98, s48, 2
  s_add_u32 s98, s48, 2
  s_cmp_eq_u32 s48, s46
  s_cselect_b32 s46, s98, s46
  s_cmp_eq_u32 s48, s47
  s_cselect_b32 s47, s98, s47
  s_barrier
  s_cmp_lg_u32 s35, 0
  s_cbranch_scc1 L_ql_82d
  s_sleep 2
  s_mov_b64 exec, s[40:41]
  buffer_load_dword v4, v11, s[12:15], s36 offen sc1
  s_mov_b64 exec, -1
  s_sub_u32 s100, s100, 1
  s_cbranch_scc0 L_ql_82
  s_branch L_end
L_ql_82d:
  s_add_u32 m0, s34, 0
  s_add_u32 s98, s33, 0
  buffer_load_dwordx4 v0, s[12:15], s98 offen offset:0 sc1 lds
  buffer_load_dwordx4 v0, s[12:15], s98 offen offset:1024 sc1 lds
  buffer_load_dwordx4 v0, s[12:15], s98 offen offset:2048 sc1 lds
  buffer_load_dwordx4 v0, s[12:15], s98 offen offset:3072 sc1 lds
  s_add_u32 m0, s34, 4096
  s_add_u32 s98, s33, 4096
  buffer_load_dwordx4 v0, s[12:15], s98 offen offset:0 sc1 lds
  buffer_load_dwordx4 v0, s[12:15], s98 offen offset:1024 sc1 lds
  buffer_load_dwordx4 v0, s[12:15], s98 offen offset:2048 sc1 lds
  buffer_load_dwordx4 v0, s[12:15], s98 offen offset:3072 sc1 lds
  s_add_u32 m0, s34, 8192
  s_add_u32 s98, s33, 8192
  buffer_load_dwordx4 v0, s[12:15], s98 offen offset:0 sc1 lds
  buffer_load_dwordx4 v0, s[12:15], s98 offen offset:1024 sc1 lds
  s_mov_b64 exec, 0xff
  buffer_load_dwordx4 v0, s[12:15], s98 offen offset:2048 sc1 lds
  s_mov_b64 exec, -1
  s_add_u32 s33, s33, 41472
  s_xor_b32 s34, s34, s39
  s_mov_b32 s35, 1
  s_mul_i32 s98, s48, 786432
  s_add_u32 s38, s52, s98
  s_add_u32 s43, s53, s98
  s_lshr_b32 s98, s48, 6
  s_mul_i32 s98, s98, 16384
  s_add_u32 s37, s50, s98
  s_and_b32 s49, s48, 63
  s_add_u32 s49, s49, 2
  s_waitcnt vmcnt(0)
L_qkv_loop:
  s_barrier
  ds_read_b128 v[32:35], v2 offset:0
  ds_read_b128 v[36:39], v2 offset:2304
  ds_read_b128 v[40:43], v2 offset:4608
  ds_read_b128 v[44:47], v2 offset:6912
  ds_read_b64 v[16:17], v3 offset:0
  ds_read_b64 v[18:19], v3 offset:2304
  ds_read_b64 v[20:21], v3 offset:4608
  s_waitcnt lgkmcnt(6)
  v_mfma_f32_16x16x32_bf16 v[48:51], a[0:3], v[32:35], 0
  v_mfma_f32_16x16x32_bf16 v[52:55], a[4:7], v[32:35], 0
  v_mfma_f32_16x16x32_bf16 v[56:59], v[32:35], a[144:147], 0
  v_mfma_f32_16x16x32_bf16 v[60:63], v[32:35], a[148:151], 0
  ds_read_b128 v[32:35], v2 offset:9216
  s_waitcnt lgkmcnt(2)
  v_add_f32 v22, v16, v18
  v_add_f32 v23, v17, v19
  v_mfma_f32_16x16x32_bf16 v[48:51], a[8:11], v[36:39], v[48:51]
  s_waitcnt lgkmcnt(1)
  v_add_f32 v22, v22, v20
  v_add_f32 v23, v23, v21
  v_mfma_f32_16x16x32_bf16 v[52:55], a[12:15], v[36:39], v[52:55]
  ds_read_b64 v[16:17], v3 offset:6912
  ds_read_b64 v[18:19], v3 offset:9216
  v_mfma_f32_16x16x32_bf16 v[56:59], v[36:39], a[152:155], v[56:59]
  ds_read_b64 v[20:21], v3 offset:11520
  v_mfma_f32_16x16x32_bf16 v[60:63], v[36:39], a[156:159], v[60:63]
  ds_read_b128 v[36:39], v2 offset:11520
  v_mfma_f32_16x16x32_bf16 v[48:51], a[16:19], v[40:43], v[48:51]
  v_mfma_f32_16x16x32_bf16 v[52:55], a[20:23], v[40:43], v[52:55]
  v_mfma_f32_16x16x32_bf16 v[56:59], v[40:43], a[160:163], v[56:59]
  s_waitcnt lgkmcnt(3)
  v_add_f32 v22, v22, v16
  v_add_f32 v23, v23, v17
  v_mfma_f32_16x16x32_bf16 v[60:63], v[40:43], a[164:167], v[60:63]
  s_waitcnt lgkmcnt(2)
  v_add_f32 v22, v22, v18
  v_add_f32 v23, v23, v19
  v_mfma_f32_16x16x32_bf16 v[48:51], a[24:27], v[44:47], v[48:51]
  ds_read_b128 v[40:43], v2 offset:13824
  s_waitcnt lgkmcnt(2)
  v_add_f32 v22, v22, v20
  v_add_f32 v23, v23, v21
  v_mfma_f32_16x16x32_bf16 v[52:55], a[28:31], v[44:47], v[52:55]
  ds_read_b64 v[16:17], v3 offset:13824
  ds_read_b64 v[18:19], v3 offset:16128
  v_mfma_f32_16x16x32_bf16 v[56:59], v[44:47], a[168:171], v[56:59]
  v_mfma_f32_16x16x32_bf16 v[60:63], v[44:47], a[172:175], v[60:63]
  ds_read_b128 v[44:47], v2 offset:16128
  v_mfma_f32_16x16x32_bf16 v[48:51], a[32:35], v[32:35], v[48:51]
  v_mfma_f32_16x16x32_bf16 v[52:55], a[36:39], v[32:35], v[52:55]
  v_mfma_f32_16x16x32_bf16 v[56:59], v[32:35], a[176:179], v[56:59]
  s_waitcnt lgkmcnt(2)
  v_add_f32 v22, v22, v16
  v_add_f32 v23, v23, v17
  v_mfma_f32_16x16x32_bf16 v[60:63], v[32:35], a[180:183], v[60:63]
  s_waitcnt lgkmcnt(1)
  v_add_f32 v22, v22, v18
  v_add_f32 v23, v23, v19
  v_mfma_f32_16x16x32_bf16 v[48:51], a[40:43], v[36:39], v[48:51]
  v_mov_b32 v16, v22
  v_mov_b32 v17, v23
  v_mfma_f32_16x16x32_bf16 v[52:55], a[44:47], v[36:39], v[52:55]
  ds_read_b128 v[32:35], v2 offset:18432
  v_permlane32_swap_b32 v22, v16
  v_mfma_f32_16x16x32_bf16 v[56:59], v[36:39], a[184:187], v[56:59]
  v_permlane32_swap_b32 v23, v17
  v_mfma_f32_16x16x32_bf16 v[60:63], v[36:39], a[188:191], v[60:63]
  v_add_f32 v22, v22, v16
  v_add_f32 v23, v23, v17
  v_mfma_f32_16x16x32_bf16 v[48:51], a[48:51], v[40:43], v[48:51]
  v_mul_f32 v22, 0x3ae38e39, v22
  v_mul_f32 v23, 0x3ae38e39, v23
  v_mfma_f32_16x16x32_bf16 v[52:55], a[52:55], v[40:43], v[52:55]
  ds_read_b128 v[36:39], v2 offset:20736
  v_fma_f32 v23, -v22, v22, v23
  v_max_f32 v23, 0, v23
  v_mfma_f32_16x16x32_bf16 v[56:59], v[40:43], a[192:195], v[56:59]
  v_add_f32 v23, 0x3727c5ac, v23
  v_mfma_f32_16x16x32_bf16 v[60:63], v[40:43], a[196:199], v[60:63]
  v_rsq_f32 v23, v23
  s_waitcnt lgkmcnt(2)
  v_mfma_f32_16x16x32_bf16 v[48:51], a[56:59], v[44:47], v[48:51]
  v_mov_b32 v12, v22
  v_mov_b32 v14, v22
  v_mfma_f32_16x16x32_bf16 v[52:55], a[60:63], v[44:47], v[52:55]
  ds_read_b128 v[40:43], v2 offset:23040
  v_mov_b32 v13, v23
  v_mov_b32 v15, v23
  v_mfma_f32_16x16x32_bf16 v[56:59], v[44:47], a[200:203], v[56:59]
  v_permlane16_swap_b32 v12, v14
  v_mfma_f32_16x16x32_bf16 v[60:63], v[44:47], a[204:207], v[60:63]
  v_permlane16_swap_b32 v13, v15
  s_waitcnt lgkmcnt(2)
  v_mfma_f32_16x16x32_bf16 v[48:51], a[64:67], v[32:35], v[48:51]
  s_mov_b32 exec_hi, 0
  ds_write_b32 v6, v22
  ds_write_b32 v6, v23 offset:128
  s_mov_b32 exec_hi, -1
  v_mfma_f32_16x16x32_bf16 v[52:55], a[68:71], v[32:35], v[52:55]
  ds_read_b128 v[44:47], v2 offset:25344
  v_mfma_f32_16x16x32_bf16 v[56:59], v[32:35], a[208:211], v[56:59]
  s_waitcnt vmcnt(0)
  v_mov_b32 v5, s56
  v_mfma_f32_16x16x32_bf16 v[60:63], v[32:35], a[212:215], v[60:63]
  s_mov_b64 exec, 1
  buffer_store_dword v5, off, s[12:15], s55 sc1
  s_mov_b64 exec, -1
  s_waitcnt lgkmcnt(4)
  v_mfma_f32_16x16x32_bf16 v[48:51], a[72:75], v[36:39], v[48:51]
  ds_read_b128 v[32:35], v2 offset:27648
  v_mfma_f32_16x16x32_bf16 v[52:55], a[76:79], v[36:39], v[52:55]
  v_mfma_f32_16x16x32_bf16 v[56:59], v[36:39], a[216:219], v[56:59]
  v_mfma_f32_16x16x32_bf16 v[60:63], v[36:39], a[220:223], v[60:63]
  ds_read_b128 v[36:39], v2 offset:29952
  s_waitcnt lgkmcnt(5)
  v_mfma_f32_16x16x32_bf16 v[48:51], a[80:83], v[40:43], v[48:51]
  v_mfma_f32_16x16x32_bf16 v[52:55], a[84:87], v[40:43], v[52:55]
  v_mfma_f32_16x16x32_bf16 v[56:59], v[40:43], a[224:227], v[56:59]
  v_mfma_f32_16x16x32_bf16 v[60:63], v[40:43], a[228:231], v[60:63]
  ds_read_b128 v[40:43], v2 offset:32256
  s_waitcnt lgkmcnt(3)
  v_mfma_f32_16x16x32_bf16 v[48:51], a[88:91], v[44:47], v[48:51]
  v_mfma_f32_16x16x32_bf16 v[52:55], a[92:95], v[44:47], v[52:55]
  s_mov_b64 exec, s[40:41]
  buffer_load_dword v4, v11, s[12:15], s36 offen sc1
  s_mov_b64 exec, -1
  v_mfma_f32_16x16x32_bf16 v[56:59], v[44:47], a[232:235], v[56:59]
  v_mfma_f32_16x16x32_bf16 v[60:63], v[44:47], a[236:239], v[60:63]
  ds_read_b128 v[44:47], v2 offset:34560
  s_waitcnt lgkmcnt(3)
  v_mfma_f32_16x16x32_bf16 v[48:51], a[96:99], v[32:35], v[48:51]
  v_mfma_f32_16x16x32_bf16 v[52:55], a[100:103], v[32:35], v[52:55]
  v_mfma_f32_16x16x32_bf16 v[56:59], v[32:35], a[240:243], v[56:59]
  v_mfma_f32_16x16x32_bf16 v[60:63], v[32:35], a[244:247], v[60:63]
  ds_read_b128 v[32:35], v2 offset:36864
  s_waitcnt lgkmcnt(3)
  v_mfma_f32_16x16x32_bf16 v[48:51], a[104:107], v[36:39], v[48:51]
  v_mfma_f32_16x16x32_bf16 v[52:55], a[108:111], v[36:39], v[52:55]
  v_mfma_f32_16x16x32_bf16 v[56:59], v[36:39], a[248:251], v[56:59]
  v_mfma_f32_16x16x32_bf16 v[60:63], v[36:39], a[252:255], v[60:63]
  ds_read_b128 v[36:39], v2 offset:39168
  s_waitcnt lgkmcnt(3)
  v_mfma_f32_16x16x32_bf16 v[48:51], a[112:115], v[40:43], v[48:51]
  v_mfma_f32_16x16x32_bf16 v[52:55], a[116:119], v[40:43], v[52:55]
  v_mfma_f32_16x16x32_bf16 v[56:59], v[40:43], v[80:83], v[56:59]
  v_mfma_f32_16x16x32_bf16 v[60:63], v[40:43], v[84:87], v[60:63]
  ds_read_b128 v[40:43], v2 offset:1152
  s_waitcnt lgkmcnt(3)
  v_mfma_f32_16x16x32_bf16 v[48:51], a[120:123], v[44:47], v[48:51]
  v_mfma_f32_16x16x32_bf16 v[52:55], a[124:127], v[44:47], v[52:55]
  v_mfma_f32_16x16x32_bf16 v[56:59], v[44:47], v[88:91], v[56:59]
  v_mfma_f32_16x16x32_bf16 v[60:63], v[44:47], v[92:95], v[60:63]
  ds_read_b128 v[44:47], v2 offset:3456
  s_waitcnt lgkmcnt(3)
  v_mfma_f32_16x16x32_bf16 v[48:51], a[128:131], v[32:35], v[48:51]
  v_mfma_f32_16x16x32_bf16 v[52:55], a[132:135], v[32:35], v[52:55]
  v_mfma_f32_16x16x32_bf16 v[56:59], v[32:35], v[96:99], v[56:59]
  v_mfma_f32_16x16x32_bf16 v[60:63], v[32:35], v[100:103], v[60:63]
  ds_read_b128 v[32:35], v2 offset:5760
  s_waitcnt lgkmcnt(3)
  v_mfma_f32_16x16x32_bf16 v[48:51], a[136:139], v[36:39], v[48:51]
  v_mfma_f32_16x16x32_bf16 v[52:55], a[140:143], v[36:39], v[52:55]
  v_mfma_f32_16x16x32_bf16 v[56:59], v[36:39], v[104:107], v[56:59]
  v_mfma_f32_16x16x32_bf16 v[60:63], v[36:39], v[108:111], v[60:63]
  ds_read_b128 v[36:39], v2 offset:8064
  ds_read_b128 v[16:19], v10 offset:256
  s_waitcnt lgkmcnt(4)
  v_mfma_f32_16x16x32_bf16 v[64:67], a[0:3], v[40:43], 0
  ds_read_b128 v[20:23], v10 offset:1280
  v_mfma_f32_16x16x32_bf16 v[68:71], a[4:7], v[40:43], 0
  v_mfma_f32_16x16x32_bf16 v[72:75], v[40:43], a[144:147], 0
  v_mfma_f32_16x16x32_bf16 v[76:79], v[40:43], a[148:151], 0
  ds_read_b128 v[40:43], v2 offset:10368
  s_waitcnt lgkmcnt(5)
  v_mfma_f32_16x16x32_bf16 v[64:67], a[8:11], v[44:47], v[64:67]
  s_waitcnt lgkmcnt(2)
  v_fma_f32 v48, -v12, v16, v48
  v_fma_f32 v49, -v12, v17, v49
  v_mfma_f32_16x16x32_bf16 v[68:71], a[12:15], v[44:47], v[68:71]
  v_fma_f32 v50, -v12, v18, v50
  v_fma_f32 v51, -v12, v19, v51
  v_mfma_f32_16x16x32_bf16 v[72:75], v[44:47], a[152:155], v[72:75]
  s_waitcnt lgkmcnt(1)
  v_fma_f32 v52, -v12, v20, v52
  v_fma_f32 v53, -v12, v21, v53
  v_mfma_f32_16x16x32_bf16 v[76:79], v[44:47], a[156:159], v[76:79]
  v_fma_f32 v54, -v12, v22, v54
  v_fma_f32 v55, -v12, v23, v55
  v_mfma_f32_16x16x32_bf16 v[64:67], a[16:19], v[32:35], v[64:67]
  ds_read_b128 v[44:47], v2 offset:12672
  v_mul_f32 v48, v13, v48
  v_mul_f32 v49, v13, v49
  v_mfma_f32_16x16x32_bf16 v[68:71], a[20:23], v[32:35], v[68:71]
  v_mul_f32 v50, v13, v50
  v_mul_f32 v51, v13, v51
  v_mfma_f32_16x16x32_bf16 v[72:75], v[32:35], a[160:163], v[72:75]
  v_mul_f32 v52, v13, v52
  v_mul_f32 v53, v13, v53
  v_mfma_f32_16x16x32_bf16 v[76:79], v[32:35], a[164:167], v[76:79]
  v_mul_f32 v54, v13, v54
  v_mul_f32 v55, v13, v55
  v_mfma_f32_16x16x32_bf16 v[64:67], a[24:27], v[36:39], v[64:67]
  ds_read_b128 v[32:35], v2 offset:14976
  v_cvt_pk_bf16_f32 v48, v48, v49
  v_cvt_pk_bf16_f32 v49, v50, v51
  v_mfma_f32_16x16x32_bf16 v[68:71], a[28:31], v[36:39], v[68:71]
  v_cvt_pk_bf16_f32 v50, v52, v53
  v_cvt_pk_bf16_f32 v51, v54, v55
  v_mfma_f32_16x16x32_bf16 v[72:75], v[36:39], a[168:171], v[72:75]
  buffer_store_dwordx4 v[48:51], v0, s[12:15], s38 offen offset:0 sc1
  v_mfma_f32_16x16x32_bf16 v[76:79], v[36:39], a[172:175], v[76:79]
  ds_read_b128 v[16:19], v7 offset:0
  ds_read_b128 v[20:23], v7 offset:128
  s_waitcnt lgkmcnt(4)
  v_mfma_f32_16x16x32_bf16 v[64:67], a[32:35], v[40:43], v[64:67]
  ds_read_b128 v[36:39], v2 offset:17280
  v_mfma_f32_16x16x32_bf16 v[68:71], a[36:39], v[40:43], v[68:71]
  v_mfma_f32_16x16x32_bf16 v[72:75], v[40:43], a[176:179], v[72:75]
  v_mfma_f32_16x16x32_bf16 v[76:79], v[40:43], a[180:183], v[76:79]
  s_waitcnt lgkmcnt(4)
  v_mfma_f32_16x16x32_bf16 v[64:67], a[40:43], v[44:47], v[64:67]
  s_waitcnt lgkmcnt(2)
  v_fma_f32 v56, -v16, v8, v56
  s_add_u32 s98, s46, 1
  v_mfma_f32_16x16x32_bf16 v[68:71], a[44:47], v[44:47], v[68:71]
  s_waitcnt vmcnt(1)
  v_cmp_gt_u32 vcc, s98, v4
  s_cmp_lt_u32 s46, 64
  v_mfma_f32_16x16x32_bf16 v[72:75], v[44:47], a[184:187], v[72:75]
  s_cselect_b32 s48, s46, -1
  v_fma_f32 v57, -v17, v8, v57
  v_fma_f32 v58, -v18, v8, v58
  v_mfma_f32_16x16x32_bf16 v[76:79], v[44:47], a[188:191], v[76:79]
  s_cmp_eq_u32 vcc_lo, 0
  s_cselect_b32 s48, s48, -1
  s_sub_u32 s98, s47, 63
  v_mfma_f32_16x16x32_bf16 v[64:67], a[48:51], v[32:35], v[64:67]
  v_cmp_gt_u32 vcc, s98, v4
  ds_read_b128 v[40:43], v2 offset:19584
  v_mfma_f32_16x16x32_bf16 v[68:71], a[52:55], v[32:35], v[68:71]
  v_fma_f32 v59, -v19, v8, v59
  s_waitcnt lgkmcnt(2)
  v_mul_f32 v56, v20, v56
  v_mfma_f32_16x16x32_bf16 v[72:75], v[32:35], a[192:195], v[72:75]
  s_cmp_lt_u32 s47, 128
  s_cselect_b32 s99, s47, s48
  s_cmp_eq_u32 vcc_hi, 0
  s_cselect_b32 s48, s99, s48
  v_mul_f32 v57, v21, v57
  v_mul_f32 v58, v22, v58
  v_mov_b32 v4, s48
  ds_write_b32 v1, v4
  v_mul_f32 v59, v23, v59
  v_cvt_pk_bf16_f32 v24, v56, v57
  v_cvt_pk_bf16_f32 v25, v58, v59
  v_fma_f32 v60, -v16, v9, v60
  ds_read_b128 v[44:47], v2 offset:21888
  v_fma_f32 v61, -v17, v9, v61
  v_fma_f32 v62, -v18, v9, v62
  v_fma_f32 v63, -v19, v9, v63
  v_mul_f32 v60, v20, v60
  v_mul_f32 v61, v21, v61
  v_mul_f32 v62, v22, v62
  s_waitcnt lgkmcnt(1)
  s_barrier
  v_mfma_f32_16x16x32_bf16 v[76:79], v[32:35], a[196:199], v[76:79]
  v_mov_b32 v4, 101376
  ds_read_b32 v4, v4
  v_mfma_f32_16x16x32_bf16 v[64:67], a[56:59], v[36:39], v[64:67]
  v_mul_f32 v63, v23, v63
  v_cvt_pk_bf16_f32 v28, v60, v61
  v_mfma_f32_16x16x32_bf16 v[68:71], a[60:63], v[36:39], v[68:71]
  ds_read_b128 v[32:35], v2 offset:24192
  v_cvt_pk_bf16_f32 v29, v62, v63
  v_mfma_f32_16x16x32_bf16 v[72:75], v[36:39], a[200:203], v[72:75]
  v_mfma_f32_16x16x32_bf16 v[76:79], v[36:39], a[204:207], v[76:79]
  v_mfma_f32_16x16x32_bf16 v[64:67], a[64:67], v[40:43], v[64:67]
  s_waitcnt lgkmcnt(1)
  v_readfirstlane_b32 s48, v4
  v_mfma_f32_16x16x32_bf16 v[68:71], a[68:71], v[40:43], v[68:71]
  ds_read_b128 v[36:39], v2 offset:26496
  s_cmp_lg_u32 s48, -1
  s_cselect_b32 s35, 1, 0
  v_mfma_f32_16x16x32_bf16 v[72:75], v[40:43], a[208:211], v[72:75]
  s_cselect_b32 s44, -1, 0
  s_and_b32 s30, s44, s14
  s_mul_i32 s33, s48, 41472
  v_mfma_f32_16x16x32_bf16 v[76:79], v[40:43], a[212:215], v[76:79]
  s_add_u32 s33, s33, s54
  s_add_u32 s98, s48, 2
  s_add_u32 s98, s48, 2
  v_mfma_f32_16x16x32_bf16 v[64:67], a[72:75], v[44:47], v[64:67]
  s_cmp_eq_u32 s48, s46
  s_cselect_b32 s46, s98, s46
  s_cmp_eq_u32 s48, s47
  v_mfma_f32_16x16x32_bf16 v[68:71], a[76:79], v[44:47], v[68:71]
  s_cselect_b32 s47, s98, s47
  s_add_u32 m0, s34, 0
  s_add_u32 s96, s33, 0
  v_mfma_f32_16x16x32_bf16 v[72:75], v[44:47], a[216:219], v[72:75]
  ds_read_b128 v[40:43], v2 offset:28800
  v_mfma_f32_16x16x32_bf16 v[76:79], v[44:47], a[220:223], v[76:79]
  buffer_load_dwordx4 v0, s[28:31], s96 offen offset:0 sc1 lds
  s_waitcnt lgkmcnt(2)
  v_mfma_f32_16x16x32_bf16 v[64:67], a[80:83], v[32:35], v[64:67]
  ds_read_b128 v[44:47], v2 offset:31104
  v_mfma_f32_16x16x32_bf16 v[68:71], a[84:87], v[32:35], v[68:71]
  buffer_load_dwordx4 v0, s[28:31], s96 offen offset:1024 sc1 lds
  v_mfma_f32_16x16x32_bf16 v[72:75], v[32:35], a[224:227], v[72:75]
  v_mfma_f32_16x16x32_bf16 v[76:79], v[32:35], a[228:231], v[76:79]
  ds_read_b128 v[32:35], v2 offset:33408
  s_waitcnt lgkmcnt(3)
  v_mfma_f32_16x16x32_bf16 v[64:67], a[88:91], v[36:39], v[64:67]
  buffer_load_dwordx4 v0, s[28:31], s96 offen offset:2048 sc1 lds
  v_mfma_f32_16x16x32_bf16 v[68:71], a[92:95], v[36:39], v[68:71]
  v_mfma_f32_16x16x32_bf16 v[72:75], v[36:39], a[232:235], v[72:75]
  v_mfma_f32_16x16x32_bf16 v[76:79], v[36:39], a[236:239], v[76:79]
  ds_read_b128 v[36:39], v2 offset:35712
  s_waitcnt lgkmcnt(3)
  v_mfma_f32_16x16x32_bf16 v[64:67], a[96:99], v[40:43], v[64:67]
  buffer_load_dwordx4 v0, s[28:31], s96 offen offset:3072 sc1 lds
  s_add_u32 m0, s34, 4096
  v_mfma_f32_16x16x32_bf16 v[68:71], a[100:103], v[40:43], v[68:71]
  s_add_u32 s96, s33, 4096
  v_mfma_f32_16x16x32_bf16 v[72:75], v[40:43], a[240:243], v[72:75]
  v_mfma_f32_16x16x32_bf16 v[76:79], v[40:43], a[244:247], v[76:79]
  ds_read_b128 v[40:43], v2 offset:38016
  s_waitcnt lgkmcnt(3)
  v_mfma_f32_16x16x32_bf16 v[64:67], a[104:107], v[44:47], v[64:67]
  buffer_load_dwordx4 v0, s[28:31], s96 offen offset:0 sc1 lds
  v_mfma_f32_16x16x32_bf16 v[68:71], a[108:111], v[44:47], v[68:71]
  v_mfma_f32_16x16x32_bf16 v[72:75], v[44:47], a[248:251], v[72:75]
  v_mfma_f32_16x16x32_bf16 v[76:79], v[44:47], a[252:255], v[76:79]
  ds_read_b128 v[44:47], v2 offset:40320
  s_waitcnt lgkmcnt(3)
  v_mfma_f32_16x16x32_bf16 v[64:67], a[112:115], v[32:35], v[64:67]
  buffer_load_dwordx4 v0, s[28:31], s96 offen offset:1024 sc1 lds
  v_mfma_f32_16x16x32_bf16 v[68:71], a[116:119], v[32:35], v[68:71]
  v_mfma_f32_16x16x32_bf16 v[72:75], v[32:35], v[80:83], v[72:75]
  v_mfma_f32_16x16x32_bf16 v[76:79], v[32:35], v[84:87], v[76:79]
  ds_read_b128 v[32:35], v2 offset:0
  s_waitcnt lgkmcnt(3)
  v_mfma_f32_16x16x32_bf16 v[64:67], a[120:123], v[36:39], v[64:67]
  buffer_load_dwordx4 v0, s[28:31], s96 offen offset:2048 sc1 lds
  v_mfma_f32_16x16x32_bf16 v[68:71], a[124:127], v[36:39], v[68:71]
  v_mfma_f32_16x16x32_bf16 v[72:75], v[36:39], v[88:91], v[72:75]
  v_mfma_f32_16x16x32_bf16 v[76:79], v[36:39], v[92:95], v[76:79]
  ds_read_b128 v[36:39], v2 offset:2304
  s_waitcnt lgkmcnt(3)
  v_mfma_f32_16x16x32_bf16 v[64:67], a[128:131], v[40:43], v[64:67]
  buffer_load_dwordx4 v0, s[28:31], s96 offen offset:3072 sc1 lds
  s_add_u32 m0, s34, 8192
  v_mfma_f32_16x16x32_bf16 v[68:71], a[132:135], v[40:43], v[68:71]
  s_add_u32 s96, s33, 8192
  v_mfma_f32_16x16x32_bf16 v[72:75], v[40:43], v[96:99], v[72:75]
  v_mfma_f32_16x16x32_bf16 v[76:79], v[40:43], v[100:103], v[76:79]
  ds_read_b128 v[40:43], v2 offset:4608
  s_waitcnt lgkmcnt(3)
  v_mfma_f32_16x16x32_bf16 v[64:67], a[136:139], v[44:47], v[64:67]
  buffer_load_dwordx4 v0, s[28:31], s96 offen offset:0 sc1 lds
  v_mfma_f32_16x16x32_bf16 v[68:71], a[140:143], v[44:47], v[68:71]
  v_mfma_f32_16x16x32_bf16 v[72:75], v[44:47], v[104:107], v[72:75]
  v_mfma_f32_16x16x32_bf16 v[76:79], v[44:47], v[108:111], v[76:79]
  ds_read_b128 v[44:47], v2 offset:6912
  ds_read_b128 v[16:19], v10 offset:256
  s_waitcnt lgkmcnt(4)
  v_mfma_f32_16x16x32_bf16 v[48:51], v[112:115], v[32:35], 0
  ds_read_b128 v[20:23], v10 offset:1280
  v_mfma_f32_16x16x32_bf16 v[52:55], v[116:119], v[32:35], 0
  buffer_load_dwordx4 v0, s[28:31], s96 offen offset:1024 sc1 lds
  s_waitcnt lgkmcnt(4)
  v_mfma_f32_16x16x32_bf16 v[48:51], v[120:123], v[36:39], v[48:51]
  ds_read_b128 v[32:35], v2 offset:9216
  v_mfma_f32_16x16x32_bf16 v[52:55], v[124:127], v[36:39], v[52:55]
  ds_read_b128 v[36:39], v2 offset:11520
  s_waitcnt lgkmcnt(5)
  v_mfma_f32_16x16x32_bf16 v[48:51], v[128:131], v[40:43], v[48:51]
  s_waitcnt lgkmcnt(3)
  v_fma_f32 v64, -v14, v16, v64
  v_fma_f32 v65, -v14, v17, v65
  v_mfma_f32_16x16x32_bf16 v[52:55], v[132:135], v[40:43], v[52:55]
  s_mov_b64 exec, 0xff
  buffer_load_dwordx4 v0, s[28:31], s96 offen offset:2048 sc1 lds
  s_mov_b64 exec, -1
  v_mfma_f32_16x16x32_bf16 v[48:51], v[136:139], v[44:47], v[48:51]
  v_fma_f32 v66, -v14, v18, v66
  v_fma_f32 v67, -v14, v19, v67
  v_mfma_f32_16x16x32_bf16 v[52:55], v[140:143], v[44:47], v[52:55]
  s_and_b32 s98, s44, s39
  s_xor_b32 s34, s34, s98
  ds_read_b128 v[40:43], v2 offset:13824
  s_waitcnt lgkmcnt(2)
  v_mfma_f32_16x16x32_bf16 v[48:51], v[144:147], v[32:35], v[48:51]
  v_fma_f32 v68, -v14, v20, v68
  v_fma_f32 v69, -v14, v21, v69
  v_mfma_f32_16x16x32_bf16 v[52:55], v[148:151], v[32:35], v[52:55]
  v_fma_f32 v70, -v14, v22, v70
  v_fma_f32 v71, -v14, v23, v71
  s_waitcnt lgkmcnt(1)
  v_mfma_f32_16x16x32_bf16 v[48:51], v[152:155], v[36:39], v[48:51]
  ds_read_b128 v[44:47], v2 offset:16128
  v_mul_f32 v64, v15, v64
  v_mul_f32 v65, v15, v65
  v_mfma_f32_16x16x32_bf16 v[52:55], v[156:159], v[36:39], v[52:55]
  v_mul_f32 v66, v15, v66
  v_mul_f32 v67, v15, v67
  ds_read_b128 v[32:35], v2 offset:18432
  s_waitcnt lgkmcnt(2)
  v_mfma_f32_16x16x32_bf16 v[48:51], v[160:163], v[40:43], v[48:51]
  v_mul_f32 v68, v15, v68
  v_mul_f32 v69, v15, v69
  v_mfma_f32_16x16x32_bf16 v[52:55], v[164:167], v[40:43], v[52:55]
  v_mul_f32 v70, v15, v70
  v_mul_f32 v71, v15, v71
  ds_read_b128 v[36:39], v2 offset:20736
  v_cvt_pk_bf16_f32 v64, v64, v65
  s_waitcnt lgkmcnt(2)
  v_mfma_f32_16x16x32_bf16 v[48:51], v[168:171], v[44:47], v[48:51]
  v_cvt_pk_bf16_f32 v65, v66, v67
  v_cvt_pk_bf16_f32 v66, v68, v69
  v_mfma_f32_16x16x32_bf16 v[52:55], v[172:175], v[44:47], v[52:55]
  v_cvt_pk_bf16_f32 v67, v70, v71
  ds_read_b128 v[40:43], v2 offset:23040
  s_waitcnt lgkmcnt(2)
  v_mfma_f32_16x16x32_bf16 v[48:51], v[176:179], v[32:35], v[48:51]
  buffer_store_dwordx4 v[64:67], v0, s[12:15], s38 offen offset:1024 sc1
  v_mfma_f32_16x16x32_bf16 v[52:55], v[180:183], v[32:35], v[52:55]
  ds_read_b128 v[16:19], v7 offset:64
  ds_read_b128 v[20:23], v7 offset:192
  s_waitcnt lgkmcnt(3)
  v_mfma_f32_16x16x32_bf16 v[48:51], v[184:187], v[36:39], v[48:51]
  ds_read_b128 v[44:47], v2 offset:25344
  ds_read_b128 v[32:35], v2 offset:27648
  v_mfma_f32_16x16x32_bf16 v[52:55], v[188:191], v[36:39], v[52:55]
  s_waitcnt lgkmcnt(4)
  v_mfma_f32_16x16x32_bf16 v[48:51], v[192:195], v[40:43], v[48:51]
  v_mfma_f32_16x16x32_bf16 v[52:55], v[196:199], v[40:43], v[52:55]
  s_waitcnt lgkmcnt(3)
  v_fma_f32 v72, -v16, v8, v72
  v_fma_f32 v73, -v17, v8, v73
  v_fma_f32 v74, -v18, v8, v74
  ds_read_b128 v[36:39], v2 offset:29952
  s_waitcnt lgkmcnt(2)
  v_mfma_f32_16x16x32_bf16 v[48:51], v[200:203], v[44:47], v[48:51]
  v_fma_f32 v75, -v19, v8, v75
  v_mul_f32 v72, v20, v72
  v_mfma_f32_16x16x32_bf16 v[52:55], v[204:207], v[44:47], v[52:55]
  v_mul_f32 v73, v21, v73
  v_mul_f32 v74, v22, v74
  s_waitcnt lgkmcnt(1)
  v_mfma_f32_16x16x32_bf16 v[48:51], v[208:211], v[32:35], v[48:51]
  ds_read_b128 v[40:43], v2 offset:32256
  v_mul_f32 v75, v23, v75
  v_cvt_pk_bf16_f32 v26, v72, v73
  v_mfma_f32_16x16x32_bf16 v[52:55], v[212:215], v[32:35], v[52:55]
  v_cvt_pk_bf16_f32 v27, v74, v75
  s_waitcnt lgkmcnt(1)
  v_mfma_f32_16x16x32_bf16 v[48:51], v[216:219], v[36:39], v[48:51]
  buffer_store_dwordx4 v[24:27], v0, s[12:15], s38 offen offset:2048 sc1
  v_mfma_f32_16x16x32_bf16 v[52:55], v[220:223], v[36:39], v[52:55]
  ds_read_b128 v[44:47], v2 offset:34560
  v_fma_f32 v76, -v16, v9, v76
  v_fma_f32 v77, -v17, v9, v77
  s_waitcnt lgkmcnt(1)
  v_mfma_f32_16x16x32_bf16 v[48:51], v[224:227], v[40:43], v[48:51]
  v_fma_f32 v78, -v18, v9, v78
  v_fma_f32 v79, -v19, v9, v79
  v_mfma_f32_16x16x32_bf16 v[52:55], v[228:231], v[40:43], v[52:55]
  ds_read_b128 v[32:35], v2 offset:36864
  v_mul_f32 v76, v20, v76
  v_mul_f32 v77, v21, v77
  v_mul_f32 v78, v22, v78
  v_mul_f32 v79, v23, v79
  ds_read_b128 v[36:39], v2 offset:39168
  v_cvt_pk_bf16_f32 v30, v76, v77
  v_cvt_pk_bf16_f32 v31, v78, v79
  s_waitcnt lgkmcnt(2)
  v_mfma_f32_16x16x32_bf16 v[48:51], v[232:235], v[44:47], v[48:51]
  buffer_store_dwordx4 v[28:31], v0, s[12:15], s38 offen offset:3072 sc1
  v_mfma_f32_16x16x32_bf16 v[52:55], v[236:239], v[44:47], v[52:55]
  ds_read_b128 v[40:43], v2 offset:1152
  ds_read_b128 v[16:19], v10 offset:2304
  s_waitcnt lgkmcnt(3)
  v_mfma_f32_16x16x32_bf16 v[48:51], v[240:243], v[32:35], v[48:51]
  ds_read_b128 v[20:23], v10 offset:3328
  ds_read_b128 v[44:47], v2 offset:3456
  v_mfma_f32_16x16x32_bf16 v[52:55], v[244:247], v[32:35], v[52:55]
  ds_read_b128 v[32:35], v2 offset:5760
  s_waitcnt lgkmcnt(5)
  v_mfma_f32_16x16x32_bf16 v[48:51], v[248:251], v[36:39], v[48:51]
  v_mfma_f32_16x16x32_bf16 v[52:55], v[252:255], v[36:39], v[52:55]
  ds_read_b128 v[36:39], v2 offset:8064
  s_waitcnt lgkmcnt(5)
  v_mfma_f32_16x16x32_bf16 v[56:59], v[112:115], v[40:43], 0
  v_mfma_f32_16x16x32_bf16 v[60:63], v[116:119], v[40:43], 0
  ds_read_b128 v[40:43], v2 offset:10368
  s_waitcnt lgkmcnt(3)
  v_mfma_f32_16x16x32_bf16 v[56:59], v[120:123], v[44:47], v[56:59]
  v_mfma_f32_16x16x32_bf16 v[60:63], v[124:127], v[44:47], v[60:63]
  ds_read_b128 v[44:47], v2 offset:12672
  v_fma_f32 v48, -v12, v16, v48
  v_fma_f32 v49, -v12, v17, v49
  s_waitcnt lgkmcnt(3)
  v_mfma_f32_16x16x32_bf16 v[56:59], v[128:131], v[32:35], v[56:59]
  v_fma_f32 v50, -v12, v18, v50
  v_fma_f32 v51, -v12, v19, v51
  v_mfma_f32_16x16x32_bf16 v[60:63], v[132:135], v[32:35], v[60:63]
  ds_read_b128 v[32:35], v2 offset:14976
  v_fma_f32 v52, -v12, v20, v52
  v_fma_f32 v53, -v12, v21, v53
  s_waitcnt lgkmcnt(3)
  v_mfma_f32_16x16x32_bf16 v[56:59], v[136:139], v[36:39], v[56:59]
  v_fma_f32 v54, -v12, v22, v54
  v_fma_f32 v55, -v12, v23, v55
  v_mfma_f32_16x16x32_bf16 v[60:63], v[140:143], v[36:39], v[60:63]
  ds_read_b128 v[36:39], v2 offset:17280
  v_mul_f32 v48, v13, v48
  v_mul_f32 v49, v13, v49
  s_waitcnt lgkmcnt(3)
  v_mfma_f32_16x16x32_bf16 v[56:59], v[144:147], v[40:43], v[56:59]
  v_mul_f32 v50, v13, v50
  v_mul_f32 v51, v13, v51
  v_mfma_f32_16x16x32_bf16 v[60:63], v[148:151], v[40:43], v[60:63]
  ds_read_b128 v[40:43], v2 offset:19584
  v_mul_f32 v52, v13, v52
  v_mul_f32 v53, v13, v53
  s_waitcnt lgkmcnt(3)
  v_mfma_f32_16x16x32_bf16 v[56:59], v[152:155], v[44:47], v[56:59]
  v_mul_f32 v54, v13, v54
  v_mul_f32 v55, v13, v55
  v_mfma_f32_16x16x32_bf16 v[60:63], v[156:159], v[44:47], v[60:63]
  ds_read_b128 v[44:47], v2 offset:21888
  v_cvt_pk_bf16_f32 v48, v48, v49
  v_cvt_pk_bf16_f32 v49, v50, v51
  s_waitcnt lgkmcnt(3)
  v_mfma_f32_16x16x32_bf16 v[56:59], v[160:163], v[32:35], v[56:59]
  v_cvt_pk_bf16_f32 v50, v52, v53
  v_cvt_pk_bf16_f32 v51, v54, v55
  v_mfma_f32_16x16x32_bf16 v[60:63], v[164:167], v[32:35], v[60:63]
  ds_read_b128 v[32:35], v2 offset:24192
  s_waitcnt lgkmcnt(3)
  v_mfma_f32_16x16x32_bf16 v[56:59], v[168:171], v[36:39], v[56:59]
  buffer_store_dwordx4 v[48:51], v0, s[12:15], s43 offen sc1
  v_mfma_f32_16x16x32_bf16 v[60:63], v[172:175], v[36:39], v[60:63]
  ds_read_b128 v[36:39], v2 offset:26496
  s_waitcnt lgkmcnt(3)
  v_mfma_f32_16x16x32_bf16 v[56:59], v[176:179], v[40:43], v[56:59]
  v_mfma_f32_16x16x32_bf16 v[60:63], v[180:183], v[40:43], v[60:63]
  ds_read_b128 v[40:43], v2 offset:28800
  s_waitcnt lgkmcnt(3)
  v_mfma_f32_16x16x32_bf16 v[56:59], v[184:187], v[44:47], v[56:59]
  v_mfma_f32_16x16x32_bf16 v[60:63], v[188:191], v[44:47], v[60:63]
  ds_read_b128 v[44:47], v2 offset:31104
  s_waitcnt lgkmcnt(3)
  v_mfma_f32_16x16x32_bf16 v[56:59], v[192:195], v[32:35], v[56:59]
  v_mfma_f32_16x16x32_bf16 v[60:63], v[196:199], v[32:35], v[60:63]
  ds_read_b128 v[32:35], v2 offset:33408
  s_waitcnt lgkmcnt(3)
  v_mfma_f32_16x16x32_bf16 v[56:59], v[200:203], v[36:39], v[56:59]
  v_mfma_f32_16x16x32_bf16 v[60:63], v[204:207], v[36:39], v[60:63]
  ds_read_b128 v[36:39], v2 offset:35712
  s_waitcnt lgkmcnt(3)
  v_mfma_f32_16x16x32_bf16 v[56:59], v[208:211], v[40:43], v[56:59]
  v_mfma_f32_16x16x32_bf16 v[60:63], v[212:215], v[40:43], v[60:63]
  ds_read_b128 v[40:43], v2 offset:38016
  s_waitcnt lgkmcnt(3)
  v_mfma_f32_16x16x32_bf16 v[56:59], v[216:219], v[44:47], v[56:59]
  v_mfma_f32_16x16x32_bf16 v[60:63], v[220:223], v[44:47], v[60:63]
  ds_read_b128 v[44:47], v2 offset:40320
  s_waitcnt lgkmcnt(3)
  v_mfma_f32_16x16x32_bf16 v[56:59], v[224:227], v[32:35], v[56:59]
  v_mfma_f32_16x16x32_bf16 v[60:63], v[228:231], v[32:35], v[60:63]
  s_waitcnt lgkmcnt(2)
  v_mfma_f32_16x16x32_bf16 v[56:59], v[232:235], v[36:39], v[56:59]
  v_mfma_f32_16x16x32_bf16 v[60:63], v[236:239], v[36:39], v[60:63]
  s_waitcnt lgkmcnt(1)
  v_mfma_f32_16x16x32_bf16 v[56:59], v[240:243], v[40:43], v[56:59]
  v_mfma_f32_16x16x32_bf16 v[60:63], v[244:247], v[40:43], v[60:63]
  s_waitcnt lgkmcnt(0)
  v_mfma_f32_16x16x32_bf16 v[56:59], v[248:251], v[44:47], v[56:59]
  v_mfma_f32_16x16x32_bf16 v[60:63], v[252:255], v[44:47], v[60:63]
  s_waitcnt vmcnt(1)
  v_mov_b32 v5, s49
  s_mov_b64 exec, 1
  buffer_store_dword v5, off, s[12:15], s37 sc1
  s_mov_b64 exec, -1
  s_nop 1
  v_pk_fma_f32 v[56:57], v[16:17], v[14:15], v[56:57] op_sel_hi:[1,0,1] neg_lo:[0,1,0] neg_hi:[0,1,0]
  v_pk_fma_f32 v[58:59], v[18:19], v[14:15], v[58:59] op_sel_hi:[1,0,1] neg_lo:[0,1,0] neg_hi:[0,1,0]
  v_pk_fma_f32 v[60:61], v[20:21], v[14:15], v[60:61] op_sel_hi:[1,0,1] neg_lo:[0,1,0] neg_hi:[0,1,0]
  v_pk_fma_f32 v[62:63], v[22:23], v[14:15], v[62:63] op_sel_hi:[1,0,1] neg_lo:[0,1,0] neg_hi:[0,1,0]
  v_pk_mul_f32 v[56:57], v[56:57], v[14:15] op_sel:[0,1] op_sel_hi:[1,1]
  v_pk_mul_f32 v[58:59], v[58:59], v[14:15] op_sel:[0,1] op_sel_hi:[1,1]
  v_pk_mul_f32 v[60:61], v[60:61], v[14:15] op_sel:[0,1] op_sel_hi:[1,1]
  v_pk_mul_f32 v[62:63], v[62:63], v[14:15] op_sel:[0,1] op_sel_hi:[1,1]
  v_cvt_pk_bf16_f32 v56, v56, v57
  v_cvt_pk_bf16_f32 v57, v58, v59
  v_cvt_pk_bf16_f32 v58, v60, v61
  v_cvt_pk_bf16_f32 v59, v62, v63
  buffer_store_dwordx4 v[56:59], v0, s[12:15], s43 offen offset:1024 sc1
  v_add_u32 v2, s42, v2
  v_add_u32 v3, s42, v3
  s_sub_u32 s42, 0, s42
  s_add_u32 s55, s37, 128
  s_mov_b32 s56, s49
  s_add_u32 s32, s32, 1
  s_cmp_eq_u32 s32, 64
  s_cbranch_scc1 L_qkv_done
  s_cmp_eq_u32 s35, 0
  s_cbranch_scc1 L_qkv_late
  s_mul_i32 s98, s48, 786432
  s_add_u32 s38, s52, s98
  s_add_u32 s43, s53, s98
  s_lshr_b32 s98, s48, 6
  s_mul_i32 s98, s98, 16384
  s_add_u32 s37, s50, s98
  s_and_b32 s49, s48, 63
  s_add_u32 s49, s49, 2
  s_branch L_qkv_loop
L_qkv_late:
  s_mov_b64 exec, s[40:41]
  buffer_load_dword v4, v11, s[12:15], s36 offen sc1
  s_mov_b64 exec, -1
  s_waitcnt vmcnt(0)
  v_mov_b32 v5, s56
  s_mov_b64 exec, 1
  buffer_store_dword v5, off, s[12:15], s55 sc1
  s_mov_b64 exec, -1
L_ql_83:
  s_add_u32 s98, s46, 1
  s_waitcnt vmcnt(0)
  v_cmp_gt_u32 vcc, s98, v4
  s_cmp_lt_u32 s46, 64
  s_cselect_b32 s48, s46, -1
  s_cmp_eq_u32 vcc_lo, 0
  s_cselect_b32 s48, s48, -1
  s_sub_u32 s98, s47, 63
  v_cmp_gt_u32 vcc, s98, v4
  s_cmp_lt_u32 s47, 128
  s_cselect_b32 s99, s47, s48
  s_cmp_eq_u32 vcc_hi, 0
  s_cselect_b32 s48, s99, s48
  v_mov_b32 v4, s48
  ds_write_b32 v1, v4
  s_waitcnt lgkmcnt(0)
  s_barrier
  v_mov_b32 v4, 101376
  ds_read_b32 v4, v4
  s_waitcnt lgkmcnt(0)
  v_readfirstlane_b32 s48, v4
  s_nop 0
  s_cmp_lg_u32 s48, -1
  s_cselect_b32 s35, 1, 0
  s_cselect_b32 s44, -1, 0
  s_and_b32 s30, s44, s14
  s_mul_i32 s33, s48, 41472
  s_add_u32 s33, s33, s54
  s_add_u32 s98, s48, 2
  s_add_u32 s98, s48, 2
  s_cmp_eq_u32 s48, s46
  s_cselect_b32 s46, s98, s46
  s_cmp_eq_u32 s48, s47
  s_cselect_b32 s47, s98, s47
  s_barrier
  s_cmp_lg_u32 s35, 0
  s_cbranch_scc1 L_ql_83d
  s_sleep 2
  s_mov_b64 exec, s[40:41]
  buffer_load_dword v4, v11, s[12:15], s36 offen sc1
  s_mov_b64 exec, -1
  s_sub_u32 s100, s100, 1
  s_cbranch_scc0 L_ql_83
  s_branch L_end
L_ql_83d:
  s_add_u32 m0, s34, 0
  s_add_u32 s98, s33, 0
  buffer_load_dwordx4 v0, s[12:15], s98 offen offset:0 sc1 lds
  buffer_load_dwordx4 v0, s[12:15], s98 offen offset:1024 sc1 lds
  buffer_load_dwordx4 v0, s[12:15], s98 offen offset:2048 sc1 lds
  buffer_load_dwordx4 v0, s[12:15], s98 offen offset:3072 sc1 lds
  s_add_u32 m0, s34, 4096
  s_add_u32 s98, s33, 4096
  buffer_load_dwordx4 v0, s[12:15], s98 offen offset:0 sc1 lds
  buffer_load_dwordx4 v0, s[12:15], s98 offen offset:1024 sc1 lds
  buffer_load_dwordx4 v0, s[12:15], s98 offen offset:2048 sc1 lds
  buffer_load_dwordx4 v0, s[12:15], s98 offen offset:3072 sc1 lds
  s_add_u32 m0, s34, 8192
  s_add_u32 s98, s33, 8192
  buffer_load_dwordx4 v0, s[12:15], s98 offen offset:0 sc1 lds
  buffer_load_dwordx4 v0, s[12:15], s98 offen offset:1024 sc1 lds
  s_mov_b64 exec, 0xff
  buffer_load_dwordx4 v0, s[12:15], s98 offen offset:2048 sc1 lds
  s_mov_b64 exec, -1
  s_add_u32 s33, s33, 41472
  s_xor_b32 s34, s34, s39
  s_mov_b32 s35, 1
  s_mul_i32 s98, s48, 786432
  s_add_u32 s38, s52, s98
  s_add_u32 s43, s53, s98
  s_lshr_b32 s98, s48, 6
  s_mul_i32 s98, s98, 16384
  s_add_u32 s37, s50, s98
  s_and_b32 s49, s48, 63
  s_add_u32 s49, s49, 2
  s_waitcnt vmcnt(0)
  s_branch L_qkv_loop
L_qkv_done:
  s_waitcnt vmcnt(0)
  v_mov_b32 v5, s56
  s_mov_b64 exec, 1
  buffer_store_dword v5, off, s[12:15], s55 sc1
  s_mov_b64 exec, -1
  s_branch L_end
L_u:
  s_load_dwordx2 s[16:17], s[0:1], 64
  s_mov_b32 s18, 5308416
  s_mov_b32 s19, 0x20000
  s_waitcnt lgkmcnt(0)
  s_and_b32 s17, s17, 0xffff
  s_load_dwordx2 s[20:21], s[0:1], 72
  s_mov_b32 s22, 5308416
  s_mov_b32 s23, 0x20000
  s_waitcnt lgkmcnt(0)
  s_and_b32 s21, s21, 0xffff
  v_lshlrev_b32 v0, 4, v63
  v_lshlrev_b32 v1, 2, v63
  v_mov_b32 v2, v0
  v_lshrrev_b32 v60, 5, v63
  v_mul_u32_u24 v4, 18, v60
  v_bfe_u32 v60, v63, 4, 1
  v_add_u32 v4, v4, v60
  v_mul_u32_u24 v4, 1152, v4
  v_mul_u32_u24 v7, 256, v60
  v_and_b32 v60, 15, v63
  v_lshl_add_u32 v7, v60, 2, v7
  v_and_b32 v60, 15, v63
  v_lshl_add_u32 v4, v60, 3, v4
  v_add_u32 v4, 1024, v4
  s_mul_i32 s33, s11, 2654208
  s_mul_i32 s34, s9, 10368
  s_add_u32 s33, s33, s34
  s_add_u32 s33, s33, 14680064
  s_add_u32 s39, s34, 41472
  s_xor_b32 s39, s39, s34
  s_mul_i32 s36, s11, 1024
  s_add_u32 s36, s36, 264192
  s_mov_b32 s40, -1
  s_mov_b32 s41, 0
  s_mov_b32 s42, 41472
  s_and_b32 s98, s9, 1
  s_mul_i32 s99, s98, 1152
  v_add_u32 v2, s99, v0
  s_sub_u32 s99, 1152, s99
  v_add_u32 v3, s99, v0
  s_sub_u32 s46, 0, s98
  s_mov_b32 s47, s46
  s_lshl_b32 s51, s11, 5
  s_add_u32 s51, s51, s10
  s_mul_i32 s99, s51, 64
  s_add_u32 s99, s99, s9
  s_lshl_b32 s99, s99, 2
  s_add_u32 s37, s99, 266240
  s_mul_i32 s38, s11, 18874368
  s_mul_i32 s99, s10, 9216
  s_add_u32 s38, s38, s99
  s_add_u32 s38, s38, 138412032
  s_lshl_b32 s99, s9, 8
  s_add_u32 s49, s38, s99
  s_add_u32 s49, s49, 8192
  s_lshl_b32 s99, s9, 11
  s_add_u32 s38, s38, s99
  s_lshl_b32 s98, s98, 10
  s_add_u32 s43, s38, 1024
  s_sub_u32 s43, s43, s98
  s_add_u32 s38, s38, s98
  s_mul_i32 s62, s9, 40960
  s_mul_i32 s90, s10, 288
  s_lshr_b32 s99, s9, 1
  s_lshl_b32 s99, s99, 4
  s_add_u32 s91, s90, s99
  s_add_u32 s91, s91, 256
  s_lshl_b32 s99, s9, 6
  s_add_u32 s90, s90, s99
  s_mov_b32 s52, 0x33333333
  s_mov_b32 s53, 0x33333333
  s_mov_b32 s54, 0xcccccccc
  s_mov_b32 s55, 0xcccccccc
  s_mov_b32 s56, 0xc0135761
  s_mov_b32 s57, 0xc0135761
  s_mov_b32 s58, 0xbdd2d3e8
  s_mov_b32 s59, 0xbdd2d3e8
  v_mov_b32 v6, 0
  s_mov_b64 exec, 1
  buffer_store_dword v6, off, s[12:15], s37 sc1
  s_mov_b64 exec, -1
  s_waitcnt vmcnt(0)
  s_barrier
  s_cmp_lg_u32 s9, 0
  s_cbranch_scc1 L_arr_84
  s_mov_b64 exec, 1
  v_mov_b32 v60, 64
  v_mov_b32 v61, 1
  global_atomic_add v60, v61, s[4:5] sc1
  s_mov_b64 exec, -1
L_arr_84:
  v_lshrrev_b32 v60, 4, v63
  v_lshlrev_b32 v96, 9, v60
  v_bfe_u32 v60, v63, 2, 2
  v_lshl_add_u32 v96, v60, 6, v96
  v_and_b32 v60, 3, v63
  v_lshl_add_u32 v96, v60, 4, v96
  v_add_u32 v96, s62, v96
  v_lshrrev_b32 v60, 2, v63
  v_mul_u32_u24 v97, 9216, v60
  v_and_b32 v60, 3, v63
  v_lshl_add_u32 v97, v60, 4, v97
  v_lshrrev_b32 v60, 2, v63
  v_mul_u32_u24 v98, 9216, v60
  v_and_b32 v60, 1, v63
  v_lshl_add_u32 v99, v60, 3, v96
  s_cmp_lg_u32 s9, 3
  s_cbranch_scc1 L_gw_85b
  s_cmp_lg_u32 s11, 0
  s_cbranch_scc1 L_gw_85a
  v_mov_b32 v60, 128
  s_mov_b64 exec, 1
L_wa_86:
  global_load_dword v61, v60, s[4:5] sc1
  s_waitcnt vmcnt(0)
  v_readfirstlane_b32 s98, v61
  s_nop 0
  s_cmp_ge_u32 s98, 32
  s_nop 1
  s_cbranch_scc1 L_wa_86d
  s_sleep 24
  s_sub_u32 s100, s100, 1
  s_cbranch_scc0 L_wa_86
  s_branch L_end
L_wa_86d:
  s_mov_b64 exec, -1
  s_branch L_gw_85b
L_gw_85a:
  v_mov_b32 v60, 192
  s_mov_b64 exec, 1
L_wa_87:
  global_load_dword v61, v60, s[4:5] sc1
  s_waitcnt vmcnt(0)
  v_readfirstlane_b32 s98, v61
  s_nop 0
  s_cmp_ge_u32 s98, 32
  s_nop 1
  s_cbranch_scc1 L_wa_87d
  s_sleep 48
  s_sub_u32 s100, s100, 1
  s_cbranch_scc0 L_wa_87
  s_branch L_end
L_wa_87d:
  s_mov_b64 exec, -1
L_gw_85b:
  s_barrier
  s_add_u32 m0, s62, 0
  s_add_u32 s99, s90, 0
  buffer_load_dwordx4 v97, s[16:19], s99 offen  lds
  s_add_u32 m0, s62, 1024
  s_add_u32 s99, s90, 147456
  buffer_load_dwordx4 v97, s[16:19], s99 offen  lds
  s_add_u32 m0, s62, 2048
  s_add_u32 s99, s90, 0
  buffer_load_dwordx4 v97, s[20:23], s99 offen  lds
  s_add_u32 m0, s62, 3072
  s_add_u32 s99, s90, 147456
  buffer_load_dwordx4 v97, s[20:23], s99 offen  lds
  s_add_u32 m0, s62, 4096
  s_add_u32 s99, s91, 0
  s_mov_b64 exec, s[52:53]
  buffer_load_dwordx4 v98, s[16:19], s99 offen  lds
  s_mov_b64 exec, -1
  s_mov_b64 exec, s[54:55]
  buffer_load_dwordx4 v98, s[20:23], s99 offen  lds
  s_mov_b64 exec, -1
  s_add_u32 m0, s62, 5120
  s_add_u32 s99, s91, 147456
  s_mov_b64 exec, s[52:53]
  buffer_load_dwordx4 v98, s[16:19], s99 offen  lds
  s_mov_b64 exec, -1
  s_mov_b64 exec, s[54:55]
  buffer_load_dwordx4 v98, s[20:23], s99 offen  lds
  s_mov_b64 exec, -1
  s_add_u32 m0, s62, 6144
  s_add_u32 s99, s90, 294912
  buffer_load_dwordx4 v97, s[16:19], s99 offen  lds
  s_add_u32 m0, s62, 7168
  s_add_u32 s99, s90, 442368
  buffer_load_dwordx4 v97, s[16:19], s99 offen  lds
  s_add_u32 m0, s62, 8192
  s_add_u32 s99, s90, 294912
  buffer_load_dwordx4 v97, s[20:23], s99 offen  lds
  s_add_u32 m0, s62, 9216
  s_add_u32 s99, s90, 442368
  buffer_load_dwordx4 v97, s[20:23], s99 offen  lds
  s_add_u32 m0, s62, 10240
  s_add_u32 s99, s91, 294912
  s_mov_b64 exec, s[52:53]
  buffer_load_dwordx4 v98, s[16:19], s99 offen  lds
  s_mov_b64 exec, -1
  s_mov_b64 exec, s[54:55]
  buffer_load_dwordx4 v98, s[20:23], s99 offen  lds
  s_mov_b64 exec, -1
  s_add_u32 m0, s62, 11264
  s_add_u32 s99, s91, 442368
  s_mov_b64 exec, s[52:53]
  buffer_load_dwordx4 v98, s[16:19], s99 offen  lds
  s_mov_b64 exec, -1
  s_mov_b64 exec, s[54:55]
  buffer_load_dwordx4 v98, s[20:23], s99 offen  lds
  s_mov_b64 exec, -1
  s_add_u32 m0, s62, 12288
  s_add_u32 s99, s90, 589824
  buffer_load_dwordx4 v97, s[16:19], s99 offen  lds
  s_add_u32 m0, s62, 13312
  s_add_u32 s99, s90, 737280
  buffer_load_dwordx4 v97, s[16:19], s99 offen  lds
  s_add_u32 m0, s62, 14336
  s_add_u32 s99, s90, 589824
  buffer_load_dwordx4 v97, s[20:23], s99 offen  lds
  s_add_u32 m0, s62, 15360
  s_add_u32 s99, s90, 737280
  buffer_load_dwordx4 v97, s[20:23], s99 offen  lds
  s_add_u32 m0, s62, 16384
  s_add_u32 s99, s91, 589824
  s_mov_b64 exec, s[52:53]
  buffer_load_dwordx4 v98, s[16:19], s99 offen  lds
  s_mov_b64 exec, -1
  s_mov_b64 exec, s[54:55]
  buffer_load_dwordx4 v98, s[20:23], s99 offen  lds
  s_mov_b64 exec, -1
  s_add_u32 m0, s62, 17408
  s_add_u32 s99, s91, 737280
  s_mov_b64 exec, s[52:53]
  buffer_load_dwordx4 v98, s[16:19], s99 offen  lds
  s_mov_b64 exec, -1
  s_mov_b64 exec, s[54:55]
  buffer_load_dwordx4 v98, s[20:23], s99 offen  lds
  s_mov_b64 exec, -1
  s_add_u32 m0, s62, 18432
  s_add_u32 s99, s90, 884736
  buffer_load_dwordx4 v97, s[16:19], s99 offen  lds
  s_add_u32 m0, s62, 19456
  s_add_u32 s99, s90, 1032192
  buffer_load_dwordx4 v97, s[16:19], s99 offen  lds
  s_add_u32 m0, s62, 20480
  s_add_u32 s99, s90, 884736
  buffer_load_dwordx4 v97, s[20:23], s99 offen  lds
  s_add_u32 m0, s62, 21504
  s_add_u32 s99, s90, 1032192
  buffer_load_dwordx4 v97, s[20:23], s99 offen  lds
  s_add_u32 m0, s62, 22528
  s_add_u32 s99, s91, 884736
  s_mov_b64 exec, s[52:53]
  buffer_load_dwordx4 v98, s[16:19], s99 offen  lds
  s_mov_b64 exec, -1
  s_mov_b64 exec, s[54:55]
  buffer_load_dwordx4 v98, s[20:23], s99 offen  lds
  s_mov_b64 exec, -1
  s_add_u32 m0, s62, 23552
  s_add_u32 s99, s91, 1032192
  s_mov_b64 exec, s[52:53]
  buffer_load_dwordx4 v98, s[16:19], s99 offen  lds
  s_mov_b64 exec, -1
  s_mov_b64 exec, s[54:55]
  buffer_load_dwordx4 v98, s[20:23], s99 offen  lds
  s_mov_b64 exec, -1
  s_add_u32 m0, s62, 24576
  s_add_u32 s99, s90, 1179648
  buffer_load_dwordx4 v97, s[16:19], s99 offen  lds
  s_add_u32 m0, s62, 25600
  s_add_u32 s99, s90, 1327104
  buffer_load_dwordx4 v97, s[16:19], s99 offen  lds
  s_add_u32 m0, s62, 26624
  s_add_u32 s99, s90, 1179648
  buffer_load_dwordx4 v97, s[20:23], s99 offen  lds
  s_add_u32 m0, s62, 27648
  s_add_u32 s99, s90, 1327104
  buffer_load_dwordx4 v97, s[20:23], s99 offen  lds
  s_add_u32 m0, s62, 28672
  s_add_u32 s99, s91, 1179648
  s_mov_b64 exec, s[52:53]
  buffer_load_dwordx4 v98, s[16:19], s99 offen  lds
  s_mov_b64 exec, -1
  s_mov_b64 exec, s[54:55]
  buffer_load_dwordx4 v98, s[20:23], s99 offen  lds
  s_mov_b64 exec, -1
  s_add_u32 m0, s62, 29696
  s_add_u32 s99, s91, 1327104
  s_mov_b64 exec, s[52:53]
  buffer_load_dwordx4 v98, s[16:19], s99 offen  lds
  s_mov_b64 exec, -1
  s_mov_b64 exec, s[54:55]
  buffer_load_dwordx4 v98, s[20:23], s99 offen  lds
  s_mov_b64 exec, -1
  s_waitcnt vmcnt(38)
  ds_read_b64_tr_b16 a[0:1], v96 offset:0
  ds_read_b64_tr_b16 a[2:3], v96 offset:256
  ds_read_b64_tr_b16 a[4:5], v96 offset:8
  ds_read_b64_tr_b16 a[6:7], v96 offset:264
  s_add_u32 m0, s62, 30720
  s_add_u32 s99, s90, 1474560
  buffer_load_dwordx4 v97, s[16:19], s99 offen  lds
  s_add_u32 m0, s62, 31744
  s_add_u32 s99, s90, 1622016
  buffer_load_dwordx4 v97, s[16:19], s99 offen  lds
  s_waitcnt vmcnt(38)
  ds_read_b64_tr_b16 a[8:9], v96 offset:2048
  ds_read_b64_tr_b16 a[10:11], v96 offset:2304
  ds_read_b64_tr_b16 a[12:13], v96 offset:2056
  ds_read_b64_tr_b16 a[14:15], v96 offset:2312
  s_waitcnt lgkmcnt(4)
  s_add_u32 m0, s62, 0
  s_add_u32 s99, s90, 1474560
  buffer_load_dwordx4 v97, s[20:23], s99 offen  lds
  s_add_u32 m0, s62, 1024
  s_add_u32 s99, s90, 1622016
  buffer_load_dwordx4 v97, s[20:23], s99 offen  lds
  s_waitcnt vmcnt(36)
  ds_read_b64_tr_b16 a[16:17], v99 offset:4096
  ds_read_b64_tr_b16 a[18:19], v99 offset:4352
  s_waitcnt lgkmcnt(2)
  s_add_u32 m0, s62, 2048
  s_add_u32 s99, s91, 1474560
  s_mov_b64 exec, s[52:53]
  buffer_load_dwordx4 v98, s[16:19], s99 offen  lds
  s_mov_b64 exec, -1
  s_mov_b64 exec, s[54:55]
  buffer_load_dwordx4 v98, s[20:23], s99 offen  lds
  s_mov_b64 exec, -1
  s_add_u32 m0, s62, 3072
  s_add_u32 s99, s91, 1622016
  s_mov_b64 exec, s[52:53]
  buffer_load_dwordx4 v98, s[16:19], s99 offen  lds
  s_mov_b64 exec, -1
  s_mov_b64 exec, s[54:55]
  buffer_load_dwordx4 v98, s[20:23], s99 offen  lds
  s_mov_b64 exec, -1
  s_waitcnt vmcnt(38)
  ds_read_b64_tr_b16 a[20:21], v96 offset:6144
  ds_read_b64_tr_b16 a[22:23], v96 offset:6400
  ds_read_b64_tr_b16 a[24:25], v96 offset:6152
  ds_read_b64_tr_b16 a[26:27], v96 offset:6408
  s_waitcnt lgkmcnt(4)
  s_add_u32 m0, s62, 4096
  s_add_u32 s99, s90, 1769472
  buffer_load_dwordx4 v97, s[16:19], s99 offen  lds
  s_add_u32 m0, s62, 5120
  s_add_u32 s99, s90, 1916928
  buffer_load_dwordx4 v97, s[16:19], s99 offen  lds
  s_waitcnt vmcnt(38)
  ds_read_b64_tr_b16 a[28:29], v96 offset:8192
  ds_read_b64_tr_b16 a[30:31], v96 offset:8448
  ds_read_b64_tr_b16 a[32:33], v96 offset:8200
  ds_read_b64_tr_b16 a[34:35], v96 offset:8456
  s_waitcnt lgkmcnt(4)
  s_add_u32 m0, s62, 6144
  s_add_u32 s99, s90, 1769472
  buffer_load_dwordx4 v97, s[20:23], s99 offen  lds
  s_add_u32 m0, s62, 7168
  s_add_u32 s99, s90, 1916928
  buffer_load_dwordx4 v97, s[20:23], s99 offen  lds
  s_waitcnt vmcnt(36)
  ds_read_b64_tr_b16 a[36:37], v99 offset:10240
  ds_read_b64_tr_b16 a[38:39], v99 offset:10496
  s_waitcnt lgkmcnt(2)
  s_add_u32 m0, s62, 8192
  s_add_u32 s99, s91, 1769472
  s_mov_b64 exec, s[52:53]
  buffer_load_dwordx4 v98, s[16:19], s99 offen  lds
  s_mov_b64 exec, -1
  s_mov_b64 exec, s[54:55]
  buffer_load_dwordx4 v98, s[20:23], s99 offen  lds
  s_mov_b64 exec, -1
  s_add_u32 m0, s62, 9216
  s_add_u32 s99, s91, 1916928
  s_mov_b64 exec, s[52:53]
  buffer_load_dwordx4 v98, s[16:19], s99 offen  lds
  s_mov_b64 exec, -1
  s_mov_b64 exec, s[54:55]
  buffer_load_dwordx4 v98, s[20:23], s99 offen  lds
  s_mov_b64 exec, -1
  s_waitcnt vmcnt(38)
  ds_read_b64_tr_b16 a[40:41], v96 offset:12288
  ds_read_b64_tr_b16 a[42:43], v96 offset:12544
  ds_read_b64_tr_b16 a[44:45], v96 offset:12296
  ds_read_b64_tr_b16 a[46:47], v96 offset:12552
  s_waitcnt lgkmcnt(4)
  s_add_u32 m0, s62, 10240
  s_add_u32 s99, s90, 2064384
  buffer_load_dwordx4 v97, s[16:19], s99 offen  lds
  s_add_u32 m0, s62, 11264
  s_add_u32 s99, s90, 2211840
  buffer_load_dwordx4 v97, s[16:19], s99 offen  lds
  s_waitcnt vmcnt(38)
  ds_read_b64_tr_b16 a[48:49], v96 offset:14336
  ds_read_b64_tr_b16 a[50:51], v96 offset:14592
  ds_read_b64_tr_b16 a[52:53], v96 offset:14344
  ds_read_b64_tr_b16 a[54:55], v96 offset:14600
  s_waitcnt lgkmcnt(4)
  s_add_u32 m0, s62, 12288
  s_add_u32 s99, s90, 2064384
  buffer_load_dwordx4 v97, s[20:23], s99 offen  lds
  s_add_u32 m0, s62, 13312
  s_add_u32 s99, s90, 2211840
  buffer_load_dwordx4 v97, s[20:23], s99 offen  lds
  s_waitcnt vmcnt(36)
  ds_read_b64_tr_b16 a[56:57], v99 offset:16384
  ds_read_b64_tr_b16 a[58:59], v99 offset:16640
  s_waitcnt lgkmcnt(2)
  s_add_u32 m0, s62, 14336
  s_add_u32 s99, s91, 2064384
  s_mov_b64 exec, s[52:53]
  buffer_load_dwordx4 v98, s[16:19], s99 offen  lds
  s_mov_b64 exec, -1
  s_mov_b64 exec, s[54:55]
  buffer_load_dwordx4 v98, s[20:23], s99 offen  lds
  s_mov_b64 exec, -1
  s_add_u32 m0, s62, 15360
  s_add_u32 s99, s91, 2211840
  s_mov_b64 exec, s[52:53]
  buffer_load_dwordx4 v98, s[16:19], s99 offen  lds
  s_mov_b64 exec, -1
  s_mov_b64 exec, s[54:55]
  buffer_load_dwordx4 v98, s[20:23], s99 offen  lds
  s_mov_b64 exec, -1
  s_waitcnt vmcnt(38)
  ds_read_b64_tr_b16 a[60:61], v96 offset:18432
  ds_read_b64_tr_b16 a[62:63], v96 offset:18688
  ds_read_b64_tr_b16 a[64:65], v96 offset:18440
  ds_read_b64_tr_b16 a[66:67], v96 offset:18696
  s_waitcnt lgkmcnt(4)
  s_add_u32 m0, s62, 16384
  s_add_u32 s99, s90, 2359296
  buffer_load_dwordx4 v97, s[16:19], s99 offen  lds
  s_add_u32 m0, s62, 17408
  s_add_u32 s99, s90, 2506752
  buffer_load_dwordx4 v97, s[16:19], s99 offen  lds
  s_waitcnt vmcnt(38)
  ds_read_b64_tr_b16 a[68:69], v96 offset:20480
  ds_read_b64_tr_b16 a[70:71], v96 offset:20736
  ds_read_b64_tr_b16 a[72:73], v96 offset:20488
  ds_read_b64_tr_b16 a[74:75], v96 offset:20744
  s_waitcnt lgkmcnt(4)
  s_add_u32 m0, s62, 18432
  s_add_u32 s99, s90, 2359296
  buffer_load_dwordx4 v97, s[20:23], s99 offen  lds
  s_add_u32 m0, s62, 19456
  s_add_u32 s99, s90, 2506752
  buffer_load_dwordx4 v97, s[20:23], s99 offen  lds
  s_waitcnt vmcnt(36)
  ds_read_b64_tr_b16 a[76:77], v99 offset:22528
  ds_read_b64_tr_b16 a[78:79], v99 offset:22784
  s_waitcnt lgkmcnt(2)
  s_add_u32 m0, s62, 20480
  s_add_u32 s99, s91, 2359296
  s_mov_b64 exec, s[52:53]
  buffer_load_dwordx4 v98, s[16:19], s99 offen  lds
  s_mov_b64 exec, -1
  s_mov_b64 exec, s[54:55]
  buffer_load_dwordx4 v98, s[20:23], s99 offen  lds
  s_mov_b64 exec, -1
  s_add_u32 m0, s62, 21504
  s_add_u32 s99, s91, 2506752
  s_mov_b64 exec, s[52:53]
  buffer_load_dwordx4 v98, s[16:19], s99 offen  lds
  s_mov_b64 exec, -1
  s_mov_b64 exec, s[54:55]
  buffer_load_dwordx4 v98, s[20:23], s99 offen  lds
  s_mov_b64 exec, -1
  s_waitcnt vmcnt(38)
  ds_read_b64_tr_b16 a[80:81], v96 offset:24576
  ds_read_b64_tr_b16 a[82:83], v96 offset:24832
  ds_read_b64_tr_b16 a[84:85], v96 offset:24584
  ds_read_b64_tr_b16 a[86:87], v96 offset:24840
  s_waitcnt lgkmcnt(4)
  s_add_u32 m0, s62, 22528
  s_add_u32 s99, s90, 2654208
  buffer_load_dwordx4 v97, s[16:19], s99 offen  lds
  s_add_u32 m0, s62, 23552
  s_add_u32 s99, s90, 2801664
  buffer_load_dwordx4 v97, s[16:19], s99 offen  lds
  s_waitcnt vmcnt(38)
  ds_read_b64_tr_b16 a[88:89], v96 offset:26624
  ds_read_b64_tr_b16 a[90:91], v96 offset:26880
  ds_read_b64_tr_b16 a[92:93], v96 offset:26632
  ds_read_b64_tr_b16 a[94:95], v96 offset:26888
  s_waitcnt lgkmcnt(4)
  s_add_u32 m0, s62, 24576
  s_add_u32 s99, s90, 2654208
  buffer_load_dwordx4 v97, s[20:23], s99 offen  lds
  s_add_u32 m0, s62, 25600
  s_add_u32 s99, s90, 2801664
  buffer_load_dwordx4 v97, s[20:23], s99 offen  lds
  s_waitcnt vmcnt(36)
  ds_read_b64_tr_b16 a[96:97], v99 offset:28672
  ds_read_b64_tr_b16 a[98:99], v99 offset:28928
  s_waitcnt lgkmcnt(2)
  s_add_u32 m0, s62, 26624
  s_add_u32 s99, s91, 2654208
  s_mov_b64 exec, s[52:53]
  buffer_load_dwordx4 v98, s[16:19], s99 offen  lds
  s_mov_b64 exec, -1
  s_mov_b64 exec, s[54:55]
  buffer_load_dwordx4 v98, s[20:23], s99 offen  lds
  s_mov_b64 exec, -1
  s_add_u32 m0, s62, 27648
  s_add_u32 s99, s91, 2801664
  s_mov_b64 exec, s[52:53]
  buffer_load_dwordx4 v98, s[16:19], s99 offen  lds
  s_mov_b64 exec, -1
  s_mov_b64 exec, s[54:55]
  buffer_load_dwordx4 v98, s[20:23], s99 offen  lds
  s_mov_b64 exec, -1
  s_waitcnt vmcnt(38)
  ds_read_b64_tr_b16 a[100:101], v96 offset:30720
  ds_read_b64_tr_b16 a[102:103], v96 offset:30976
  ds_read_b64_tr_b16 a[104:105], v96 offset:30728
  ds_read_b64_tr_b16 a[106:107], v96 offset:30984
  s_waitcnt lgkmcnt(4)
  s_add_u32 m0, s62, 28672
  s_add_u32 s99, s90, 2949120
  buffer_load_dwordx4 v97, s[16:19], s99 offen  lds
  s_add_u32 m0, s62, 29696
  s_add_u32 s99, s90, 3096576
  buffer_load_dwordx4 v97, s[16:19], s99 offen  lds
  s_waitcnt vmcnt(38)
  ds_read_b64_tr_b16 a[108:109], v96 offset:0
  ds_read_b64_tr_b16 a[110:111], v96 offset:256
  ds_read_b64_tr_b16 a[112:113], v96 offset:8
  ds_read_b64_tr_b16 a[114:115], v96 offset:264
  s_waitcnt lgkmcnt(4)
  s_add_u32 m0, s62, 30720
  s_add_u32 s99, s90, 2949120
  buffer_load_dwordx4 v97, s[20:23], s99 offen  lds
  s_add_u32 m0, s62, 31744
  s_add_u32 s99, s90, 3096576
  buffer_load_dwordx4 v97, s[20:23], s99 offen  lds
  s_waitcnt vmcnt(36)
  ds_read_b64_tr_b16 a[116:117], v99 offset:2048
  ds_read_b64_tr_b16 a[118:119], v99 offset:2304
  s_waitcnt lgkmcnt(2)
  s_add_u32 m0, s62, 0
  s_add_u32 s99, s91, 2949120
  s_mov_b64 exec, s[52:53]
  buffer_load_dwordx4 v98, s[16:19], s99 offen  lds
  s_mov_b64 exec, -1
  s_mov_b64 exec, s[54:55]
  buffer_load_dwordx4 v98, s[20:23], s99 offen  lds
  s_mov_b64 exec, -1
  s_add_u32 m0, s62, 1024
  s_add_u32 s99, s91, 3096576
  s_mov_b64 exec, s[52:53]
  buffer_load_dwordx4 v98, s[16:19], s99 offen  lds
  s_mov_b64 exec, -1
  s_mov_b64 exec, s[54:55]
  buffer_load_dwordx4 v98, s[20:23], s99 offen  lds
  s_mov_b64 exec, -1
  s_waitcnt vmcnt(38)
  ds_read_b64_tr_b16 a[120:121], v96 offset:4096
  ds_read_b64_tr_b16 a[122:123], v96 offset:4352
  ds_read_b64_tr_b16 a[124:125], v96 offset:4104
  ds_read_b64_tr_b16 a[126:127], v96 offset:4360
  s_waitcnt lgkmcnt(4)
  s_add_u32 m0, s62, 2048
  s_add_u32 s99, s90, 3244032
  buffer_load_dwordx4 v97, s[16:19], s99 offen  lds
  s_add_u32 m0, s62, 3072
  s_add_u32 s99, s90, 3391488
  buffer_load_dwordx4 v97, s[16:19], s99 offen  lds
  s_waitcnt vmcnt(38)
  ds_read_b64_tr_b16 a[128:129], v96 offset:6144
  ds_read_b64_tr_b16 a[130:131], v96 offset:6400
  ds_read_b64_tr_b16 a[132:133], v96 offset:6152
  ds_read_b64_tr_b16 a[134:135], v96 offset:6408
  s_waitcnt lgkmcnt(4)
  s_add_u32 m0, s62, 4096
  s_add_u32 s99, s90, 3244032
  buffer_load_dwordx4 v97, s[20:23], s99 offen  lds
  s_add_u32 m0, s62, 5120
  s_add_u32 s99, s90, 3391488
  buffer_load_dwordx4 v97, s[20:23], s99 offen  lds
  s_waitcnt vmcnt(36)
  ds_read_b64_tr_b16 a[136:137], v99 offset:8192
  ds_read_b64_tr_b16 a[138:139], v99 offset:8448
  s_waitcnt lgkmcnt(2)
  s_add_u32 m0, s62, 6144
  s_add_u32 s99, s91, 3244032
  s_mov_b64 exec, s[52:53]
  buffer_load_dwordx4 v98, s[16:19], s99 offen  lds
  s_mov_b64 exec, -1
  s_mov_b64 exec, s[54:55]
  buffer_load_dwordx4 v98, s[20:23], s99 offen  lds
  s_mov_b64 exec, -1
  s_add_u32 m0, s62, 7168
  s_add_u32 s99, s91, 3391488
  s_mov_b64 exec, s[52:53]
  buffer_load_dwordx4 v98, s[16:19], s99 offen  lds
  s_mov_b64 exec, -1
  s_mov_b64 exec, s[54:55]
  buffer_load_dwordx4 v98, s[20:23], s99 offen  lds
  s_mov_b64 exec, -1
  s_waitcnt vmcnt(38)
  ds_read_b64_tr_b16 a[140:141], v96 offset:10240
  ds_read_b64_tr_b16 a[142:143], v96 offset:10496
  ds_read_b64_tr_b16 a[144:145], v96 offset:10248
  ds_read_b64_tr_b16 a[146:147], v96 offset:10504
  s_waitcnt lgkmcnt(4)
  s_add_u32 m0, s62, 8192
  s_add_u32 s99, s90, 3538944
  buffer_load_dwordx4 v97, s[16:19], s99 offen  lds
  s_add_u32 m0, s62, 9216
  s_add_u32 s99, s90, 3686400
  buffer_load_dwordx4 v97, s[16:19], s99 offen  lds
  s_waitcnt vmcnt(38)
  ds_read_b64_tr_b16 a[148:149], v96 offset:12288
  ds_read_b64_tr_b16 a[150:151], v96 offset:12544
  ds_read_b64_tr_b16 a[152:153], v96 offset:12296
  ds_read_b64_tr_b16 a[154:155], v96 offset:12552
  s_waitcnt lgkmcnt(4)
  s_add_u32 m0, s62, 10240
  s_add_u32 s99, s90, 3538944
  buffer_load_dwordx4 v97, s[20:23], s99 offen  lds
  s_add_u32 m0, s62, 11264
  s_add_u32 s99, s90, 3686400
  buffer_load_dwordx4 v97, s[20:23], s99 offen  lds
  s_waitcnt vmcnt(36)
  ds_read_b64_tr_b16 a[156:157], v99 offset:14336
  ds_read_b64_tr_b16 a[158:159], v99 offset:14592
  s_waitcnt lgkmcnt(2)
  s_add_u32 m0, s62, 12288
  s_add_u32 s99, s91, 3538944
  s_mov_b64 exec, s[52:53]
  buffer_load_dwordx4 v98, s[16:19], s99 offen  lds
  s_mov_b64 exec, -1
  s_mov_b64 exec, s[54:55]
  buffer_load_dwordx4 v98, s[20:23], s99 offen  lds
  s_mov_b64 exec, -1
  s_add_u32 m0, s62, 13312
  s_add_u32 s99, s91, 3686400
  s_mov_b64 exec, s[52:53]
  buffer_load_dwordx4 v98, s[16:19], s99 offen  lds
  s_mov_b64 exec, -1
  s_mov_b64 exec, s[54:55]
  buffer_load_dwordx4 v98, s[20:23], s99 offen  lds
  s_mov_b64 exec, -1
  s_waitcnt vmcnt(38)
  ds_read_b64_tr_b16 a[160:161], v96 offset:16384
  ds_read_b64_tr_b16 a[162:163], v96 offset:16640
  ds_read_b64_tr_b16 a[164:165], v96 offset:16392
  ds_read_b64_tr_b16 a[166:167], v96 offset:16648
  s_waitcnt lgkmcnt(4)
  s_add_u32 m0, s62, 14336
  s_add_u32 s99, s90, 3833856
  buffer_load_dwordx4 v97, s[16:19], s99 offen  lds
  s_add_u32 m0, s62, 15360
  s_add_u32 s99, s90, 3981312
  buffer_load_dwordx4 v97, s[16:19], s99 offen  lds
  s_waitcnt vmcnt(38)
  ds_read_b64_tr_b16 a[168:169], v96 offset:18432
  ds_read_b64_tr_b16 a[170:171], v96 offset:18688
  ds_read_b64_tr_b16 a[172:173], v96 offset:18440
  ds_read_b64_tr_b16 a[174:175], v96 offset:18696
  s_waitcnt lgkmcnt(4)
  s_add_u32 m0, s62, 16384
  s_add_u32 s99, s90, 3833856
  buffer_load_dwordx4 v97, s[20:23], s99 offen  lds
  s_add_u32 m0, s62, 17408
  s_add_u32 s99, s90, 3981312
  buffer_load_dwordx4 v97, s[20:23], s99 offen  lds
  s_waitcnt vmcnt(36)
  ds_read_b64_tr_b16 a[176:177], v99 offset:20480
  ds_read_b64_tr_b16 a[178:179], v99 offset:20736
  s_waitcnt lgkmcnt(2)
  s_add_u32 m0, s62, 18432
  s_add_u32 s99, s91, 3833856
  s_mov_b64 exec, s[52:53]
  buffer_load_dwordx4 v98, s[16:19], s99 offen  lds
  s_mov_b64 exec, -1
  s_mov_b64 exec, s[54:55]
  buffer_load_dwordx4 v98, s[20:23], s99 offen  lds
  s_mov_b64 exec, -1
  s_add_u32 m0, s62, 19456
  s_add_u32 s99, s91, 3981312
  s_mov_b64 exec, s[52:53]
  buffer_load_dwordx4 v98, s[16:19], s99 offen  lds
  s_mov_b64 exec, -1
  s_mov_b64 exec, s[54:55]
  buffer_load_dwordx4 v98, s[20:23], s99 offen  lds
  s_mov_b64 exec, -1
  s_waitcnt vmcnt(38)
  ds_read_b64_tr_b16 a[180:181], v96 offset:22528
  ds_read_b64_tr_b16 a[182:183], v96 offset:22784
  ds_read_b64_tr_b16 a[184:185], v96 offset:22536
  ds_read_b64_tr_b16 a[186:187], v96 offset:22792
  s_waitcnt lgkmcnt(4)
  s_add_u32 m0, s62, 20480
  s_add_u32 s99, s90, 4128768
  buffer_load_dwordx4 v97, s[16:19], s99 offen  lds
  s_add_u32 m0, s62, 21504
  s_add_u32 s99, s90, 4276224
  buffer_load_dwordx4 v97, s[16:19], s99 offen  lds
  s_waitcnt vmcnt(38)
  ds_read_b64_tr_b16 a[188:189], v96 offset:24576
  ds_read_b64_tr_b16 a[190:191], v96 offset:24832
  ds_read_b64_tr_b16 a[192:193], v96 offset:24584
  ds_read_b64_tr_b16 a[194:195], v96 offset:24840
  s_waitcnt lgkmcnt(4)
  s_add_u32 m0, s62, 22528
  s_add_u32 s99, s90, 4128768
  buffer_load_dwordx4 v97, s[20:23], s99 offen  lds
  s_add_u32 m0, s62, 23552
  s_add_u32 s99, s90, 4276224
  buffer_load_dwordx4 v97, s[20:23], s99 offen  lds
  s_waitcnt vmcnt(36)
  ds_read_b64_tr_b16 a[196:197], v99 offset:26624
  ds_read_b64_tr_b16 a[198:199], v99 offset:26880
  s_waitcnt lgkmcnt(2)
  s_add_u32 m0, s62, 24576
  s_add_u32 s99, s91, 4128768
  s_mov_b64 exec, s[52:53]
  buffer_load_dwordx4 v98, s[16:19], s99 offen  lds
  s_mov_b64 exec, -1
  s_mov_b64 exec, s[54:55]
  buffer_load_dwordx4 v98, s[20:23], s99 offen  lds
  s_mov_b64 exec, -1
  s_add_u32 m0, s62, 25600
  s_add_u32 s99, s91, 4276224
  s_mov_b64 exec, s[52:53]
  buffer_load_dwordx4 v98, s[16:19], s99 offen  lds
  s_mov_b64 exec, -1
  s_mov_b64 exec, s[54:55]
  buffer_load_dwordx4 v98, s[20:23], s99 offen  lds
  s_mov_b64 exec, -1
  s_waitcnt vmcnt(38)
  ds_read_b64_tr_b16 a[200:201], v96 offset:28672
  ds_read_b64_tr_b16 a[202:203], v96 offset:28928
  ds_read_b64_tr_b16 a[204:205], v96 offset:28680
  ds_read_b64_tr_b16 a[206:207], v96 offset:28936
  s_waitcnt lgkmcnt(4)
  s_add_u32 m0, s62, 26624
  s_add_u32 s99, s90, 4423680
  buffer_load_dwordx4 v97, s[16:19], s99 offen  lds
  s_add_u32 m0, s62, 27648
  s_add_u32 s99, s90, 4571136
  buffer_load_dwordx4 v97, s[16:19], s99 offen  lds
  s_waitcnt vmcnt(38)
  ds_read_b64_tr_b16 a[208:209], v96 offset:30720
  ds_read_b64_tr_b16 a[210:211], v96 offset:30976
  ds_read_b64_tr_b16 a[212:213], v96 offset:30728
  ds_read_b64_tr_b16 a[214:215], v96 offset:30984
  s_waitcnt lgkmcnt(4)
  s_add_u32 m0, s62, 28672
  s_add_u32 s99, s90, 4423680
  buffer_load_dwordx4 v97, s[20:23], s99 offen  lds
  s_add_u32 m0, s62, 29696
  s_add_u32 s99, s90, 4571136
  buffer_load_dwordx4 v97, s[20:23], s99 offen  lds
  s_waitcnt vmcnt(36)
  ds_read_b64_tr_b16 a[216:217], v99 offset:0
  ds_read_b64_tr_b16 a[218:219], v99 offset:256
  s_waitcnt lgkmcnt(2)
  s_add_u32 m0, s62, 30720
  s_add_u32 s99, s91, 4423680
  s_mov_b64 exec, s[52:53]
  buffer_load_dwordx4 v98, s[16:19], s99 offen  lds
  s_mov_b64 exec, -1
  s_mov_b64 exec, s[54:55]
  buffer_load_dwordx4 v98, s[20:23], s99 offen  lds
  s_mov_b64 exec, -1
  s_add_u32 m0, s62, 31744
  s_add_u32 s99, s91, 4571136
  s_mov_b64 exec, s[52:53]
  buffer_load_dwordx4 v98, s[16:19], s99 offen  lds
  s_mov_b64 exec, -1
  s_mov_b64 exec, s[54:55]
  buffer_load_dwordx4 v98, s[20:23], s99 offen  lds
  s_mov_b64 exec, -1
  s_waitcnt vmcnt(38)
  ds_read_b64_tr_b16 a[220:221], v96 offset:2048
  ds_read_b64_tr_b16 a[222:223], v96 offset:2304
  ds_read_b64_tr_b16 a[224:225], v96 offset:2056
  ds_read_b64_tr_b16 a[226:227], v96 offset:2312
  s_waitcnt lgkmcnt(4)
  s_add_u32 m0, s62, 0
  s_add_u32 s99, s90, 4718592
  buffer_load_dwordx4 v97, s[16:19], s99 offen  lds
  s_add_u32 m0, s62, 1024
  s_add_u32 s99, s90, 4866048
  buffer_load_dwordx4 v97, s[16:19], s99 offen  lds
  s_waitcnt vmcnt(38)
  ds_read_b64_tr_b16 a[228:229], v96 offset:4096
  ds_read_b64_tr_b16 a[230:231], v96 offset:4352
  ds_read_b64_tr_b16 a[232:233], v96 offset:4104
  ds_read_b64_tr_b16 a[234:235], v96 offset:4360
  s_waitcnt lgkmcnt(4)
  s_add_u32 m0, s62, 2048
  s_add_u32 s99, s90, 4718592
  buffer_load_dwordx4 v97, s[20:23], s99 offen  lds
  s_add_u32 m0, s62, 3072
  s_add_u32 s99, s90, 4866048
  buffer_load_dwordx4 v97, s[20:23], s99 offen  lds
  s_waitcnt vmcnt(36)
  ds_read_b64_tr_b16 a[236:237], v99 offset:6144
  ds_read_b64_tr_b16 a[238:239], v99 offset:6400
  s_waitcnt lgkmcnt(2)
  s_add_u32 m0, s62, 4096
  s_add_u32 s99, s91, 4718592
  s_mov_b64 exec, s[52:53]
  buffer_load_dwordx4 v98, s[16:19], s99 offen  lds
  s_mov_b64 exec, -1
  s_mov_b64 exec, s[54:55]
  buffer_load_dwordx4 v98, s[20:23], s99 offen  lds
  s_mov_b64 exec, -1
  s_add_u32 m0, s62, 5120
  s_add_u32 s99, s91, 4866048
  s_mov_b64 exec, s[52:53]
  buffer_load_dwordx4 v98, s[16:19], s99 offen  lds
  s_mov_b64 exec, -1
  s_mov_b64 exec, s[54:55]
  buffer_load_dwordx4 v98, s[20:23], s99 offen  lds
  s_mov_b64 exec, -1
  s_waitcnt vmcnt(38)
  ds_read_b64_tr_b16 a[240:241], v96 offset:8192
  ds_read_b64_tr_b16 a[242:243], v96 offset:8448
  ds_read_b64_tr_b16 a[244:245], v96 offset:8200
  ds_read_b64_tr_b16 a[246:247], v96 offset:8456
  s_waitcnt lgkmcnt(4)
  s_add_u32 m0, s62, 6144
  s_add_u32 s99, s90, 5013504
  buffer_load_dwordx4 v97, s[16:19], s99 offen  lds
  s_add_u32 m0, s62, 7168
  s_add_u32 s99, s90, 5160960
  buffer_load_dwordx4 v97, s[16:19], s99 offen  lds
  s_waitcnt vmcnt(38)
  ds_read_b64_tr_b16 a[248:249], v96 offset:10240
  ds_read_b64_tr_b16 a[250:251], v96 offset:10496
  ds_read_b64_tr_b16 a[252:253], v96 offset:10248
  ds_read_b64_tr_b16 a[254:255], v96 offset:10504
  s_waitcnt lgkmcnt(4)
  s_add_u32 m0, s62, 8192
  s_add_u32 s99, s90, 5013504
  buffer_load_dwordx4 v97, s[20:23], s99 offen  lds
  s_add_u32 m0, s62, 9216
  s_add_u32 s99, s90, 5160960
  buffer_load_dwordx4 v97, s[20:23], s99 offen  lds
  s_waitcnt vmcnt(36)
  ds_read_b64_tr_b16 v[152:153], v99 offset:12288
  ds_read_b64_tr_b16 v[154:155], v99 offset:12544
  s_waitcnt lgkmcnt(2)
  s_add_u32 m0, s62, 10240
  s_add_u32 s99, s91, 5013504
  s_mov_b64 exec, s[52:53]
  buffer_load_dwordx4 v98, s[16:19], s99 offen  lds
  s_mov_b64 exec, -1
  s_mov_b64 exec, s[54:55]
  buffer_load_dwordx4 v98, s[20:23], s99 offen  lds
  s_mov_b64 exec, -1
  s_add_u32 m0, s62, 11264
  s_add_u32 s99, s91, 5160960
  s_mov_b64 exec, s[52:53]
  buffer_load_dwordx4 v98, s[16:19], s99 offen  lds
  s_mov_b64 exec, -1
  s_mov_b64 exec, s[54:55]
  buffer_load_dwordx4 v98, s[20:23], s99 offen  lds
  s_mov_b64 exec, -1
  s_waitcnt vmcnt(38)
  ds_read_b64_tr_b16 v[156:157], v96 offset:14336
  ds_read_b64_tr_b16 v[158:159], v96 offset:14592
  ds_read_b64_tr_b16 v[160:161], v96 offset:14344
  ds_read_b64_tr_b16 v[162:163], v96 offset:14600
  s_waitcnt vmcnt(36)
  ds_read_b64_tr_b16 v[164:165], v96 offset:16384
  ds_read_b64_tr_b16 v[166:167], v96 offset:16640
  ds_read_b64_tr_b16 v[168:169], v96 offset:16392
  ds_read_b64_tr_b16 v[170:171], v96 offset:16648
  s_waitcnt vmcnt(32)
  ds_read_b64_tr_b16 v[172:173], v99 offset:18432
  ds_read_b64_tr_b16 v[174:175], v99 offset:18688
  s_waitcnt vmcnt(30)
  ds_read_b64_tr_b16 v[176:177], v96 offset:20480
  ds_read_b64_tr_b16 v[178:179], v96 offset:20736
  ds_read_b64_tr_b16 v[180:181], v96 offset:20488
  ds_read_b64_tr_b16 v[182:183], v96 offset:20744
  s_waitcnt vmcnt(28)
  ds_read_b64_tr_b16 v[184:185], v96 offset:22528
  ds_read_b64_tr_b16 v[186:187], v96 offset:22784
  ds_read_b64_tr_b16 v[188:189], v96 offset:22536
  ds_read_b64_tr_b16 v[190:191], v96 offset:22792
  s_waitcnt vmcnt(24)
  ds_read_b64_tr_b16 v[192:193], v99 offset:24576
  ds_read_b64_tr_b16 v[194:195], v99 offset:24832
  s_waitcnt vmcnt(22)
  ds_read_b64_tr_b16 v[196:197], v96 offset:26624
  ds_read_b64_tr_b16 v[198:199], v96 offset:26880
  ds_read_b64_tr_b16 v[200:201], v96 offset:26632
  ds_read_b64_tr_b16 v[202:203], v96 offset:26888
  s_waitcnt vmcnt(20)
  ds_read_b64_tr_b16 v[204:205], v96 offset:28672
  ds_read_b64_tr_b16 v[206:207], v96 offset:28928
  ds_read_b64_tr_b16 v[208:209], v96 offset:28680
  ds_read_b64_tr_b16 v[210:211], v96 offset:28936
  s_waitcnt vmcnt(16)
  ds_read_b64_tr_b16 v[212:213], v99 offset:30720
  ds_read_b64_tr_b16 v[214:215], v99 offset:30976
  s_waitcnt vmcnt(14)
  ds_read_b64_tr_b16 v[216:217], v96 offset:0
  ds_read_b64_tr_b16 v[218:219], v96 offset:256
  ds_read_b64_tr_b16 v[220:221], v96 offset:8
  ds_read_b64_tr_b16 v[222:223], v96 offset:264
  s_waitcnt vmcnt(12)
  ds_read_b64_tr_b16 v[224:225], v96 offset:2048
  ds_read_b64_tr_b16 v[226:227], v96 offset:2304
  ds_read_b64_tr_b16 v[228:229], v96 offset:2056
  ds_read_b64_tr_b16 v[230:231], v96 offset:2312
  s_waitcnt vmcnt(8)
  ds_read_b64_tr_b16 v[232:233], v99 offset:4096
  ds_read_b64_tr_b16 v[234:235], v99 offset:4352
  s_waitcnt vmcnt(6)
  ds_read_b64_tr_b16 v[236:237], v96 offset:6144
  ds_read_b64_tr_b16 v[238:239], v96 offset:6400
  ds_read_b64_tr_b16 v[240:241], v96 offset:6152
  ds_read_b64_tr_b16 v[242:243], v96 offset:6408
  s_waitcnt vmcnt(4)
  ds_read_b64_tr_b16 v[244:245], v96 offset:8192
  ds_read_b64_tr_b16 v[246:247], v96 offset:8448
  ds_read_b64_tr_b16 v[248:249], v96 offset:8200
  ds_read_b64_tr_b16 v[250:251], v96 offset:8456
  s_waitcnt vmcnt(0)
  ds_read_b64_tr_b16 v[252:253], v99 offset:10240
  ds_read_b64_tr_b16 v[254:255], v99 offset:10496
  s_waitcnt lgkmcnt(0)
  s_barrier
  v_mov_b32 v44, 0x3f803f80
  v_mov_b32 v45, 0x3f803f80
  v_mov_b32 v46, 0x3f803f80
  v_mov_b32 v47, 0x3f803f80
  s_nop 1
  v_mfma_f32_16x16x32_bf16 v[24:27], a[0:3], v[44:47], 0
  v_mfma_f32_16x16x32_bf16 v[28:31], a[4:7], v[44:47], 0
  v_mfma_f32_16x16x32_bf16 v[32:35], a[8:11], v[44:47], 0
  v_mfma_f32_16x16x32_bf16 v[36:39], a[12:15], v[44:47], 0
  v_mfma_f32_16x16x32_bf16 v[40:43], a[16:19], v[44:47], 0
  v_mfma_f32_16x16x32_bf16 v[24:27], a[20:23], v[44:47], v[24:27]
  v_mfma_f32_16x16x32_bf16 v[28:31], a[24:27], v[44:47], v[28:31]
  v_mfma_f32_16x16x32_bf16 v[32:35], a[28:31], v[44:47], v[32:35]
  v_mfma_f32_16x16x32_bf16 v[36:39], a[32:35], v[44:47], v[36:39]
  v_mfma_f32_16x16x32_bf16 v[40:43], a[36:39], v[44:47], v[40:43]
  v_mfma_f32_16x16x32_bf16 v[24:27], a[40:43], v[44:47], v[24:27]
  v_mfma_f32_16x16x32_bf16 v[28:31], a[44:47], v[44:47], v[28:31]
  v_mfma_f32_16x16x32_bf16 v[32:35], a[48:51], v[44:47], v[32:35]
  v_mfma_f32_16x16x32_bf16 v[36:39], a[52:55], v[44:47], v[36:39]
  v_mfma_f32_16x16x32_bf16 v[40:43], a[56:59], v[44:47], v[40:43]
  v_mfma_f32_16x16x32_bf16 v[24:27], a[60:63], v[44:47], v[24:27]
  v_mfma_f32_16x16x32_bf16 v[28:31], a[64:67], v[44:47], v[28:31]
  v_mfma_f32_16x16x32_bf16 v[32:35], a[68:71], v[44:47], v[32:35]
  v_mfma_f32_16x16x32_bf16 v[36:39], a[72:75], v[44:47], v[36:39]
  v_mfma_f32_16x16x32_bf16 v[40:43], a[76:79], v[44:47], v[40:43]
  v_mfma_f32_16x16x32_bf16 v[24:27], a[80:83], v[44:47], v[24:27]
  v_mfma_f32_16x16x32_bf16 v[28:31], a[84:87], v[44:47], v[28:31]
  v_mfma_f32_16x16x32_bf16 v[32:35], a[88:91], v[44:47], v[32:35]
  v_mfma_f32_16x16x32_bf16 v[36:39], a[92:95], v[44:47], v[36:39]
  v_mfma_f32_16x16x32_bf16 v[40:43], a[96:99], v[44:47], v[40:43]
  v_mfma_f32_16x16x32_bf16 v[24:27], a[100:103], v[44:47], v[24:27]
  v_mfma_f32_16x16x32_bf16 v[28:31], a[104:107], v[44:47], v[28:31]
  v_mfma_f32_16x16x32_bf16 v[32:35], a[108:111], v[44:47], v[32:35]
  v_mfma_f32_16x16x32_bf16 v[36:39], a[112:115], v[44:47], v[36:39]
  v_mfma_f32_16x16x32_bf16 v[40:43], a[116:119], v[44:47], v[40:43]
  v_mfma_f32_16x16x32_bf16 v[24:27], a[120:123], v[44:47], v[24:27]
  v_mfma_f32_16x16x32_bf16 v[28:31], a[124:127], v[44:47], v[28:31]
  v_mfma_f32_16x16x32_bf16 v[32:35], a[128:131], v[44:47], v[32:35]
  v_mfma_f32_16x16x32_bf16 v[36:39], a[132:135], v[44:47], v[36:39]
  v_mfma_f32_16x16x32_bf16 v[40:43], a[136:139], v[44:47], v[40:43]
  v_mfma_f32_16x16x32_bf16 v[24:27], a[140:143], v[44:47], v[24:27]
  v_mfma_f32_16x16x32_bf16 v[28:31], a[144:147], v[44:47], v[28:31]
  v_mfma_f32_16x16x32_bf16 v[32:35], a[148:151], v[44:47], v[32:35]
  v_mfma_f32_16x16x32_bf16 v[36:39], a[152:155], v[44:47], v[36:39]
  v_mfma_f32_16x16x32_bf16 v[40:43], a[156:159], v[44:47], v[40:43]
  v_mfma_f32_16x16x32_bf16 v[24:27], a[160:163], v[44:47], v[24:27]
  v_mfma_f32_16x16x32_bf16 v[28:31], a[164:167], v[44:47], v[28:31]
  v_mfma_f32_16x16x32_bf16 v[32:35], a[168:171], v[44:47], v[32:35]
  v_mfma_f32_16x16x32_bf16 v[36:39], a[172:175], v[44:47], v[36:39]
  v_mfma_f32_16x16x32_bf16 v[40:43], a[176:179], v[44:47], v[40:43]
  v_mfma_f32_16x16x32_bf16 v[24:27], a[180:183], v[44:47], v[24:27]
  v_mfma_f32_16x16x32_bf16 v[28:31], a[184:187], v[44:47], v[28:31]
  v_mfma_f32_16x16x32_bf16 v[32:35], a[188:191], v[44:47], v[32:35]
  v_mfma_f32_16x16x32_bf16 v[36:39], a[192:195], v[44:47], v[36:39]
  v_mfma_f32_16x16x32_bf16 v[40:43], a[196:199], v[44:47], v[40:43]
  v_mfma_f32_16x16x32_bf16 v[24:27], a[200:203], v[44:47], v[24:27]
  v_mfma_f32_16x16x32_bf16 v[28:31], a[204:207], v[44:47], v[28:31]
  v_mfma_f32_16x16x32_bf16 v[32:35], a[208:211], v[44:47], v[32:35]
  v_mfma_f32_16x16x32_bf16 v[36:39], a[212:215], v[44:47], v[36:39]
  v_mfma_f32_16x16x32_bf16 v[40:43], a[216:219], v[44:47], v[40:43]
  v_mfma_f32_16x16x32_bf16 v[24:27], a[220:223], v[44:47], v[24:27]
  v_mfma_f32_16x16x32_bf16 v[28:31], a[224:227], v[44:47], v[28:31]
  v_mfma_f32_16x16x32_bf16 v[32:35], a[228:231], v[44:47], v[32:35]
  v_mfma_f32_16x16x32_bf16 v[36:39], a[232:235], v[44:47], v[36:39]
  v_mfma_f32_16x16x32_bf16 v[40:43], a[236:239], v[44:47], v[40:43]
  v_mfma_f32_16x16x32_bf16 v[24:27], a[240:243], v[44:47], v[24:27]
  v_mfma_f32_16x16x32_bf16 v[28:31], a[244:247], v[44:47], v[28:31]
  v_mfma_f32_16x16x32_bf16 v[32:35], a[248:251], v[44:47], v[32:35]
  v_mfma_f32_16x16x32_bf16 v[36:39], a[252:255], v[44:47], v[36:39]
  v_mfma_f32_16x16x32_bf16 v[40:43], v[152:155], v[44:47], v[40:43]
  v_mfma_f32_16x16x32_bf16 v[24:27], v[156:159], v[44:47], v[24:27]
  v_mfma_f32_16x16x32_bf16 v[28:31], v[160:163], v[44:47], v[28:31]
  v_mfma_f32_16x16x32_bf16 v[32:35], v[164:167], v[44:47], v[32:35]
  v_mfma_f32_16x16x32_bf16 v[36:39], v[168:171], v[44:47], v[36:39]
  v_mfma_f32_16x16x32_bf16 v[40:43], v[172:175], v[44:47], v[40:43]
  v_mfma_f32_16x16x32_bf16 v[24:27], v[176:179], v[44:47], v[24:27]
  v_mfma_f32_16x16x32_bf16 v[28:31], v[180:183], v[44:47], v[28:31]
  v_mfma_f32_16x16x32_bf16 v[32:35], v[184:187], v[44:47], v[32:35]
  v_mfma_f32_16x16x32_bf16 v[36:39], v[188:191], v[44:47], v[36:39]
  v_mfma_f32_16x16x32_bf16 v[40:43], v[192:195], v[44:47], v[40:43]
  v_mfma_f32_16x16x32_bf16 v[24:27], v[196:199], v[44:47], v[24:27]
  v_mfma_f32_16x16x32_bf16 v[28:31], v[200:203], v[44:47], v[28:31]
  v_mfma_f32_16x16x32_bf16 v[32:35], v[204:207], v[44:47], v[32:35]
  v_mfma_f32_16x16x32_bf16 v[36:39], v[208:211], v[44:47], v[36:39]
  v_mfma_f32_16x16x32_bf16 v[40:43], v[212:215], v[44:47], v[40:43]
  v_mfma_f32_16x16x32_bf16 v[24:27], v[216:219], v[44:47], v[24:27]
  v_mfma_f32_16x16x32_bf16 v[28:31], v[220:223], v[44:47], v[28:31]
  v_mfma_f32_16x16x32_bf16 v[32:35], v[224:227], v[44:47], v[32:35]
  v_mfma_f32_16x16x32_bf16 v[36:39], v[228:231], v[44:47], v[36:39]
  v_mfma_f32_16x16x32_bf16 v[40:43], v[232:235], v[44:47], v[40:43]
  v_mfma_f32_16x16x32_bf16 v[24:27], v[236:239], v[44:47], v[24:27]
  v_mfma_f32_16x16x32_bf16 v[28:31], v[240:243], v[44:47], v[28:31]
  v_mfma_f32_16x16x32_bf16 v[32:35], v[244:247], v[44:47], v[32:35]
  v_mfma_f32_16x16x32_bf16 v[36:39], v[248:251], v[44:47], v[36:39]
  v_mfma_f32_16x16x32_bf16 v[40:43], v[252:255], v[44:47], v[40:43]
  v_mov_b32 v96, 64
  s_mov_b64 exec, 1
L_wa_88:
  global_load_dword v97, v96, s[4:5] sc1
  s_waitcnt vmcnt(0)
  v_readfirstlane_b32 s98, v97
  s_nop 0
  s_cmp_ge_u32 s98, 256
  s_nop 1
  s_cbranch_scc1 L_wa_88d
  s_sleep 8
  s_sub_u32 s100, s100, 1
  s_cbranch_scc0 L_wa_88
  s_branch L_end
L_wa_88d:
  s_mov_b64 exec, -1
  s_mov_b32 s28, s12
  s_mov_b32 s29, s13
  s_mov_b32 s30, 0
  s_mov_b32 s31, 0x20000
  s_lshl_b32 s45, s9, 8
  s_add_u32 s45, s45, 82944
  v_mbcnt_lo_u32_b32 v14, -1, 0
  v_mbcnt_hi_u32_b32 v14, -1, v14
  v_lshl_add_u32 v14, v14, 2, s45
  v_mov_b32 v5, 0
  ds_write_b32 v14, v5
  s_mov_b32 s32, 0
L_bk_89:
  s_mov_b64 exec, s[40:41]
  buffer_load_dword v5, v7, s[12:15], s36 offen sc1
  s_mov_b64 exec, -1
  s_add_u32 s98, s32, 1
  s_mov_b64 exec, s[40:41]
  s_waitcnt vmcnt(0)
  v_cmp_gt_u32 vcc, s98, v5
  s_mov_b64 exec, -1
  s_cbranch_vccz L_bk_89d
  s_sleep 1
  s_sub_u32 s100, s100, 1
  s_cbranch_scc0 L_bk_89
  s_branch L_end
L_bk_89d:
  s_add_u32 m0, s34, 0
  s_add_u32 s98, s33, 0
  buffer_load_dwordx4 v0, s[12:15], s98 offen offset:0 sc1 lds
  buffer_load_dwordx4 v0, s[12:15], s98 offen offset:1024 sc1 lds
  buffer_load_dwordx4 v0, s[12:15], s98 offen offset:2048 sc1 lds
  buffer_load_dwordx4 v0, s[12:15], s98 offen offset:3072 sc1 lds
  s_add_u32 m0, s34, 4096
  s_add_u32 s98, s33, 4096
  buffer_load_dwordx4 v0, s[12:15], s98 offen offset:0 sc1 lds
  buffer_load_dwordx4 v0, s[12:15], s98 offen offset:1024 sc1 lds
  buffer_load_dwordx4 v0, s[12:15], s98 offen offset:2048 sc1 lds
  buffer_load_dwordx4 v0, s[12:15], s98 offen offset:3072 sc1 lds
  s_add_u32 m0, s34, 8192
  s_add_u32 s98, s33, 8192
  buffer_load_dwordx4 v0, s[12:15], s98 offen offset:0 sc1 lds
  buffer_load_dwordx4 v0, s[12:15], s98 offen offset:1024 sc1 lds
  s_mov_b64 exec, 0xff
  buffer_load_dwordx4 v0, s[12:15], s98 offen offset:2048 sc1 lds
  s_mov_b64 exec, -1
  s_add_u32 s33, s33, 41472
  s_xor_b32 s34, s34, s39
  s_mov_b32 s35, 1
  s_waitcnt vmcnt(0)
L_u_loop:
  s_barrier
  ds_read_b128 v[44:47], v2 offset:0
  ds_read_b128 v[48:51], v2 offset:2304
  ds_read_b128 v[52:55], v2 offset:4608
  ds_read_b128 v[56:59], v2 offset:6912
  s_cmp_ge_u32 s32, 63
  s_cselect_b32 s35, 1, 0
  ds_read_b64 v[16:17], v4 offset:0
  ds_read_b64 v[18:19], v4 offset:2304
  s_mov_b32 m0, s45
  s_waitcnt lgkmcnt(5)
  v_mfma_f32_16x16x32_bf16 v[60:63], a[0:3], v[44:47], 0
  v_mfma_f32_16x16x32_bf16 v[64:67], a[4:7], v[44:47], 0
  s_mov_b64 exec, s[40:41]
  buffer_load_dword v7, s[12:15], s36 offen sc1 lds
  s_mov_b64 exec, -1
  v_mfma_f32_16x16x32_bf16 v[68:71], a[8:11], v[44:47], 0
  ds_read_b64 v[20:21], v4 offset:4608
  s_waitcnt lgkmcnt(1)
  v_add_f32 v22, v16, v18
  v_mfma_f32_16x16x32_bf16 v[72:75], a[12:15], v[44:47], 0
  v_mfma_f32_16x16x32_bf16 v[76:79], a[16:19], v[44:47], 0
  ds_read_b128 v[44:47], v2 offset:9216
  v_add_f32 v23, v17, v19
  v_mfma_f32_16x16x32_bf16 v[60:63], a[20:23], v[48:51], v[60:63]
  v_mfma_f32_16x16x32_bf16 v[64:67], a[24:27], v[48:51], v[64:67]
  v_mfma_f32_16x16x32_bf16 v[68:71], a[28:31], v[48:51], v[68:71]
  s_waitcnt lgkmcnt(1)
  v_add_f32 v22, v22, v20
  v_add_f32 v23, v23, v21
  v_mfma_f32_16x16x32_bf16 v[72:75], a[32:35], v[48:51], v[72:75]
  ds_read_b64 v[16:17], v4 offset:6912
  ds_read_b64 v[18:19], v4 offset:9216
  v_mfma_f32_16x16x32_bf16 v[76:79], a[36:39], v[48:51], v[76:79]
  ds_read_b64 v[20:21], v4 offset:11520
  ds_read_b128 v[48:51], v2 offset:11520
  v_mfma_f32_16x16x32_bf16 v[60:63], a[40:43], v[52:55], v[60:63]
  v_mfma_f32_16x16x32_bf16 v[64:67], a[44:47], v[52:55], v[64:67]
  v_mfma_f32_16x16x32_bf16 v[68:71], a[48:51], v[52:55], v[68:71]
  v_mfma_f32_16x16x32_bf16 v[72:75], a[52:55], v[52:55], v[72:75]
  s_waitcnt lgkmcnt(3)
  v_add_f32 v22, v22, v16
  v_add_f32 v23, v23, v17
  v_mfma_f32_16x16x32_bf16 v[76:79], a[56:59], v[52:55], v[76:79]
  s_waitcnt lgkmcnt(2)
  v_add_f32 v22, v22, v18
  v_add_f32 v23, v23, v19
  v_mfma_f32_16x16x32_bf16 v[60:63], a[60:63], v[56:59], v[60:63]
  s_waitcnt lgkmcnt(1)
  v_add_f32 v22, v22, v20
  v_add_f32 v23, v23, v21
  v_mfma_f32_16x16x32_bf16 v[64:67], a[64:67], v[56:59], v[64:67]
  ds_read_b64 v[16:17], v4 offset:13824
  ds_read_b64 v[18:19], v4 offset:16128
  v_mfma_f32_16x16x32_bf16 v[68:71], a[68:71], v[56:59], v[68:71]
  ds_read_b128 v[52:55], v2 offset:13824
  v_mfma_f32_16x16x32_bf16 v[72:75], a[72:75], v[56:59], v[72:75]
  v_mfma_f32_16x16x32_bf16 v[76:79], a[76:79], v[56:59], v[76:79]
  v_mfma_f32_16x16x32_bf16 v[60:63], a[80:83], v[44:47], v[60:63]
  v_mfma_f32_16x16x32_bf16 v[64:67], a[84:87], v[44:47], v[64:67]
  s_waitcnt lgkmcnt(2)
  v_add_f32 v22, v22, v16
  v_add_f32 v23, v23, v17
  v_mfma_f32_16x16x32_bf16 v[68:71], a[88:91], v[44:47], v[68:71]
  s_waitcnt lgkmcnt(1)
  v_add_f32 v22, v22, v18
  v_add_f32 v23, v23, v19
  v_mfma_f32_16x16x32_bf16 v[72:75], a[92:95], v[44:47], v[72:75]
  v_mov_b32 v16, v22
  v_mov_b32 v17, v23
  v_mfma_f32_16x16x32_bf16 v[76:79], a[96:99], v[44:47], v[76:79]
  ds_read_b128 v[56:59], v2 offset:16128
  v_permlane32_swap_b32 v22, v16
  v_mfma_f32_16x16x32_bf16 v[60:63], a[100:103], v[48:51], v[60:63]
  v_permlane32_swap_b32 v23, v17
  v_mfma_f32_16x16x32_bf16 v[64:67], a[104:107], v[48:51], v[64:67]
  v_add_f32 v22, v22, v16
  v_add_f32 v23, v23, v17
  v_mfma_f32_16x16x32_bf16 v[68:71], a[108:111], v[48:51], v[68:71]
  v_mul_f32 v22, 0x3ae38e39, v22
  v_mul_f32 v23, 0x3ae38e39, v23
  v_mfma_f32_16x16x32_bf16 v[72:75], a[112:115], v[48:51], v[72:75]
  v_fma_f32 v23, -v22, v22, v23
  v_max_f32 v23, 0, v23
  s_waitcnt vmcnt(1)
  v_mfma_f32_16x16x32_bf16 v[76:79], a[116:119], v[48:51], v[76:79]
  v_mov_b32 v6, s32
  s_mov_b64 exec, 1
  buffer_store_dword v6, off, s[12:15], s37 sc1
  s_mov_b64 exec, -1
  ds_read_b32 v5, v14
  ds_read_b128 v[44:47], v2 offset:18432
  v_add_f32 v23, 0x3727c5ac, v23
  v_rsq_f32 v23, v23
  v_mov_b32 v8, v22
  v_mov_b32 v10, v22
  v_mov_b32 v9, v23
  v_mov_b32 v11, v23
  v_permlane16_swap_b32 v8, v10
  s_cmp_lg_u32 s35, 0
  s_cbranch_scc1 L_wn_90p
  s_add_u32 s98, s32, 2
  s_mov_b64 exec, s[40:41]
  s_waitcnt lgkmcnt(1)
  v_cmp_gt_u32 vcc, s98, v5
  s_mov_b64 exec, -1
  s_cbranch_vccz L_wn_90d
  s_mov_b32 m0, s45
  s_mov_b64 exec, s[40:41]
  buffer_load_dword v7, s[12:15], s36 offen sc1 lds
  s_mov_b64 exec, -1
L_wn_90p:
  s_waitcnt lgkmcnt(3)
  v_mfma_f32_16x16x32_bf16 v[60:63], a[120:123], v[52:55], v[60:63]
  ds_read_b128 v[48:51], v2 offset:20736
  v_permlane16_swap_b32 v9, v11
  v_mfma_f32_16x16x32_bf16 v[64:67], a[124:127], v[52:55], v[64:67]
  s_mov_b64 exec, s[46:47]
  v_swap_b32 v8, v10
  v_swap_b32 v9, v11
  s_mov_b64 exec, -1
  v_mfma_f32_16x16x32_bf16 v[68:71], a[128:131], v[52:55], v[68:71]
  v_rcp_f32 v12, v9
  v_mfma_f32_16x16x32_bf16 v[72:75], a[132:135], v[52:55], v[72:75]
  v_rcp_f32 v13, v11
  v_mfma_f32_16x16x32_bf16 v[76:79], a[136:139], v[52:55], v[76:79]
  ds_read_b128 v[52:55], v2 offset:23040
  s_waitcnt lgkmcnt(4)
  v_mfma_f32_16x16x32_bf16 v[60:63], a[140:143], v[56:59], v[60:63]
  v_mfma_f32_16x16x32_bf16 v[64:67], a[144:147], v[56:59], v[64:67]
  v_mfma_f32_16x16x32_bf16 v[68:71], a[148:151], v[56:59], v[68:71]
  v_mfma_f32_16x16x32_bf16 v[72:75], a[152:155], v[56:59], v[72:75]
  v_mfma_f32_16x16x32_bf16 v[76:79], a[156:159], v[56:59], v[76:79]
  ds_read_b128 v[56:59], v2 offset:25344
  s_waitcnt lgkmcnt(3)
  v_mfma_f32_16x16x32_bf16 v[60:63], a[160:163], v[44:47], v[60:63]
  v_mfma_f32_16x16x32_bf16 v[64:67], a[164:167], v[44:47], v[64:67]
  v_mfma_f32_16x16x32_bf16 v[68:71], a[168:171], v[44:47], v[68:71]
  v_mfma_f32_16x16x32_bf16 v[72:75], a[172:175], v[44:47], v[72:75]
  v_mfma_f32_16x16x32_bf16 v[76:79], a[176:179], v[44:47], v[76:79]
  ds_read_b128 v[44:47], v2 offset:27648
  s_waitcnt lgkmcnt(3)
  v_mfma_f32_16x16x32_bf16 v[60:63], a[180:183], v[48:51], v[60:63]
  v_mfma_f32_16x16x32_bf16 v[64:67], a[184:187], v[48:51], v[64:67]
  v_mfma_f32_16x16x32_bf16 v[68:71], a[188:191], v[48:51], v[68:71]
  v_mfma_f32_16x16x32_bf16 v[72:75], a[192:195], v[48:51], v[72:75]
  v_mfma_f32_16x16x32_bf16 v[76:79], a[196:199], v[48:51], v[76:79]
  ds_read_b128 v[48:51], v2 offset:29952
  s_waitcnt lgkmcnt(3)
  v_mfma_f32_16x16x32_bf16 v[60:63], a[200:203], v[52:55], v[60:63]
  v_mfma_f32_16x16x32_bf16 v[64:67], a[204:207], v[52:55], v[64:67]
  v_mfma_f32_16x16x32_bf16 v[68:71], a[208:211], v[52:55], v[68:71]
  v_mfma_f32_16x16x32_bf16 v[72:75], a[212:215], v[52:55], v[72:75]
  v_mfma_f32_16x16x32_bf16 v[76:79], a[216:219], v[52:55], v[76:79]
  ds_read_b128 v[52:55], v2 offset:32256
  s_waitcnt lgkmcnt(3)
  v_mfma_f32_16x16x32_bf16 v[60:63], a[220:223], v[56:59], v[60:63]
  v_mfma_f32_16x16x32_bf16 v[64:67], a[224:227], v[56:59], v[64:67]
  v_mfma_f32_16x16x32_bf16 v[68:71], a[228:231], v[56:59], v[68:71]
  v_mfma_f32_16x16x32_bf16 v[72:75], a[232:235], v[56:59], v[72:75]
  v_mfma_f32_16x16x32_bf16 v[76:79], a[236:239], v[56:59], v[76:79]
  ds_read_b128 v[56:59], v2 offset:34560
  s_waitcnt lgkmcnt(3)
  v_mfma_f32_16x16x32_bf16 v[60:63], a[240:243], v[44:47], v[60:63]
  v_mfma_f32_16x16x32_bf16 v[64:67], a[244:247], v[44:47], v[64:67]
  v_mfma_f32_16x16x32_bf16 v[68:71], a[248:251], v[44:47], v[68:71]
  v_mfma_f32_16x16x32_bf16 v[72:75], a[252:255], v[44:47], v[72:75]
  v_mfma_f32_16x16x32_bf16 v[76:79], v[152:155], v[44:47], v[76:79]
L_wn_90j:
  s_waitcnt lgkmcnt(2)
  v_mfma_f32_16x16x32_bf16 v[60:63], v[156:159], v[48:51], v[60:63]
  ds_read_b128 v[44:47], v2 offset:36864
  s_cmp_lg_u32 s35, 0
  v_mfma_f32_16x16x32_bf16 v[64:67], v[160:163], v[48:51], v[64:67]
  v_mfma_f32_16x16x32_bf16 v[68:71], v[164:167], v[48:51], v[68:71]
  v_mfma_f32_16x16x32_bf16 v[72:75], v[168:171], v[48:51], v[72:75]
  v_mfma_f32_16x16x32_bf16 v[76:79], v[172:175], v[48:51], v[76:79]
  s_cbranch_scc1 L_wn_91p
  s_add_u32 s98, s32, 2
  s_mov_b64 exec, s[40:41]
  v_cmp_gt_u32 vcc, s98, v5
  s_mov_b64 exec, -1
  s_cbranch_vccz L_wn_91d
  s_mov_b32 m0, s45
  s_mov_b64 exec, s[40:41]
  buffer_load_dword v7, s[12:15], s36 offen sc1 lds
  s_mov_b64 exec, -1
L_wn_91p:
  s_waitcnt lgkmcnt(2)
  v_mfma_f32_16x16x32_bf16 v[60:63], v[176:179], v[52:55], v[60:63]
  ds_read_b128 v[48:51], v2 offset:39168
  v_mfma_f32_16x16x32_bf16 v[64:67], v[180:183], v[52:55], v[64:67]
  v_mfma_f32_16x16x32_bf16 v[68:71], v[184:187], v[52:55], v[68:71]
  v_mfma_f32_16x16x32_bf16 v[72:75], v[188:191], v[52:55], v[72:75]
  v_mfma_f32_16x16x32_bf16 v[76:79], v[192:195], v[52:55], v[76:79]
  ds_read_b128 v[52:55], v3 offset:0
  s_waitcnt lgkmcnt(3)
  v_mfma_f32_16x16x32_bf16 v[60:63], v[196:199], v[56:59], v[60:63]
  v_mfma_f32_16x16x32_bf16 v[64:67], v[200:203], v[56:59], v[64:67]
  v_mfma_f32_16x16x32_bf16 v[68:71], v[204:207], v[56:59], v[68:71]
  v_mfma_f32_16x16x32_bf16 v[72:75], v[208:211], v[56:59], v[72:75]
  v_mfma_f32_16x16x32_bf16 v[76:79], v[212:215], v[56:59], v[76:79]
  ds_read_b128 v[56:59], v3 offset:2304
  s_waitcnt lgkmcnt(3)
  v_mfma_f32_16x16x32_bf16 v[60:63], v[216:219], v[44:47], v[60:63]
  v_mfma_f32_16x16x32_bf16 v[64:67], v[220:223], v[44:47], v[64:67]
  v_mfma_f32_16x16x32_bf16 v[68:71], v[224:227], v[44:47], v[68:71]
  v_mfma_f32_16x16x32_bf16 v[72:75], v[228:231], v[44:47], v[72:75]
  v_mfma_f32_16x16x32_bf16 v[76:79], v[232:235], v[44:47], v[76:79]
  ds_read_b128 v[44:47], v3 offset:4608
  s_waitcnt lgkmcnt(3)
  v_mfma_f32_16x16x32_bf16 v[60:63], v[236:239], v[48:51], v[60:63]
  v_mfma_f32_16x16x32_bf16 v[64:67], v[240:243], v[48:51], v[64:67]
  v_mfma_f32_16x16x32_bf16 v[68:71], v[244:247], v[48:51], v[68:71]
  v_mfma_f32_16x16x32_bf16 v[72:75], v[248:251], v[48:51], v[72:75]
  v_mfma_f32_16x16x32_bf16 v[76:79], v[252:255], v[48:51], v[76:79]
  ds_read_b128 v[48:51], v3 offset:6912
  v_mov_b32 v16, s56
  s_nop 1
  v_fma_f32 v60, -v8, v24, v60
  s_waitcnt lgkmcnt(3)
  v_mfma_f32_16x16x32_bf16 v[80:83], a[0:3], v[52:55], 0
  v_fma_f32 v61, -v8, v25, v61
  v_fma_f32 v62, -v8, v26, v62
  v_mfma_f32_16x16x32_bf16 v[84:87], a[4:7], v[52:55], 0
  v_mfma_f32_16x16x32_bf16 v[88:91], a[8:11], v[52:55], 0
  v_mfma_f32_16x16x32_bf16 v[92:95], a[12:15], v[52:55], 0
  ds_read_b128 v[52:55], v3 offset:9216
  v_fma_f32 v63, -v8, v27, v63
  v_fma_f32 v64, -v8, v28, v64
  s_waitcnt lgkmcnt(3)
  v_mfma_f32_16x16x32_bf16 v[80:83], a[20:23], v[56:59], v[80:83]
  v_fma_f32 v65, -v8, v29, v65
  v_fma_f32 v66, -v8, v30, v66
  v_mfma_f32_16x16x32_bf16 v[84:87], a[24:27], v[56:59], v[84:87]
  v_fma_f32 v67, -v8, v31, v67
  v_fma_f32 v68, -v8, v32, v68
  v_mfma_f32_16x16x32_bf16 v[88:91], a[28:31], v[56:59], v[88:91]
  v_fma_f32 v69, -v8, v33, v69
  v_fma_f32 v70, -v8, v34, v70
  v_mfma_f32_16x16x32_bf16 v[92:95], a[32:35], v[56:59], v[92:95]
  ds_read_b128 v[56:59], v3 offset:11520
  v_fma_f32 v71, -v8, v35, v71
  v_fma_f32 v72, -v8, v36, v72
  s_waitcnt lgkmcnt(3)
  v_mfma_f32_16x16x32_bf16 v[80:83], a[40:43], v[44:47], v[80:83]
  v_fma_f32 v73, -v8, v37, v73
  v_fma_f32 v74, -v8, v38, v74
  v_mfma_f32_16x16x32_bf16 v[84:87], a[44:47], v[44:47], v[84:87]
  v_fma_f32 v75, -v8, v39, v75
  v_fma_f32 v76, -v8, v40, v76
  v_mfma_f32_16x16x32_bf16 v[88:91], a[48:51], v[44:47], v[88:91]
  v_fma_f32 v77, -v8, v41, v77
  v_fma_f32 v78, -v8, v42, v78
  v_mfma_f32_16x16x32_bf16 v[92:95], a[52:55], v[44:47], v[92:95]
  ds_read_b128 v[44:47], v3 offset:13824
  v_fma_f32 v79, -v8, v43, v79
  v_mul_f32 v60, v9, v60
  s_waitcnt lgkmcnt(3)
  v_mfma_f32_16x16x32_bf16 v[80:83], a[60:63], v[48:51], v[80:83]
  v_mul_f32 v61, v9, v61
  v_mul_f32 v62, v9, v62
  v_mfma_f32_16x16x32_bf16 v[84:87], a[64:67], v[48:51], v[84:87]
  v_mul_f32 v63, v9, v63
  v_mul_f32 v64, v9, v64
  v_mfma_f32_16x16x32_bf16 v[88:91], a[68:71], v[48:51], v[88:91]
L_wn_91j:
  v_mfma_f32_16x16x32_bf16 v[92:95], a[72:75], v[48:51], v[92:95]
  v_mul_f32 v65, v9, v65
  v_mul_f32 v66, v9, v66
  s_cmp_lg_u32 s35, 0
  s_cbranch_scc1 L_wn_92p
  s_add_u32 s98, s32, 2
  s_mov_b64 exec, s[40:41]
  v_cmp_gt_u32 vcc, s98, v5
  s_mov_b64 exec, -1
  s_cbranch_vccz L_wn_92d
  s_mov_b32 m0, s45
  s_mov_b64 exec, s[40:41]
  buffer_load_dword v7, s[12:15], s36 offen sc1 lds
  s_mov_b64 exec, -1
L_wn_92p:
  s_waitcnt lgkmcnt(2)
  v_mfma_f32_16x16x32_bf16 v[80:83], a[80:83], v[52:55], v[80:83]
  ds_read_b128 v[48:51], v3 offset:16128
  v_mul_f32 v67, v9, v67
  v_mfma_f32_16x16x32_bf16 v[84:87], a[84:87], v[52:55], v[84:87]
  v_permlane32_swap_b32 v76, v77
  v_mfma_f32_16x16x32_bf16 v[88:91], a[88:91], v[52:55], v[88:91]
  v_permlane32_swap_b32 v78, v79
  v_mfma_f32_16x16x32_bf16 v[92:95], a[92:95], v[52:55], v[92:95]
  v_mul_f32 v76, v9, v76
  v_mul_f32 v78, v9, v78
  s_waitcnt lgkmcnt(2)
  v_mfma_f32_16x16x32_bf16 v[80:83], a[100:103], v[56:59], v[80:83]
  ds_read_b128 v[52:55], v3 offset:18432
  v_mul_f32 v96, v60, v60
  v_mul_f32 v97, v61, v61
  v_mfma_f32_16x16x32_bf16 v[84:87], a[104:107], v[56:59], v[84:87]
  v_mul_f32 v98, v62, v62
  v_mul_f32 v99, v63, v63
  v_mfma_f32_16x16x32_bf16 v[88:91], a[108:111], v[56:59], v[88:91]
  v_mul_f32 v68, v60, v68
  v_mul_f32 v69, v61, v69
  v_mfma_f32_16x16x32_bf16 v[92:95], a[112:115], v[56:59], v[92:95]
  v_mul_f32 v70, v62, v70
  v_mul_f32 v71, v63, v71
  s_waitcnt lgkmcnt(2)
  v_mfma_f32_16x16x32_bf16 v[80:83], a[120:123], v[44:47], v[80:83]
  ds_read_b128 v[56:59], v3 offset:20736
  v_fma_f32 v96, v96, s58, v16
  v_fma_f32 v97, v97, s58, v16
  v_mfma_f32_16x16x32_bf16 v[84:87], a[124:127], v[44:47], v[84:87]
  v_fma_f32 v98, v98, s58, v16
  v_fma_f32 v99, v99, s58, v16
  v_mfma_f32_16x16x32_bf16 v[88:91], a[128:131], v[44:47], v[88:91]
  v_mul_f32 v96, v60, v96
  v_mul_f32 v97, v61, v97
  v_mfma_f32_16x16x32_bf16 v[92:95], a[132:135], v[44:47], v[92:95]
  v_mul_f32 v98, v62, v98
  v_mul_f32 v99, v63, v99
  s_waitcnt lgkmcnt(2)
  v_mfma_f32_16x16x32_bf16 v[80:83], a[140:143], v[48:51], v[80:83]
  ds_read_b128 v[44:47], v3 offset:23040
  v_exp_f32 v96, v96
  v_mfma_f32_16x16x32_bf16 v[84:87], a[144:147], v[48:51], v[84:87]
  v_exp_f32 v97, v97
  v_mfma_f32_16x16x32_bf16 v[88:91], a[148:151], v[48:51], v[88:91]
  v_exp_f32 v98, v98
  v_mfma_f32_16x16x32_bf16 v[92:95], a[152:155], v[48:51], v[92:95]
  v_exp_f32 v99, v99
  s_waitcnt lgkmcnt(2)
  v_mfma_f32_16x16x32_bf16 v[80:83], a[160:163], v[52:55], v[80:83]
  ds_read_b128 v[48:51], v3 offset:25344
  v_fma_f32 v96, v96, v12, v12
  v_fma_f32 v97, v97, v12, v12
  v_mfma_f32_16x16x32_bf16 v[84:87], a[164:167], v[52:55], v[84:87]
  v_fma_f32 v98, v98, v12, v12
  v_fma_f32 v99, v99, v12, v12
  v_mfma_f32_16x16x32_bf16 v[88:91], a[168:171], v[52:55], v[88:91]
  v_rcp_f32 v96, v96
  v_mfma_f32_16x16x32_bf16 v[92:95], a[172:175], v[52:55], v[92:95]
  v_rcp_f32 v97, v97
  s_waitcnt lgkmcnt(2)
  v_mfma_f32_16x16x32_bf16 v[80:83], a[180:183], v[56:59], v[80:83]
  ds_read_b128 v[52:55], v3 offset:27648
  v_rcp_f32 v98, v98
  v_mfma_f32_16x16x32_bf16 v[84:87], a[184:187], v[56:59], v[84:87]
  v_rcp_f32 v99, v99
  v_mfma_f32_16x16x32_bf16 v[88:91], a[188:191], v[56:59], v[88:91]
  v_mul_f32 v60, v68, v96
  v_mul_f32 v61, v69, v97
  v_mfma_f32_16x16x32_bf16 v[92:95], a[192:195], v[56:59], v[92:95]
  v_mul_f32 v62, v70, v98
  v_mul_f32 v63, v71, v99
  s_waitcnt lgkmcnt(2)
  v_mfma_f32_16x16x32_bf16 v[80:83], a[200:203], v[44:47], v[80:83]
  ds_read_b128 v[56:59], v3 offset:29952
  v_mul_f32 v96, v64, v64
  v_mul_f32 v97, v65, v65
  v_mfma_f32_16x16x32_bf16 v[84:87], a[204:207], v[44:47], v[84:87]
  v_mul_f32 v98, v66, v66
  v_mul_f32 v99, v67, v67
  v_mfma_f32_16x16x32_bf16 v[88:91], a[208:211], v[44:47], v[88:91]
  v_mul_f32 v72, v64, v72
  v_mul_f32 v73, v65, v73
  v_mfma_f32_16x16x32_bf16 v[92:95], a[212:215], v[44:47], v[92:95]
  v_mul_f32 v74, v66, v74
  v_mul_f32 v75, v67, v75
  s_waitcnt lgkmcnt(2)
  v_mfma_f32_16x16x32_bf16 v[80:83], a[220:223], v[48:51], v[80:83]
  ds_read_b128 v[44:47], v3 offset:32256
  v_fma_f32 v96, v96, s58, v16
  v_fma_f32 v97, v97, s58, v16
  v_mfma_f32_16x16x32_bf16 v[84:87], a[224:227], v[48:51], v[84:87]
  v_fma_f32 v98, v98, s58, v16
  v_fma_f32 v99, v99, s58, v16
  v_mfma_f32_16x16x32_bf16 v[88:91], a[228:231], v[48:51], v[88:91]
  v_mul_f32 v96, v64, v96
  v_mul_f32 v97, v65, v97
  v_mfma_f32_16x16x32_bf16 v[92:95], a[232:235], v[48:51], v[92:95]
  v_mul_f32 v98, v66, v98
  v_mul_f32 v99, v67, v99
  s_waitcnt lgkmcnt(2)
  v_mfma_f32_16x16x32_bf16 v[80:83], a[240:243], v[52:55], v[80:83]
  ds_read_b128 v[48:51], v3 offset:34560
  v_exp_f32 v96, v96
  v_mfma_f32_16x16x32_bf16 v[84:87], a[244:247], v[52:55], v[84:87]
  v_exp_f32 v97, v97
  v_mfma_f32_16x16x32_bf16 v[88:91], a[248:251], v[52:55], v[88:91]
  v_exp_f32 v98, v98
L_wn_92j:
  s_cmp_lg_u32 s35, 0
  s_cbranch_scc1 L_wn_93p
  s_add_u32 s98, s32, 2
  s_mov_b64 exec, s[40:41]
  v_cmp_gt_u32 vcc, s98, v5
  s_mov_b64 exec, -1
  s_cbranch_vccz L_wn_93d
  s_mov_b32 m0, s45
  s_mov_b64 exec, s[40:41]
  buffer_load_dword v7, s[12:15], s36 offen sc1 lds
  s_mov_b64 exec, -1
L_wn_93p:
  v_mfma_f32_16x16x32_bf16 v[92:95], a[252:255], v[52:55], v[92:95]
  v_exp_f32 v99, v99
  s_waitcnt lgkmcnt(2)
  v_mfma_f32_16x16x32_bf16 v[80:83], v[156:159], v[56:59], v[80:83]
  ds_read_b128 v[52:55], v3 offset:36864
  v_fma_f32 v96, v96, v12, v12
  v_fma_f32 v97, v97, v12, v12
  v_mfma_f32_16x16x32_bf16 v[84:87], v[160:163], v[56:59], v[84:87]
  v_fma_f32 v98, v98, v12, v12
  v_fma_f32 v99, v99, v12, v12
  v_mfma_f32_16x16x32_bf16 v[88:91], v[164:167], v[56:59], v[88:91]
  v_rcp_f32 v96, v96
  v_mfma_f32_16x16x32_bf16 v[92:95], v[168:171], v[56:59], v[92:95]
  v_rcp_f32 v97, v97
  s_waitcnt lgkmcnt(2)
  v_mfma_f32_16x16x32_bf16 v[80:83], v[176:179], v[44:47], v[80:83]
  ds_read_b128 v[56:59], v3 offset:39168
  v_rcp_f32 v98, v98
  v_mfma_f32_16x16x32_bf16 v[84:87], v[180:183], v[44:47], v[84:87]
  v_rcp_f32 v99, v99
  v_mfma_f32_16x16x32_bf16 v[88:91], v[184:187], v[44:47], v[88:91]
  v_mul_f32 v64, v72, v96
  v_mul_f32 v65, v73, v97
  v_mfma_f32_16x16x32_bf16 v[92:95], v[188:191], v[44:47], v[92:95]
  v_mul_f32 v66, v74, v98
  v_mul_f32 v67, v75, v99
  s_waitcnt lgkmcnt(2)
  v_mfma_f32_16x16x32_bf16 v[80:83], v[196:199], v[48:51], v[80:83]
  v_cvt_pk_bf16_f32 v60, v60, v61
  v_cvt_pk_bf16_f32 v61, v62, v63
  v_mfma_f32_16x16x32_bf16 v[84:87], v[200:203], v[48:51], v[84:87]
  v_cvt_pk_bf16_f32 v62, v64, v65
  v_cvt_pk_bf16_f32 v63, v66, v67
  v_mfma_f32_16x16x32_bf16 v[88:91], v[204:207], v[48:51], v[88:91]
  buffer_store_dwordx4 v[60:63], v0, s[12:15], s38 offen sc1
  v_mfma_f32_16x16x32_bf16 v[92:95], v[208:211], v[48:51], v[92:95]
  v_mul_f32 v96, v76, v76
  v_mul_f32 v97, v78, v78
  v_mul_f32 v77, v76, v77
L_wn_93j:
  s_waitcnt lgkmcnt(1)
  v_mfma_f32_16x16x32_bf16 v[80:83], v[216:219], v[52:55], v[80:83]
  v_mul_f32 v79, v78, v79
  v_fma_f32 v96, v96, s58, v16
  v_mfma_f32_16x16x32_bf16 v[84:87], v[220:223], v[52:55], v[84:87]
  v_fma_f32 v97, v97, s58, v16
  v_mul_f32 v96, v76, v96
  v_mfma_f32_16x16x32_bf16 v[88:91], v[224:227], v[52:55], v[88:91]
  v_mul_f32 v97, v78, v97
  v_mfma_f32_16x16x32_bf16 v[92:95], v[228:231], v[52:55], v[92:95]
  v_exp_f32 v96, v96
  s_waitcnt lgkmcnt(0)
  v_mfma_f32_16x16x32_bf16 v[80:83], v[236:239], v[56:59], v[80:83]
  v_exp_f32 v97, v97
  v_mfma_f32_16x16x32_bf16 v[84:87], v[240:243], v[56:59], v[84:87]
  v_fma_f32 v96, v96, v12, v12
  v_fma_f32 v97, v97, v12, v12
  v_mfma_f32_16x16x32_bf16 v[88:91], v[244:247], v[56:59], v[88:91]
  v_rcp_f32 v96, v96
  v_mfma_f32_16x16x32_bf16 v[92:95], v[248:251], v[56:59], v[92:95]
  v_rcp_f32 v97, v97
  v_mul_f32 v76, v77, v96
  v_mul_f32 v78, v79, v97
  v_cvt_pk_bf16_f32 v76, v76, v78
  buffer_store_dword v76, v1, s[12:15], s49 offen sc1
  ds_read_b32 v5, v14
  s_cmp_lg_u32 s35, 0
  s_cbranch_scc1 L_ck_94
  s_add_u32 s98, s32, 2
  s_mov_b64 exec, s[40:41]
  s_waitcnt lgkmcnt(0)
  v_cmp_gt_u32 vcc, s98, v5
  s_mov_b64 exec, -1
  s_cbranch_vccnz L_ck_94r
  s_add_u32 m0, s34, 0
  s_add_u32 s98, s33, 0
  buffer_load_dwordx4 v0, s[12:15], s98 offen offset:0 sc1 lds
  buffer_load_dwordx4 v0, s[12:15], s98 offen offset:1024 sc1 lds
  buffer_load_dwordx4 v0, s[12:15], s98 offen offset:2048 sc1 lds
  buffer_load_dwordx4 v0, s[12:15], s98 offen offset:3072 sc1 lds
  s_add_u32 m0, s34, 4096
  s_add_u32 s98, s33, 4096
  buffer_load_dwordx4 v0, s[12:15], s98 offen offset:0 sc1 lds
  buffer_load_dwordx4 v0, s[12:15], s98 offen offset:1024 sc1 lds
  buffer_load_dwordx4 v0, s[12:15], s98 offen offset:2048 sc1 lds
  buffer_load_dwordx4 v0, s[12:15], s98 offen offset:3072 sc1 lds
  s_add_u32 m0, s34, 8192
  s_add_u32 s98, s33, 8192
  buffer_load_dwordx4 v0, s[12:15], s98 offen offset:0 sc1 lds
  buffer_load_dwordx4 v0, s[12:15], s98 offen offset:1024 sc1 lds
  s_mov_b64 exec, 0xff
  buffer_load_dwordx4 v0, s[12:15], s98 offen offset:2048 sc1 lds
  s_mov_b64 exec, -1
  s_add_u32 s33, s33, 41472
  s_xor_b32 s34, s34, s39
  s_mov_b32 s35, 1
  s_branch L_ck_94
L_ck_94r:
L_ck_94:
  v_mov_b32 v17, s56
  v_pk_fma_f32 v[80:81], v[24:25], v[10:11], v[80:81] op_sel_hi:[1,0,1] neg_lo:[0,1,0] neg_hi:[0,1,0]
  v_pk_fma_f32 v[82:83], v[26:27], v[10:11], v[82:83] op_sel_hi:[1,0,1] neg_lo:[0,1,0] neg_hi:[0,1,0]
  v_pk_fma_f32 v[84:85], v[28:29], v[10:11], v[84:85] op_sel_hi:[1,0,1] neg_lo:[0,1,0] neg_hi:[0,1,0]
  v_pk_fma_f32 v[86:87], v[30:31], v[10:11], v[86:87] op_sel_hi:[1,0,1] neg_lo:[0,1,0] neg_hi:[0,1,0]
  v_pk_fma_f32 v[88:89], v[32:33], v[10:11], v[88:89] op_sel_hi:[1,0,1] neg_lo:[0,1,0] neg_hi:[0,1,0]
  v_pk_fma_f32 v[90:91], v[34:35], v[10:11], v[90:91] op_sel_hi:[1,0,1] neg_lo:[0,1,0] neg_hi:[0,1,0]
  v_pk_fma_f32 v[92:93], v[36:37], v[10:11], v[92:93] op_sel_hi:[1,0,1] neg_lo:[0,1,0] neg_hi:[0,1,0]
  v_pk_fma_f32 v[94:95], v[38:39], v[10:11], v[94:95] op_sel_hi:[1,0,1] neg_lo:[0,1,0] neg_hi:[0,1,0]
  v_pk_mul_f32 v[80:81], v[80:81], v[10:11] op_sel:[0,1] op_sel_hi:[1,1]
  v_pk_mul_f32 v[82:83], v[82:83], v[10:11] op_sel:[0,1] op_sel_hi:[1,1]
  v_pk_mul_f32 v[84:85], v[84:85], v[10:11] op_sel:[0,1] op_sel_hi:[1,1]
  v_pk_mul_f32 v[86:87], v[86:87], v[10:11] op_sel:[0,1] op_sel_hi:[1,1]
  v_pk_mul_f32 v[96:97], v[80:81], v[80:81]
  v_pk_mul_f32 v[98:99], v[82:83], v[82:83]
  v_pk_mul_f32 v[100:101], v[84:85], v[84:85]
  v_pk_mul_f32 v[102:103], v[86:87], v[86:87]
  v_pk_fma_f32 v[96:97], v[96:97], s[58:59], v[16:17]
  v_pk_fma_f32 v[98:99], v[98:99], s[58:59], v[16:17]
  v_pk_fma_f32 v[100:101], v[100:101], s[58:59], v[16:17]
  v_pk_fma_f32 v[102:103], v[102:103], s[58:59], v[16:17]
  v_pk_mul_f32 v[96:97], v[96:97], v[80:81]
  v_pk_mul_f32 v[98:99], v[98:99], v[82:83]
  v_pk_mul_f32 v[100:101], v[100:101], v[84:85]
  v_pk_mul_f32 v[102:103], v[102:103], v[86:87]
  v_exp_f32 v96, v96
  v_exp_f32 v97, v97
  v_exp_f32 v98, v98
  v_exp_f32 v99, v99
  v_exp_f32 v100, v100
  v_exp_f32 v101, v101
  v_exp_f32 v102, v102
  v_exp_f32 v103, v103
  v_pk_mul_f32 v[80:81], v[80:81], v[88:89]
  v_pk_mul_f32 v[82:83], v[82:83], v[90:91]
  v_pk_mul_f32 v[84:85], v[84:85], v[92:93]
  v_pk_mul_f32 v[86:87], v[86:87], v[94:95]
  v_pk_fma_f32 v[96:97], v[96:97], v[12:13], v[12:13] op_sel:[0,1,1] op_sel_hi:[1,1,1]
  v_pk_fma_f32 v[98:99], v[98:99], v[12:13], v[12:13] op_sel:[0,1,1] op_sel_hi:[1,1,1]
  v_pk_fma_f32 v[100:101], v[100:101], v[12:13], v[12:13] op_sel:[0,1,1] op_sel_hi:[1,1,1]
  v_pk_fma_f32 v[102:103], v[102:103], v[12:13], v[12:13] op_sel:[0,1,1] op_sel_hi:[1,1,1]
  v_rcp_f32 v96, v96
  v_rcp_f32 v97, v97
  v_rcp_f32 v98, v98
  v_rcp_f32 v99, v99
  v_rcp_f32 v100, v100
  v_rcp_f32 v101, v101
  v_rcp_f32 v102, v102
  v_rcp_f32 v103, v103
  v_pk_mul_f32 v[80:81], v[80:81], v[96:97]
  v_pk_mul_f32 v[82:83], v[82:83], v[98:99]
  v_pk_mul_f32 v[84:85], v[84:85], v[100:101]
  v_pk_mul_f32 v[86:87], v[86:87], v[102:103]
  v_cvt_pk_bf16_f32 v80, v80, v81
  v_cvt_pk_bf16_f32 v81, v82, v83
  v_cvt_pk_bf16_f32 v82, v84, v85
  v_cvt_pk_bf16_f32 v83, v86, v87
  buffer_store_dwordx4 v[80:83], v0, s[12:15], s43 offen sc1
  v_add_u32 v2, s42, v2
  v_add_u32 v3, s42, v3
  v_add_u32 v4, s42, v4
  s_sub_u32 s42, 0, s42
  s_add_u32 s32, s32, 1
  s_add_u32 s38, s38, 294912
  s_add_u32 s43, s43, 294912
  s_add_u32 s49, s49, 294912
  s_cmp_eq_u32 s32, 64
  s_cbranch_scc1 L_u_done
  s_cmp_eq_u32 s35, 0
  s_cbranch_scc1 L_u_late
  s_waitcnt vmcnt(1)
  s_branch L_u_loop
L_u_late:
  s_mov_b64 exec, s[40:41]
  s_waitcnt lgkmcnt(0)
  buffer_load_dword v5, v7, s[12:15], s36 offen sc1
  s_mov_b64 exec, -1
  s_add_u32 s98, s32, 1
  s_mov_b64 exec, s[40:41]
  s_waitcnt vmcnt(0)
  v_cmp_gt_u32 vcc, s98, v5
  s_mov_b64 exec, -1
  s_cbranch_vccnz L_lt_95s
  v_mov_b32 v6, s32
  s_mov_b64 exec, 1
  buffer_store_dword v6, off, s[12:15], s37 sc1
  s_mov_b64 exec, -1
  s_add_u32 m0, s34, 0
  s_add_u32 s98, s33, 0
  buffer_load_dwordx4 v0, s[12:15], s98 offen offset:0 sc1 lds
  buffer_load_dwordx4 v0, s[12:15], s98 offen offset:1024 sc1 lds
  buffer_load_dwordx4 v0, s[12:15], s98 offen offset:2048 sc1 lds
  buffer_load_dwordx4 v0, s[12:15], s98 offen offset:3072 sc1 lds
  s_add_u32 m0, s34, 4096
  s_add_u32 s98, s33, 4096
  buffer_load_dwordx4 v0, s[12:15], s98 offen offset:0 sc1 lds
  buffer_load_dwordx4 v0, s[12:15], s98 offen offset:1024 sc1 lds
  buffer_load_dwordx4 v0, s[12:15], s98 offen offset:2048 sc1 lds
  buffer_load_dwordx4 v0, s[12:15], s98 offen offset:3072 sc1 lds
  s_add_u32 m0, s34, 8192
  s_add_u32 s98, s33, 8192
  buffer_load_dwordx4 v0, s[12:15], s98 offen offset:0 sc1 lds
  buffer_load_dwordx4 v0, s[12:15], s98 offen offset:1024 sc1 lds
  s_mov_b64 exec, 0xff
  buffer_load_dwordx4 v0, s[12:15], s98 offen offset:2048 sc1 lds
  s_mov_b64 exec, -1
  s_add_u32 s33, s33, 41472
  s_xor_b32 s34, s34, s39
  s_mov_b32 s35, 1
  s_branch L_lt_95e
L_lt_95s:
  v_mov_b32 v6, s32
  s_mov_b64 exec, 1
  buffer_store_dword v6, off, s[12:15], s37 sc1
  s_mov_b64 exec, -1
L_bk_96:
  s_mov_b64 exec, s[40:41]
  buffer_load_dword v5, v7, s[12:15], s36 offen sc1
  s_mov_b64 exec, -1
  s_add_u32 s98, s32, 1
  s_mov_b64 exec, s[40:41]
  s_waitcnt vmcnt(0)
  v_cmp_gt_u32 vcc, s98, v5
  s_mov_b64 exec, -1
  s_cbranch_vccz L_bk_96d
  s_sleep 1
  s_sub_u32 s100, s100, 1
  s_cbranch_scc0 L_bk_96
  s_branch L_end
L_bk_96d:
  s_add_u32 m0, s34, 0
  s_add_u32 s98, s33, 0
  buffer_load_dwordx4 v0, s[12:15], s98 offen offset:0 sc1 lds
  buffer_load_dwordx4 v0, s[12:15], s98 offen offset:1024 sc1 lds
  buffer_load_dwordx4 v0, s[12:15], s98 offen offset:2048 sc1 lds
  buffer_load_dwordx4 v0, s[12:15], s98 offen offset:3072 sc1 lds
  s_add_u32 m0, s34, 4096
  s_add_u32 s98, s33, 4096
  buffer_load_dwordx4 v0, s[12:15], s98 offen offset:0 sc1 lds
  buffer_load_dwordx4 v0, s[12:15], s98 offen offset:1024 sc1 lds
  buffer_load_dwordx4 v0, s[12:15], s98 offen offset:2048 sc1 lds
  buffer_load_dwordx4 v0, s[12:15], s98 offen offset:3072 sc1 lds
  s_add_u32 m0, s34, 8192
  s_add_u32 s98, s33, 8192
  buffer_load_dwordx4 v0, s[12:15], s98 offen offset:0 sc1 lds
  buffer_load_dwordx4 v0, s[12:15], s98 offen offset:1024 sc1 lds
  s_mov_b64 exec, 0xff
  buffer_load_dwordx4 v0, s[12:15], s98 offen offset:2048 sc1 lds
  s_mov_b64 exec, -1
  s_add_u32 s33, s33, 41472
  s_xor_b32 s34, s34, s39
  s_mov_b32 s35, 1
L_lt_95e:
  s_waitcnt vmcnt(0)
  s_branch L_u_loop
L_u_done:
  s_waitcnt vmcnt(0)
  v_mov_b32 v6, s32
  s_mov_b64 exec, 1
  buffer_store_dword v6, off, s[12:15], s37 sc1
  s_mov_b64 exec, -1
  s_branch L_end
L_wn_90d:
  v_mfma_f32_16x16x32_bf16 v[60:63], a[120:123], v[52:55], v[60:63]
  s_mov_b32 s30, s14
  s_mov_b32 s35, 1
  ds_read_b128 v[48:51], v2 offset:20736
  v_mfma_f32_16x16x32_bf16 v[64:67], a[124:127], v[52:55], v[64:67]
  v_permlane16_swap_b32 v9, v11
  v_mfma_f32_16x16x32_bf16 v[68:71], a[128:131], v[52:55], v[68:71]
  s_add_u32 m0, s34, 0
  s_add_u32 s96, s33, 0
  v_mfma_f32_16x16x32_bf16 v[72:75], a[132:135], v[52:55], v[72:75]
  buffer_load_dwordx4 v0, s[28:31], s96 offen offset:0 sc1 lds
  v_mfma_f32_16x16x32_bf16 v[76:79], a[136:139], v[52:55], v[76:79]
  s_mov_b64 exec, s[46:47]
  v_swap_b32 v8, v10
  v_swap_b32 v9, v11
  s_mov_b64 exec, -1
  v_mfma_f32_16x16x32_bf16 v[60:63], a[140:143], v[56:59], v[60:63]
  v_rcp_f32 v12, v9
  v_mfma_f32_16x16x32_bf16 v[64:67], a[144:147], v[56:59], v[64:67]
  v_rcp_f32 v13, v11
  v_mfma_f32_16x16x32_bf16 v[68:71], a[148:151], v[56:59], v[68:71]
  buffer_load_dwordx4 v0, s[28:31], s96 offen offset:1024 sc1 lds
  v_mfma_f32_16x16x32_bf16 v[72:75], a[152:155], v[56:59], v[72:75]
  ds_read_b128 v[52:55], v2 offset:23040
  v_mfma_f32_16x16x32_bf16 v[76:79], a[156:159], v[56:59], v[76:79]
  buffer_load_dwordx4 v0, s[28:31], s96 offen offset:2048 sc1 lds
  s_waitcnt lgkmcnt(2)
  v_mfma_f32_16x16x32_bf16 v[60:63], a[160:163], v[44:47], v[60:63]
  ds_read_b128 v[56:59], v2 offset:25344
  v_mfma_f32_16x16x32_bf16 v[64:67], a[164:167], v[44:47], v[64:67]
  buffer_load_dwordx4 v0, s[28:31], s96 offen offset:3072 sc1 lds
  s_add_u32 m0, s34, 4096
  v_mfma_f32_16x16x32_bf16 v[68:71], a[168:171], v[44:47], v[68:71]
  s_add_u32 s96, s33, 4096
  v_mfma_f32_16x16x32_bf16 v[72:75], a[172:175], v[44:47], v[72:75]
  buffer_load_dwordx4 v0, s[28:31], s96 offen offset:0 sc1 lds
  v_mfma_f32_16x16x32_bf16 v[76:79], a[176:179], v[44:47], v[76:79]
  ds_read_b128 v[44:47], v2 offset:27648
  s_waitcnt lgkmcnt(3)
  v_mfma_f32_16x16x32_bf16 v[60:63], a[180:183], v[48:51], v[60:63]
  v_mfma_f32_16x16x32_bf16 v[64:67], a[184:187], v[48:51], v[64:67]
  buffer_load_dwordx4 v0, s[28:31], s96 offen offset:1024 sc1 lds
  v_mfma_f32_16x16x32_bf16 v[68:71], a[188:191], v[48:51], v[68:71]
  v_mfma_f32_16x16x32_bf16 v[72:75], a[192:195], v[48:51], v[72:75]
  v_mfma_f32_16x16x32_bf16 v[76:79], a[196:199], v[48:51], v[76:79]
  buffer_load_dwordx4 v0, s[28:31], s96 offen offset:2048 sc1 lds
  s_waitcnt lgkmcnt(2)
  v_mfma_f32_16x16x32_bf16 v[60:63], a[200:203], v[52:55], v[60:63]
  ds_read_b128 v[48:51], v2 offset:29952
  v_mfma_f32_16x16x32_bf16 v[64:67], a[204:207], v[52:55], v[64:67]
  v_mfma_f32_16x16x32_bf16 v[68:71], a[208:211], v[52:55], v[68:71]
  buffer_load_dwordx4 v0, s[28:31], s96 offen offset:3072 sc1 lds
  s_add_u32 m0, s34, 8192
  v_mfma_f32_16x16x32_bf16 v[72:75], a[212:215], v[52:55], v[72:75]
  s_add_u32 s96, s33, 8192
  v_mfma_f32_16x16x32_bf16 v[76:79], a[216:219], v[52:55], v[76:79]
  ds_read_b128 v[52:55], v2 offset:32256
  s_waitcnt lgkmcnt(3)
  v_mfma_f32_16x16x32_bf16 v[60:63], a[220:223], v[56:59], v[60:63]
  buffer_load_dwordx4 v0, s[28:31], s96 offen offset:0 sc1 lds
  v_mfma_f32_16x16x32_bf16 v[64:67], a[224:227], v[56:59], v[64:67]
  v_mfma_f32_16x16x32_bf16 v[68:71], a[228:231], v[56:59], v[68:71]
  v_mfma_f32_16x16x32_bf16 v[72:75], a[232:235], v[56:59], v[72:75]
  buffer_load_dwordx4 v0, s[28:31], s96 offen offset:1024 sc1 lds
  v_mfma_f32_16x16x32_bf16 v[76:79], a[236:239], v[56:59], v[76:79]
  ds_read_b128 v[56:59], v2 offset:34560
  s_waitcnt lgkmcnt(3)
  v_mfma_f32_16x16x32_bf16 v[60:63], a[240:243], v[44:47], v[60:63]
  v_mfma_f32_16x16x32_bf16 v[64:67], a[244:247], v[44:47], v[64:67]
  s_mov_b64 exec, 0xff
  buffer_load_dwordx4 v0, s[28:31], s96 offen offset:2048 sc1 lds
  s_mov_b64 exec, -1
  v_mfma_f32_16x16x32_bf16 v[68:71], a[248:251], v[44:47], v[68:71]
  s_add_u32 s33, s33, 41472
  s_xor_b32 s34, s34, s39
  v_mfma_f32_16x16x32_bf16 v[72:75], a[252:255], v[44:47], v[72:75]
  v_mfma_f32_16x16x32_bf16 v[76:79], v[152:155], v[44:47], v[76:79]
  s_branch L_wn_90j
L_wn_91d:
  s_waitcnt lgkmcnt(2)
  v_mfma_f32_16x16x32_bf16 v[60:63], v[176:179], v[52:55], v[60:63]
  s_mov_b32 s30, s14
  s_mov_b32 s35, 1
  ds_read_b128 v[48:51], v2 offset:39168
  v_mfma_f32_16x16x32_bf16 v[64:67], v[180:183], v[52:55], v[64:67]
  s_add_u32 m0, s34, 0
  s_add_u32 s96, s33, 0
  v_mfma_f32_16x16x32_bf16 v[68:71], v[184:187], v[52:55], v[68:71]
  buffer_load_dwordx4 v0, s[28:31], s96 offen offset:0 sc1 lds
  v_mfma_f32_16x16x32_bf16 v[72:75], v[188:191], v[52:55], v[72:75]
  v_mfma_f32_16x16x32_bf16 v[76:79], v[192:195], v[52:55], v[76:79]
  buffer_load_dwordx4 v0, s[28:31], s96 offen offset:1024 sc1 lds
  s_waitcnt lgkmcnt(2)
  v_mfma_f32_16x16x32_bf16 v[60:63], v[196:199], v[56:59], v[60:63]
  ds_read_b128 v[52:55], v3 offset:0
  v_mfma_f32_16x16x32_bf16 v[64:67], v[200:203], v[56:59], v[64:67]
  v_mfma_f32_16x16x32_bf16 v[68:71], v[204:207], v[56:59], v[68:71]
  buffer_load_dwordx4 v0, s[28:31], s96 offen offset:2048 sc1 lds
  v_mfma_f32_16x16x32_bf16 v[72:75], v[208:211], v[56:59], v[72:75]
  v_mfma_f32_16x16x32_bf16 v[76:79], v[212:215], v[56:59], v[76:79]
  ds_read_b128 v[56:59], v3 offset:2304
  s_waitcnt lgkmcnt(3)
  v_mfma_f32_16x16x32_bf16 v[60:63], v[216:219], v[44:47], v[60:63]
  buffer_load_dwordx4 v0, s[28:31], s96 offen offset:3072 sc1 lds
  s_add_u32 m0, s34, 4096
  v_mfma_f32_16x16x32_bf16 v[64:67], v[220:223], v[44:47], v[64:67]
  s_add_u32 s96, s33, 4096
  v_mfma_f32_16x16x32_bf16 v[68:71], v[224:227], v[44:47], v[68:71]
  v_mfma_f32_16x16x32_bf16 v[72:75], v[228:231], v[44:47], v[72:75]
  buffer_load_dwordx4 v0, s[28:31], s96 offen offset:0 sc1 lds
  v_mfma_f32_16x16x32_bf16 v[76:79], v[232:235], v[44:47], v[76:79]
  ds_read_b128 v[44:47], v3 offset:4608
  s_waitcnt lgkmcnt(3)
  v_mfma_f32_16x16x32_bf16 v[60:63], v[236:239], v[48:51], v[60:63]
  v_mfma_f32_16x16x32_bf16 v[64:67], v[240:243], v[48:51], v[64:67]
  buffer_load_dwordx4 v0, s[28:31], s96 offen offset:1024 sc1 lds
  v_mfma_f32_16x16x32_bf16 v[68:71], v[244:247], v[48:51], v[68:71]
  v_mfma_f32_16x16x32_bf16 v[72:75], v[248:251], v[48:51], v[72:75]
  v_mfma_f32_16x16x32_bf16 v[76:79], v[252:255], v[48:51], v[76:79]
  buffer_load_dwordx4 v0, s[28:31], s96 offen offset:2048 sc1 lds
  s_waitcnt lgkmcnt(2)
  v_mfma_f32_16x16x32_bf16 v[80:83], a[0:3], v[52:55], 0
  ds_read_b128 v[48:51], v3 offset:6912
  v_mov_b32 v16, s56
  v_fma_f32 v60, -v8, v24, v60
  v_mfma_f32_16x16x32_bf16 v[84:87], a[4:7], v[52:55], 0
  v_mfma_f32_16x16x32_bf16 v[88:91], a[8:11], v[52:55], 0
  buffer_load_dwordx4 v0, s[28:31], s96 offen offset:3072 sc1 lds
  v_fma_f32 v61, -v8, v25, v61
  v_mfma_f32_16x16x32_bf16 v[92:95], a[12:15], v[52:55], 0
  v_fma_f32 v62, -v8, v26, v62
  ds_read_b128 v[52:55], v3 offset:9216
  s_waitcnt lgkmcnt(3)
  v_mfma_f32_16x16x32_bf16 v[80:83], a[20:23], v[56:59], v[80:83]
  v_fma_f32 v63, -v8, v27, v63
  v_fma_f32 v64, -v8, v28, v64
  v_mfma_f32_16x16x32_bf16 v[84:87], a[24:27], v[56:59], v[84:87]
  s_add_u32 m0, s34, 8192
  s_add_u32 s96, s33, 8192
  v_fma_f32 v65, -v8, v29, v65
  v_mfma_f32_16x16x32_bf16 v[88:91], a[28:31], v[56:59], v[88:91]
  v_fma_f32 v66, -v8, v30, v66
  v_mfma_f32_16x16x32_bf16 v[92:95], a[32:35], v[56:59], v[92:95]
  buffer_load_dwordx4 v0, s[28:31], s96 offen offset:0 sc1 lds
  v_fma_f32 v67, -v8, v31, v67
  s_waitcnt lgkmcnt(2)
  v_mfma_f32_16x16x32_bf16 v[80:83], a[40:43], v[44:47], v[80:83]
  v_fma_f32 v68, -v8, v32, v68
  v_fma_f32 v69, -v8, v33, v69
  v_mfma_f32_16x16x32_bf16 v[84:87], a[44:47], v[44:47], v[84:87]
  v_fma_f32 v70, -v8, v34, v70
  ds_read_b128 v[56:59], v3 offset:11520
  v_mfma_f32_16x16x32_bf16 v[88:91], a[48:51], v[44:47], v[88:91]
  v_fma_f32 v71, -v8, v35, v71
  v_fma_f32 v72, -v8, v36, v72
  v_mfma_f32_16x16x32_bf16 v[92:95], a[52:55], v[44:47], v[92:95]
  buffer_load_dwordx4 v0, s[28:31], s96 offen offset:1024 sc1 lds
  v_fma_f32 v73, -v8, v37, v73
  s_waitcnt lgkmcnt(2)
  v_mfma_f32_16x16x32_bf16 v[80:83], a[60:63], v[48:51], v[80:83]
  v_fma_f32 v74, -v8, v38, v74
  v_fma_f32 v75, -v8, v39, v75
  v_mfma_f32_16x16x32_bf16 v[84:87], a[64:67], v[48:51], v[84:87]
  v_fma_f32 v76, -v8, v40, v76
  v_fma_f32 v77, -v8, v41, v77
  v_mfma_f32_16x16x32_bf16 v[88:91], a[68:71], v[48:51], v[88:91]
  v_fma_f32 v78, -v8, v42, v78
  s_mov_b64 exec, 0xff
  buffer_load_dwordx4 v0, s[28:31], s96 offen offset:2048 sc1 lds
  s_mov_b64 exec, -1
  ds_read_b128 v[44:47], v3 offset:13824
  v_fma_f32 v79, -v8, v43, v79
  v_mul_f32 v60, v9, v60
  v_mul_f32 v61, v9, v61
  v_mul_f32 v62, v9, v62
  v_mul_f32 v63, v9, v63
  v_mul_f32 v64, v9, v64
  s_add_u32 s33, s33, 41472
  s_xor_b32 s34, s34, s39
  s_branch L_wn_91j
L_wn_92d:
  s_waitcnt lgkmcnt(2)
  v_mfma_f32_16x16x32_bf16 v[80:83], a[80:83], v[52:55], v[80:83]
  s_mov_b32 s30, s14
  s_mov_b32 s35, 1
  ds_read_b128 v[48:51], v3 offset:16128
  v_mfma_f32_16x16x32_bf16 v[84:87], a[84:87], v[52:55], v[84:87]
  v_mul_f32 v67, v9, v67
  s_add_u32 m0, s34, 0
  v_mfma_f32_16x16x32_bf16 v[88:91], a[88:91], v[52:55], v[88:91]
  s_add_u32 s96, s33, 0
  buffer_load_dwordx4 v0, s[28:31], s96 offen offset:0 sc1 lds
  v_mfma_f32_16x16x32_bf16 v[92:95], a[92:95], v[52:55], v[92:95]
  v_permlane32_swap_b32 v76, v77
  s_waitcnt lgkmcnt(2)
  v_mfma_f32_16x16x32_bf16 v[80:83], a[100:103], v[56:59], v[80:83]
  v_permlane32_swap_b32 v78, v79
  v_mfma_f32_16x16x32_bf16 v[84:87], a[104:107], v[56:59], v[84:87]
  v_mul_f32 v76, v9, v76
  v_mul_f32 v78, v9, v78
  v_mfma_f32_16x16x32_bf16 v[88:91], a[108:111], v[56:59], v[88:91]
  ds_read_b128 v[52:55], v3 offset:18432
  v_mul_f32 v96, v60, v60
  v_mul_f32 v97, v61, v61
  v_mfma_f32_16x16x32_bf16 v[92:95], a[112:115], v[56:59], v[92:95]
  buffer_load_dwordx4 v0, s[28:31], s96 offen offset:1024 sc1 lds
  v_mul_f32 v98, v62, v62
  s_waitcnt lgkmcnt(2)
  v_mfma_f32_16x16x32_bf16 v[80:83], a[120:123], v[44:47], v[80:83]
  v_mul_f32 v99, v63, v63
  v_mul_f32 v68, v60, v68
  v_mfma_f32_16x16x32_bf16 v[84:87], a[124:127], v[44:47], v[84:87]
  v_mul_f32 v69, v61, v69
  v_mul_f32 v70, v62, v70
  v_mfma_f32_16x16x32_bf16 v[88:91], a[128:131], v[44:47], v[88:91]
  v_mul_f32 v71, v63, v71
  v_mfma_f32_16x16x32_bf16 v[92:95], a[132:135], v[44:47], v[92:95]
  buffer_load_dwordx4 v0, s[28:31], s96 offen offset:2048 sc1 lds
  s_waitcnt lgkmcnt(1)
  v_mfma_f32_16x16x32_bf16 v[80:83], a[140:143], v[48:51], v[80:83]
  ds_read_b128 v[56:59], v3 offset:20736
  v_fma_f32 v96, v96, s58, v16
  v_fma_f32 v97, v97, s58, v16
  v_mfma_f32_16x16x32_bf16 v[84:87], a[144:147], v[48:51], v[84:87]
  v_fma_f32 v98, v98, s58, v16
  v_fma_f32 v99, v99, s58, v16
  v_mfma_f32_16x16x32_bf16 v[88:91], a[148:151], v[48:51], v[88:91]
  v_mul_f32 v96, v60, v96
  v_mul_f32 v97, v61, v97
  v_mfma_f32_16x16x32_bf16 v[92:95], a[152:155], v[48:51], v[92:95]
  buffer_load_dwordx4 v0, s[28:31], s96 offen offset:3072 sc1 lds
  v_mul_f32 v98, v62, v98
  s_waitcnt lgkmcnt(1)
  v_mfma_f32_16x16x32_bf16 v[80:83], a[160:163], v[52:55], v[80:83]
  v_mul_f32 v99, v63, v99
  ds_read_b128 v[44:47], v3 offset:23040
  v_mfma_f32_16x16x32_bf16 v[84:87], a[164:167], v[52:55], v[84:87]
  v_exp_f32 v96, v96
  v_mfma_f32_16x16x32_bf16 v[88:91], a[168:171], v[52:55], v[88:91]
  s_add_u32 m0, s34, 4096
  s_add_u32 s96, s33, 4096
  v_mfma_f32_16x16x32_bf16 v[92:95], a[172:175], v[52:55], v[92:95]
  v_exp_f32 v97, v97
  s_waitcnt lgkmcnt(1)
  v_mfma_f32_16x16x32_bf16 v[80:83], a[180:183], v[56:59], v[80:83]
  buffer_load_dwordx4 v0, s[28:31], s96 offen offset:0 sc1 lds
  v_mfma_f32_16x16x32_bf16 v[84:87], a[184:187], v[56:59], v[84:87]
  v_exp_f32 v98, v98
  v_mfma_f32_16x16x32_bf16 v[88:91], a[188:191], v[56:59], v[88:91]
  v_exp_f32 v99, v99
  v_mfma_f32_16x16x32_bf16 v[92:95], a[192:195], v[56:59], v[92:95]
  ds_read_b128 v[48:51], v3 offset:25344
  v_fma_f32 v96, v96, v12, v12
  v_fma_f32 v97, v97, v12, v12
  s_waitcnt lgkmcnt(1)
  v_mfma_f32_16x16x32_bf16 v[80:83], a[200:203], v[44:47], v[80:83]
  buffer_load_dwordx4 v0, s[28:31], s96 offen offset:1024 sc1 lds
  v_fma_f32 v98, v98, v12, v12
  v_mfma_f32_16x16x32_bf16 v[84:87], a[204:207], v[44:47], v[84:87]
  v_fma_f32 v99, v99, v12, v12
  v_mfma_f32_16x16x32_bf16 v[88:91], a[208:211], v[44:47], v[88:91]
  v_rcp_f32 v96, v96
  v_mfma_f32_16x16x32_bf16 v[92:95], a[212:215], v[44:47], v[92:95]
  v_rcp_f32 v97, v97
  buffer_load_dwordx4 v0, s[28:31], s96 offen offset:2048 sc1 lds
  s_waitcnt lgkmcnt(0)
  v_mfma_f32_16x16x32_bf16 v[80:83], a[220:223], v[48:51], v[80:83]
  ds_read_b128 v[52:55], v3 offset:27648
  v_rcp_f32 v98, v98
  v_mfma_f32_16x16x32_bf16 v[84:87], a[224:227], v[48:51], v[84:87]
  v_rcp_f32 v99, v99
  v_mfma_f32_16x16x32_bf16 v[88:91], a[228:231], v[48:51], v[88:91]
  v_mul_f32 v60, v68, v96
  v_mul_f32 v61, v69, v97
  buffer_load_dwordx4 v0, s[28:31], s96 offen offset:3072 sc1 lds
  v_mfma_f32_16x16x32_bf16 v[92:95], a[232:235], v[48:51], v[92:95]
  v_mul_f32 v62, v70, v98
  v_mul_f32 v63, v71, v99
  ds_read_b128 v[56:59], v3 offset:29952
  s_waitcnt lgkmcnt(1)
  v_mfma_f32_16x16x32_bf16 v[80:83], a[240:243], v[52:55], v[80:83]
  v_mul_f32 v96, v64, v64
  v_mul_f32 v97, v65, v65
  s_add_u32 m0, s34, 8192
  s_add_u32 s96, s33, 8192
  v_mfma_f32_16x16x32_bf16 v[84:87], a[244:247], v[52:55], v[84:87]
  v_mul_f32 v98, v66, v66
  v_mul_f32 v99, v67, v67
  buffer_load_dwordx4 v0, s[28:31], s96 offen offset:0 sc1 lds
  v_mfma_f32_16x16x32_bf16 v[88:91], a[248:251], v[52:55], v[88:91]
  v_mul_f32 v72, v64, v72
  v_mul_f32 v73, v65, v73
  v_mul_f32 v74, v66, v74
  v_mul_f32 v75, v67, v75
  ds_read_b128 v[44:47], v3 offset:32256
  v_fma_f32 v96, v96, s58, v16
  v_fma_f32 v97, v97, s58, v16
  buffer_load_dwordx4 v0, s[28:31], s96 offen offset:1024 sc1 lds
  v_fma_f32 v98, v98, s58, v16
  v_fma_f32 v99, v99, s58, v16
  v_mul_f32 v96, v64, v96
  v_mul_f32 v97, v65, v97
  v_mul_f32 v98, v66, v98
  v_mul_f32 v99, v67, v99
  s_mov_b64 exec, 0xff
  buffer_load_dwordx4 v0, s[28:31], s96 offen offset:2048 sc1 lds
  s_mov_b64 exec, -1
  ds_read_b128 v[48:51], v3 offset:34560
  v_exp_f32 v96, v96
  v_exp_f32 v97, v97
  v_exp_f32 v98, v98
  s_add_u32 s33, s33, 41472
  s_xor_b32 s34, s34, s39
  s_branch L_wn_92j
L_wn_93d:
  v_mfma_f32_16x16x32_bf16 v[92:95], a[252:255], v[52:55], v[92:95]
  s_mov_b32 s30, s14
  s_mov_b32 s35, 1
  s_waitcnt lgkmcnt(2)
  v_mfma_f32_16x16x32_bf16 v[80:83], v[156:159], v[56:59], v[80:83]
  v_exp_f32 v99, v99
  v_mfma_f32_16x16x32_bf16 v[84:87], v[160:163], v[56:59], v[84:87]
  s_add_u32 m0, s34, 0
  s_add_u32 s96, s33, 0
  v_mfma_f32_16x16x32_bf16 v[88:91], v[164:167], v[56:59], v[88:91]
  buffer_load_dwordx4 v0, s[28:31], s96 offen offset:0 sc1 lds
  v_mfma_f32_16x16x32_bf16 v[92:95], v[168:171], v[56:59], v[92:95]
  ds_read_b128 v[52:55], v3 offset:36864
  v_fma_f32 v96, v96, v12, v12
  v_fma_f32 v97, v97, v12, v12
  s_waitcnt lgkmcnt(2)
  v_mfma_f32_16x16x32_bf16 v[80:83], v[176:179], v[44:47], v[80:83]
  v_fma_f32 v98, v98, v12, v12
  v_fma_f32 v99, v99, v12, v12
  v_mfma_f32_16x16x32_bf16 v[84:87], v[180:183], v[44:47], v[84:87]
  buffer_load_dwordx4 v0, s[28:31], s96 offen offset:1024 sc1 lds
  v_mfma_f32_16x16x32_bf16 v[88:91], v[184:187], v[44:47], v[88:91]
  v_rcp_f32 v96, v96
  v_mfma_f32_16x16x32_bf16 v[92:95], v[188:191], v[44:47], v[92:95]
  buffer_load_dwordx4 v0, s[28:31], s96 offen offset:2048 sc1 lds
  s_waitcnt lgkmcnt(1)
  v_mfma_f32_16x16x32_bf16 v[80:83], v[196:199], v[48:51], v[80:83]
  v_rcp_f32 v97, v97
  v_mfma_f32_16x16x32_bf16 v[84:87], v[200:203], v[48:51], v[84:87]
  buffer_load_dwordx4 v0, s[28:31], s96 offen offset:3072 sc1 lds
  s_add_u32 m0, s34, 4096
  v_mfma_f32_16x16x32_bf16 v[88:91], v[204:207], v[48:51], v[88:91]
  s_add_u32 s96, s33, 4096
  ds_read_b128 v[56:59], v3 offset:39168
  v_mfma_f32_16x16x32_bf16 v[92:95], v[208:211], v[48:51], v[92:95]
  v_rcp_f32 v98, v98
  buffer_load_dwordx4 v0, s[28:31], s96 offen offset:0 sc1 lds
  v_rcp_f32 v99, v99
  buffer_load_dwordx4 v0, s[28:31], s96 offen offset:1024 sc1 lds
  v_mul_f32 v64, v72, v96
  v_mul_f32 v65, v73, v97
  buffer_load_dwordx4 v0, s[28:31], s96 offen offset:2048 sc1 lds
  v_mul_f32 v66, v74, v98
  v_mul_f32 v67, v75, v99
  buffer_load_dwordx4 v0, s[28:31], s96 offen offset:3072 sc1 lds
  s_add_u32 m0, s34, 8192
  s_add_u32 s96, s33, 8192
  v_cvt_pk_bf16_f32 v60, v60, v61
  v_cvt_pk_bf16_f32 v61, v62, v63
  buffer_load_dwordx4 v0, s[28:31], s96 offen offset:0 sc1 lds
  v_cvt_pk_bf16_f32 v62, v64, v65
  v_cvt_pk_bf16_f32 v63, v66, v67
  buffer_load_dwordx4 v0, s[28:31], s96 offen offset:1024 sc1 lds
  buffer_store_dwordx4 v[60:63], v0, s[12:15], s38 offen sc1
  v_mul_f32 v96, v76, v76
  s_mov_b64 exec, 0xff
  buffer_load_dwordx4 v0, s[28:31], s96 offen offset:2048 sc1 lds
  s_mov_b64 exec, -1
  v_mul_f32 v97, v78, v78
  v_mul_f32 v77, v76, v77
  s_add_u32 s33, s33, 41472
  s_xor_b32 s34, s34, s39
  s_branch L_wn_93j
L_aw:
  s_mov_b32 s101, 0
  s_load_dwordx2 s[16:17], s[0:1], 40
  s_mov_b32 s18, 4718592
  s_mov_b32 s19, 0x20000
  s_waitcnt lgkmcnt(0)
  s_and_b32 s17, s17, 0xffff
  s_load_dwordx2 s[20:21], s[0:1], 0
  s_mov_b32 s22, 2359296
  s_mov_b32 s23, 0x20000
  s_waitcnt lgkmcnt(0)
  s_and_b32 s21, s21, 0xffff
  v_lshlrev_b32 v0, 4, v63
  v_lshlrev_b32 v1, 2, v63
  v_add_u32 v6, 98304, v0
  s_and_b32 s60, s9, 1
  s_lshl_b32 s98, s11, 11
  s_lshl_b32 s99, s10, 1
  s_add_u32 s99, s99, s60
  s_add_u32 s98, s98, s99
  s_mul_i32 s33, s98, 24576
  s_add_u32 s33, s33, 37748736
  s_lshl_b32 s64, s98, 12
  s_add_u32 s64, s64, 20971520
  s_mul_i32 s34, s60, 24576
  s_add_u32 s39, s34, 49152
  s_xor_b32 s39, s39, s34
  s_lshl_b32 s98, s11, 5
  s_add_u32 s98, s98, s99
  s_mul_i32 s98, s98, 256
  s_mul_i32 s36, s11, 8192
  s_add_u32 s36, s36, s98
  s_add_u32 s36, s36, 282752
  s_add_u32 s65, s98, 315392
  s_mov_b32 s40, 0xf
  s_mov_b32 s41, 0
  s_mov_b32 s42, 49152
  s_mul_i32 s61, s11, 0x280000
  s_add_u32 s61, s61, 201326592
  s_mul_i32 s95, s10, 36992
  s_add_u32 s95, s95, s61
  s_mul_i32 s98, s60, 9
  s_lshr_b32 s99, s9, 1
  s_lshl_b32 s99, s99, 2
  s_add_u32 s99, s99, s98
  s_lshl_b32 s46, s99, 11
  s_add_u32 s46, s46, s95
  s_add_u32 s47, s46, 4096
  s_add_u32 s48, s46, 16384
  s_mul_i32 s90, s10, 294912
  s_lshl_b32 s99, s99, 6
  s_add_u32 s90, s90, s99
  s_mul_i32 s62, s9, 40960
  s_lshr_b32 s98, s10, 3
  s_add_u32 s99, s10, s98
  s_lshl_b32 s99, s99, 1
  s_add_u32 s99, s99, s60
  s_lshl_b32 s49, s99, 10
  s_add_u32 s49, s49, s61
  s_mul_i32 s38, s99, 1152
  s_mul_i32 s98, s98, 18
  s_add_u32 s98, s98, s60
  s_add_u32 s98, s98, 16
  s_and_b32 s99, s10, 7
  s_lshl_b32 s99, s99, 7
  s_lshl_b32 s57, s98, 10
  s_add_u32 s57, s57, s99
  s_add_u32 s57, s57, s61
  s_mul_i32 s55, s98, 1152
  s_add_u32 s55, s55, s99
  s_mul_i32 s37, s60, 256
  s_lshl_b32 s98, s10, 2
  s_add_u32 s37, s37, s98
  s_add_u32 s37, s37, 262144
  s_mov_b32 s32, 0
  s_mov_b32 s50, 0
  s_mov_b32 s92, 0
  s_mov_b32 s43, 0
  s_lshl_b32 s93, s11, 8
  s_add_u32 s93, s93, 32768
  v_mov_b32 v3, 0
  buffer_store_dword v3, v1, s[12:15], s93 offen
  s_cmp_ge_u32 s9, 2
  s_cbranch_scc1 L_aw_nf
  s_mul_i32 s98, s11, 1024
  s_add_u32 s98, s98, s37
  s_add_u32 s94, s98, 2048
  v_mov_b32 v3, 0
  s_mov_b64 exec, 1
  buffer_store_dword v3, off, s[12:15], s94 sc1
  s_mov_b64 exec, -1
  s_cmp_lg_u32 s11, 1
  s_cbranch_scc1 L_aw_nf
  v_mov_b32 v3, 0
  s_mov_b64 exec, 1
  buffer_store_dword v3, off, s[12:15], s37 sc1
  s_mov_b64 exec, -1
L_aw_nf:
  v_mov_b32 v32, 1
  v_mov_b32 v33, 1
  v_mov_b32 v34, 1
  v_mov_b32 v35, 1
  s_mul_i32 s98, s9, 9216
  s_add_u32 s98, s98, s95
  s_add_u32 s99, s98, 0
  buffer_store_dwordx4 v[32:35], v0, s[12:15], s99 offen offset:0
  buffer_store_dwordx4 v[32:35], v0, s[12:15], s99 offen offset:1024
  buffer_store_dwordx4 v[32:35], v0, s[12:15], s99 offen offset:2048
  buffer_store_dwordx4 v[32:35], v0, s[12:15], s99 offen offset:3072
  s_add_u32 s99, s98, 4096
  buffer_store_dwordx4 v[32:35], v0, s[12:15], s99 offen offset:0
  buffer_store_dwordx4 v[32:35], v0, s[12:15], s99 offen offset:1024
  buffer_store_dwordx4 v[32:35], v0, s[12:15], s99 offen offset:2048
  buffer_store_dwordx4 v[32:35], v0, s[12:15], s99 offen offset:3072
  s_add_u32 s99, s98, 8192
  buffer_store_dwordx4 v[32:35], v0, s[12:15], s99 offen offset:0
  s_add_u32 s99, s98, 591872
  buffer_store_dwordx4 v[32:35], v0, s[12:15], s99 offen offset:0
  buffer_store_dwordx4 v[32:35], v0, s[12:15], s99 offen offset:1024
  buffer_store_dwordx4 v[32:35], v0, s[12:15], s99 offen offset:2048
  buffer_store_dwordx4 v[32:35], v0, s[12:15], s99 offen offset:3072
  s_add_u32 s99, s98, 595968
  buffer_store_dwordx4 v[32:35], v0, s[12:15], s99 offen offset:0
  buffer_store_dwordx4 v[32:35], v0, s[12:15], s99 offen offset:1024
  buffer_store_dwordx4 v[32:35], v0, s[12:15], s99 offen offset:2048
  buffer_store_dwordx4 v[32:35], v0, s[12:15], s99 offen offset:3072
  s_add_u32 s99, s98, 600064
  buffer_store_dwordx4 v[32:35], v0, s[12:15], s99 offen offset:0
  s_waitcnt vmcnt(0)
  s_barrier
  s_cmp_lg_u32 s9, 0
  s_cbranch_scc1 L_arr_97
  s_mov_b64 exec, 1
  v_mov_b32 v60, 64
  v_mov_b32 v61, 1
  global_atomic_add v60, v61, s[4:5] sc1
  s_mov_b64 exec, -1
L_arr_97:
  v_lshrrev_b32 v60, 4, v63
  v_lshlrev_b32 v16, 9, v60
  v_bfe_u32 v60, v63, 2, 2
  v_lshl_add_u32 v16, v60, 6, v16
  v_and_b32 v60, 3, v63
  v_lshl_add_u32 v16, v60, 4, v16
  v_add_u32 v16, s62, v16
  s_and_b32 s98, s10, 1
  s_lshl_b32 s98, s98, 3
  v_add_u32 v18, s98, v16
  v_xor_b32 v19, 8, v18
  v_lshrrev_b32 v60, 2, v63
  v_mul_u32_u24 v17, 1152, v60
  v_and_b32 v60, 3, v63
  v_lshl_add_u32 v17, v60, 4, v17
  s_cmp_ge_u32 s9, 2
  s_cbranch_scc1 L_aw_G
  v_lshlrev_b32 v4, 3, v63
  v_and_b32 v60, 1, v63
  v_lshlrev_b32 v60, 4, v60
  v_mov_b32 v61, 0x3f80
  v_lshlrev_b32 v61, v60, v61
  v_bfe_u32 v60, v63, 1, 3
  v_lshrrev_b32 v62, 4, v63
  v_lshlrev_b32 v62, 1, v62
  v_sub_u32 v60, v60, v62
  v_cmp_eq_u32 vcc, 0, v60
  s_nop 1
  v_cndmask_b32 v64, 0, v61, vcc
  v_cmp_eq_u32 vcc, 1, v60
  s_nop 1
  v_cndmask_b32 v65, 0, v61, vcc
  v_mov_b32 v66, v64
  v_mov_b32 v67, v65
  v_and_b32 v60, 15, v63
  v_and_b32 v61, 1, v60
  v_lshlrev_b32 v61, 4, v61
  v_mov_b32 v62, 0x3f80
  v_lshlrev_b32 v62, v61, v62
  v_lshrrev_b32 v60, 1, v60
  v_cmp_eq_u32 vcc, 0, v60
  s_nop 1
  v_cndmask_b32 v68, 0, v62, vcc
  v_cmp_eq_u32 vcc, 1, v60
  s_nop 1
  v_cndmask_b32 v69, 0, v62, vcc
  v_cmp_eq_u32 vcc, 2, v60
  s_nop 1
  v_cndmask_b32 v70, 0, v62, vcc
  v_cmp_eq_u32 vcc, 3, v60
  s_nop 1
  v_cndmask_b32 v71, 0, v62, vcc
  v_lshrrev_b32 v60, 3, v63
  v_mul_u32_u24 v7, 36992, v60
  v_and_b32 v60, 7, v63
  v_lshl_add_u32 v7, v60, 4, v7
  s_and_b32 s98, s10, 1
  s_lshl_b32 s98, s98, 3
  s_lshl_b32 s52, 0x00ff00ff, s98
  s_mov_b32 s53, s52
  v_mov_b32 v160, 0
  v_mov_b32 v161, 0
  v_mov_b32 v162, 0
  v_mov_b32 v163, 0
  v_mov_b32 v164, 0x3f803f80
  v_mov_b32 v165, 0x3f803f80
  v_mov_b32 v166, 0x3f803f80
  v_mov_b32 v167, 0x3f803f80
  v_and_b32 v4, 15, v63
  v_lshlrev_b32 v4, 3, v4
  s_mov_b32 s70, 0x00f0000f
  s_mov_b32 s71, 0xf0000f00
  s_mov_b32 s72, 0xaaaaaaaa
  s_mov_b32 s73, 0xaaaaaaaa
  s_mov_b32 s74, 0xcccccccc
  s_mov_b32 s75, 0xcccccccc
  s_cmp_lg_u32 s11, 1
  s_cbranch_scc1 L_aw_nc
  v_and_b32 v60, 15, v63
  v_mul_u32_u24 v168, 1152, v60
  v_lshrrev_b32 v60, 4, v63
  v_lshl_add_u32 v168, v60, 4, v168
  s_lshr_b32 s98, s10, 3
  s_add_u32 s99, s10, s98
  s_lshl_b32 s68, s99, 6
  s_mul_i32 s99, s60, 18432
  s_add_u32 s68, s68, s99
  s_mul_i32 s69, s98, 576
  s_add_u32 s69, s69, 512
  s_add_u32 s69, s69, s99
  s_and_b32 s98, s10, 1
  s_mul_i32 s98, s98, 9216
  s_add_u32 s69, s69, s98
  s_bfe_u32 s98, s10, 0x20001
  s_lshl_b32 s98, s98, 4
  s_add_u32 s69, s69, s98
  s_mov_b32 s58, s38
  s_mov_b32 s56, s55
  s_add_u32 s38, s38, 8388608
  s_add_u32 s55, s55, 8388608
  v_mov_b32 v196, 0
  v_mov_b32 v197, 0
  v_mov_b32 v198, 0
  v_mov_b32 v199, 0
  v_mov_b32 v204, 0
  v_mov_b32 v205, 0
  v_mov_b32 v206, 0
  v_mov_b32 v207, 0
  v_mov_b32 v212, 0
  v_mov_b32 v213, 0
  v_mov_b32 v214, 0
  v_mov_b32 v215, 0
  v_mov_b32 v220, 0
  v_mov_b32 v221, 0
  v_mov_b32 v222, 0
  v_mov_b32 v223, 0
  v_mov_b32 v228, 0
  v_mov_b32 v229, 0
  v_mov_b32 v230, 0
  v_mov_b32 v231, 0
  v_mov_b32 v236, 0
  v_mov_b32 v237, 0
  v_mov_b32 v238, 0
  v_mov_b32 v239, 0
  v_mov_b32 v244, 0
  v_mov_b32 v245, 0
  v_mov_b32 v246, 0
  v_mov_b32 v247, 0
  v_mov_b32 v252, 0
  v_mov_b32 v253, 0
  v_mov_b32 v254, 0
  v_mov_b32 v255, 0
  buffer_load_dwordx4 v[192:195], v168, s[20:23], s68 offen
  s_mov_b64 exec, 0xff
  buffer_load_dwordx4 v[196:199], v168, s[20:23], s69 offen
  s_mov_b64 exec, -1
  s_add_u32 s68, s68, 36864
  s_add_u32 s69, s69, 36864
  buffer_load_dwordx4 v[200:203], v168, s[20:23], s68 offen
  s_mov_b64 exec, 0xff
  buffer_load_dwordx4 v[204:207], v168, s[20:23], s69 offen
  s_mov_b64 exec, -1
  s_add_u32 s68, s68, 36864
  s_add_u32 s69, s69, 36864
  buffer_load_dwordx4 v[208:211], v168, s[20:23], s68 offen
  s_mov_b64 exec, 0xff
  buffer_load_dwordx4 v[212:215], v168, s[20:23], s69 offen
  s_mov_b64 exec, -1
  s_add_u32 s68, s68, 36864
  s_add_u32 s69, s69, 36864
  buffer_load_dwordx4 v[216:219], v168, s[20:23], s68 offen
  s_mov_b64 exec, 0xff
  buffer_load_dwordx4 v[220:223], v168, s[20:23], s69 offen
  s_mov_b64 exec, -1
  s_add_u32 s68, s68, 36864
  s_add_u32 s69, s69, 36864
L_aw_cv:
  buffer_load_dwordx4 v[224:227], v168, s[20:23], s68 offen
  s_mov_b64 exec, 0xff
  buffer_load_dwordx4 v[228:231], v168, s[20:23], s69 offen
  s_mov_b64 exec, -1
  s_add_u32 s68, s68, 36864
  s_add_u32 s69, s69, 36864
  buffer_load_dwordx4 v[232:235], v168, s[20:23], s68 offen
  s_mov_b64 exec, 0xff
  buffer_load_dwordx4 v[236:239], v168, s[20:23], s69 offen
  s_mov_b64 exec, -1
  s_add_u32 s68, s68, 36864
  s_add_u32 s69, s69, 36864
  buffer_load_dwordx4 v[240:243], v168, s[20:23], s68 offen
  s_mov_b64 exec, 0xff
  buffer_load_dwordx4 v[244:247], v168, s[20:23], s69 offen
  s_mov_b64 exec, -1
  s_add_u32 s68, s68, 36864
  s_add_u32 s69, s69, 36864
  buffer_load_dwordx4 v[248:251], v168, s[20:23], s68 offen
  s_mov_b64 exec, 0xff
  buffer_load_dwordx4 v[252:255], v168, s[20:23], s69 offen
  s_mov_b64 exec, -1
  s_add_u32 s68, s68, 36864
  s_add_u32 s69, s69, 36864
  s_waitcnt vmcnt(15)
  v_mfma_f32_16x16x16_bf16 v[72:75], v[64:65], v[192:193], 0
  v_mfma_f32_16x16x16_bf16 v[76:79], v[64:65], v[194:195], 0
  s_waitcnt vmcnt(14)
  v_mfma_f32_16x16x32_bf16 v[80:83], v[68:71], v[196:199], 0
  s_nop 4
  v_cvt_pk_bf16_f32 v72, v72, v73
  v_cvt_pk_bf16_f32 v73, v74, v75
  v_cvt_pk_bf16_f32 v74, v76, v77
  v_cvt_pk_bf16_f32 v75, v78, v79
  v_add_f32 v80, v80, v80 row_ror:8 row_mask:0xf bank_mask:0xf
  v_add_f32 v81, v81, v81 row_ror:8 row_mask:0xf bank_mask:0xf
  v_add_f32 v82, v82, v82 row_ror:8 row_mask:0xf bank_mask:0xf
  v_add_f32 v83, v83, v83 row_ror:8 row_mask:0xf bank_mask:0xf
  buffer_store_dwordx4 v[72:75], v0, s[12:15], s38 offen sc1
  v_mfma_f32_16x16x32_bf16 v[84:87], v[164:167], v[72:75], 0
  v_mfma_f32_16x16x32_bf16 v[88:91], v[72:75], v[72:75], 0
  v_cvt_pk_bf16_f32 v80, v80, v81
  v_cvt_pk_bf16_f32 v81, v82, v83
  v_cndmask_b32 v92, 0, v80, s[52:53]
  v_cndmask_b32 v93, 0, v81, s[52:53]
  v_permlane16_swap_b32 v80, v82
  v_permlane16_swap_b32 v81, v83
  v_mfma_f32_16x16x16_bf16 v[84:87], v[164:165], v[92:93], v[84:87]
  v_mfma_f32_16x16x16_bf16 v[88:91], v[92:93], v[92:93], v[88:91]
  s_mov_b64 exec, 0xff
  buffer_store_dwordx4 v[80:83], v0, s[12:15], s55 offen sc1
  s_mov_b64 exec, -1
  s_nop 4
  v_cndmask_b32 v88, v88, v89, s[72:73]
  v_cndmask_b32 v90, v90, v91, s[72:73]
  v_cndmask_b32 v85, v88, v90, s[74:75]
  s_mov_b64 exec, s[70:71]
  buffer_store_dwordx2 v[84:85], v4, s[12:15], s38 offen offset:1024 sc1
  s_mov_b64 exec, -1
  s_add_u32 s38, s38, 41472
  s_add_u32 s55, s55, 41472
  s_waitcnt vmcnt(16)
  v_mfma_f32_16x16x16_bf16 v[72:75], v[64:65], v[200:201], 0
  v_mfma_f32_16x16x16_bf16 v[76:79], v[64:65], v[202:203], 0
  s_waitcnt vmcnt(15)
  v_mfma_f32_16x16x32_bf16 v[80:83], v[68:71], v[204:207], 0
  s_nop 4
  v_cvt_pk_bf16_f32 v72, v72, v73
  v_cvt_pk_bf16_f32 v73, v74, v75
  v_cvt_pk_bf16_f32 v74, v76, v77
  v_cvt_pk_bf16_f32 v75, v78, v79
  v_add_f32 v80, v80, v80 row_ror:8 row_mask:0xf bank_mask:0xf
  v_add_f32 v81, v81, v81 row_ror:8 row_mask:0xf bank_mask:0xf
  v_add_f32 v82, v82, v82 row_ror:8 row_mask:0xf bank_mask:0xf
  v_add_f32 v83, v83, v83 row_ror:8 row_mask:0xf bank_mask:0xf
  buffer_store_dwordx4 v[72:75], v0, s[12:15], s38 offen sc1
  v_mfma_f32_16x16x32_bf16 v[84:87], v[164:167], v[72:75], 0
  v_mfma_f32_16x16x32_bf16 v[88:91], v[72:75], v[72:75], 0
  v_cvt_pk_bf16_f32 v80, v80, v81
  v_cvt_pk_bf16_f32 v81, v82, v83
  v_cndmask_b32 v92, 0, v80, s[52:53]
  v_cndmask_b32 v93, 0, v81, s[52:53]
  v_permlane16_swap_b32 v80, v82
  v_permlane16_swap_b32 v81, v83
  v_mfma_f32_16x16x16_bf16 v[84:87], v[164:165], v[92:93], v[84:87]
  v_mfma_f32_16x16x16_bf16 v[88:91], v[92:93], v[92:93], v[88:91]
  s_mov_b64 exec, 0xff
  buffer_store_dwordx4 v[80:83], v0, s[12:15], s55 offen sc1
  s_mov_b64 exec, -1
  s_nop 4
  v_cndmask_b32 v88, v88, v89, s[72:73]
  v_cndmask_b32 v90, v90, v91, s[72:73]
  v_cndmask_b32 v85, v88, v90, s[74:75]
  s_mov_b64 exec, s[70:71]
  buffer_store_dwordx2 v[84:85], v4, s[12:15], s38 offen offset:1024 sc1
  s_mov_b64 exec, -1
  s_add_u32 s38, s38, 41472
  s_add_u32 s55, s55, 41472
  s_waitcnt vmcnt(17)
  v_mfma_f32_16x16x16_bf16 v[72:75], v[64:65], v[208:209], 0
  v_mfma_f32_16x16x16_bf16 v[76:79], v[64:65], v[210:211], 0
  s_waitcnt vmcnt(16)
  v_mfma_f32_16x16x32_bf16 v[80:83], v[68:71], v[212:215], 0
  s_nop 4
  v_cvt_pk_bf16_f32 v72, v72, v73
  v_cvt_pk_bf16_f32 v73, v74, v75
  v_cvt_pk_bf16_f32 v74, v76, v77
  v_cvt_pk_bf16_f32 v75, v78, v79
  v_add_f32 v80, v80, v80 row_ror:8 row_mask:0xf bank_mask:0xf
  v_add_f32 v81, v81, v81 row_ror:8 row_mask:0xf bank_mask:0xf
  v_add_f32 v82, v82, v82 row_ror:8 row_mask:0xf bank_mask:0xf
  v_add_f32 v83, v83, v83 row_ror:8 row_mask:0xf bank_mask:0xf
  buffer_store_dwordx4 v[72:75], v0, s[12:15], s38 offen sc1
  v_mfma_f32_16x16x32_bf16 v[84:87], v[164:167], v[72:75], 0
  v_mfma_f32_16x16x32_bf16 v[88:91], v[72:75], v[72:75], 0
  v_cvt_pk_bf16_f32 v80, v80, v81
  v_cvt_pk_bf16_f32 v81, v82, v83
  v_cndmask_b32 v92, 0, v80, s[52:53]
  v_cndmask_b32 v93, 0, v81, s[52:53]
  v_permlane16_swap_b32 v80, v82
  v_permlane16_swap_b32 v81, v83
  v_mfma_f32_16x16x16_bf16 v[84:87], v[164:165], v[92:93], v[84:87]
  v_mfma_f32_16x16x16_bf16 v[88:91], v[92:93], v[92:93], v[88:91]
  s_mov_b64 exec, 0xff
  buffer_store_dwordx4 v[80:83], v0, s[12:15], s55 offen sc1
  s_mov_b64 exec, -1
  s_nop 4
  v_cndmask_b32 v88, v88, v89, s[72:73]
  v_cndmask_b32 v90, v90, v91, s[72:73]
  v_cndmask_b32 v85, v88, v90, s[74:75]
  s_mov_b64 exec, s[70:71]
  buffer_store_dwordx2 v[84:85], v4, s[12:15], s38 offen offset:1024 sc1
  s_mov_b64 exec, -1
  s_add_u32 s38, s38, 41472
  s_add_u32 s55, s55, 41472
  s_waitcnt vmcnt(18)
  v_mfma_f32_16x16x16_bf16 v[72:75], v[64:65], v[216:217], 0
  v_mfma_f32_16x16x16_bf16 v[76:79], v[64:65], v[218:219], 0
  s_waitcnt vmcnt(17)
  v_mfma_f32_16x16x32_bf16 v[80:83], v[68:71], v[220:223], 0
  s_nop 4
  v_cvt_pk_bf16_f32 v72, v72, v73
  v_cvt_pk_bf16_f32 v73, v74, v75
  v_cvt_pk_bf16_f32 v74, v76, v77
  v_cvt_pk_bf16_f32 v75, v78, v79
  v_add_f32 v80, v80, v80 row_ror:8 row_mask:0xf bank_mask:0xf
  v_add_f32 v81, v81, v81 row_ror:8 row_mask:0xf bank_mask:0xf
  v_add_f32 v82, v82, v82 row_ror:8 row_mask:0xf bank_mask:0xf
  v_add_f32 v83, v83, v83 row_ror:8 row_mask:0xf bank_mask:0xf
  buffer_store_dwordx4 v[72:75], v0, s[12:15], s38 offen sc1
  v_mfma_f32_16x16x32_bf16 v[84:87], v[164:167], v[72:75], 0
  v_mfma_f32_16x16x32_bf16 v[88:91], v[72:75], v[72:75], 0
  v_cvt_pk_bf16_f32 v80, v80, v81
  v_cvt_pk_bf16_f32 v81, v82, v83
  v_cndmask_b32 v92, 0, v80, s[52:53]
  v_cndmask_b32 v93, 0, v81, s[52:53]
  v_permlane16_swap_b32 v80, v82
  v_permlane16_swap_b32 v81, v83
  v_mfma_f32_16x16x16_bf16 v[84:87], v[164:165], v[92:93], v[84:87]
  v_mfma_f32_16x16x16_bf16 v[88:91], v[92:93], v[92:93], v[88:91]
  s_mov_b64 exec, 0xff
  buffer_store_dwordx4 v[80:83], v0, s[12:15], s55 offen sc1
  s_mov_b64 exec, -1
  s_nop 4
  v_cndmask_b32 v88, v88, v89, s[72:73]
  v_cndmask_b32 v90, v90, v91, s[72:73]
  v_cndmask_b32 v85, v88, v90, s[74:75]
  s_mov_b64 exec, s[70:71]
  buffer_store_dwordx2 v[84:85], v4, s[12:15], s38 offen offset:1024 sc1
  s_mov_b64 exec, -1
  s_add_u32 s38, s38, 41472
  s_add_u32 s55, s55, 41472
  s_add_u32 s43, s43, 4
  s_waitcnt vmcnt(0)
  v_mov_b32 v3, s43
  s_mov_b64 exec, 1
  buffer_store_dword v3, off, s[12:15], s37 sc1
  s_mov_b64 exec, -1
  buffer_load_dwordx4 v[192:195], v168, s[20:23], s68 offen
  s_mov_b64 exec, 0xff
  buffer_load_dwordx4 v[196:199], v168, s[20:23], s69 offen
  s_mov_b64 exec, -1
  s_add_u32 s68, s68, 36864
  s_add_u32 s69, s69, 36864
  buffer_load_dwordx4 v[200:203], v168, s[20:23], s68 offen
  s_mov_b64 exec, 0xff
  buffer_load_dwordx4 v[204:207], v168, s[20:23], s69 offen
  s_mov_b64 exec, -1
  s_add_u32 s68, s68, 36864
  s_add_u32 s69, s69, 36864
  buffer_load_dwordx4 v[208:211], v168, s[20:23], s68 offen
  s_mov_b64 exec, 0xff
  buffer_load_dwordx4 v[212:215], v168, s[20:23], s69 offen
  s_mov_b64 exec, -1
  s_add_u32 s68, s68, 36864
  s_add_u32 s69, s69, 36864
  buffer_load_dwordx4 v[216:219], v168, s[20:23], s68 offen
  s_mov_b64 exec, 0xff
  buffer_load_dwordx4 v[220:223], v168, s[20:23], s69 offen
  s_mov_b64 exec, -1
  s_add_u32 s68, s68, 36864
  s_add_u32 s69, s69, 36864
  v_mfma_f32_16x16x16_bf16 v[72:75], v[64:65], v[224:225], 0
  v_mfma_f32_16x16x16_bf16 v[76:79], v[64:65], v[226:227], 0
  v_mfma_f32_16x16x32_bf16 v[80:83], v[68:71], v[228:231], 0
  s_nop 5
  v_cvt_pk_bf16_f32 v72, v72, v73
  v_cvt_pk_bf16_f32 v73, v74, v75
  v_cvt_pk_bf16_f32 v74, v76, v77
  v_cvt_pk_bf16_f32 v75, v78, v79
  v_add_f32 v80, v80, v80 row_ror:8 row_mask:0xf bank_mask:0xf
  v_add_f32 v81, v81, v81 row_ror:8 row_mask:0xf bank_mask:0xf
  v_add_f32 v82, v82, v82 row_ror:8 row_mask:0xf bank_mask:0xf
  v_add_f32 v83, v83, v83 row_ror:8 row_mask:0xf bank_mask:0xf
  buffer_store_dwordx4 v[72:75], v0, s[12:15], s38 offen sc1
  v_mfma_f32_16x16x32_bf16 v[84:87], v[164:167], v[72:75], 0
  v_mfma_f32_16x16x32_bf16 v[88:91], v[72:75], v[72:75], 0
  v_cvt_pk_bf16_f32 v80, v80, v81
  v_cvt_pk_bf16_f32 v81, v82, v83
  v_cndmask_b32 v92, 0, v80, s[52:53]
  v_cndmask_b32 v93, 0, v81, s[52:53]
  v_permlane16_swap_b32 v80, v82
  v_permlane16_swap_b32 v81, v83
  v_mfma_f32_16x16x16_bf16 v[84:87], v[164:165], v[92:93], v[84:87]
  v_mfma_f32_16x16x16_bf16 v[88:91], v[92:93], v[92:93], v[88:91]
  s_mov_b64 exec, 0xff
  buffer_store_dwordx4 v[80:83], v0, s[12:15], s55 offen sc1
  s_mov_b64 exec, -1
  s_nop 4
  v_cndmask_b32 v88, v88, v89, s[72:73]
  v_cndmask_b32 v90, v90, v91, s[72:73]
  v_cndmask_b32 v85, v88, v90, s[74:75]
  s_mov_b64 exec, s[70:71]
  buffer_store_dwordx2 v[84:85], v4, s[12:15], s38 offen offset:1024 sc1
  s_mov_b64 exec, -1
  s_add_u32 s38, s38, 41472
  s_add_u32 s55, s55, 41472
  v_mfma_f32_16x16x16_bf16 v[72:75], v[64:65], v[232:233], 0
  v_mfma_f32_16x16x16_bf16 v[76:79], v[64:65], v[234:235], 0
  v_mfma_f32_16x16x32_bf16 v[80:83], v[68:71], v[236:239], 0
  s_nop 5
  v_cvt_pk_bf16_f32 v72, v72, v73
  v_cvt_pk_bf16_f32 v73, v74, v75
  v_cvt_pk_bf16_f32 v74, v76, v77
  v_cvt_pk_bf16_f32 v75, v78, v79
  v_add_f32 v80, v80, v80 row_ror:8 row_mask:0xf bank_mask:0xf
  v_add_f32 v81, v81, v81 row_ror:8 row_mask:0xf bank_mask:0xf
  v_add_f32 v82, v82, v82 row_ror:8 row_mask:0xf bank_mask:0xf
  v_add_f32 v83, v83, v83 row_ror:8 row_mask:0xf bank_mask:0xf
  buffer_store_dwordx4 v[72:75], v0, s[12:15], s38 offen sc1
  v_mfma_f32_16x16x32_bf16 v[84:87], v[164:167], v[72:75], 0
  v_mfma_f32_16x16x32_bf16 v[88:91], v[72:75], v[72:75], 0
  v_cvt_pk_bf16_f32 v80, v80, v81
  v_cvt_pk_bf16_f32 v81, v82, v83
  v_cndmask_b32 v92, 0, v80, s[52:53]
  v_cndmask_b32 v93, 0, v81, s[52:53]
  v_permlane16_swap_b32 v80, v82
  v_permlane16_swap_b32 v81, v83
  v_mfma_f32_16x16x16_bf16 v[84:87], v[164:165], v[92:93], v[84:87]
  v_mfma_f32_16x16x16_bf16 v[88:91], v[92:93], v[92:93], v[88:91]
  s_mov_b64 exec, 0xff
  buffer_store_dwordx4 v[80:83], v0, s[12:15], s55 offen sc1
  s_mov_b64 exec, -1
  s_nop 4
  v_cndmask_b32 v88, v88, v89, s[72:73]
  v_cndmask_b32 v90, v90, v91, s[72:73]
  v_cndmask_b32 v85, v88, v90, s[74:75]
  s_mov_b64 exec, s[70:71]
  buffer_store_dwordx2 v[84:85], v4, s[12:15], s38 offen offset:1024 sc1
  s_mov_b64 exec, -1
  s_add_u32 s38, s38, 41472
  s_add_u32 s55, s55, 41472
  v_mfma_f32_16x16x16_bf16 v[72:75], v[64:65], v[240:241], 0
  v_mfma_f32_16x16x16_bf16 v[76:79], v[64:65], v[242:243], 0
  v_mfma_f32_16x16x32_bf16 v[80:83], v[68:71], v[244:247], 0
  s_nop 5
  v_cvt_pk_bf16_f32 v72, v72, v73
  v_cvt_pk_bf16_f32 v73, v74, v75
  v_cvt_pk_bf16_f32 v74, v76, v77
  v_cvt_pk_bf16_f32 v75, v78, v79
  v_add_f32 v80, v80, v80 row_ror:8 row_mask:0xf bank_mask:0xf
  v_add_f32 v81, v81, v81 row_ror:8 row_mask:0xf bank_mask:0xf
  v_add_f32 v82, v82, v82 row_ror:8 row_mask:0xf bank_mask:0xf
  v_add_f32 v83, v83, v83 row_ror:8 row_mask:0xf bank_mask:0xf
  buffer_store_dwordx4 v[72:75], v0, s[12:15], s38 offen sc1
  v_mfma_f32_16x16x32_bf16 v[84:87], v[164:167], v[72:75], 0
  v_mfma_f32_16x16x32_bf16 v[88:91], v[72:75], v[72:75], 0
  v_cvt_pk_bf16_f32 v80, v80, v81
  v_cvt_pk_bf16_f32 v81, v82, v83
  v_cndmask_b32 v92, 0, v80, s[52:53]
  v_cndmask_b32 v93, 0, v81, s[52:53]
  v_permlane16_swap_b32 v80, v82
  v_permlane16_swap_b32 v81, v83
  v_mfma_f32_16x16x16_bf16 v[84:87], v[164:165], v[92:93], v[84:87]
  v_mfma_f32_16x16x16_bf16 v[88:91], v[92:93], v[92:93], v[88:91]
  s_mov_b64 exec, 0xff
  buffer_store_dwordx4 v[80:83], v0, s[12:15], s55 offen sc1
  s_mov_b64 exec, -1
  s_nop 4
  v_cndmask_b32 v88, v88, v89, s[72:73]
  v_cndmask_b32 v90, v90, v91, s[72:73]
  v_cndmask_b32 v85, v88, v90, s[74:75]
  s_mov_b64 exec, s[70:71]
  buffer_store_dwordx2 v[84:85], v4, s[12:15], s38 offen offset:1024 sc1
  s_mov_b64 exec, -1
  s_add_u32 s38, s38, 41472
  s_add_u32 s55, s55, 41472
  v_mfma_f32_16x16x16_bf16 v[72:75], v[64:65], v[248:249], 0
  v_mfma_f32_16x16x16_bf16 v[76:79], v[64:65], v[250:251], 0
  v_mfma_f32_16x16x32_bf16 v[80:83], v[68:71], v[252:255], 0
  s_nop 5
  v_cvt_pk_bf16_f32 v72, v72, v73
  v_cvt_pk_bf16_f32 v73, v74, v75
  v_cvt_pk_bf16_f32 v74, v76, v77
  v_cvt_pk_bf16_f32 v75, v78, v79
  v_add_f32 v80, v80, v80 row_ror:8 row_mask:0xf bank_mask:0xf
  v_add_f32 v81, v81, v81 row_ror:8 row_mask:0xf bank_mask:0xf
  v_add_f32 v82, v82, v82 row_ror:8 row_mask:0xf bank_mask:0xf
  v_add_f32 v83, v83, v83 row_ror:8 row_mask:0xf bank_mask:0xf
  buffer_store_dwordx4 v[72:75], v0, s[12:15], s38 offen sc1
  v_mfma_f32_16x16x32_bf16 v[84:87], v[164:167], v[72:75], 0
  v_mfma_f32_16x16x32_bf16 v[88:91], v[72:75], v[72:75], 0
  v_cvt_pk_bf16_f32 v80, v80, v81
  v_cvt_pk_bf16_f32 v81, v82, v83
  v_cndmask_b32 v92, 0, v80, s[52:53]
  v_cndmask_b32 v93, 0, v81, s[52:53]
  v_permlane16_swap_b32 v80, v82
  v_permlane16_swap_b32 v81, v83
  v_mfma_f32_16x16x16_bf16 v[84:87], v[164:165], v[92:93], v[84:87]
  v_mfma_f32_16x16x16_bf16 v[88:91], v[92:93], v[92:93], v[88:91]
  s_mov_b64 exec, 0xff
  buffer_store_dwordx4 v[80:83], v0, s[12:15], s55 offen sc1
  s_mov_b64 exec, -1
  s_nop 4
  v_cndmask_b32 v88, v88, v89, s[72:73]
  v_cndmask_b32 v90, v90, v91, s[72:73]
  v_cndmask_b32 v85, v88, v90, s[74:75]
  s_mov_b64 exec, s[70:71]
  buffer_store_dwordx2 v[84:85], v4, s[12:15], s38 offen offset:1024 sc1
  s_mov_b64 exec, -1
  s_add_u32 s38, s38, 41472
  s_add_u32 s55, s55, 41472
  s_add_u32 s43, s43, 4
  s_waitcnt vmcnt(0)
  v_mov_b32 v3, s43
  s_mov_b64 exec, 1
  buffer_store_dword v3, off, s[12:15], s37 sc1
  s_mov_b64 exec, -1
  s_cmp_lt_u32 s43, 64
  s_cbranch_scc1 L_aw_cv
  s_mov_b32 s43, 0
  s_mov_b32 s38, s58
  s_mov_b32 s55, s56
L_aw_nc:
  s_mul_i32 s99, s11, 2654208
  s_add_u32 s38, s38, s99
  s_add_u32 s55, s55, s99
  s_add_u32 s58, s38, 8388608
  s_add_u32 s56, s55, 8388608
  s_add_u32 s38, s38, 14680064
  s_add_u32 s55, s55, 14680064
  s_mov_b32 s37, s94
  s_lshl_b32 s91, s60, 4
  s_add_u32 s91, s91, s10
  s_lshl_b32 s91, s91, 2
  s_add_u32 s91, s91, s93
  s_cmp_lg_u32 s9, 3
  s_cbranch_scc1 L_gw_98b
  s_cmp_lg_u32 s11, 0
  s_cbranch_scc1 L_gw_98a
  v_mov_b32 v60, 128
  s_mov_b64 exec, 1
L_wa_99:
  global_load_dword v61, v60, s[4:5] sc1
  s_waitcnt vmcnt(0)
  v_readfirstlane_b32 s98, v61
  s_nop 0
  s_cmp_ge_u32 s98, 32
  s_nop 1
  s_cbranch_scc1 L_wa_99d
  s_sleep 24
  s_sub_u32 s100, s100, 1
  s_cbranch_scc0 L_wa_99
  s_branch L_end
L_wa_99d:
  s_mov_b64 exec, -1
  s_branch L_gw_98b
L_gw_98a:
  v_mov_b32 v60, 192
  s_mov_b64 exec, 1
L_wa_100:
  global_load_dword v61, v60, s[4:5] sc1
  s_waitcnt vmcnt(0)
  v_readfirstlane_b32 s98, v61
  s_nop 0
  s_cmp_ge_u32 s98, 32
  s_nop 1
  s_cbranch_scc1 L_wa_100d
  s_sleep 48
  s_sub_u32 s100, s100, 1
  s_cbranch_scc0 L_wa_100
  s_branch L_end
L_wa_100d:
  s_mov_b64 exec, -1
L_gw_98b:
  s_barrier
  s_add_u32 m0, s62, 0
  s_add_u32 s99, s90, 0
  buffer_load_dwordx4 v17, s[16:19], s99 offen  lds
  s_add_u32 m0, s62, 1024
  s_add_u32 s99, s90, 18432
  buffer_load_dwordx4 v17, s[16:19], s99 offen  lds
  s_add_u32 m0, s62, 2048
  s_add_u32 s99, s90, 64
  buffer_load_dwordx4 v17, s[16:19], s99 offen  lds
  s_add_u32 m0, s62, 3072
  s_add_u32 s99, s90, 18496
  buffer_load_dwordx4 v17, s[16:19], s99 offen  lds
  s_add_u32 m0, s62, 4096
  s_add_u32 s99, s90, 128
  buffer_load_dwordx4 v17, s[16:19], s99 offen  lds
  s_add_u32 m0, s62, 5120
  s_add_u32 s99, s90, 18560
  buffer_load_dwordx4 v17, s[16:19], s99 offen  lds
  s_add_u32 m0, s62, 6144
  s_add_u32 s99, s90, 192
  buffer_load_dwordx4 v17, s[16:19], s99 offen  lds
  s_add_u32 m0, s62, 7168
  s_add_u32 s99, s90, 18624
  buffer_load_dwordx4 v17, s[16:19], s99 offen  lds
  s_add_u32 m0, s62, 8192
  s_add_u32 s99, s90, 512
  buffer_load_dwordx4 v17, s[16:19], s99 offen  lds
  s_add_u32 m0, s62, 9216
  s_add_u32 s99, s90, 18944
  buffer_load_dwordx4 v17, s[16:19], s99 offen  lds
  s_add_u32 m0, s62, 10240
  s_add_u32 s99, s90, 36864
  buffer_load_dwordx4 v17, s[16:19], s99 offen  lds
  s_add_u32 m0, s62, 11264
  s_add_u32 s99, s90, 55296
  buffer_load_dwordx4 v17, s[16:19], s99 offen  lds
  s_add_u32 m0, s62, 12288
  s_add_u32 s99, s90, 36928
  buffer_load_dwordx4 v17, s[16:19], s99 offen  lds
  s_add_u32 m0, s62, 13312
  s_add_u32 s99, s90, 55360
  buffer_load_dwordx4 v17, s[16:19], s99 offen  lds
  s_add_u32 m0, s62, 14336
  s_add_u32 s99, s90, 36992
  buffer_load_dwordx4 v17, s[16:19], s99 offen  lds
  s_add_u32 m0, s62, 15360
  s_add_u32 s99, s90, 55424
  buffer_load_dwordx4 v17, s[16:19], s99 offen  lds
  s_add_u32 m0, s62, 16384
  s_add_u32 s99, s90, 37056
  buffer_load_dwordx4 v17, s[16:19], s99 offen  lds
  s_add_u32 m0, s62, 17408
  s_add_u32 s99, s90, 55488
  buffer_load_dwordx4 v17, s[16:19], s99 offen  lds
  s_add_u32 m0, s62, 18432
  s_add_u32 s99, s90, 37376
  buffer_load_dwordx4 v17, s[16:19], s99 offen  lds
  s_add_u32 m0, s62, 19456
  s_add_u32 s99, s90, 55808
  buffer_load_dwordx4 v17, s[16:19], s99 offen  lds
  s_add_u32 m0, s62, 20480
  s_add_u32 s99, s90, 73728
  buffer_load_dwordx4 v17, s[16:19], s99 offen  lds
  s_add_u32 m0, s62, 21504
  s_add_u32 s99, s90, 92160
  buffer_load_dwordx4 v17, s[16:19], s99 offen  lds
  s_add_u32 m0, s62, 22528
  s_add_u32 s99, s90, 73792
  buffer_load_dwordx4 v17, s[16:19], s99 offen  lds
  s_add_u32 m0, s62, 23552
  s_add_u32 s99, s90, 92224
  buffer_load_dwordx4 v17, s[16:19], s99 offen  lds
  s_add_u32 m0, s62, 24576
  s_add_u32 s99, s90, 73856
  buffer_load_dwordx4 v17, s[16:19], s99 offen  lds
  s_add_u32 m0, s62, 25600
  s_add_u32 s99, s90, 92288
  buffer_load_dwordx4 v17, s[16:19], s99 offen  lds
  s_add_u32 m0, s62, 26624
  s_add_u32 s99, s90, 73920
  buffer_load_dwordx4 v17, s[16:19], s99 offen  lds
  s_add_u32 m0, s62, 27648
  s_add_u32 s99, s90, 92352
  buffer_load_dwordx4 v17, s[16:19], s99 offen  lds
  s_add_u32 m0, s62, 28672
  s_add_u32 s99, s90, 74240
  buffer_load_dwordx4 v17, s[16:19], s99 offen  lds
  s_add_u32 m0, s62, 29696
  s_add_u32 s99, s90, 92672
  buffer_load_dwordx4 v17, s[16:19], s99 offen  lds
  s_add_u32 m0, s62, 30720
  s_add_u32 s99, s90, 110592
  buffer_load_dwordx4 v17, s[16:19], s99 offen  lds
  s_add_u32 m0, s62, 31744
  s_add_u32 s99, s90, 129024
  buffer_load_dwordx4 v17, s[16:19], s99 offen  lds
  s_add_u32 m0, s62, 32768
  s_add_u32 s99, s90, 110656
  buffer_load_dwordx4 v17, s[16:19], s99 offen  lds
  s_add_u32 m0, s62, 33792
  s_add_u32 s99, s90, 129088
  buffer_load_dwordx4 v17, s[16:19], s99 offen  lds
  s_add_u32 m0, s62, 34816
  s_add_u32 s99, s90, 110720
  buffer_load_dwordx4 v17, s[16:19], s99 offen  lds
  s_add_u32 m0, s62, 35840
  s_add_u32 s99, s90, 129152
  buffer_load_dwordx4 v17, s[16:19], s99 offen  lds
  s_add_u32 m0, s62, 36864
  s_add_u32 s99, s90, 110784
  buffer_load_dwordx4 v17, s[16:19], s99 offen  lds
  s_add_u32 m0, s62, 37888
  s_add_u32 s99, s90, 129216
  buffer_load_dwordx4 v17, s[16:19], s99 offen  lds
  s_waitcnt vmcnt(36)
  ds_read_b64_tr_b16 a[0:1], v18 offset:0
  ds_read_b64_tr_b16 a[2:3], v18 offset:256
  ds_read_b64_tr_b16 a[4:5], v19 offset:0
  ds_read_b64_tr_b16 a[6:7], v19 offset:256
  s_add_u32 m0, s62, 38912
  s_add_u32 s99, s90, 111104
  buffer_load_dwordx4 v17, s[16:19], s99 offen  lds
  s_add_u32 m0, s62, 39936
  s_add_u32 s99, s90, 129536
  buffer_load_dwordx4 v17, s[16:19], s99 offen  lds
  s_waitcnt vmcnt(36)
  ds_read_b64_tr_b16 a[8:9], v18 offset:2048
  ds_read_b64_tr_b16 a[10:11], v18 offset:2304
  ds_read_b64_tr_b16 a[12:13], v19 offset:2048
  ds_read_b64_tr_b16 a[14:15], v19 offset:2304
  s_waitcnt lgkmcnt(4)
  s_add_u32 m0, s62, 0
  s_add_u32 s99, s90, 147456
  buffer_load_dwordx4 v17, s[16:19], s99 offen  lds
  s_add_u32 m0, s62, 1024
  s_add_u32 s99, s90, 165888
  buffer_load_dwordx4 v17, s[16:19], s99 offen  lds
  s_waitcnt vmcnt(36)
  ds_read_b64_tr_b16 a[16:17], v18 offset:4096
  ds_read_b64_tr_b16 a[18:19], v18 offset:4352
  ds_read_b64_tr_b16 a[20:21], v19 offset:4096
  ds_read_b64_tr_b16 a[22:23], v19 offset:4352
  s_waitcnt lgkmcnt(4)
  s_add_u32 m0, s62, 2048
  s_add_u32 s99, s90, 147520
  buffer_load_dwordx4 v17, s[16:19], s99 offen  lds
  s_add_u32 m0, s62, 3072
  s_add_u32 s99, s90, 165952
  buffer_load_dwordx4 v17, s[16:19], s99 offen  lds
  s_waitcnt vmcnt(36)
  ds_read_b64_tr_b16 a[24:25], v18 offset:6144
  ds_read_b64_tr_b16 a[26:27], v18 offset:6400
  ds_read_b64_tr_b16 a[28:29], v19 offset:6144
  ds_read_b64_tr_b16 a[30:31], v19 offset:6400
  s_waitcnt lgkmcnt(4)
  s_add_u32 m0, s62, 4096
  s_add_u32 s99, s90, 147584
  buffer_load_dwordx4 v17, s[16:19], s99 offen  lds
  s_add_u32 m0, s62, 5120
  s_add_u32 s99, s90, 166016
  buffer_load_dwordx4 v17, s[16:19], s99 offen  lds
  s_waitcnt vmcnt(36)
  ds_read_b64_tr_b16 a[32:33], v16 offset:8192
  ds_read_b64_tr_b16 a[34:35], v16 offset:8448
  ds_read_b64_tr_b16 a[36:37], v16 offset:8200
  ds_read_b64_tr_b16 a[38:39], v16 offset:8456
  s_waitcnt lgkmcnt(4)
  s_add_u32 m0, s62, 6144
  s_add_u32 s99, s90, 147648
  buffer_load_dwordx4 v17, s[16:19], s99 offen  lds
  s_add_u32 m0, s62, 7168
  s_add_u32 s99, s90, 166080
  buffer_load_dwordx4 v17, s[16:19], s99 offen  lds
  s_waitcnt vmcnt(36)
  ds_read_b64_tr_b16 a[40:41], v18 offset:10240
  ds_read_b64_tr_b16 a[42:43], v18 offset:10496
  ds_read_b64_tr_b16 a[44:45], v19 offset:10240
  ds_read_b64_tr_b16 a[46:47], v19 offset:10496
  s_waitcnt lgkmcnt(4)
  s_add_u32 m0, s62, 8192
  s_add_u32 s99, s90, 147968
  buffer_load_dwordx4 v17, s[16:19], s99 offen  lds
  s_add_u32 m0, s62, 9216
  s_add_u32 s99, s90, 166400
  buffer_load_dwordx4 v17, s[16:19], s99 offen  lds
  s_waitcnt vmcnt(36)
  ds_read_b64_tr_b16 a[48:49], v18 offset:12288
  ds_read_b64_tr_b16 a[50:51], v18 offset:12544
  ds_read_b64_tr_b16 a[52:53], v19 offset:12288
  ds_read_b64_tr_b16 a[54:55], v19 offset:12544
  s_waitcnt lgkmcnt(4)
  s_add_u32 m0, s62, 10240
  s_add_u32 s99, s90, 184320
  buffer_load_dwordx4 v17, s[16:19], s99 offen  lds
  s_add_u32 m0, s62, 11264
  s_add_u32 s99, s90, 202752
  buffer_load_dwordx4 v17, s[16:19], s99 offen  lds
  s_waitcnt vmcnt(36)
  ds_read_b64_tr_b16 a[56:57], v18 offset:14336
  ds_read_b64_tr_b16 a[58:59], v18 offset:14592
  ds_read_b64_tr_b16 a[60:61], v19 offset:14336
  ds_read_b64_tr_b16 a[62:63], v19 offset:14592
  s_waitcnt lgkmcnt(4)
  s_add_u32 m0, s62, 12288
  s_add_u32 s99, s90, 184384
  buffer_load_dwordx4 v17, s[16:19], s99 offen  lds
  s_add_u32 m0, s62, 13312
  s_add_u32 s99, s90, 202816
  buffer_load_dwordx4 v17, s[16:19], s99 offen  lds
  s_waitcnt vmcnt(36)
  ds_read_b64_tr_b16 a[64:65], v18 offset:16384
  ds_read_b64_tr_b16 a[66:67], v18 offset:16640
  ds_read_b64_tr_b16 a[68:69], v19 offset:16384
  ds_read_b64_tr_b16 a[70:71], v19 offset:16640
  s_waitcnt lgkmcnt(4)
  s_add_u32 m0, s62, 14336
  s_add_u32 s99, s90, 184448
  buffer_load_dwordx4 v17, s[16:19], s99 offen  lds
  s_add_u32 m0, s62, 15360
  s_add_u32 s99, s90, 202880
  buffer_load_dwordx4 v17, s[16:19], s99 offen  lds
  s_waitcnt vmcnt(36)
  ds_read_b64_tr_b16 a[72:73], v16 offset:18432
  ds_read_b64_tr_b16 a[74:75], v16 offset:18688
  ds_read_b64_tr_b16 a[76:77], v16 offset:18440
  ds_read_b64_tr_b16 a[78:79], v16 offset:18696
  s_waitcnt lgkmcnt(4)
  s_add_u32 m0, s62, 16384
  s_add_u32 s99, s90, 184512
  buffer_load_dwordx4 v17, s[16:19], s99 offen  lds
  s_add_u32 m0, s62, 17408
  s_add_u32 s99, s90, 202944
  buffer_load_dwordx4 v17, s[16:19], s99 offen  lds
  s_waitcnt vmcnt(36)
  ds_read_b64_tr_b16 a[80:81], v18 offset:20480
  ds_read_b64_tr_b16 a[82:83], v18 offset:20736
  ds_read_b64_tr_b16 a[84:85], v19 offset:20480
  ds_read_b64_tr_b16 a[86:87], v19 offset:20736
  s_waitcnt lgkmcnt(4)
  s_add_u32 m0, s62, 18432
  s_add_u32 s99, s90, 184832
  buffer_load_dwordx4 v17, s[16:19], s99 offen  lds
  s_add_u32 m0, s62, 19456
  s_add_u32 s99, s90, 203264
  buffer_load_dwordx4 v17, s[16:19], s99 offen  lds
  s_waitcnt vmcnt(36)
  ds_read_b64_tr_b16 a[88:89], v18 offset:22528
  ds_read_b64_tr_b16 a[90:91], v18 offset:22784
  ds_read_b64_tr_b16 a[92:93], v19 offset:22528
  ds_read_b64_tr_b16 a[94:95], v19 offset:22784
  s_waitcnt lgkmcnt(4)
  s_add_u32 m0, s62, 20480
  s_add_u32 s99, s90, 221184
  buffer_load_dwordx4 v17, s[16:19], s99 offen  lds
  s_add_u32 m0, s62, 21504
  s_add_u32 s99, s90, 239616
  buffer_load_dwordx4 v17, s[16:19], s99 offen  lds
  s_waitcnt vmcnt(36)
  ds_read_b64_tr_b16 a[96:97], v18 offset:24576
  ds_read_b64_tr_b16 a[98:99], v18 offset:24832
  ds_read_b64_tr_b16 a[100:101], v19 offset:24576
  ds_read_b64_tr_b16 a[102:103], v19 offset:24832
  s_waitcnt lgkmcnt(4)
  s_add_u32 m0, s62, 22528
  s_add_u32 s99, s90, 221248
  buffer_load_dwordx4 v17, s[16:19], s99 offen  lds
  s_add_u32 m0, s62, 23552
  s_add_u32 s99, s90, 239680
  buffer_load_dwordx4 v17, s[16:19], s99 offen  lds
  s_waitcnt vmcnt(36)
  ds_read_b64_tr_b16 a[104:105], v18 offset:26624
  ds_read_b64_tr_b16 a[106:107], v18 offset:26880
  ds_read_b64_tr_b16 a[108:109], v19 offset:26624
  ds_read_b64_tr_b16 a[110:111], v19 offset:26880
  s_waitcnt lgkmcnt(4)
  s_add_u32 m0, s62, 24576
  s_add_u32 s99, s90, 221312
  buffer_load_dwordx4 v17, s[16:19], s99 offen  lds
  s_add_u32 m0, s62, 25600
  s_add_u32 s99, s90, 239744
  buffer_load_dwordx4 v17, s[16:19], s99 offen  lds
  s_waitcnt vmcnt(36)
  ds_read_b64_tr_b16 a[112:113], v16 offset:28672
  ds_read_b64_tr_b16 a[114:115], v16 offset:28928
  ds_read_b64_tr_b16 a[116:117], v16 offset:28680
  ds_read_b64_tr_b16 a[118:119], v16 offset:28936
  s_waitcnt lgkmcnt(4)
  s_add_u32 m0, s62, 26624
  s_add_u32 s99, s90, 221376
  buffer_load_dwordx4 v17, s[16:19], s99 offen  lds
  s_add_u32 m0, s62, 27648
  s_add_u32 s99, s90, 239808
  buffer_load_dwordx4 v17, s[16:19], s99 offen  lds
  s_waitcnt vmcnt(36)
  ds_read_b64_tr_b16 a[120:121], v18 offset:30720
  ds_read_b64_tr_b16 a[122:123], v18 offset:30976
  ds_read_b64_tr_b16 a[124:125], v19 offset:30720
  ds_read_b64_tr_b16 a[126:127], v19 offset:30976
  s_waitcnt lgkmcnt(4)
  s_add_u32 m0, s62, 28672
  s_add_u32 s99, s90, 221696
  buffer_load_dwordx4 v17, s[16:19], s99 offen  lds
  s_add_u32 m0, s62, 29696
  s_add_u32 s99, s90, 240128
  buffer_load_dwordx4 v17, s[16:19], s99 offen  lds
  s_waitcnt vmcnt(36)
  ds_read_b64_tr_b16 a[128:129], v18 offset:32768
  ds_read_b64_tr_b16 a[130:131], v18 offset:33024
  ds_read_b64_tr_b16 a[132:133], v19 offset:32768
  ds_read_b64_tr_b16 a[134:135], v19 offset:33024
  s_waitcnt lgkmcnt(4)
  s_add_u32 m0, s62, 30720
  s_add_u32 s99, s90, 258048
  buffer_load_dwordx4 v17, s[16:19], s99 offen  lds
  s_add_u32 m0, s62, 31744
  s_add_u32 s99, s90, 276480
  buffer_load_dwordx4 v17, s[16:19], s99 offen  lds
  s_waitcnt vmcnt(36)
  ds_read_b64_tr_b16 a[136:137], v18 offset:34816
  ds_read_b64_tr_b16 a[138:139], v18 offset:35072
  ds_read_b64_tr_b16 a[140:141], v19 offset:34816
  ds_read_b64_tr_b16 a[142:143], v19 offset:35072
  s_waitcnt lgkmcnt(4)
  s_add_u32 m0, s62, 32768
  s_add_u32 s99, s90, 258112
  buffer_load_dwordx4 v17, s[16:19], s99 offen  lds
  s_add_u32 m0, s62, 33792
  s_add_u32 s99, s90, 276544
  buffer_load_dwordx4 v17, s[16:19], s99 offen  lds
  s_waitcnt vmcnt(36)
  ds_read_b64_tr_b16 a[144:145], v18 offset:36864
  ds_read_b64_tr_b16 a[146:147], v18 offset:37120
  ds_read_b64_tr_b16 a[148:149], v19 offset:36864
  ds_read_b64_tr_b16 a[150:151], v19 offset:37120
  s_waitcnt lgkmcnt(4)
  s_add_u32 m0, s62, 34816
  s_add_u32 s99, s90, 258176
  buffer_load_dwordx4 v17, s[16:19], s99 offen  lds
  s_add_u32 m0, s62, 35840
  s_add_u32 s99, s90, 276608
  buffer_load_dwordx4 v17, s[16:19], s99 offen  lds
  s_waitcnt vmcnt(36)
  ds_read_b64_tr_b16 a[152:153], v16 offset:38912
  ds_read_b64_tr_b16 a[154:155], v16 offset:39168
  ds_read_b64_tr_b16 a[156:157], v16 offset:38920
  ds_read_b64_tr_b16 a[158:159], v16 offset:39176
  s_waitcnt lgkmcnt(4)
  s_add_u32 m0, s62, 36864
  s_add_u32 s99, s90, 258240
  buffer_load_dwordx4 v17, s[16:19], s99 offen  lds
  s_add_u32 m0, s62, 37888
  s_add_u32 s99, s90, 276672
  buffer_load_dwordx4 v17, s[16:19], s99 offen  lds
  s_waitcnt vmcnt(36)
  ds_read_b64_tr_b16 a[160:161], v18 offset:0
  ds_read_b64_tr_b16 a[162:163], v18 offset:256
  ds_read_b64_tr_b16 a[164:165], v19 offset:0
  ds_read_b64_tr_b16 a[166:167], v19 offset:256
  s_waitcnt lgkmcnt(4)
  s_add_u32 m0, s62, 38912
  s_add_u32 s99, s90, 258560
  buffer_load_dwordx4 v17, s[16:19], s99 offen  lds
  s_add_u32 m0, s62, 39936
  s_add_u32 s99, s90, 276992
  buffer_load_dwordx4 v17, s[16:19], s99 offen  lds
  s_waitcnt vmcnt(36)
  ds_read_b64_tr_b16 a[168:169], v18 offset:2048
  ds_read_b64_tr_b16 a[170:171], v18 offset:2304
  ds_read_b64_tr_b16 a[172:173], v19 offset:2048
  ds_read_b64_tr_b16 a[174:175], v19 offset:2304
  s_waitcnt vmcnt(34)
  ds_read_b64_tr_b16 a[176:177], v18 offset:4096
  ds_read_b64_tr_b16 a[178:179], v18 offset:4352
  ds_read_b64_tr_b16 a[180:181], v19 offset:4096
  ds_read_b64_tr_b16 a[182:183], v19 offset:4352
  s_waitcnt vmcnt(32)
  ds_read_b64_tr_b16 a[184:185], v18 offset:6144
  ds_read_b64_tr_b16 a[186:187], v18 offset:6400
  ds_read_b64_tr_b16 a[188:189], v19 offset:6144
  ds_read_b64_tr_b16 a[190:191], v19 offset:6400
  s_waitcnt vmcnt(30)
  ds_read_b64_tr_b16 a[192:193], v16 offset:8192
  ds_read_b64_tr_b16 a[194:195], v16 offset:8448
  ds_read_b64_tr_b16 a[196:197], v16 offset:8200
  ds_read_b64_tr_b16 a[198:199], v16 offset:8456
  s_waitcnt vmcnt(28)
  ds_read_b64_tr_b16 a[200:201], v18 offset:10240
  ds_read_b64_tr_b16 a[202:203], v18 offset:10496
  ds_read_b64_tr_b16 a[204:205], v19 offset:10240
  ds_read_b64_tr_b16 a[206:207], v19 offset:10496
  s_waitcnt vmcnt(26)
  ds_read_b64_tr_b16 a[208:209], v18 offset:12288
  ds_read_b64_tr_b16 a[210:211], v18 offset:12544
  ds_read_b64_tr_b16 a[212:213], v19 offset:12288
  ds_read_b64_tr_b16 a[214:215], v19 offset:12544
  s_waitcnt vmcnt(24)
  ds_read_b64_tr_b16 a[216:217], v18 offset:14336
  ds_read_b64_tr_b16 a[218:219], v18 offset:14592
  ds_read_b64_tr_b16 a[220:221], v19 offset:14336
  ds_read_b64_tr_b16 a[222:223], v19 offset:14592
  s_waitcnt vmcnt(22)
  ds_read_b64_tr_b16 a[224:225], v18 offset:16384
  ds_read_b64_tr_b16 a[226:227], v18 offset:16640
  ds_read_b64_tr_b16 a[228:229], v19 offset:16384
  ds_read_b64_tr_b16 a[230:231], v19 offset:16640
  s_waitcnt vmcnt(20)
  ds_read_b64_tr_b16 a[232:233], v16 offset:18432
  ds_read_b64_tr_b16 a[234:235], v16 offset:18688
  ds_read_b64_tr_b16 a[236:237], v16 offset:18440
  ds_read_b64_tr_b16 a[238:239], v16 offset:18696
  s_waitcnt vmcnt(18)
  ds_read_b64_tr_b16 a[240:241], v18 offset:20480
  ds_read_b64_tr_b16 a[242:243], v18 offset:20736
  ds_read_b64_tr_b16 a[244:245], v19 offset:20480
  ds_read_b64_tr_b16 a[246:247], v19 offset:20736
  s_waitcnt vmcnt(16)
  ds_read_b64_tr_b16 a[248:249], v18 offset:22528
  ds_read_b64_tr_b16 a[250:251], v18 offset:22784
  ds_read_b64_tr_b16 a[252:253], v19 offset:22528
  ds_read_b64_tr_b16 a[254:255], v19 offset:22784
  s_waitcnt vmcnt(14)
  ds_read_b64_tr_b16 v[192:193], v18 offset:24576
  ds_read_b64_tr_b16 v[194:195], v18 offset:24832
  ds_read_b64_tr_b16 v[196:197], v19 offset:24576
  ds_read_b64_tr_b16 v[198:199], v19 offset:24832
  s_waitcnt vmcnt(12)
  ds_read_b64_tr_b16 v[200:201], v18 offset:26624
  ds_read_b64_tr_b16 v[202:203], v18 offset:26880
  ds_read_b64_tr_b16 v[204:205], v19 offset:26624
  ds_read_b64_tr_b16 v[206:207], v19 offset:26880
  s_waitcnt vmcnt(10)
  ds_read_b64_tr_b16 v[208:209], v16 offset:28672
  ds_read_b64_tr_b16 v[210:211], v16 offset:28928
  ds_read_b64_tr_b16 v[212:213], v16 offset:28680
  ds_read_b64_tr_b16 v[214:215], v16 offset:28936
  s_waitcnt vmcnt(8)
  ds_read_b64_tr_b16 v[216:217], v18 offset:30720
  ds_read_b64_tr_b16 v[218:219], v18 offset:30976
  ds_read_b64_tr_b16 v[220:221], v19 offset:30720
  ds_read_b64_tr_b16 v[222:223], v19 offset:30976
  s_waitcnt vmcnt(6)
  ds_read_b64_tr_b16 v[224:225], v18 offset:32768
  ds_read_b64_tr_b16 v[226:227], v18 offset:33024
  ds_read_b64_tr_b16 v[228:229], v19 offset:32768
  ds_read_b64_tr_b16 v[230:231], v19 offset:33024
  s_waitcnt vmcnt(4)
  ds_read_b64_tr_b16 v[232:233], v18 offset:34816
  ds_read_b64_tr_b16 v[234:235], v18 offset:35072
  ds_read_b64_tr_b16 v[236:237], v19 offset:34816
  ds_read_b64_tr_b16 v[238:239], v19 offset:35072
  s_waitcnt vmcnt(2)
  ds_read_b64_tr_b16 v[240:241], v18 offset:36864
  ds_read_b64_tr_b16 v[242:243], v18 offset:37120
  ds_read_b64_tr_b16 v[244:245], v19 offset:36864
  ds_read_b64_tr_b16 v[246:247], v19 offset:37120
  s_waitcnt vmcnt(0)
  ds_read_b64_tr_b16 v[248:249], v16 offset:38912
  ds_read_b64_tr_b16 v[250:251], v16 offset:39168
  ds_read_b64_tr_b16 v[252:253], v16 offset:38920
  ds_read_b64_tr_b16 v[254:255], v16 offset:39176
  s_waitcnt lgkmcnt(0)
  s_barrier
  v_mov_b32 v24, 64
  s_mov_b64 exec, 1
L_wa_101:
  global_load_dword v25, v24, s[4:5] sc1
  s_waitcnt vmcnt(0)
  v_readfirstlane_b32 s98, v25
  s_nop 0
  s_cmp_ge_u32 s98, 256
  s_nop 1
  s_cbranch_scc1 L_wa_101d
  s_sleep 8
  s_sub_u32 s100, s100, 1
  s_cbranch_scc0 L_wa_101
  s_branch L_end
L_wa_101d:
  s_mov_b64 exec, -1
  s_mov_b32 s66, -1
  s_mov_b32 s67, 0
  s_mov_b32 s28, s12
  s_mov_b32 s29, s13
  s_mov_b32 s30, 0
  s_mov_b32 s31, 0x20000
  v_and_b32 v170, 12, v1
  v_bfe_u32 v171, v1, 4, 2
  v_mul_u32_u24 v171, 8192, v171
  v_add_u32 v170, v170, v171
  s_mov_b32 s40, 255
  s_lshl_b32 s45, s9, 9
  s_add_u32 s45, s45, 139520
  v_add_u32 v169, s45, v1
  v_mov_b32 v2, 0
  ds_write_b32 v169, v2
  ds_write_b32 v169, v2 offset:256
L_bk_102:
  s_mov_b64 exec, s[40:41]
  buffer_load_dword v2, v170, s[12:15], s36 offen sc1
  s_mov_b64 exec, -1
  s_add_u32 s98, s32, 1
  s_mov_b64 exec, s[40:41]
  s_waitcnt vmcnt(0)
  v_cmp_gt_u32 vcc, s98, v2
  s_mov_b64 exec, -1
  s_cbranch_vccz L_bk_102d
  s_sleep 1
  s_sub_u32 s100, s100, 1
  s_cbranch_scc0 L_bk_102
  s_branch L_end
L_bk_102d:
  s_add_u32 m0, s34, 0
  s_add_u32 s98, s33, 0
  buffer_load_dwordx4 v0, s[12:15], s98 offen offset:0 sc1 lds
  buffer_load_dwordx4 v0, s[12:15], s98 offen offset:1024 sc1 lds
  buffer_load_dwordx4 v0, s[12:15], s98 offen offset:2048 sc1 lds
  buffer_load_dwordx4 v0, s[12:15], s98 offen offset:3072 sc1 lds
  s_add_u32 m0, s34, 4096
  s_add_u32 s98, s33, 4096
  buffer_load_dwordx4 v0, s[12:15], s98 offen offset:0 sc1 lds
  buffer_load_dwordx4 v0, s[12:15], s98 offen offset:1024 sc1 lds
  buffer_load_dwordx4 v0, s[12:15], s98 offen offset:2048 sc1 lds
  buffer_load_dwordx4 v0, s[12:15], s98 offen offset:3072 sc1 lds
  s_add_u32 m0, s34, 8192
  s_add_u32 s98, s33, 8192
  buffer_load_dwordx4 v0, s[12:15], s98 offen offset:0 sc1 lds
  buffer_load_dwordx4 v0, s[12:15], s98 offen offset:1024 sc1 lds
  buffer_load_dwordx4 v0, s[12:15], s98 offen offset:2048 sc1 lds
  buffer_load_dwordx4 v0, s[12:15], s98 offen offset:3072 sc1 lds
  s_add_u32 m0, s34, 12288
  s_add_u32 s98, s33, 12288
  buffer_load_dwordx4 v0, s[12:15], s98 offen offset:0 sc1 lds
  buffer_load_dwordx4 v0, s[12:15], s98 offen offset:1024 sc1 lds
  buffer_load_dwordx4 v0, s[12:15], s98 offen offset:2048 sc1 lds
  buffer_load_dwordx4 v0, s[12:15], s98 offen offset:3072 sc1 lds
  s_add_u32 m0, s34, 16384
  s_add_u32 s98, s33, 16384
  buffer_load_dwordx4 v0, s[12:15], s98 offen offset:0 sc1 lds
  buffer_load_dwordx4 v0, s[12:15], s98 offen offset:1024 sc1 lds
  buffer_load_dwordx4 v0, s[12:15], s98 offen offset:2048 sc1 lds
  buffer_load_dwordx4 v0, s[12:15], s98 offen offset:3072 sc1 lds
  s_add_u32 m0, s34, 20480
  s_add_u32 s98, s33, 20480
  buffer_load_dwordx4 v0, s[12:15], s98 offen offset:0 sc1 lds
  buffer_load_dwordx4 v0, s[12:15], s98 offen offset:1024 sc1 lds
  buffer_load_dwordx4 v0, s[12:15], s98 offen offset:2048 sc1 lds
  buffer_load_dwordx4 v0, s[12:15], s98 offen offset:3072 sc1 lds
  s_add_u32 s33, s33, 786432
  s_xor_b32 s34, s34, s39
  s_mov_b32 s35, 1
  s_waitcnt vmcnt(0)
  s_barrier
L_bk_103:
  s_mov_b64 exec, s[40:41]
  buffer_load_dword v2, v170, s[12:15], s36 offen sc1
  s_mov_b64 exec, -1
  s_add_u32 s98, s32, 2
  s_mov_b64 exec, s[40:41]
  s_waitcnt vmcnt(0)
  v_cmp_gt_u32 vcc, s98, v2
  s_mov_b64 exec, -1
  s_cbranch_vccz L_bk_103d
  s_sleep 1
  s_sub_u32 s100, s100, 1
  s_cbranch_scc0 L_bk_103
  s_branch L_end
L_bk_103d:
  s_add_u32 m0, s34, 0
  s_add_u32 s98, s33, 0
  buffer_load_dwordx4 v0, s[12:15], s98 offen offset:0 sc1 lds
  buffer_load_dwordx4 v0, s[12:15], s98 offen offset:1024 sc1 lds
  buffer_load_dwordx4 v0, s[12:15], s98 offen offset:2048 sc1 lds
  buffer_load_dwordx4 v0, s[12:15], s98 offen offset:3072 sc1 lds
  s_add_u32 m0, s34, 4096
  s_add_u32 s98, s33, 4096
  buffer_load_dwordx4 v0, s[12:15], s98 offen offset:0 sc1 lds
  buffer_load_dwordx4 v0, s[12:15], s98 offen offset:1024 sc1 lds
  buffer_load_dwordx4 v0, s[12:15], s98 offen offset:2048 sc1 lds
  buffer_load_dwordx4 v0, s[12:15], s98 offen offset:3072 sc1 lds
  s_add_u32 m0, s34, 8192
  s_add_u32 s98, s33, 8192
  buffer_load_dwordx4 v0, s[12:15], s98 offen offset:0 sc1 lds
  buffer_load_dwordx4 v0, s[12:15], s98 offen offset:1024 sc1 lds
  buffer_load_dwordx4 v0, s[12:15], s98 offen offset:2048 sc1 lds
  buffer_load_dwordx4 v0, s[12:15], s98 offen offset:3072 sc1 lds
  s_add_u32 m0, s34, 12288
  s_add_u32 s98, s33, 12288
  buffer_load_dwordx4 v0, s[12:15], s98 offen offset:0 sc1 lds
  buffer_load_dwordx4 v0, s[12:15], s98 offen offset:1024 sc1 lds
  buffer_load_dwordx4 v0, s[12:15], s98 offen offset:2048 sc1 lds
  buffer_load_dwordx4 v0, s[12:15], s98 offen offset:3072 sc1 lds
  s_add_u32 m0, s34, 16384
  s_add_u32 s98, s33, 16384
  buffer_load_dwordx4 v0, s[12:15], s98 offen offset:0 sc1 lds
  buffer_load_dwordx4 v0, s[12:15], s98 offen offset:1024 sc1 lds
  buffer_load_dwordx4 v0, s[12:15], s98 offen offset:2048 sc1 lds
  buffer_load_dwordx4 v0, s[12:15], s98 offen offset:3072 sc1 lds
  s_add_u32 m0, s34, 20480
  s_add_u32 s98, s33, 20480
  buffer_load_dwordx4 v0, s[12:15], s98 offen offset:0 sc1 lds
  buffer_load_dwordx4 v0, s[12:15], s98 offen offset:1024 sc1 lds
  buffer_load_dwordx4 v0, s[12:15], s98 offen offset:2048 sc1 lds
  buffer_load_dwordx4 v0, s[12:15], s98 offen offset:3072 sc1 lds
  s_add_u32 s33, s33, 786432
  s_xor_b32 s34, s34, s39
  s_mov_b32 s35, 1
  s_waitcnt vmcnt(0)
  v_mov_b32 v5, 0
L_awR_loop:
  s_waitcnt lgkmcnt(0)
  s_barrier
  s_bfe_u32 s63, s32, 65537
  ds_read_b128 v[32:35], v6 offset:0
  ds_read_b128 v[36:39], v6 offset:2048
  ds_read_b128 v[40:43], v6 offset:4096
  ds_read_b128 v[44:47], v6 offset:6144
  ds_read_b128 v[48:51], v6 offset:8192
  ds_read_b128 v[52:55], v6 offset:10240
  ds_read_b128 v[56:59], v6 offset:12288
  ds_read_b128 v[60:63], v6 offset:14336
  s_cmp_lg_u32 s92, 0
  s_cbranch_scc1 L_aw_hp
  s_waitcnt lgkmcnt(7)
  v_mfma_f32_16x16x32_bf16 v[16:19], a[0:3], v[32:35], 0
  s_mov_b64 exec, s[66:67]
  buffer_load_dword v5, v1, s[12:15], s93 offen sc1
  s_mov_b64 exec, -1
  v_mfma_f32_16x16x32_bf16 v[20:23], a[4:7], v[32:35], 0
  s_add_u32 s98, s32, 3
  s_waitcnt lgkmcnt(6)
  v_mfma_f32_16x16x32_bf16 v[16:19], a[40:43], v[36:39], v[16:19]
  s_mov_b64 exec, s[40:41]
  s_waitcnt vmcnt(3)
  v_cmp_gt_u32 vcc, s98, v2
  s_mov_b64 exec, -1
  v_mfma_f32_16x16x32_bf16 v[20:23], a[44:47], v[36:39], v[20:23]
  s_cmp_eq_u64 vcc, 0
  s_cselect_b32 s35, 1, 0
  s_cmp_ge_u32 s32, 62
  s_waitcnt lgkmcnt(5)
  v_mfma_f32_16x16x32_bf16 v[16:19], a[80:83], v[40:43], v[16:19]
  s_cselect_b32 s35, 0, s35
  s_sub_u32 s44, 0, s35
  s_and_b32 s30, s44, s14
  v_mfma_f32_16x16x32_bf16 v[20:23], a[84:87], v[40:43], v[20:23]
  s_add_u32 m0, s34, 0
  s_add_u32 s96, s33, 0
  s_waitcnt lgkmcnt(4)
  v_mfma_f32_16x16x32_bf16 v[16:19], a[120:123], v[44:47], v[16:19]
  buffer_load_dwordx4 v0, s[28:31], s96 offen offset:0 sc1 lds
  v_mfma_f32_16x16x32_bf16 v[20:23], a[124:127], v[44:47], v[20:23]
  buffer_load_dwordx4 v0, s[28:31], s96 offen offset:1024 sc1 lds
  s_waitcnt lgkmcnt(3)
  v_mfma_f32_16x16x32_bf16 v[16:19], a[160:163], v[48:51], v[16:19]
  buffer_load_dwordx4 v0, s[28:31], s96 offen offset:2048 sc1 lds
  v_mfma_f32_16x16x32_bf16 v[20:23], a[164:167], v[48:51], v[20:23]
  buffer_load_dwordx4 v0, s[28:31], s96 offen offset:3072 sc1 lds
  s_add_u32 m0, s34, 4096
  s_waitcnt lgkmcnt(2)
  v_mfma_f32_16x16x32_bf16 v[16:19], a[200:203], v[52:55], v[16:19]
  s_add_u32 s96, s33, 4096
  buffer_load_dwordx4 v0, s[28:31], s96 offen offset:0 sc1 lds
  v_mfma_f32_16x16x32_bf16 v[20:23], a[204:207], v[52:55], v[20:23]
  s_waitcnt lgkmcnt(1)
  v_mfma_f32_16x16x32_bf16 v[16:19], a[240:243], v[56:59], v[16:19]
  buffer_load_dwordx4 v0, s[28:31], s96 offen offset:1024 sc1 lds
  v_mfma_f32_16x16x32_bf16 v[20:23], a[244:247], v[56:59], v[20:23]
  s_waitcnt lgkmcnt(0)
  v_mfma_f32_16x16x32_bf16 v[16:19], v[216:219], v[60:63], v[16:19]
  buffer_load_dwordx4 v0, s[28:31], s96 offen offset:2048 sc1 lds
  v_mfma_f32_16x16x32_bf16 v[20:23], v[220:223], v[60:63], v[20:23]
  v_mfma_f32_16x16x32_bf16 v[24:27], a[8:11], v[32:35], 0
  buffer_load_dwordx4 v0, s[28:31], s96 offen offset:3072 sc1 lds
  v_mfma_f32_16x16x32_bf16 v[28:31], a[12:15], v[32:35], 0
  v_mfma_f32_16x16x32_bf16 v[24:27], a[48:51], v[36:39], v[24:27]
L_bpc_104:
  s_sub_i32 s98, s32, 1
  s_mov_b64 exec, s[66:67]
  s_waitcnt vmcnt(8)
  v_cmp_gt_i32 vcc, s98, v5
  s_mov_b64 exec, -1
  s_cbranch_vccnz L_bpr_105
  v_mfma_f32_16x16x32_bf16 v[28:31], a[52:55], v[36:39], v[28:31]
  v_cvt_pk_bf16_f32 v16, v16, v17
  v_cvt_pk_bf16_f32 v17, v18, v19
  v_mfma_f32_16x16x32_bf16 v[24:27], a[88:91], v[40:43], v[24:27]
  v_cvt_pk_bf16_f32 v18, v20, v21
  v_cvt_pk_bf16_f32 v19, v22, v23
  v_mfma_f32_16x16x32_bf16 v[28:31], a[92:95], v[40:43], v[28:31]
  v_bfi_b32 v16, 1, s63, v16
  v_bfi_b32 v18, 1, s63, v18
  v_mfma_f32_16x16x32_bf16 v[24:27], a[128:131], v[44:47], v[24:27]
  buffer_store_dwordx4 v[16:19], v0, s[12:15], s46 offen offset:0
  v_mfma_f32_16x16x32_bf16 v[28:31], a[132:135], v[44:47], v[28:31]
  v_mfma_f32_16x16x32_bf16 v[24:27], a[168:171], v[48:51], v[24:27]
  v_mfma_f32_16x16x32_bf16 v[28:31], a[172:175], v[48:51], v[28:31]
  v_mfma_f32_16x16x32_bf16 v[24:27], a[208:211], v[52:55], v[24:27]
  v_mfma_f32_16x16x32_bf16 v[28:31], a[212:215], v[52:55], v[28:31]
  v_mfma_f32_16x16x32_bf16 v[24:27], a[248:251], v[56:59], v[24:27]
  v_mfma_f32_16x16x32_bf16 v[28:31], a[252:255], v[56:59], v[28:31]
  v_mfma_f32_16x16x32_bf16 v[24:27], v[224:227], v[60:63], v[24:27]
  v_mfma_f32_16x16x32_bf16 v[28:31], v[228:231], v[60:63], v[28:31]
  v_mfma_f32_16x16x32_bf16 v[16:19], a[16:19], v[32:35], 0
  s_nop 5
  v_cvt_pk_bf16_f32 v24, v24, v25
  v_cvt_pk_bf16_f32 v25, v26, v27
  v_mfma_f32_16x16x32_bf16 v[20:23], a[20:23], v[32:35], 0
  v_cvt_pk_bf16_f32 v26, v28, v29
  v_cvt_pk_bf16_f32 v27, v30, v31
  v_mfma_f32_16x16x32_bf16 v[16:19], a[56:59], v[36:39], v[16:19]
  v_bfi_b32 v24, 1, s63, v24
  v_bfi_b32 v26, 1, s63, v26
  v_mfma_f32_16x16x32_bf16 v[20:23], a[60:63], v[36:39], v[20:23]
  v_mfma_f32_16x16x32_bf16 v[16:19], a[96:99], v[40:43], v[16:19]
  v_mfma_f32_16x16x32_bf16 v[20:23], a[100:103], v[40:43], v[20:23]
  v_mfma_f32_16x16x32_bf16 v[16:19], a[136:139], v[44:47], v[16:19]
  buffer_store_dwordx4 v[24:27], v0, s[12:15], s46 offen offset:2048
  v_mfma_f32_16x16x32_bf16 v[20:23], a[140:143], v[44:47], v[20:23]
  v_mfma_f32_16x16x32_bf16 v[16:19], a[176:179], v[48:51], v[16:19]
  v_mfma_f32_16x16x32_bf16 v[20:23], a[180:183], v[48:51], v[20:23]
  v_mfma_f32_16x16x32_bf16 v[16:19], a[216:219], v[52:55], v[16:19]
  v_mfma_f32_16x16x32_bf16 v[20:23], a[220:223], v[52:55], v[20:23]
  v_mfma_f32_16x16x32_bf16 v[16:19], v[192:195], v[56:59], v[16:19]
  v_mfma_f32_16x16x32_bf16 v[20:23], v[196:199], v[56:59], v[20:23]
  v_mfma_f32_16x16x32_bf16 v[16:19], v[232:235], v[60:63], v[16:19]
  v_mfma_f32_16x16x32_bf16 v[20:23], v[236:239], v[60:63], v[20:23]
  v_mfma_f32_16x16x32_bf16 v[24:27], a[24:27], v[32:35], 0
  s_nop 5
  v_cvt_pk_bf16_f32 v16, v16, v17
  v_cvt_pk_bf16_f32 v17, v18, v19
  v_mfma_f32_16x16x32_bf16 v[28:31], a[28:31], v[32:35], 0
  v_cvt_pk_bf16_f32 v18, v20, v21
  v_cvt_pk_bf16_f32 v19, v22, v23
  v_mfma_f32_16x16x32_bf16 v[24:27], a[64:67], v[36:39], v[24:27]
  v_bfi_b32 v16, 1, s63, v16
  v_bfi_b32 v18, 1, s63, v18
  v_mfma_f32_16x16x32_bf16 v[28:31], a[68:71], v[36:39], v[28:31]
  v_mfma_f32_16x16x32_bf16 v[24:27], a[104:107], v[40:43], v[24:27]
  v_mfma_f32_16x16x32_bf16 v[28:31], a[108:111], v[40:43], v[28:31]
  v_mfma_f32_16x16x32_bf16 v[24:27], a[144:147], v[44:47], v[24:27]
  buffer_store_dwordx4 v[16:19], v0, s[12:15], s47 offen offset:0
  v_mfma_f32_16x16x32_bf16 v[28:31], a[148:151], v[44:47], v[28:31]
  v_mfma_f32_16x16x32_bf16 v[24:27], a[184:187], v[48:51], v[24:27]
  v_mfma_f32_16x16x32_bf16 v[28:31], a[188:191], v[48:51], v[28:31]
  v_mfma_f32_16x16x32_bf16 v[24:27], a[224:227], v[52:55], v[24:27]
  v_mfma_f32_16x16x32_bf16 v[28:31], a[228:231], v[52:55], v[28:31]
  v_mfma_f32_16x16x32_bf16 v[24:27], v[200:203], v[56:59], v[24:27]
  v_mfma_f32_16x16x32_bf16 v[28:31], v[204:207], v[56:59], v[28:31]
  v_mfma_f32_16x16x32_bf16 v[24:27], v[240:243], v[60:63], v[24:27]
  v_mfma_f32_16x16x32_bf16 v[28:31], v[244:247], v[60:63], v[28:31]
  v_mfma_f32_16x16x32_bf16 v[16:19], a[32:35], v[32:35], 0
  v_mfma_f32_16x16x32_bf16 v[20:23], a[36:39], v[32:35], 0
  ds_read_b128 v[32:35], v6 offset:1024
  s_nop 3
  v_cvt_pk_bf16_f32 v24, v24, v25
  v_cvt_pk_bf16_f32 v25, v26, v27
  v_mfma_f32_16x16x32_bf16 v[16:19], a[72:75], v[36:39], v[16:19]
  v_mfma_f32_16x16x32_bf16 v[20:23], a[76:79], v[36:39], v[20:23]
  ds_read_b128 v[36:39], v6 offset:3072
  v_cvt_pk_bf16_f32 v26, v28, v29
  v_cvt_pk_bf16_f32 v27, v30, v31
  v_mfma_f32_16x16x32_bf16 v[16:19], a[112:115], v[40:43], v[16:19]
  v_bfi_b32 v24, 1, s63, v24
  v_bfi_b32 v26, 1, s63, v26
  v_mfma_f32_16x16x32_bf16 v[20:23], a[116:119], v[40:43], v[20:23]
  ds_read_b128 v[40:43], v6 offset:5120
  v_mfma_f32_16x16x32_bf16 v[16:19], a[152:155], v[44:47], v[16:19]
  buffer_store_dwordx4 v[24:27], v0, s[12:15], s47 offen offset:2048
  v_mfma_f32_16x16x32_bf16 v[20:23], a[156:159], v[44:47], v[20:23]
  ds_read_b128 v[44:47], v6 offset:7168
  s_add_u32 m0, s34, 8192
  s_add_u32 s96, s33, 8192
  v_mfma_f32_16x16x32_bf16 v[16:19], a[192:195], v[48:51], v[16:19]
  buffer_load_dwordx4 v0, s[28:31], s96 offen offset:0 sc1 lds
  v_mfma_f32_16x16x32_bf16 v[20:23], a[196:199], v[48:51], v[20:23]
  ds_read_b128 v[48:51], v6 offset:9216
  v_mfma_f32_16x16x32_bf16 v[16:19], a[232:235], v[52:55], v[16:19]
  v_mfma_f32_16x16x32_bf16 v[20:23], a[236:239], v[52:55], v[20:23]
  ds_read_b128 v[52:55], v6 offset:11264
  v_mfma_f32_16x16x32_bf16 v[16:19], v[208:211], v[56:59], v[16:19]
  buffer_load_dwordx4 v0, s[28:31], s96 offen offset:1024 sc1 lds
  v_mfma_f32_16x16x32_bf16 v[20:23], v[212:215], v[56:59], v[20:23]
  ds_read_b128 v[56:59], v6 offset:13312
  v_mfma_f32_16x16x32_bf16 v[16:19], v[248:251], v[60:63], v[16:19]
  v_mfma_f32_16x16x32_bf16 v[20:23], v[252:255], v[60:63], v[20:23]
  ds_read_b128 v[60:63], v6 offset:15360
  v_xor_b32 v6, 0x4000, v6
  s_waitcnt lgkmcnt(7)
  v_mfma_f32_16x16x32_bf16 v[24:27], a[0:3], v[32:35], 0
  buffer_load_dwordx4 v0, s[28:31], s96 offen offset:2048 sc1 lds
  s_nop 1
  v_cvt_pk_bf16_f32 v16, v16, v17
  v_mfma_f32_16x16x32_bf16 v[28:31], a[4:7], v[32:35], 0
  v_cvt_pk_bf16_f32 v17, v18, v19
  v_cvt_pk_bf16_f32 v18, v20, v21
  s_waitcnt lgkmcnt(6)
  v_mfma_f32_16x16x32_bf16 v[24:27], a[40:43], v[36:39], v[24:27]
  v_cvt_pk_bf16_f32 v19, v22, v23
  v_mfma_f32_16x16x32_bf16 v[28:31], a[44:47], v[36:39], v[28:31]
  s_waitcnt lgkmcnt(5)
  v_mfma_f32_16x16x32_bf16 v[24:27], a[80:83], v[40:43], v[24:27]
  buffer_load_dwordx4 v0, s[28:31], s96 offen offset:3072 sc1 lds
  v_bfi_b32 v16, 1, s63, v16
  v_mfma_f32_16x16x32_bf16 v[28:31], a[84:87], v[40:43], v[28:31]
  v_bfi_b32 v18, 1, s63, v18
  s_waitcnt lgkmcnt(4)
  v_mfma_f32_16x16x32_bf16 v[24:27], a[120:123], v[44:47], v[24:27]
  buffer_store_dwordx4 v[16:19], v0, s[12:15], s48 offen offset:0
  v_mfma_f32_16x16x32_bf16 v[28:31], a[124:127], v[44:47], v[28:31]
  s_add_u32 m0, s34, 12288
  s_add_u32 s96, s33, 12288
  s_waitcnt lgkmcnt(3)
  v_mfma_f32_16x16x32_bf16 v[24:27], a[160:163], v[48:51], v[24:27]
  buffer_load_dwordx4 v0, s[28:31], s96 offen offset:0 sc1 lds
  v_mfma_f32_16x16x32_bf16 v[28:31], a[164:167], v[48:51], v[28:31]
  s_waitcnt lgkmcnt(2)
  v_mfma_f32_16x16x32_bf16 v[24:27], a[200:203], v[52:55], v[24:27]
  v_mfma_f32_16x16x32_bf16 v[28:31], a[204:207], v[52:55], v[28:31]
  s_waitcnt lgkmcnt(1)
  v_mfma_f32_16x16x32_bf16 v[24:27], a[240:243], v[56:59], v[24:27]
  buffer_load_dwordx4 v0, s[28:31], s96 offen offset:1024 sc1 lds
  v_mfma_f32_16x16x32_bf16 v[28:31], a[244:247], v[56:59], v[28:31]
  s_waitcnt lgkmcnt(0)
  v_mfma_f32_16x16x32_bf16 v[24:27], v[216:219], v[60:63], v[24:27]
  v_mfma_f32_16x16x32_bf16 v[28:31], v[220:223], v[60:63], v[28:31]
  v_mfma_f32_16x16x32_bf16 v[16:19], a[8:11], v[32:35], 0
  buffer_load_dwordx4 v0, s[28:31], s96 offen offset:2048 sc1 lds
  s_nop 4
  v_cvt_pk_bf16_f32 v24, v24, v25
  v_mfma_f32_16x16x32_bf16 v[20:23], a[12:15], v[32:35], 0
  v_cvt_pk_bf16_f32 v25, v26, v27
  v_cvt_pk_bf16_f32 v26, v28, v29
  v_mfma_f32_16x16x32_bf16 v[16:19], a[48:51], v[36:39], v[16:19]
  v_cvt_pk_bf16_f32 v27, v30, v31
  v_mfma_f32_16x16x32_bf16 v[20:23], a[52:55], v[36:39], v[20:23]
  v_mfma_f32_16x16x32_bf16 v[16:19], a[88:91], v[40:43], v[16:19]
  buffer_load_dwordx4 v0, s[28:31], s96 offen offset:3072 sc1 lds
  v_bfi_b32 v24, 1, s63, v24
  v_mfma_f32_16x16x32_bf16 v[20:23], a[92:95], v[40:43], v[20:23]
  v_bfi_b32 v26, 1, s63, v26
  v_mfma_f32_16x16x32_bf16 v[16:19], a[128:131], v[44:47], v[16:19]
  buffer_store_dwordx4 v[24:27], v0, s[12:15], s46 offen offset:1024
  v_mfma_f32_16x16x32_bf16 v[20:23], a[132:135], v[44:47], v[20:23]
  s_add_u32 m0, s34, 16384
  s_add_u32 s96, s33, 16384
  v_mfma_f32_16x16x32_bf16 v[16:19], a[168:171], v[48:51], v[16:19]
  buffer_load_dwordx4 v0, s[28:31], s96 offen offset:0 sc1 lds
  v_mfma_f32_16x16x32_bf16 v[20:23], a[172:175], v[48:51], v[20:23]
  v_mfma_f32_16x16x32_bf16 v[16:19], a[208:211], v[52:55], v[16:19]
  v_mfma_f32_16x16x32_bf16 v[20:23], a[212:215], v[52:55], v[20:23]
  s_branch L_aw_hj
L_aw_hp:
  s_waitcnt lgkmcnt(7)
  s_nop 2
  v_mfma_f32_16x16x32_bf16 v[16:19], a[0:3], v[32:35], 0
  s_mov_b64 exec, s[66:67]
  buffer_load_dword v5, v1, s[12:15], s93 offen sc1
  s_mov_b64 exec, -1
  v_mfma_f32_16x16x32_bf16 v[20:23], a[4:7], v[32:35], 0
  s_add_u32 s98, s32, 3
  s_waitcnt lgkmcnt(6)
  v_mfma_f32_16x16x32_bf16 v[16:19], a[40:43], v[36:39], v[16:19]
  s_mov_b64 exec, s[40:41]
  s_waitcnt vmcnt(3)
  v_cmp_gt_u32 vcc, s98, v2
  s_mov_b64 exec, -1
  v_mfma_f32_16x16x32_bf16 v[20:23], a[44:47], v[36:39], v[20:23]
  s_cmp_eq_u64 vcc, 0
  s_cselect_b32 s35, 1, 0
  s_cmp_ge_u32 s32, 62
  s_waitcnt lgkmcnt(5)
  v_mfma_f32_16x16x32_bf16 v[16:19], a[80:83], v[40:43], v[16:19]
  s_cselect_b32 s35, 0, s35
  s_sub_u32 s44, 0, s35
  s_and_b32 s30, s44, s14
  v_mfma_f32_16x16x32_bf16 v[20:23], a[84:87], v[40:43], v[20:23]
  s_add_u32 m0, s34, 0
  s_add_u32 s96, s33, 0
  s_waitcnt lgkmcnt(4)
  v_mfma_f32_16x16x32_bf16 v[16:19], a[120:123], v[44:47], v[16:19]
  buffer_load_dwordx4 v0, s[28:31], s96 offen offset:0 sc1 lds
  v_mfma_f32_16x16x32_bf16 v[20:23], a[124:127], v[44:47], v[20:23]
  buffer_load_dwordx4 v0, s[28:31], s96 offen offset:1024 sc1 lds
  s_waitcnt lgkmcnt(3)
  v_mfma_f32_16x16x32_bf16 v[16:19], a[160:163], v[48:51], v[16:19]
  buffer_load_dwordx4 v0, s[28:31], s96 offen offset:2048 sc1 lds
  v_mfma_f32_16x16x32_bf16 v[20:23], a[164:167], v[48:51], v[20:23]
  buffer_load_dwordx4 v0, s[28:31], s96 offen offset:3072 sc1 lds
  s_add_u32 m0, s34, 4096
  s_waitcnt lgkmcnt(2)
  v_mfma_f32_16x16x32_bf16 v[16:19], a[200:203], v[52:55], v[16:19]
  s_add_u32 s96, s33, 4096
  buffer_load_dwordx4 v0, s[28:31], s96 offen offset:0 sc1 lds
  v_mfma_f32_16x16x32_bf16 v[20:23], a[204:207], v[52:55], v[20:23]
  s_waitcnt lgkmcnt(1)
  v_mfma_f32_16x16x32_bf16 v[16:19], a[240:243], v[56:59], v[16:19]
  buffer_load_dwordx4 v0, s[28:31], s96 offen offset:1024 sc1 lds
  v_mfma_f32_16x16x32_bf16 v[20:23], a[244:247], v[56:59], v[20:23]
  s_waitcnt lgkmcnt(0)
  v_mfma_f32_16x16x32_bf16 v[16:19], v[216:219], v[60:63], v[16:19]
  buffer_load_dwordx4 v0, s[28:31], s96 offen offset:2048 sc1 lds
  v_mfma_f32_16x16x32_bf16 v[20:23], v[220:223], v[60:63], v[20:23]
  v_mfma_f32_16x16x32_bf16 v[24:27], a[8:11], v[32:35], 0
  buffer_load_dwordx4 v0, s[28:31], s96 offen offset:3072 sc1 lds
  v_mfma_f32_16x16x32_bf16 v[28:31], a[12:15], v[32:35], 0
  v_mfma_f32_16x16x32_bf16 v[24:27], a[48:51], v[36:39], v[24:27]
L_bpc_106:
  s_sub_i32 s98, s32, 1
  s_mov_b64 exec, s[66:67]
  s_waitcnt vmcnt(8)
  v_cmp_gt_i32 vcc, s98, v5
  s_mov_b64 exec, -1
  s_cbranch_vccnz L_bpr_107
  v_mfma_f32_16x16x32_bf16 v[28:31], a[52:55], v[36:39], v[28:31]
  v_cvt_pk_bf16_f32 v16, v16, v17
  v_cvt_pk_bf16_f32 v17, v18, v19
  v_mfma_f32_16x16x32_bf16 v[24:27], a[88:91], v[40:43], v[24:27]
  v_cvt_pk_bf16_f32 v18, v20, v21
  v_cvt_pk_bf16_f32 v19, v22, v23
  v_mfma_f32_16x16x32_bf16 v[28:31], a[92:95], v[40:43], v[28:31]
  v_bfi_b32 v16, 1, s63, v16
  v_bfi_b32 v18, 1, s63, v18
  v_mfma_f32_16x16x32_bf16 v[24:27], a[128:131], v[44:47], v[24:27]
  buffer_store_dwordx4 v[16:19], v0, s[12:15], s46 offen offset:0
  v_mfma_f32_16x16x32_bf16 v[28:31], a[132:135], v[44:47], v[28:31]
  v_mfma_f32_16x16x32_bf16 v[24:27], a[168:171], v[48:51], v[24:27]
  v_mfma_f32_16x16x32_bf16 v[28:31], a[172:175], v[48:51], v[28:31]
  v_mfma_f32_16x16x32_bf16 v[24:27], a[208:211], v[52:55], v[24:27]
  v_mfma_f32_16x16x32_bf16 v[28:31], a[212:215], v[52:55], v[28:31]
  v_mfma_f32_16x16x32_bf16 v[24:27], a[248:251], v[56:59], v[24:27]
  s_add_u32 s98, s49, 0
  v_mfma_f32_16x16x32_bf16 v[28:31], a[252:255], v[56:59], v[28:31]
  v_mfma_f32_16x16x32_bf16 v[24:27], v[224:227], v[60:63], v[24:27]
  v_mfma_f32_16x16x32_bf16 v[28:31], v[228:231], v[60:63], v[28:31]
  v_mfma_f32_16x16x32_bf16 v[16:19], a[16:19], v[32:35], 0
  v_mfma_f32_16x16x32_bf16 v[20:23], a[20:23], v[32:35], 0
  v_mfma_f32_16x16x32_bf16 v[16:19], a[56:59], v[36:39], v[16:19]
  buffer_load_dwordx4 v[84:87], v0, s[12:15], s98 offen sc1
  s_nop 2
  v_cvt_pk_bf16_f32 v24, v24, v25
  v_mfma_f32_16x16x32_bf16 v[20:23], a[60:63], v[36:39], v[20:23]
  v_cvt_pk_bf16_f32 v25, v26, v27
  v_cvt_pk_bf16_f32 v26, v28, v29
  v_mfma_f32_16x16x32_bf16 v[16:19], a[96:99], v[40:43], v[16:19]
  v_cvt_pk_bf16_f32 v27, v30, v31
  s_add_u32 s98, s49, 36992
  v_mfma_f32_16x16x32_bf16 v[20:23], a[100:103], v[40:43], v[20:23]
  buffer_load_dwordx4 v[88:91], v0, s[12:15], s98 offen sc1
  v_bfi_b32 v24, 1, s63, v24
  v_mfma_f32_16x16x32_bf16 v[16:19], a[136:139], v[44:47], v[16:19]
  v_bfi_b32 v26, 1, s63, v26
  v_mfma_f32_16x16x32_bf16 v[20:23], a[140:143], v[44:47], v[20:23]
  buffer_store_dwordx4 v[24:27], v0, s[12:15], s46 offen offset:2048
  v_mfma_f32_16x16x32_bf16 v[16:19], a[176:179], v[48:51], v[16:19]
  s_add_u32 s98, s49, 73984
  buffer_load_dwordx4 v[92:95], v0, s[12:15], s98 offen sc1
  v_mfma_f32_16x16x32_bf16 v[20:23], a[180:183], v[48:51], v[20:23]
  s_add_u32 s98, s49, 110976
  buffer_load_dwordx4 v[96:99], v0, s[12:15], s98 offen sc1
  v_mfma_f32_16x16x32_bf16 v[16:19], a[216:219], v[52:55], v[16:19]
  s_add_u32 s98, s49, 147968
  buffer_load_dwordx4 v[100:103], v0, s[12:15], s98 offen sc1
  v_mfma_f32_16x16x32_bf16 v[20:23], a[220:223], v[52:55], v[20:23]
  s_add_u32 s98, s49, 184960
  v_mfma_f32_16x16x32_bf16 v[16:19], v[192:195], v[56:59], v[16:19]
  buffer_load_dwordx4 v[104:107], v0, s[12:15], s98 offen sc1
  s_add_u32 s98, s49, 221952
  v_mfma_f32_16x16x32_bf16 v[20:23], v[196:199], v[56:59], v[20:23]
  v_mfma_f32_16x16x32_bf16 v[16:19], v[232:235], v[60:63], v[16:19]
  buffer_load_dwordx4 v[108:111], v0, s[12:15], s98 offen sc1
  s_add_u32 s98, s49, 258944
  v_mfma_f32_16x16x32_bf16 v[20:23], v[236:239], v[60:63], v[20:23]
  v_mfma_f32_16x16x32_bf16 v[24:27], a[24:27], v[32:35], 0
  buffer_load_dwordx4 v[112:115], v0, s[12:15], s98 offen sc1
  s_add_u32 s98, s49, 295936
  v_mfma_f32_16x16x32_bf16 v[28:31], a[28:31], v[32:35], 0
  v_mfma_f32_16x16x32_bf16 v[24:27], a[64:67], v[36:39], v[24:27]
  buffer_load_dwordx4 v[116:119], v0, s[12:15], s98 offen sc1
  v_cvt_pk_bf16_f32 v16, v16, v17
  v_mfma_f32_16x16x32_bf16 v[28:31], a[68:71], v[36:39], v[28:31]
  v_cvt_pk_bf16_f32 v17, v18, v19
  v_cvt_pk_bf16_f32 v18, v20, v21
  v_mfma_f32_16x16x32_bf16 v[24:27], a[104:107], v[40:43], v[24:27]
  v_cvt_pk_bf16_f32 v19, v22, v23
  s_add_u32 s98, s49, 332928
  v_mfma_f32_16x16x32_bf16 v[28:31], a[108:111], v[40:43], v[28:31]
  buffer_load_dwordx4 v[120:123], v0, s[12:15], s98 offen sc1
  v_bfi_b32 v16, 1, s63, v16
  v_mfma_f32_16x16x32_bf16 v[24:27], a[144:147], v[44:47], v[24:27]
  v_bfi_b32 v18, 1, s63, v18
  v_mfma_f32_16x16x32_bf16 v[28:31], a[148:151], v[44:47], v[28:31]
  buffer_store_dwordx4 v[16:19], v0, s[12:15], s47 offen offset:0
  v_mfma_f32_16x16x32_bf16 v[24:27], a[184:187], v[48:51], v[24:27]
  s_add_u32 s98, s49, 369920
  buffer_load_dwordx4 v[124:127], v0, s[12:15], s98 offen sc1
  v_mfma_f32_16x16x32_bf16 v[28:31], a[188:191], v[48:51], v[28:31]
  s_add_u32 s98, s49, 406912
  buffer_load_dwordx4 v[128:131], v0, s[12:15], s98 offen sc1
  v_mfma_f32_16x16x32_bf16 v[24:27], a[224:227], v[52:55], v[24:27]
  s_add_u32 s98, s49, 443904
  buffer_load_dwordx4 v[132:135], v0, s[12:15], s98 offen sc1
  v_mfma_f32_16x16x32_bf16 v[28:31], a[228:231], v[52:55], v[28:31]
  s_add_u32 s98, s49, 480896
  v_mfma_f32_16x16x32_bf16 v[24:27], v[200:203], v[56:59], v[24:27]
  buffer_load_dwordx4 v[136:139], v0, s[12:15], s98 offen sc1
  s_add_u32 s98, s49, 517888
  v_mfma_f32_16x16x32_bf16 v[28:31], v[204:207], v[56:59], v[28:31]
  v_mfma_f32_16x16x32_bf16 v[24:27], v[240:243], v[60:63], v[24:27]
  buffer_load_dwordx4 v[140:143], v0, s[12:15], s98 offen sc1
  s_add_u32 s98, s49, 554880
  v_mfma_f32_16x16x32_bf16 v[28:31], v[244:247], v[60:63], v[28:31]
  v_mfma_f32_16x16x32_bf16 v[16:19], a[32:35], v[32:35], 0
  buffer_load_dwordx4 v[144:147], v0, s[12:15], s98 offen sc1
  v_mfma_f32_16x16x32_bf16 v[20:23], a[36:39], v[32:35], 0
  ds_read_b128 v[32:35], v6 offset:1024
  s_add_u32 s98, s57, 0
  v_mfma_f32_16x16x32_bf16 v[16:19], a[72:75], v[36:39], v[16:19]
  buffer_load_dwordx4 v[152:155], v7, s[12:15], s98 offen sc1
  v_cvt_pk_bf16_f32 v24, v24, v25
  v_mfma_f32_16x16x32_bf16 v[20:23], a[76:79], v[36:39], v[20:23]
  v_cvt_pk_bf16_f32 v25, v26, v27
  ds_read_b128 v[36:39], v6 offset:3072
  v_mfma_f32_16x16x32_bf16 v[16:19], a[112:115], v[40:43], v[16:19]
  v_cvt_pk_bf16_f32 v26, v28, v29
  v_cvt_pk_bf16_f32 v27, v30, v31
  v_mfma_f32_16x16x32_bf16 v[20:23], a[116:119], v[40:43], v[20:23]
  s_add_u32 s98, s57, 295936
  buffer_load_dwordx4 v[156:159], v7, s[12:15], s98 offen sc1
  v_mfma_f32_16x16x32_bf16 v[16:19], a[152:155], v[44:47], v[16:19]
  v_bfi_b32 v24, 1, s63, v24
  v_bfi_b32 v26, 1, s63, v26
  v_mfma_f32_16x16x32_bf16 v[20:23], a[156:159], v[44:47], v[20:23]
  ds_read_b128 v[40:43], v6 offset:5120
  v_mfma_f32_16x16x32_bf16 v[16:19], a[192:195], v[48:51], v[16:19]
  buffer_store_dwordx4 v[24:27], v0, s[12:15], s47 offen offset:2048
  v_mfma_f32_16x16x32_bf16 v[20:23], a[196:199], v[48:51], v[20:23]
  ds_read_b128 v[44:47], v6 offset:7168
  s_add_u32 m0, s34, 8192
  s_add_u32 s96, s33, 8192
  v_mfma_f32_16x16x32_bf16 v[16:19], a[232:235], v[52:55], v[16:19]
  buffer_load_dwordx4 v0, s[28:31], s96 offen offset:0 sc1 lds
  v_mfma_f32_16x16x32_bf16 v[20:23], a[236:239], v[52:55], v[20:23]
  ds_read_b128 v[48:51], v6 offset:9216
  ds_read_b128 v[52:55], v6 offset:11264
  v_mfma_f32_16x16x32_bf16 v[16:19], v[208:211], v[56:59], v[16:19]
  buffer_load_dwordx4 v0, s[28:31], s96 offen offset:1024 sc1 lds
  v_mfma_f32_16x16x32_bf16 v[20:23], v[212:215], v[56:59], v[20:23]
  ds_read_b128 v[56:59], v6 offset:13312
  v_mfma_f32_16x16x32_bf16 v[16:19], v[248:251], v[60:63], v[16:19]
  v_mfma_f32_16x16x32_bf16 v[20:23], v[252:255], v[60:63], v[20:23]
  ds_read_b128 v[60:63], v6 offset:15360
  v_xor_b32 v6, 0x4000, v6
  s_waitcnt lgkmcnt(7)
  v_mfma_f32_16x16x32_bf16 v[24:27], a[0:3], v[32:35], 0
  buffer_load_dwordx4 v0, s[28:31], s96 offen offset:2048 sc1 lds
  s_nop 1
  v_cvt_pk_bf16_f32 v16, v16, v17
  v_mfma_f32_16x16x32_bf16 v[28:31], a[4:7], v[32:35], 0
  v_cvt_pk_bf16_f32 v17, v18, v19
  v_cvt_pk_bf16_f32 v18, v20, v21
  s_waitcnt lgkmcnt(6)
  v_mfma_f32_16x16x32_bf16 v[24:27], a[40:43], v[36:39], v[24:27]
  v_cvt_pk_bf16_f32 v19, v22, v23
  v_mfma_f32_16x16x32_bf16 v[28:31], a[44:47], v[36:39], v[28:31]
  s_waitcnt lgkmcnt(5)
  v_mfma_f32_16x16x32_bf16 v[24:27], a[80:83], v[40:43], v[24:27]
  buffer_load_dwordx4 v0, s[28:31], s96 offen offset:3072 sc1 lds
  s_bfe_u32 s97, s50, 65537
L_awRr_108:
  v_mfma_f32_16x16x16_bf16 v[76:79], v[64:65], v[150:151], 0
  s_waitcnt vmcnt(24)
  v_bitop3_b32 v12, v84, v86, s97 bitop3:0x7e
  v_lshlrev_b32 v12, 31, v12
  v_mfma_f32_16x16x16_bf16 v[72:75], v[64:65], v[84:85], 0
  s_waitcnt vmcnt(23)
  v_bitop3_b32 v13, v88, v90, s97 bitop3:0x7e
  v_alignbit_b32 v12, v13, v12, 1
  v_mfma_f32_16x16x32_bf16 v[80:83], v[68:71], v[160:163], 0
  s_waitcnt vmcnt(21)
  v_bitop3_b32 v13, v92, v94, s97 bitop3:0x7e
  v_alignbit_b32 v12, v13, v12, 1
  v_mfma_f32_16x16x32_bf16 v[76:79], v[64:67], v[86:89], v[76:79]
  s_waitcnt vmcnt(20)
  v_bitop3_b32 v13, v96, v98, s97 bitop3:0x7e
  v_alignbit_b32 v12, v13, v12, 1
  v_mfma_f32_16x16x32_bf16 v[72:75], v[64:67], v[90:93], v[72:75]
  s_waitcnt vmcnt(19)
  v_bitop3_b32 v13, v100, v102, s97 bitop3:0x7e
  v_alignbit_b32 v12, v13, v12, 1
  v_mfma_f32_16x16x32_bf16 v[76:79], v[64:67], v[94:97], v[76:79]
  s_waitcnt vmcnt(18)
  v_bitop3_b32 v13, v104, v106, s97 bitop3:0x7e
  v_alignbit_b32 v12, v13, v12, 1
  v_mfma_f32_16x16x32_bf16 v[72:75], v[64:67], v[98:101], v[72:75]
  s_waitcnt vmcnt(17)
  v_bitop3_b32 v13, v108, v110, s97 bitop3:0x7e
  v_alignbit_b32 v12, v13, v12, 1
  v_mfma_f32_16x16x32_bf16 v[76:79], v[64:67], v[102:105], v[76:79]
  s_waitcnt vmcnt(16)
  v_bitop3_b32 v13, v112, v114, s97 bitop3:0x7e
  v_alignbit_b32 v12, v13, v12, 1
  v_mfma_f32_16x16x32_bf16 v[72:75], v[64:67], v[106:109], v[72:75]
  s_waitcnt vmcnt(15)
  v_bitop3_b32 v13, v116, v118, s97 bitop3:0x7e
  v_alignbit_b32 v12, v13, v12, 1
  v_mfma_f32_16x16x32_bf16 v[76:79], v[64:67], v[110:113], v[76:79]
  s_waitcnt vmcnt(14)
  v_bitop3_b32 v13, v120, v122, s97 bitop3:0x7e
  v_alignbit_b32 v12, v13, v12, 1
  v_mfma_f32_16x16x32_bf16 v[72:75], v[64:67], v[114:117], v[72:75]
  s_waitcnt vmcnt(12)
  v_bitop3_b32 v13, v124, v126, s97 bitop3:0x7e
  v_alignbit_b32 v12, v13, v12, 1
  v_mfma_f32_16x16x32_bf16 v[76:79], v[64:67], v[118:121], v[76:79]
  s_waitcnt vmcnt(11)
  v_bitop3_b32 v13, v128, v130, s97 bitop3:0x7e
  v_alignbit_b32 v12, v13, v12, 1
  v_mfma_f32_16x16x32_bf16 v[72:75], v[64:67], v[122:125], v[72:75]
  s_waitcnt vmcnt(10)
  v_bitop3_b32 v13, v132, v134, s97 bitop3:0x7e
  v_alignbit_b32 v12, v13, v12, 1
  v_mfma_f32_16x16x32_bf16 v[76:79], v[64:67], v[126:129], v[76:79]
  s_waitcnt vmcnt(9)
  v_bitop3_b32 v13, v136, v138, s97 bitop3:0x7e
  v_alignbit_b32 v12, v13, v12, 1
  v_mfma_f32_16x16x32_bf16 v[72:75], v[64:67], v[130:133], v[72:75]
  s_waitcnt vmcnt(8)
  v_bitop3_b32 v13, v140, v142, s97 bitop3:0x7e
  v_alignbit_b32 v12, v13, v12, 1
  v_mfma_f32_16x16x32_bf16 v[76:79], v[64:67], v[134:137], v[76:79]
  s_waitcnt vmcnt(7)
  v_bitop3_b32 v13, v144, v146, s97 bitop3:0x7e
  v_alignbit_b32 v12, v13, v12, 1
  v_mfma_f32_16x16x32_bf16 v[72:75], v[64:67], v[138:141], v[72:75]
  s_waitcnt vmcnt(6)
  v_bitop3_b32 v13, v152, v154, s97 bitop3:0x7e
  v_alignbit_b32 v12, v13, v12, 1
  v_mfma_f32_16x16x32_bf16 v[76:79], v[64:67], v[142:145], v[76:79]
  s_waitcnt vmcnt(5)
  v_bitop3_b32 v13, v156, v158, s97 bitop3:0x7e
  v_alignbit_b32 v12, v13, v12, 1
  v_mfma_f32_16x16x32_bf16 v[72:75], v[64:67], v[146:149], v[72:75]
  v_cmp_ne_u32 vcc, 0, v12
  v_mfma_f32_16x16x32_bf16 v[80:83], v[68:71], v[152:155], v[80:83]
  v_mfma_f32_16x16x32_bf16 v[80:83], v[68:71], v[156:159], v[80:83]
  s_cbranch_vccz L_awRr_109
  s_mov_b64 exec, vcc
  v_readfirstlane_b32 s99, v12
  s_mov_b64 exec, -1
  s_bitcmp0_b32 s99, 14
  s_cbranch_scc1 L_awRr_110_0
  s_add_u32 s98, s49, 0
  buffer_load_dwordx4 v[84:87], v0, s[12:15], s98 offen sc1
L_awRr_110_0:
  s_bitcmp0_b32 s99, 15
  s_cbranch_scc1 L_awRr_110_1
  s_add_u32 s98, s49, 36992
  buffer_load_dwordx4 v[88:91], v0, s[12:15], s98 offen sc1
L_awRr_110_1:
  s_bitcmp0_b32 s99, 16
  s_cbranch_scc1 L_awRr_110_2
  s_add_u32 s98, s49, 73984
  buffer_load_dwordx4 v[92:95], v0, s[12:15], s98 offen sc1
L_awRr_110_2:
  s_bitcmp0_b32 s99, 17
  s_cbranch_scc1 L_awRr_110_3
  s_add_u32 s98, s49, 110976
  buffer_load_dwordx4 v[96:99], v0, s[12:15], s98 offen sc1
L_awRr_110_3:
  s_bitcmp0_b32 s99, 18
  s_cbranch_scc1 L_awRr_110_4
  s_add_u32 s98, s49, 147968
  buffer_load_dwordx4 v[100:103], v0, s[12:15], s98 offen sc1
L_awRr_110_4:
  s_bitcmp0_b32 s99, 19
  s_cbranch_scc1 L_awRr_110_5
  s_add_u32 s98, s49, 184960
  buffer_load_dwordx4 v[104:107], v0, s[12:15], s98 offen sc1
L_awRr_110_5:
  s_bitcmp0_b32 s99, 20
  s_cbranch_scc1 L_awRr_110_6
  s_add_u32 s98, s49, 221952
  buffer_load_dwordx4 v[108:111], v0, s[12:15], s98 offen sc1
L_awRr_110_6:
  s_bitcmp0_b32 s99, 21
  s_cbranch_scc1 L_awRr_110_7
  s_add_u32 s98, s49, 258944
  buffer_load_dwordx4 v[112:115], v0, s[12:15], s98 offen sc1
L_awRr_110_7:
  s_bitcmp0_b32 s99, 22
  s_cbranch_scc1 L_awRr_110_8
  s_add_u32 s98, s49, 295936
  buffer_load_dwordx4 v[116:119], v0, s[12:15], s98 offen sc1
L_awRr_110_8:
  s_bitcmp0_b32 s99, 23
  s_cbranch_scc1 L_awRr_110_9
  s_add_u32 s98, s49, 332928
  buffer_load_dwordx4 v[120:123], v0, s[12:15], s98 offen sc1
L_awRr_110_9:
  s_bitcmp0_b32 s99, 24
  s_cbranch_scc1 L_awRr_110_10
  s_add_u32 s98, s49, 369920
  buffer_load_dwordx4 v[124:127], v0, s[12:15], s98 offen sc1
L_awRr_110_10:
  s_bitcmp0_b32 s99, 25
  s_cbranch_scc1 L_awRr_110_11
  s_add_u32 s98, s49, 406912
  buffer_load_dwordx4 v[128:131], v0, s[12:15], s98 offen sc1
L_awRr_110_11:
  s_bitcmp0_b32 s99, 26
  s_cbranch_scc1 L_awRr_110_12
  s_add_u32 s98, s49, 443904
  buffer_load_dwordx4 v[132:135], v0, s[12:15], s98 offen sc1
L_awRr_110_12:
  s_bitcmp0_b32 s99, 27
  s_cbranch_scc1 L_awRr_110_13
  s_add_u32 s98, s49, 480896
  buffer_load_dwordx4 v[136:139], v0, s[12:15], s98 offen sc1
L_awRr_110_13:
  s_bitcmp0_b32 s99, 28
  s_cbranch_scc1 L_awRr_110_14
  s_add_u32 s98, s49, 517888
  buffer_load_dwordx4 v[140:143], v0, s[12:15], s98 offen sc1
L_awRr_110_14:
  s_bitcmp0_b32 s99, 29
  s_cbranch_scc1 L_awRr_110_15
  s_add_u32 s98, s49, 554880
  buffer_load_dwordx4 v[144:147], v0, s[12:15], s98 offen sc1
L_awRr_110_15:
  s_bitcmp0_b32 s99, 30
  s_cbranch_scc1 L_awRr_110_16
  s_add_u32 s98, s57, 0
  buffer_load_dwordx4 v[152:155], v7, s[12:15], s98 offen sc1
L_awRr_110_16:
  s_bitcmp0_b32 s99, 31
  s_cbranch_scc1 L_awRr_110_17
  s_add_u32 s98, s57, 295936
  buffer_load_dwordx4 v[156:159], v7, s[12:15], s98 offen sc1
L_awRr_110_17:
  s_waitcnt vmcnt(0)
  s_sub_u32 s100, s100, 1
  s_cbranch_scc0 L_awRr_108
  s_branch L_end
L_awRr_109:
  v_mfma_f32_16x16x32_bf16 v[28:31], a[84:87], v[40:43], v[28:31]
  v_bfi_b32 v16, 1, s63, v16
  v_bfi_b32 v18, 1, s63, v18
  s_waitcnt lgkmcnt(4)
  v_mfma_f32_16x16x32_bf16 v[24:27], a[120:123], v[44:47], v[24:27]
  buffer_store_dwordx4 v[16:19], v0, s[12:15], s48 offen offset:0
  v_mfma_f32_16x16x32_bf16 v[28:31], a[124:127], v[44:47], v[28:31]
  s_add_u32 m0, s34, 12288
  s_add_u32 s96, s33, 12288
  s_waitcnt lgkmcnt(3)
  v_mfma_f32_16x16x32_bf16 v[24:27], a[160:163], v[48:51], v[24:27]
  buffer_load_dwordx4 v0, s[28:31], s96 offen offset:0 sc1 lds
  s_add_u32 s98, s50, 1
  v_mfma_f32_16x16x32_bf16 v[28:31], a[164:167], v[48:51], v[28:31]
  v_mov_b32 v3, s98
  s_waitcnt lgkmcnt(2)
  v_mfma_f32_16x16x32_bf16 v[24:27], a[200:203], v[52:55], v[24:27]
  s_mov_b64 exec, 1
  buffer_store_dword v3, off, s[12:15], s91
  s_mov_b64 exec, -1
  v_mfma_f32_16x16x32_bf16 v[28:31], a[204:207], v[52:55], v[28:31]
  v_cvt_pk_bf16_f32 v72, v72, v73
  v_cvt_pk_bf16_f32 v73, v74, v75
  s_waitcnt lgkmcnt(1)
  v_mfma_f32_16x16x32_bf16 v[24:27], a[240:243], v[56:59], v[24:27]
  v_cvt_pk_bf16_f32 v74, v76, v77
  v_cvt_pk_bf16_f32 v75, v78, v79
  v_mfma_f32_16x16x32_bf16 v[28:31], a[244:247], v[56:59], v[28:31]
  buffer_load_dwordx4 v0, s[28:31], s96 offen offset:1024 sc1 lds
  v_add_f32 v80, v80, v80 row_ror:8 row_mask:0xf bank_mask:0xf
  s_waitcnt lgkmcnt(0)
  v_mfma_f32_16x16x32_bf16 v[24:27], v[216:219], v[60:63], v[24:27]
  v_add_f32 v81, v81, v81 row_ror:8 row_mask:0xf bank_mask:0xf
  v_add_f32 v82, v82, v82 row_ror:8 row_mask:0xf bank_mask:0xf
  v_mfma_f32_16x16x32_bf16 v[28:31], v[220:223], v[60:63], v[28:31]
  v_add_f32 v83, v83, v83 row_ror:8 row_mask:0xf bank_mask:0xf
  v_mfma_f32_16x16x32_bf16 v[84:87], v[164:167], v[72:75], 0
  buffer_store_dwordx4 v[72:75], v0, s[12:15], s38 offen sc1
  v_mfma_f32_16x16x32_bf16 v[88:91], v[72:75], v[72:75], 0
  v_cvt_pk_bf16_f32 v80, v80, v81
  v_cvt_pk_bf16_f32 v81, v82, v83
  v_mfma_f32_16x16x32_bf16 v[16:19], a[8:11], v[32:35], 0
  v_cndmask_b32 v92, 0, v80, s[52:53]
  v_cndmask_b32 v93, 0, v81, s[52:53]
  v_mfma_f32_16x16x32_bf16 v[20:23], a[12:15], v[32:35], 0
  v_permlane16_swap_b32 v80, v82
  v_mfma_f32_16x16x16_bf16 v[84:87], v[164:165], v[92:93], v[84:87]
  buffer_load_dwordx4 v0, s[28:31], s96 offen offset:2048 sc1 lds
  v_mfma_f32_16x16x16_bf16 v[88:91], v[92:93], v[92:93], v[88:91]
  v_permlane16_swap_b32 v81, v83
  v_mfma_f32_16x16x32_bf16 v[16:19], a[48:51], v[36:39], v[16:19]
  s_mov_b64 exec, 0xff
  buffer_store_dwordx4 v[80:83], v0, s[12:15], s55 offen sc1
  s_mov_b64 exec, -1
  v_mfma_f32_16x16x32_bf16 v[20:23], a[52:55], v[36:39], v[20:23]
  v_cvt_pk_bf16_f32 v24, v24, v25
  v_cvt_pk_bf16_f32 v25, v26, v27
  v_mfma_f32_16x16x32_bf16 v[16:19], a[88:91], v[40:43], v[16:19]
  v_cvt_pk_bf16_f32 v26, v28, v29
  v_cvt_pk_bf16_f32 v27, v30, v31
  v_mfma_f32_16x16x32_bf16 v[20:23], a[92:95], v[40:43], v[20:23]
  buffer_load_dwordx4 v0, s[28:31], s96 offen offset:3072 sc1 lds
  v_bfi_b32 v24, 1, s63, v24
  v_mfma_f32_16x16x32_bf16 v[16:19], a[128:131], v[44:47], v[16:19]
  v_bfi_b32 v26, 1, s63, v26
  v_mfma_f32_16x16x32_bf16 v[20:23], a[132:135], v[44:47], v[20:23]
  buffer_store_dwordx4 v[24:27], v0, s[12:15], s46 offen offset:1024
  v_mfma_f32_16x16x32_bf16 v[16:19], a[168:171], v[48:51], v[16:19]
  s_add_u32 m0, s34, 16384
  s_add_u32 s96, s33, 16384
  v_mfma_f32_16x16x32_bf16 v[20:23], a[172:175], v[48:51], v[20:23]
  buffer_load_dwordx4 v0, s[28:31], s96 offen offset:0 sc1 lds
  v_cndmask_b32 v88, v88, v89, s[72:73]
  v_mfma_f32_16x16x32_bf16 v[16:19], a[208:211], v[52:55], v[16:19]
  v_cndmask_b32 v90, v90, v91, s[72:73]
  v_cndmask_b32 v85, v88, v90, s[74:75]
  v_mfma_f32_16x16x32_bf16 v[20:23], a[212:215], v[52:55], v[20:23]
  s_mov_b64 exec, s[70:71]
  buffer_store_dwordx2 v[84:85], v4, s[12:15], s38 offen offset:1024 sc1
  s_mov_b64 exec, -1
  s_add_u32 s50, s50, 1
  s_add_u32 s38, s38, 41472
  s_add_u32 s55, s55, 41472
  s_mov_b32 s92, 0
  s_mov_b32 s43, s50
  s_and_b32 s98, s50, 1
  s_cselect_b32 s98, 0, 1183744
  s_sub_u32 s98, 591872, s98
  s_add_u32 s49, s49, s98
  s_add_u32 s57, s57, s98
L_aw_hj:
  v_mfma_f32_16x16x32_bf16 v[16:19], a[248:251], v[56:59], v[16:19]
  buffer_load_dwordx4 v0, s[28:31], s96 offen offset:1024 sc1 lds
  v_mfma_f32_16x16x32_bf16 v[20:23], a[252:255], v[56:59], v[20:23]
  v_mfma_f32_16x16x32_bf16 v[16:19], v[224:227], v[60:63], v[16:19]
  v_mfma_f32_16x16x32_bf16 v[20:23], v[228:231], v[60:63], v[20:23]
  v_mfma_f32_16x16x32_bf16 v[24:27], a[16:19], v[32:35], 0
  buffer_load_dwordx4 v0, s[28:31], s96 offen offset:2048 sc1 lds
  v_mfma_f32_16x16x32_bf16 v[28:31], a[20:23], v[32:35], 0
  v_mfma_f32_16x16x32_bf16 v[24:27], a[56:59], v[36:39], v[24:27]
  buffer_load_dwordx4 v[148:151], v0, s[12:15], s58 offen sc1
  s_add_u32 s58, s58, 41472
  v_mfma_f32_16x16x32_bf16 v[28:31], a[60:63], v[36:39], v[28:31]
  v_cvt_pk_bf16_f32 v16, v16, v17
  v_cvt_pk_bf16_f32 v17, v18, v19
  v_mfma_f32_16x16x32_bf16 v[24:27], a[96:99], v[40:43], v[24:27]
  v_cvt_pk_bf16_f32 v18, v20, v21
  v_cvt_pk_bf16_f32 v19, v22, v23
  v_mfma_f32_16x16x32_bf16 v[28:31], a[100:103], v[40:43], v[28:31]
  buffer_load_dwordx4 v0, s[28:31], s96 offen offset:3072 sc1 lds
  v_mfma_f32_16x16x32_bf16 v[24:27], a[136:139], v[44:47], v[24:27]
  s_mov_b64 exec, 0xff
  buffer_load_dwordx4 v[160:163], v0, s[12:15], s56 offen sc1
  s_mov_b64 exec, -1
  v_mfma_f32_16x16x32_bf16 v[28:31], a[140:143], v[44:47], v[28:31]
  s_add_u32 s56, s56, 41472
  v_bfi_b32 v16, 1, s63, v16
  v_bfi_b32 v18, 1, s63, v18
  v_mfma_f32_16x16x32_bf16 v[24:27], a[176:179], v[48:51], v[24:27]
  buffer_store_dwordx4 v[16:19], v0, s[12:15], s46 offen offset:3072
  v_mfma_f32_16x16x32_bf16 v[28:31], a[180:183], v[48:51], v[28:31]
  s_add_u32 m0, s34, 20480
  s_add_u32 s96, s33, 20480
  v_mfma_f32_16x16x32_bf16 v[24:27], a[216:219], v[52:55], v[24:27]
  buffer_load_dwordx4 v0, s[28:31], s96 offen offset:0 sc1 lds
  v_mfma_f32_16x16x32_bf16 v[28:31], a[220:223], v[52:55], v[28:31]
  v_mfma_f32_16x16x32_bf16 v[24:27], v[192:195], v[56:59], v[24:27]
  buffer_load_dwordx4 v0, s[28:31], s96 offen offset:1024 sc1 lds
  v_mfma_f32_16x16x32_bf16 v[28:31], v[196:199], v[56:59], v[28:31]
  v_mfma_f32_16x16x32_bf16 v[24:27], v[232:235], v[60:63], v[24:27]
  v_mfma_f32_16x16x32_bf16 v[28:31], v[236:239], v[60:63], v[28:31]
  v_mfma_f32_16x16x32_bf16 v[16:19], a[24:27], v[32:35], 0
  buffer_load_dwordx4 v0, s[28:31], s96 offen offset:2048 sc1 lds
  s_nop 4
  v_cvt_pk_bf16_f32 v24, v24, v25
  v_mfma_f32_16x16x32_bf16 v[20:23], a[28:31], v[32:35], 0
  v_cvt_pk_bf16_f32 v25, v26, v27
  v_cvt_pk_bf16_f32 v26, v28, v29
  v_mfma_f32_16x16x32_bf16 v[16:19], a[64:67], v[36:39], v[16:19]
  v_cvt_pk_bf16_f32 v27, v30, v31
  v_mfma_f32_16x16x32_bf16 v[20:23], a[68:71], v[36:39], v[20:23]
  v_mfma_f32_16x16x32_bf16 v[16:19], a[104:107], v[40:43], v[16:19]
  buffer_load_dwordx4 v0, s[28:31], s96 offen offset:3072 sc1 lds
  v_bfi_b32 v24, 1, s63, v24
  v_mfma_f32_16x16x32_bf16 v[20:23], a[108:111], v[40:43], v[20:23]
  v_bfi_b32 v26, 1, s63, v26
  s_and_b32 s98, s44, 786432
  v_mfma_f32_16x16x32_bf16 v[16:19], a[144:147], v[44:47], v[16:19]
  s_add_u32 s33, s33, s98
  v_mfma_f32_16x16x32_bf16 v[20:23], a[148:151], v[44:47], v[20:23]
  buffer_store_dwordx4 v[24:27], v0, s[12:15], s47 offen offset:1024
  v_mfma_f32_16x16x32_bf16 v[16:19], a[184:187], v[48:51], v[16:19]
  s_and_b32 s98, s44, s39
  s_xor_b32 s34, s34, s98
  s_mov_b64 exec, s[40:41]
  buffer_load_dword v2, v170, s[12:15], s36 offen sc1
  s_mov_b64 exec, -1
  s_waitcnt vmcnt(12)
  s_cmp_eq_u32 s43, 0
  s_cbranch_scc1 L_fl_111
  v_mov_b32 v3, s43
  s_mov_b64 exec, 1
  buffer_store_dword v3, off, s[12:15], s37 sc1
  s_mov_b64 exec, -1
  s_mov_b32 s43, 0
L_fl_111:
  v_mfma_f32_16x16x32_bf16 v[20:23], a[188:191], v[48:51], v[20:23]
  v_mfma_f32_16x16x32_bf16 v[16:19], a[224:227], v[52:55], v[16:19]
  v_mfma_f32_16x16x32_bf16 v[20:23], a[228:231], v[52:55], v[20:23]
  v_mfma_f32_16x16x32_bf16 v[16:19], v[200:203], v[56:59], v[16:19]
  v_mfma_f32_16x16x32_bf16 v[20:23], v[204:207], v[56:59], v[20:23]
  v_mfma_f32_16x16x32_bf16 v[16:19], v[240:243], v[60:63], v[16:19]
  v_mfma_f32_16x16x32_bf16 v[20:23], v[244:247], v[60:63], v[20:23]
  v_mfma_f32_16x16x32_bf16 v[24:27], a[32:35], v[32:35], 0
  s_nop 5
  v_cvt_pk_bf16_f32 v16, v16, v17
  v_cvt_pk_bf16_f32 v17, v18, v19
  v_mfma_f32_16x16x32_bf16 v[28:31], a[36:39], v[32:35], 0
  v_cvt_pk_bf16_f32 v18, v20, v21
  v_cvt_pk_bf16_f32 v19, v22, v23
  v_mfma_f32_16x16x32_bf16 v[24:27], a[72:75], v[36:39], v[24:27]
  v_bfi_b32 v16, 1, s63, v16
  v_bfi_b32 v18, 1, s63, v18
  v_mfma_f32_16x16x32_bf16 v[28:31], a[76:79], v[36:39], v[28:31]
  v_mfma_f32_16x16x32_bf16 v[24:27], a[112:115], v[40:43], v[24:27]
  v_mfma_f32_16x16x32_bf16 v[28:31], a[116:119], v[40:43], v[28:31]
  v_mfma_f32_16x16x32_bf16 v[24:27], a[152:155], v[44:47], v[24:27]
  buffer_store_dwordx4 v[16:19], v0, s[12:15], s47 offen offset:3072
  v_mfma_f32_16x16x32_bf16 v[28:31], a[156:159], v[44:47], v[28:31]
  v_mov_b32 v12, 139264
  ds_read_b64 v[12:13], v12
  v_mfma_f32_16x16x32_bf16 v[24:27], a[192:195], v[48:51], v[24:27]
  v_mfma_f32_16x16x32_bf16 v[28:31], a[196:199], v[48:51], v[28:31]
  v_mfma_f32_16x16x32_bf16 v[24:27], a[232:235], v[52:55], v[24:27]
  v_mfma_f32_16x16x32_bf16 v[28:31], a[236:239], v[52:55], v[28:31]
  v_mfma_f32_16x16x32_bf16 v[24:27], v[208:211], v[56:59], v[24:27]
  v_mfma_f32_16x16x32_bf16 v[28:31], v[212:215], v[56:59], v[28:31]
  v_mfma_f32_16x16x32_bf16 v[24:27], v[248:251], v[60:63], v[24:27]
  v_mfma_f32_16x16x32_bf16 v[28:31], v[252:255], v[60:63], v[28:31]
  s_nop 6
  v_cvt_pk_bf16_f32 v24, v24, v25
  v_cvt_pk_bf16_f32 v25, v26, v27
  v_cvt_pk_bf16_f32 v26, v28, v29
  v_cvt_pk_bf16_f32 v27, v30, v31
  v_bfi_b32 v24, 1, s63, v24
  v_bfi_b32 v26, 1, s63, v26
  buffer_store_dwordx4 v[24:27], v0, s[12:15], s48 offen offset:1024
  s_waitcnt lgkmcnt(0)
  v_min_u32 v12, v12, v13
  s_nop 0
  v_readfirstlane_b32 s98, v12
  s_cmp_lt_u32 s32, 0
  s_cselect_b32 s99, 0, 62
  s_max_u32 s98, s98, s99
  s_cmp_gt_u32 s98, s32
  s_cselect_b32 s92, 1, 0
  s_cbranch_scc1 L_awR_j
  s_add_u32 s98, s49, 0
  buffer_load_dwordx4 v[84:87], v0, s[12:15], s98 offen sc1
  s_add_u32 s98, s49, 36992
  buffer_load_dwordx4 v[88:91], v0, s[12:15], s98 offen sc1
  s_add_u32 s98, s49, 73984
  buffer_load_dwordx4 v[92:95], v0, s[12:15], s98 offen sc1
  s_add_u32 s98, s49, 110976
  buffer_load_dwordx4 v[96:99], v0, s[12:15], s98 offen sc1
  s_add_u32 s98, s49, 147968
  buffer_load_dwordx4 v[100:103], v0, s[12:15], s98 offen sc1
  s_add_u32 s98, s49, 184960
  buffer_load_dwordx4 v[104:107], v0, s[12:15], s98 offen sc1
  s_add_u32 s98, s49, 221952
  buffer_load_dwordx4 v[108:111], v0, s[12:15], s98 offen sc1
  s_add_u32 s98, s49, 258944
  buffer_load_dwordx4 v[112:115], v0, s[12:15], s98 offen sc1
  s_add_u32 s98, s49, 295936
  buffer_load_dwordx4 v[116:119], v0, s[12:15], s98 offen sc1
  s_add_u32 s98, s49, 332928
  buffer_load_dwordx4 v[120:123], v0, s[12:15], s98 offen sc1
  s_add_u32 s98, s49, 369920
  buffer_load_dwordx4 v[124:127], v0, s[12:15], s98 offen sc1
  s_add_u32 s98, s49, 406912
  buffer_load_dwordx4 v[128:131], v0, s[12:15], s98 offen sc1
  s_add_u32 s98, s49, 443904
  buffer_load_dwordx4 v[132:135], v0, s[12:15], s98 offen sc1
  s_add_u32 s98, s49, 480896
  buffer_load_dwordx4 v[136:139], v0, s[12:15], s98 offen sc1
  s_add_u32 s98, s49, 517888
  buffer_load_dwordx4 v[140:143], v0, s[12:15], s98 offen sc1
  s_add_u32 s98, s49, 554880
  buffer_load_dwordx4 v[144:147], v0, s[12:15], s98 offen sc1
  s_add_u32 s98, s57, 0
  buffer_load_dwordx4 v[152:155], v7, s[12:15], s98 offen sc1
  s_add_u32 s98, s57, 295936
  buffer_load_dwordx4 v[156:159], v7, s[12:15], s98 offen sc1
  s_bfe_u32 s97, s50, 65537
L_awRr_112:
  s_waitcnt vmcnt(29)
  v_mfma_f32_16x16x16_bf16 v[76:79], v[64:65], v[150:151], 0
  s_waitcnt vmcnt(17)
  v_bitop3_b32 v12, v84, v86, s97 bitop3:0x7e
  v_lshlrev_b32 v12, 31, v12
  v_mfma_f32_16x16x16_bf16 v[72:75], v[64:65], v[84:85], 0
  s_waitcnt vmcnt(16)
  v_bitop3_b32 v13, v88, v90, s97 bitop3:0x7e
  v_alignbit_b32 v12, v13, v12, 1
  v_mfma_f32_16x16x32_bf16 v[80:83], v[68:71], v[160:163], 0
  s_waitcnt vmcnt(15)
  v_bitop3_b32 v13, v92, v94, s97 bitop3:0x7e
  v_alignbit_b32 v12, v13, v12, 1
  v_mfma_f32_16x16x32_bf16 v[76:79], v[64:67], v[86:89], v[76:79]
  s_waitcnt vmcnt(14)
  v_bitop3_b32 v13, v96, v98, s97 bitop3:0x7e
  v_alignbit_b32 v12, v13, v12, 1
  v_mfma_f32_16x16x32_bf16 v[72:75], v[64:67], v[90:93], v[72:75]
  s_waitcnt vmcnt(13)
  v_bitop3_b32 v13, v100, v102, s97 bitop3:0x7e
  v_alignbit_b32 v12, v13, v12, 1
  v_mfma_f32_16x16x32_bf16 v[76:79], v[64:67], v[94:97], v[76:79]
  s_waitcnt vmcnt(12)
  v_bitop3_b32 v13, v104, v106, s97 bitop3:0x7e
  v_alignbit_b32 v12, v13, v12, 1
  v_mfma_f32_16x16x32_bf16 v[72:75], v[64:67], v[98:101], v[72:75]
  s_waitcnt vmcnt(11)
  v_bitop3_b32 v13, v108, v110, s97 bitop3:0x7e
  v_alignbit_b32 v12, v13, v12, 1
  v_mfma_f32_16x16x32_bf16 v[76:79], v[64:67], v[102:105], v[76:79]
  s_waitcnt vmcnt(10)
  v_bitop3_b32 v13, v112, v114, s97 bitop3:0x7e
  v_alignbit_b32 v12, v13, v12, 1
  v_mfma_f32_16x16x32_bf16 v[72:75], v[64:67], v[106:109], v[72:75]
  s_waitcnt vmcnt(9)
  v_bitop3_b32 v13, v116, v118, s97 bitop3:0x7e
  v_alignbit_b32 v12, v13, v12, 1
  v_mfma_f32_16x16x32_bf16 v[76:79], v[64:67], v[110:113], v[76:79]
  s_waitcnt vmcnt(8)
  v_bitop3_b32 v13, v120, v122, s97 bitop3:0x7e
  v_alignbit_b32 v12, v13, v12, 1
  v_mfma_f32_16x16x32_bf16 v[72:75], v[64:67], v[114:117], v[72:75]
  s_waitcnt vmcnt(7)
  v_bitop3_b32 v13, v124, v126, s97 bitop3:0x7e
  v_alignbit_b32 v12, v13, v12, 1
  v_mfma_f32_16x16x32_bf16 v[76:79], v[64:67], v[118:121], v[76:79]
  s_waitcnt vmcnt(6)
  v_bitop3_b32 v13, v128, v130, s97 bitop3:0x7e
  v_alignbit_b32 v12, v13, v12, 1
  v_mfma_f32_16x16x32_bf16 v[72:75], v[64:67], v[122:125], v[72:75]
  s_waitcnt vmcnt(5)
  v_bitop3_b32 v13, v132, v134, s97 bitop3:0x7e
  v_alignbit_b32 v12, v13, v12, 1
  v_mfma_f32_16x16x32_bf16 v[76:79], v[64:67], v[126:129], v[76:79]
  s_waitcnt vmcnt(4)
  v_bitop3_b32 v13, v136, v138, s97 bitop3:0x7e
  v_alignbit_b32 v12, v13, v12, 1
  v_mfma_f32_16x16x32_bf16 v[72:75], v[64:67], v[130:133], v[72:75]
  s_waitcnt vmcnt(3)
  v_bitop3_b32 v13, v140, v142, s97 bitop3:0x7e
  v_alignbit_b32 v12, v13, v12, 1
  v_mfma_f32_16x16x32_bf16 v[76:79], v[64:67], v[134:137], v[76:79]
  s_waitcnt vmcnt(2)
  v_bitop3_b32 v13, v144, v146, s97 bitop3:0x7e
  v_alignbit_b32 v12, v13, v12, 1
  v_mfma_f32_16x16x32_bf16 v[72:75], v[64:67], v[138:141], v[72:75]
  s_waitcnt vmcnt(1)
  v_bitop3_b32 v13, v152, v154, s97 bitop3:0x7e
  v_alignbit_b32 v12, v13, v12, 1
  v_mfma_f32_16x16x32_bf16 v[76:79], v[64:67], v[142:145], v[76:79]
  s_waitcnt vmcnt(0)
  v_bitop3_b32 v13, v156, v158, s97 bitop3:0x7e
  v_alignbit_b32 v12, v13, v12, 1
  v_mfma_f32_16x16x32_bf16 v[72:75], v[64:67], v[146:149], v[72:75]
  v_cmp_ne_u32 vcc, 0, v12
  v_mfma_f32_16x16x32_bf16 v[80:83], v[68:71], v[152:155], v[80:83]
  v_mfma_f32_16x16x32_bf16 v[80:83], v[68:71], v[156:159], v[80:83]
  s_cbranch_vccz L_awRr_113
  s_mov_b64 exec, vcc
  v_readfirstlane_b32 s99, v12
  s_mov_b64 exec, -1
  s_bitcmp0_b32 s99, 14
  s_cbranch_scc1 L_awRr_114_0
  s_add_u32 s98, s49, 0
  buffer_load_dwordx4 v[84:87], v0, s[12:15], s98 offen sc1
L_awRr_114_0:
  s_bitcmp0_b32 s99, 15
  s_cbranch_scc1 L_awRr_114_1
  s_add_u32 s98, s49, 36992
  buffer_load_dwordx4 v[88:91], v0, s[12:15], s98 offen sc1
L_awRr_114_1:
  s_bitcmp0_b32 s99, 16
  s_cbranch_scc1 L_awRr_114_2
  s_add_u32 s98, s49, 73984
  buffer_load_dwordx4 v[92:95], v0, s[12:15], s98 offen sc1
L_awRr_114_2:
  s_bitcmp0_b32 s99, 17
  s_cbranch_scc1 L_awRr_114_3
  s_add_u32 s98, s49, 110976
  buffer_load_dwordx4 v[96:99], v0, s[12:15], s98 offen sc1
L_awRr_114_3:
  s_bitcmp0_b32 s99, 18
  s_cbranch_scc1 L_awRr_114_4
  s_add_u32 s98, s49, 147968
  buffer_load_dwordx4 v[100:103], v0, s[12:15], s98 offen sc1
L_awRr_114_4:
  s_bitcmp0_b32 s99, 19
  s_cbranch_scc1 L_awRr_114_5
  s_add_u32 s98, s49, 184960
  buffer_load_dwordx4 v[104:107], v0, s[12:15], s98 offen sc1
L_awRr_114_5:
  s_bitcmp0_b32 s99, 20
  s_cbranch_scc1 L_awRr_114_6
  s_add_u32 s98, s49, 221952
  buffer_load_dwordx4 v[108:111], v0, s[12:15], s98 offen sc1
L_awRr_114_6:
  s_bitcmp0_b32 s99, 21
  s_cbranch_scc1 L_awRr_114_7
  s_add_u32 s98, s49, 258944
  buffer_load_dwordx4 v[112:115], v0, s[12:15], s98 offen sc1
L_awRr_114_7:
  s_bitcmp0_b32 s99, 22
  s_cbranch_scc1 L_awRr_114_8
  s_add_u32 s98, s49, 295936
  buffer_load_dwordx4 v[116:119], v0, s[12:15], s98 offen sc1
L_awRr_114_8:
  s_bitcmp0_b32 s99, 23
  s_cbranch_scc1 L_awRr_114_9
  s_add_u32 s98, s49, 332928
  buffer_load_dwordx4 v[120:123], v0, s[12:15], s98 offen sc1
L_awRr_114_9:
  s_bitcmp0_b32 s99, 24
  s_cbranch_scc1 L_awRr_114_10
  s_add_u32 s98, s49, 369920
  buffer_load_dwordx4 v[124:127], v0, s[12:15], s98 offen sc1
L_awRr_114_10:
  s_bitcmp0_b32 s99, 25
  s_cbranch_scc1 L_awRr_114_11
  s_add_u32 s98, s49, 406912
  buffer_load_dwordx4 v[128:131], v0, s[12:15], s98 offen sc1
L_awRr_114_11:
  s_bitcmp0_b32 s99, 26
  s_cbranch_scc1 L_awRr_114_12
  s_add_u32 s98, s49, 443904
  buffer_load_dwordx4 v[132:135], v0, s[12:15], s98 offen sc1
L_awRr_114_12:
  s_bitcmp0_b32 s99, 27
  s_cbranch_scc1 L_awRr_114_13
  s_add_u32 s98, s49, 480896
  buffer_load_dwordx4 v[136:139], v0, s[12:15], s98 offen sc1
L_awRr_114_13:
  s_bitcmp0_b32 s99, 28
  s_cbranch_scc1 L_awRr_114_14
  s_add_u32 s98, s49, 517888
  buffer_load_dwordx4 v[140:143], v0, s[12:15], s98 offen sc1
L_awRr_114_14:
  s_bitcmp0_b32 s99, 29
  s_cbranch_scc1 L_awRr_114_15
  s_add_u32 s98, s49, 554880
  buffer_load_dwordx4 v[144:147], v0, s[12:15], s98 offen sc1
L_awRr_114_15:
  s_bitcmp0_b32 s99, 30
  s_cbranch_scc1 L_awRr_114_16
  s_add_u32 s98, s57, 0
  buffer_load_dwordx4 v[152:155], v7, s[12:15], s98 offen sc1
L_awRr_114_16:
  s_bitcmp0_b32 s99, 31
  s_cbranch_scc1 L_awRr_114_17
  s_add_u32 s98, s57, 295936
  buffer_load_dwordx4 v[156:159], v7, s[12:15], s98 offen sc1
L_awRr_114_17:
  s_waitcnt vmcnt(0)
  s_sub_u32 s100, s100, 1
  s_cbranch_scc0 L_awRr_112
  s_branch L_end
L_awRr_113:
  s_add_u32 s98, s50, 1
  v_mov_b32 v3, s98
  s_mov_b64 exec, 1
  buffer_store_dword v3, off, s[12:15], s91
  s_mov_b64 exec, -1
  v_cvt_pk_bf16_f32 v72, v72, v73
  v_cvt_pk_bf16_f32 v73, v74, v75
  v_cvt_pk_bf16_f32 v74, v76, v77
  v_cvt_pk_bf16_f32 v75, v78, v79
  v_add_f32 v80, v80, v80 row_ror:8 row_mask:0xf bank_mask:0xf
  s_nop 0
  v_mfma_f32_16x16x32_bf16 v[84:87], v[164:167], v[72:75], 0
  v_add_f32 v81, v81, v81 row_ror:8 row_mask:0xf bank_mask:0xf
  v_add_f32 v82, v82, v82 row_ror:8 row_mask:0xf bank_mask:0xf
  v_mfma_f32_16x16x32_bf16 v[88:91], v[72:75], v[72:75], 0
  v_add_f32 v83, v83, v83 row_ror:8 row_mask:0xf bank_mask:0xf
  buffer_store_dwordx4 v[72:75], v0, s[12:15], s38 offen sc1
  v_cvt_pk_bf16_f32 v80, v80, v81
  v_cvt_pk_bf16_f32 v81, v82, v83
  v_cndmask_b32 v92, 0, v80, s[52:53]
  v_cndmask_b32 v93, 0, v81, s[52:53]
  s_nop 1
  v_mfma_f32_16x16x16_bf16 v[84:87], v[164:165], v[92:93], v[84:87]
  v_permlane16_swap_b32 v80, v82
  v_mfma_f32_16x16x16_bf16 v[88:91], v[92:93], v[92:93], v[88:91]
  v_permlane16_swap_b32 v81, v83
  s_mov_b64 exec, 0xff
  buffer_store_dwordx4 v[80:83], v0, s[12:15], s55 offen sc1
  s_mov_b64 exec, -1
  s_nop 3
  v_cndmask_b32 v88, v88, v89, s[72:73]
  v_cndmask_b32 v90, v90, v91, s[72:73]
  v_cndmask_b32 v85, v88, v90, s[74:75]
  s_mov_b64 exec, s[70:71]
  buffer_store_dwordx2 v[84:85], v4, s[12:15], s38 offen offset:1024 sc1
  s_mov_b64 exec, -1
  s_add_u32 s50, s50, 1
  s_add_u32 s38, s38, 41472
  s_add_u32 s55, s55, 41472
  s_mov_b32 s92, 0
  s_mov_b32 s43, s50
  s_and_b32 s98, s50, 1
  s_cselect_b32 s98, 0, 1183744
  s_sub_u32 s98, 591872, s98
  s_add_u32 s49, s49, s98
  s_add_u32 s57, s57, s98
  s_waitcnt vmcnt(0)
  s_cmp_eq_u32 s43, 0
  s_cbranch_scc1 L_fl_115
  v_mov_b32 v3, s43
  s_mov_b64 exec, 1
  buffer_store_dword v3, off, s[12:15], s37 sc1
  s_mov_b64 exec, -1
  s_mov_b32 s43, 0
L_fl_115:
  s_cmp_eq_u32 s32, 63
  s_cbranch_scc1 L_end
L_awR_j:
  s_add_u32 s32, s32, 1
  s_and_b32 s98, s32, 1
  s_cselect_b32 s98, 0, 1183744
  s_sub_u32 s98, 591872, s98
  s_add_u32 s46, s46, s98
  s_add_u32 s47, s47, s98
  s_add_u32 s48, s48, s98
  s_cmp_eq_u32 s32, 63
  s_cselect_b32 s35, 1, s35
  s_cmp_eq_u32 s35, 0
  s_cbranch_scc1 L_awR_late
  s_waitcnt vmcnt(4)
  s_branch L_awR_loop
L_awR_late:
L_bk_116:
  s_mov_b64 exec, s[40:41]
  buffer_load_dword v2, v170, s[12:15], s36 offen sc1
  s_mov_b64 exec, -1
  s_add_u32 s98, s32, 2
  s_mov_b64 exec, s[40:41]
  s_waitcnt vmcnt(0)
  v_cmp_gt_u32 vcc, s98, v2
  s_mov_b64 exec, -1
  s_cbranch_vccz L_bk_116d
  s_sleep 1
  s_sub_u32 s100, s100, 1
  s_cbranch_scc0 L_bk_116
  s_branch L_end
L_bk_116d:
  s_add_u32 m0, s34, 0
  s_add_u32 s98, s33, 0
  buffer_load_dwordx4 v0, s[12:15], s98 offen offset:0 sc1 lds
  buffer_load_dwordx4 v0, s[12:15], s98 offen offset:1024 sc1 lds
  buffer_load_dwordx4 v0, s[12:15], s98 offen offset:2048 sc1 lds
  buffer_load_dwordx4 v0, s[12:15], s98 offen offset:3072 sc1 lds
  s_add_u32 m0, s34, 4096
  s_add_u32 s98, s33, 4096
  buffer_load_dwordx4 v0, s[12:15], s98 offen offset:0 sc1 lds
  buffer_load_dwordx4 v0, s[12:15], s98 offen offset:1024 sc1 lds
  buffer_load_dwordx4 v0, s[12:15], s98 offen offset:2048 sc1 lds
  buffer_load_dwordx4 v0, s[12:15], s98 offen offset:3072 sc1 lds
  s_add_u32 m0, s34, 8192
  s_add_u32 s98, s33, 8192
  buffer_load_dwordx4 v0, s[12:15], s98 offen offset:0 sc1 lds
  buffer_load_dwordx4 v0, s[12:15], s98 offen offset:1024 sc1 lds
  buffer_load_dwordx4 v0, s[12:15], s98 offen offset:2048 sc1 lds
  buffer_load_dwordx4 v0, s[12:15], s98 offen offset:3072 sc1 lds
  s_add_u32 m0, s34, 12288
  s_add_u32 s98, s33, 12288
  buffer_load_dwordx4 v0, s[12:15], s98 offen offset:0 sc1 lds
  buffer_load_dwordx4 v0, s[12:15], s98 offen offset:1024 sc1 lds
  buffer_load_dwordx4 v0, s[12:15], s98 offen offset:2048 sc1 lds
  buffer_load_dwordx4 v0, s[12:15], s98 offen offset:3072 sc1 lds
  s_add_u32 m0, s34, 16384
  s_add_u32 s98, s33, 16384
  buffer_load_dwordx4 v0, s[12:15], s98 offen offset:0 sc1 lds
  buffer_load_dwordx4 v0, s[12:15], s98 offen offset:1024 sc1 lds
  buffer_load_dwordx4 v0, s[12:15], s98 offen offset:2048 sc1 lds
  buffer_load_dwordx4 v0, s[12:15], s98 offen offset:3072 sc1 lds
  s_add_u32 m0, s34, 20480
  s_add_u32 s98, s33, 20480
  buffer_load_dwordx4 v0, s[12:15], s98 offen offset:0 sc1 lds
  buffer_load_dwordx4 v0, s[12:15], s98 offen offset:1024 sc1 lds
  buffer_load_dwordx4 v0, s[12:15], s98 offen offset:2048 sc1 lds
  buffer_load_dwordx4 v0, s[12:15], s98 offen offset:3072 sc1 lds
  s_add_u32 s33, s33, 786432
  s_xor_b32 s34, s34, s39
  s_mov_b32 s35, 1
  s_waitcnt vmcnt(0)
  s_branch L_awR_loop
L_bpr_105:
  s_mov_b64 exec, s[66:67]
  buffer_load_dword v5, v1, s[12:15], s93 offen sc1
  s_mov_b64 exec, -1
  s_waitcnt vmcnt(0)
  s_sub_u32 s100, s100, 1
  s_cbranch_scc0 L_bpc_104
  s_branch L_end
L_bpr_107:
  s_mov_b64 exec, s[66:67]
  buffer_load_dword v5, v1, s[12:15], s93 offen sc1
  s_mov_b64 exec, -1
  s_waitcnt vmcnt(0)
  s_sub_u32 s100, s100, 1
  s_cbranch_scc0 L_bpc_106
  s_branch L_end
L_aw_G:
  s_lshl_b32 s59, s60, 12
  s_add_u32 s59, s59, 131072
  v_and_b32 v61, 7, v63
  v_lshrrev_b32 v60, 4, v63
  v_lshlrev_b32 v10, 4, v61
  v_lshl_add_u32 v10, v60, 8, v10
  v_add_u32 v10, s59, v10
  v_add_u32 v4, 2048, v10
  v_and_b32 v11, 0x1f0, v0
  v_add_u32 v11, s59, v11
  v_add_u32 v11, 8, v11
  v_add_u32 v9, s34, v0
  s_lshl_b32 s98, s60, 13
  s_add_u32 s98, s98, 98304
  v_add_u32 v7, s98, v0
  s_lshl_b32 s98, s60, 2
  s_add_u32 s98, s98, 139264
  v_mov_b32 v8, s98
  s_mov_b32 s94, 0x3e0293ee
  s_mov_b32 s95, s94
  s_mov_b32 s28, s12
  s_mov_b32 s29, s13
  s_mov_b32 s30, 0
  s_mov_b32 s31, 0x20000
  v_and_b32 v61, 15, v63
  v_lshlrev_b32 v60, 2, v60
  v_sub_u32 v61, v61, v60
  v_mov_b32 v62, 0xff800000
  v_cmp_le_i32 vcc, 0, v61
  s_nop 1
  v_cndmask_b32 v64, v62, 0, vcc
  v_cmp_le_i32 vcc, 1, v61
  s_nop 1
  v_cndmask_b32 v65, v62, 0, vcc
  v_cmp_le_i32 vcc, 2, v61
  s_nop 1
  v_cndmask_b32 v66, v62, 0, vcc
  v_cmp_le_i32 vcc, 3, v61
  s_nop 1
  v_cndmask_b32 v67, v62, 0, vcc
  v_cmp_gt_u32 vcc, 32, v63
  s_nop 1
  v_cndmask_b32 v68, v62, 0, vcc
  v_cndmask_b32 v69, v62, 0, vcc
  v_cndmask_b32 v70, v62, 0, vcc
  v_cndmask_b32 v71, v62, 0, vcc
  s_cmp_lg_u32 s9, 3
  s_cbranch_scc1 L_gw_117b
  s_cmp_lg_u32 s11, 0
  s_cbranch_scc1 L_gw_117a
  v_mov_b32 v60, 128
  s_mov_b64 exec, 1
L_wa_118:
  global_load_dword v61, v60, s[4:5] sc1
  s_waitcnt vmcnt(0)
  v_readfirstlane_b32 s98, v61
  s_nop 0
  s_cmp_ge_u32 s98, 32
  s_nop 1
  s_cbranch_scc1 L_wa_118d
  s_sleep 24
  s_sub_u32 s100, s100, 1
  s_cbranch_scc0 L_wa_118
  s_branch L_end
L_wa_118d:
  s_mov_b64 exec, -1
  s_branch L_gw_117b
L_gw_117a:
  v_mov_b32 v60, 192
  s_mov_b64 exec, 1
L_wa_119:
  global_load_dword v61, v60, s[4:5] sc1
  s_waitcnt vmcnt(0)
  v_readfirstlane_b32 s98, v61
  s_nop 0
  s_cmp_ge_u32 s98, 32
  s_nop 1
  s_cbranch_scc1 L_wa_119d
  s_sleep 48
  s_sub_u32 s100, s100, 1
  s_cbranch_scc0 L_wa_119
  s_branch L_end
L_wa_119d:
  s_mov_b64 exec, -1
L_gw_117b:
  s_barrier
  s_add_u32 m0, s62, 0
  s_add_u32 s99, s90, 0
  buffer_load_dwordx4 v17, s[16:19], s99 offen  lds
  s_add_u32 m0, s62, 1024
  s_add_u32 s99, s90, 18432
  buffer_load_dwordx4 v17, s[16:19], s99 offen  lds
  s_add_u32 m0, s62, 2048
  s_add_u32 s99, s90, 64
  buffer_load_dwordx4 v17, s[16:19], s99 offen  lds
  s_add_u32 m0, s62, 3072
  s_add_u32 s99, s90, 18496
  buffer_load_dwordx4 v17, s[16:19], s99 offen  lds
  s_add_u32 m0, s62, 4096
  s_add_u32 s99, s90, 128
  buffer_load_dwordx4 v17, s[16:19], s99 offen  lds
  s_add_u32 m0, s62, 5120
  s_add_u32 s99, s90, 18560
  buffer_load_dwordx4 v17, s[16:19], s99 offen  lds
  s_add_u32 m0, s62, 6144
  s_add_u32 s99, s90, 192
  buffer_load_dwordx4 v17, s[16:19], s99 offen  lds
  s_add_u32 m0, s62, 7168
  s_add_u32 s99, s90, 18624
  buffer_load_dwordx4 v17, s[16:19], s99 offen  lds
  s_add_u32 m0, s62, 8192
  s_add_u32 s99, s90, 36864
  buffer_load_dwordx4 v17, s[16:19], s99 offen  lds
  s_add_u32 m0, s62, 9216
  s_add_u32 s99, s90, 55296
  buffer_load_dwordx4 v17, s[16:19], s99 offen  lds
  s_add_u32 m0, s62, 10240
  s_add_u32 s99, s90, 36928
  buffer_load_dwordx4 v17, s[16:19], s99 offen  lds
  s_add_u32 m0, s62, 11264
  s_add_u32 s99, s90, 55360
  buffer_load_dwordx4 v17, s[16:19], s99 offen  lds
  s_add_u32 m0, s62, 12288
  s_add_u32 s99, s90, 36992
  buffer_load_dwordx4 v17, s[16:19], s99 offen  lds
  s_add_u32 m0, s62, 13312
  s_add_u32 s99, s90, 55424
  buffer_load_dwordx4 v17, s[16:19], s99 offen  lds
  s_add_u32 m0, s62, 14336
  s_add_u32 s99, s90, 37056
  buffer_load_dwordx4 v17, s[16:19], s99 offen  lds
  s_add_u32 m0, s62, 15360
  s_add_u32 s99, s90, 55488
  buffer_load_dwordx4 v17, s[16:19], s99 offen  lds
  s_add_u32 m0, s62, 16384
  s_add_u32 s99, s90, 73728
  buffer_load_dwordx4 v17, s[16:19], s99 offen  lds
  s_add_u32 m0, s62, 17408
  s_add_u32 s99, s90, 92160
  buffer_load_dwordx4 v17, s[16:19], s99 offen  lds
  s_add_u32 m0, s62, 18432
  s_add_u32 s99, s90, 73792
  buffer_load_dwordx4 v17, s[16:19], s99 offen  lds
  s_add_u32 m0, s62, 19456
  s_add_u32 s99, s90, 92224
  buffer_load_dwordx4 v17, s[16:19], s99 offen  lds
  s_add_u32 m0, s62, 20480
  s_add_u32 s99, s90, 73856
  buffer_load_dwordx4 v17, s[16:19], s99 offen  lds
  s_add_u32 m0, s62, 21504
  s_add_u32 s99, s90, 92288
  buffer_load_dwordx4 v17, s[16:19], s99 offen  lds
  s_add_u32 m0, s62, 22528
  s_add_u32 s99, s90, 73920
  buffer_load_dwordx4 v17, s[16:19], s99 offen  lds
  s_add_u32 m0, s62, 23552
  s_add_u32 s99, s90, 92352
  buffer_load_dwordx4 v17, s[16:19], s99 offen  lds
  s_add_u32 m0, s62, 24576
  s_add_u32 s99, s90, 110592
  buffer_load_dwordx4 v17, s[16:19], s99 offen  lds
  s_add_u32 m0, s62, 25600
  s_add_u32 s99, s90, 129024
  buffer_load_dwordx4 v17, s[16:19], s99 offen  lds
  s_add_u32 m0, s62, 26624
  s_add_u32 s99, s90, 110656
  buffer_load_dwordx4 v17, s[16:19], s99 offen  lds
  s_add_u32 m0, s62, 27648
  s_add_u32 s99, s90, 129088
  buffer_load_dwordx4 v17, s[16:19], s99 offen  lds
  s_add_u32 m0, s62, 28672
  s_add_u32 s99, s90, 110720
  buffer_load_dwordx4 v17, s[16:19], s99 offen  lds
  s_add_u32 m0, s62, 29696
  s_add_u32 s99, s90, 129152
  buffer_load_dwordx4 v17, s[16:19], s99 offen  lds
  s_add_u32 m0, s62, 30720
  s_add_u32 s99, s90, 110784
  buffer_load_dwordx4 v17, s[16:19], s99 offen  lds
  s_add_u32 m0, s62, 31744
  s_add_u32 s99, s90, 129216
  buffer_load_dwordx4 v17, s[16:19], s99 offen  lds
  s_add_u32 m0, s62, 32768
  s_add_u32 s99, s90, 147456
  buffer_load_dwordx4 v17, s[16:19], s99 offen  lds
  s_add_u32 m0, s62, 33792
  s_add_u32 s99, s90, 165888
  buffer_load_dwordx4 v17, s[16:19], s99 offen  lds
  s_add_u32 m0, s62, 34816
  s_add_u32 s99, s90, 147520
  buffer_load_dwordx4 v17, s[16:19], s99 offen  lds
  s_add_u32 m0, s62, 35840
  s_add_u32 s99, s90, 165952
  buffer_load_dwordx4 v17, s[16:19], s99 offen  lds
  s_add_u32 m0, s62, 36864
  s_add_u32 s99, s90, 147584
  buffer_load_dwordx4 v17, s[16:19], s99 offen  lds
  s_add_u32 m0, s62, 37888
  s_add_u32 s99, s90, 166016
  buffer_load_dwordx4 v17, s[16:19], s99 offen  lds
  s_waitcnt vmcnt(36)
  ds_read_b64_tr_b16 a[0:1], v18 offset:0
  ds_read_b64_tr_b16 a[2:3], v18 offset:256
  ds_read_b64_tr_b16 a[4:5], v19 offset:0
  ds_read_b64_tr_b16 a[6:7], v19 offset:256
  s_add_u32 m0, s62, 38912
  s_add_u32 s99, s90, 147648
  buffer_load_dwordx4 v17, s[16:19], s99 offen  lds
  s_add_u32 m0, s62, 39936
  s_add_u32 s99, s90, 166080
  buffer_load_dwordx4 v17, s[16:19], s99 offen  lds
  s_waitcnt vmcnt(36)
  ds_read_b64_tr_b16 a[8:9], v18 offset:2048
  ds_read_b64_tr_b16 a[10:11], v18 offset:2304
  ds_read_b64_tr_b16 a[12:13], v19 offset:2048
  ds_read_b64_tr_b16 a[14:15], v19 offset:2304
  s_waitcnt lgkmcnt(4)
  s_add_u32 m0, s62, 0
  s_add_u32 s99, s90, 184320
  buffer_load_dwordx4 v17, s[16:19], s99 offen  lds
  s_add_u32 m0, s62, 1024
  s_add_u32 s99, s90, 202752
  buffer_load_dwordx4 v17, s[16:19], s99 offen  lds
  s_waitcnt vmcnt(36)
  ds_read_b64_tr_b16 a[16:17], v18 offset:4096
  ds_read_b64_tr_b16 a[18:19], v18 offset:4352
  ds_read_b64_tr_b16 a[20:21], v19 offset:4096
  ds_read_b64_tr_b16 a[22:23], v19 offset:4352
  s_waitcnt lgkmcnt(4)
  s_add_u32 m0, s62, 2048
  s_add_u32 s99, s90, 184384
  buffer_load_dwordx4 v17, s[16:19], s99 offen  lds
  s_add_u32 m0, s62, 3072
  s_add_u32 s99, s90, 202816
  buffer_load_dwordx4 v17, s[16:19], s99 offen  lds
  s_waitcnt vmcnt(36)
  ds_read_b64_tr_b16 a[24:25], v18 offset:6144
  ds_read_b64_tr_b16 a[26:27], v18 offset:6400
  ds_read_b64_tr_b16 a[28:29], v19 offset:6144
  ds_read_b64_tr_b16 a[30:31], v19 offset:6400
  s_waitcnt lgkmcnt(4)
  s_add_u32 m0, s62, 4096
  s_add_u32 s99, s90, 184448
  buffer_load_dwordx4 v17, s[16:19], s99 offen  lds
  s_add_u32 m0, s62, 5120
  s_add_u32 s99, s90, 202880
  buffer_load_dwordx4 v17, s[16:19], s99 offen  lds
  s_waitcnt vmcnt(36)
  ds_read_b64_tr_b16 a[32:33], v18 offset:8192
  ds_read_b64_tr_b16 a[34:35], v18 offset:8448
  ds_read_b64_tr_b16 a[36:37], v19 offset:8192
  ds_read_b64_tr_b16 a[38:39], v19 offset:8448
  s_waitcnt lgkmcnt(4)
  s_add_u32 m0, s62, 6144
  s_add_u32 s99, s90, 184512
  buffer_load_dwordx4 v17, s[16:19], s99 offen  lds
  s_add_u32 m0, s62, 7168
  s_add_u32 s99, s90, 202944
  buffer_load_dwordx4 v17, s[16:19], s99 offen  lds
  s_waitcnt vmcnt(36)
  ds_read_b64_tr_b16 a[40:41], v18 offset:10240
  ds_read_b64_tr_b16 a[42:43], v18 offset:10496
  ds_read_b64_tr_b16 a[44:45], v19 offset:10240
  ds_read_b64_tr_b16 a[46:47], v19 offset:10496
  s_waitcnt lgkmcnt(4)
  s_add_u32 m0, s62, 8192
  s_add_u32 s99, s90, 221184
  buffer_load_dwordx4 v17, s[16:19], s99 offen  lds
  s_add_u32 m0, s62, 9216
  s_add_u32 s99, s90, 239616
  buffer_load_dwordx4 v17, s[16:19], s99 offen  lds
  s_waitcnt vmcnt(36)
  ds_read_b64_tr_b16 a[48:49], v18 offset:12288
  ds_read_b64_tr_b16 a[50:51], v18 offset:12544
  ds_read_b64_tr_b16 a[52:53], v19 offset:12288
  ds_read_b64_tr_b16 a[54:55], v19 offset:12544
  s_waitcnt lgkmcnt(4)
  s_add_u32 m0, s62, 10240
  s_add_u32 s99, s90, 221248
  buffer_load_dwordx4 v17, s[16:19], s99 offen  lds
  s_add_u32 m0, s62, 11264
  s_add_u32 s99, s90, 239680
  buffer_load_dwordx4 v17, s[16:19], s99 offen  lds
  s_waitcnt vmcnt(36)
  ds_read_b64_tr_b16 a[56:57], v18 offset:14336
  ds_read_b64_tr_b16 a[58:59], v18 offset:14592
  ds_read_b64_tr_b16 a[60:61], v19 offset:14336
  ds_read_b64_tr_b16 a[62:63], v19 offset:14592
  s_waitcnt lgkmcnt(4)
  s_add_u32 m0, s62, 12288
  s_add_u32 s99, s90, 221312
  buffer_load_dwordx4 v17, s[16:19], s99 offen  lds
  s_add_u32 m0, s62, 13312
  s_add_u32 s99, s90, 239744
  buffer_load_dwordx4 v17, s[16:19], s99 offen  lds
  s_waitcnt vmcnt(36)
  ds_read_b64_tr_b16 a[64:65], v18 offset:16384
  ds_read_b64_tr_b16 a[66:67], v18 offset:16640
  ds_read_b64_tr_b16 a[68:69], v19 offset:16384
  ds_read_b64_tr_b16 a[70:71], v19 offset:16640
  s_waitcnt lgkmcnt(4)
  s_add_u32 m0, s62, 14336
  s_add_u32 s99, s90, 221376
  buffer_load_dwordx4 v17, s[16:19], s99 offen  lds
  s_add_u32 m0, s62, 15360
  s_add_u32 s99, s90, 239808
  buffer_load_dwordx4 v17, s[16:19], s99 offen  lds
  s_waitcnt vmcnt(36)
  ds_read_b64_tr_b16 a[72:73], v18 offset:18432
  ds_read_b64_tr_b16 a[74:75], v18 offset:18688
  ds_read_b64_tr_b16 a[76:77], v19 offset:18432
  ds_read_b64_tr_b16 a[78:79], v19 offset:18688
  s_waitcnt lgkmcnt(4)
  s_add_u32 m0, s62, 16384
  s_add_u32 s99, s90, 258048
  buffer_load_dwordx4 v17, s[16:19], s99 offen  lds
  s_add_u32 m0, s62, 17408
  s_add_u32 s99, s90, 276480
  buffer_load_dwordx4 v17, s[16:19], s99 offen  lds
  s_waitcnt vmcnt(36)
  ds_read_b64_tr_b16 a[80:81], v18 offset:20480
  ds_read_b64_tr_b16 a[82:83], v18 offset:20736
  ds_read_b64_tr_b16 a[84:85], v19 offset:20480
  ds_read_b64_tr_b16 a[86:87], v19 offset:20736
  s_waitcnt lgkmcnt(4)
  s_add_u32 m0, s62, 18432
  s_add_u32 s99, s90, 258112
  buffer_load_dwordx4 v17, s[16:19], s99 offen  lds
  s_add_u32 m0, s62, 19456
  s_add_u32 s99, s90, 276544
  buffer_load_dwordx4 v17, s[16:19], s99 offen  lds
  s_waitcnt vmcnt(36)
  ds_read_b64_tr_b16 a[88:89], v18 offset:22528
  ds_read_b64_tr_b16 a[90:91], v18 offset:22784
  ds_read_b64_tr_b16 a[92:93], v19 offset:22528
  ds_read_b64_tr_b16 a[94:95], v19 offset:22784
  s_waitcnt lgkmcnt(4)
  s_add_u32 m0, s62, 20480
  s_add_u32 s99, s90, 258176
  buffer_load_dwordx4 v17, s[16:19], s99 offen  lds
  s_add_u32 m0, s62, 21504
  s_add_u32 s99, s90, 276608
  buffer_load_dwordx4 v17, s[16:19], s99 offen  lds
  s_waitcnt vmcnt(36)
  ds_read_b64_tr_b16 a[96:97], v18 offset:24576
  ds_read_b64_tr_b16 a[98:99], v18 offset:24832
  ds_read_b64_tr_b16 a[100:101], v19 offset:24576
  ds_read_b64_tr_b16 a[102:103], v19 offset:24832
  s_waitcnt lgkmcnt(4)
  s_add_u32 m0, s62, 22528
  s_add_u32 s99, s90, 258240
  buffer_load_dwordx4 v17, s[16:19], s99 offen  lds
  s_add_u32 m0, s62, 23552
  s_add_u32 s99, s90, 276672
  buffer_load_dwordx4 v17, s[16:19], s99 offen  lds
  s_waitcnt vmcnt(36)
  ds_read_b64_tr_b16 a[104:105], v18 offset:26624
  ds_read_b64_tr_b16 a[106:107], v18 offset:26880
  ds_read_b64_tr_b16 a[108:109], v19 offset:26624
  ds_read_b64_tr_b16 a[110:111], v19 offset:26880
  s_waitcnt vmcnt(34)
  ds_read_b64_tr_b16 a[112:113], v18 offset:28672
  ds_read_b64_tr_b16 a[114:115], v18 offset:28928
  ds_read_b64_tr_b16 a[116:117], v19 offset:28672
  ds_read_b64_tr_b16 a[118:119], v19 offset:28928
  s_waitcnt vmcnt(32)
  ds_read_b64_tr_b16 a[120:121], v18 offset:30720
  ds_read_b64_tr_b16 a[122:123], v18 offset:30976
  ds_read_b64_tr_b16 a[124:125], v19 offset:30720
  ds_read_b64_tr_b16 a[126:127], v19 offset:30976
  s_waitcnt vmcnt(30)
  ds_read_b64_tr_b16 a[128:129], v18 offset:32768
  ds_read_b64_tr_b16 a[130:131], v18 offset:33024
  ds_read_b64_tr_b16 a[132:133], v19 offset:32768
  ds_read_b64_tr_b16 a[134:135], v19 offset:33024
  s_waitcnt vmcnt(28)
  ds_read_b64_tr_b16 a[136:137], v18 offset:34816
  ds_read_b64_tr_b16 a[138:139], v18 offset:35072
  ds_read_b64_tr_b16 a[140:141], v19 offset:34816
  ds_read_b64_tr_b16 a[142:143], v19 offset:35072
  s_waitcnt vmcnt(26)
  ds_read_b64_tr_b16 a[144:145], v18 offset:36864
  ds_read_b64_tr_b16 a[146:147], v18 offset:37120
  ds_read_b64_tr_b16 a[148:149], v19 offset:36864
  ds_read_b64_tr_b16 a[150:151], v19 offset:37120
  s_waitcnt vmcnt(24)
  ds_read_b64_tr_b16 a[152:153], v18 offset:38912
  ds_read_b64_tr_b16 a[154:155], v18 offset:39168
  ds_read_b64_tr_b16 a[156:157], v19 offset:38912
  ds_read_b64_tr_b16 a[158:159], v19 offset:39168
  s_waitcnt vmcnt(22)
  ds_read_b64_tr_b16 a[160:161], v18 offset:0
  ds_read_b64_tr_b16 a[162:163], v18 offset:256
  ds_read_b64_tr_b16 a[164:165], v19 offset:0
  ds_read_b64_tr_b16 a[166:167], v19 offset:256
  s_waitcnt vmcnt(20)
  ds_read_b64_tr_b16 a[168:169], v18 offset:2048
  ds_read_b64_tr_b16 a[170:171], v18 offset:2304
  ds_read_b64_tr_b16 a[172:173], v19 offset:2048
  ds_read_b64_tr_b16 a[174:175], v19 offset:2304
  s_waitcnt vmcnt(18)
  ds_read_b64_tr_b16 a[176:177], v18 offset:4096
  ds_read_b64_tr_b16 a[178:179], v18 offset:4352
  ds_read_b64_tr_b16 a[180:181], v19 offset:4096
  ds_read_b64_tr_b16 a[182:183], v19 offset:4352
  s_waitcnt vmcnt(16)
  ds_read_b64_tr_b16 a[184:185], v18 offset:6144
  ds_read_b64_tr_b16 a[186:187], v18 offset:6400
  ds_read_b64_tr_b16 a[188:189], v19 offset:6144
  ds_read_b64_tr_b16 a[190:191], v19 offset:6400
  s_waitcnt vmcnt(14)
  ds_read_b64_tr_b16 a[192:193], v18 offset:8192
  ds_read_b64_tr_b16 a[194:195], v18 offset:8448
  ds_read_b64_tr_b16 a[196:197], v19 offset:8192
  ds_read_b64_tr_b16 a[198:199], v19 offset:8448
  s_waitcnt vmcnt(12)
  ds_read_b64_tr_b16 a[200:201], v18 offset:10240
  ds_read_b64_tr_b16 a[202:203], v18 offset:10496
  ds_read_b64_tr_b16 a[204:205], v19 offset:10240
  ds_read_b64_tr_b16 a[206:207], v19 offset:10496
  s_waitcnt vmcnt(10)
  ds_read_b64_tr_b16 a[208:209], v18 offset:12288
  ds_read_b64_tr_b16 a[210:211], v18 offset:12544
  ds_read_b64_tr_b16 a[212:213], v19 offset:12288
  ds_read_b64_tr_b16 a[214:215], v19 offset:12544
  s_waitcnt vmcnt(8)
  ds_read_b64_tr_b16 a[216:217], v18 offset:14336
  ds_read_b64_tr_b16 a[218:219], v18 offset:14592
  ds_read_b64_tr_b16 a[220:221], v19 offset:14336
  ds_read_b64_tr_b16 a[222:223], v19 offset:14592
  s_waitcnt vmcnt(6)
  ds_read_b64_tr_b16 a[224:225], v18 offset:16384
  ds_read_b64_tr_b16 a[226:227], v18 offset:16640
  ds_read_b64_tr_b16 a[228:229], v19 offset:16384
  ds_read_b64_tr_b16 a[230:231], v19 offset:16640
  s_waitcnt vmcnt(4)
  ds_read_b64_tr_b16 a[232:233], v18 offset:18432
  ds_read_b64_tr_b16 a[234:235], v18 offset:18688
  ds_read_b64_tr_b16 a[236:237], v19 offset:18432
  ds_read_b64_tr_b16 a[238:239], v19 offset:18688
  s_waitcnt vmcnt(2)
  ds_read_b64_tr_b16 a[240:241], v18 offset:20480
  ds_read_b64_tr_b16 a[242:243], v18 offset:20736
  ds_read_b64_tr_b16 a[244:245], v19 offset:20480
  ds_read_b64_tr_b16 a[246:247], v19 offset:20736
  s_waitcnt vmcnt(0)
  ds_read_b64_tr_b16 a[248:249], v18 offset:22528
  ds_read_b64_tr_b16 a[250:251], v18 offset:22784
  ds_read_b64_tr_b16 a[252:253], v19 offset:22528
  ds_read_b64_tr_b16 a[254:255], v19 offset:22784
  s_waitcnt lgkmcnt(0)
  s_barrier
  v_mov_b32 v24, 64
  s_mov_b64 exec, 1
L_wa_120:
  global_load_dword v25, v24, s[4:5] sc1
  s_waitcnt vmcnt(0)
  v_readfirstlane_b32 s98, v25
  s_nop 0
  s_cmp_ge_u32 s98, 256
  s_nop 1
  s_cbranch_scc1 L_wa_120d
  s_sleep 8
  s_sub_u32 s100, s100, 1
  s_cbranch_scc0 L_wa_120
  s_branch L_end
L_wa_120d:
  s_mov_b64 exec, -1
  s_mov_b32 s66, -1
  s_mov_b32 s67, 0
  v_mov_b32 v12, 0
  ds_write_b32 v8, v12
  s_lshl_b32 s45, s9, 9
  s_add_u32 s45, s45, 139520
  v_add_u32 v188, s45, v1
  v_mov_b32 v2, 0
  ds_write_b32 v188, v2
  ds_write_b32 v188, v2 offset:256
  s_mov_b32 s69, 0
  s_barrier
  ds_read_b128 v[72:75], v9 offset:16384
  ds_read_b128 v[76:79], v9 offset:17408
  ds_read_b128 v[104:107], v9 offset:0
  ds_read_b128 v[108:111], v9 offset:1024
  ds_read_b128 v[80:83], v9 offset:18432
  ds_read_b128 v[84:87], v9 offset:19456
  ds_read_b128 v[112:115], v9 offset:4096
  ds_read_b128 v[116:119], v9 offset:5120
  ds_read_b128 v[88:91], v9 offset:20480
  ds_read_b128 v[92:95], v9 offset:21504
  ds_read_b128 v[120:123], v9 offset:8192
  ds_read_b128 v[124:127], v9 offset:9216
  ds_read_b128 v[96:99], v9 offset:22528
  ds_read_b128 v[100:103], v9 offset:23552
  ds_read_b128 v[128:131], v9 offset:12288
  ds_read_b128 v[132:135], v9 offset:13312
  s_waitcnt lgkmcnt(13)
  v_mfma_f32_16x16x32_bf16 v[152:155], v[104:107], v[72:75], v[64:67]
  v_mfma_f32_16x16x32_bf16 v[160:163], v[104:107], v[76:79], 0
  s_waitcnt lgkmcnt(12)
  v_mfma_f32_16x16x32_bf16 v[164:167], v[108:111], v[76:79], v[64:67]
  s_waitcnt lgkmcnt(9)
  v_mfma_f32_16x16x32_bf16 v[152:155], v[112:115], v[80:83], v[152:155]
  v_mfma_f32_16x16x32_bf16 v[160:163], v[112:115], v[84:87], v[160:163]
  s_waitcnt lgkmcnt(8)
  v_mfma_f32_16x16x32_bf16 v[164:167], v[116:119], v[84:87], v[164:167]
  s_waitcnt lgkmcnt(5)
  v_mfma_f32_16x16x32_bf16 v[152:155], v[120:123], v[88:91], v[152:155]
  v_mfma_f32_16x16x32_bf16 v[160:163], v[120:123], v[92:95], v[160:163]
  s_waitcnt lgkmcnt(4)
  v_mfma_f32_16x16x32_bf16 v[164:167], v[124:127], v[92:95], v[164:167]
  s_waitcnt lgkmcnt(1)
  v_mfma_f32_16x16x32_bf16 v[152:155], v[128:131], v[96:99], v[152:155]
  v_mfma_f32_16x16x32_bf16 v[160:163], v[128:131], v[100:103], v[160:163]
  s_waitcnt lgkmcnt(0)
  v_mfma_f32_16x16x32_bf16 v[164:167], v[132:135], v[100:103], v[164:167]
  ds_read_b128 v[104:107], v9 offset:2048
  ds_read_b128 v[108:111], v9 offset:3072
  ds_read_b128 v[112:115], v9 offset:6144
  ds_read_b128 v[116:119], v9 offset:7168
  ds_read_b128 v[120:123], v9 offset:10240
  ds_read_b128 v[124:127], v9 offset:11264
  ds_read_b128 v[128:131], v9 offset:14336
  ds_read_b128 v[132:135], v9 offset:15360
L_awkp_121:
  s_mov_b64 exec, s[40:41]
  buffer_load_dword v2, v1, s[12:15], s65 offen sc1
  s_mov_b64 exec, -1
  s_add_u32 s98, s32, 1
  s_mov_b64 exec, s[40:41]
  s_waitcnt vmcnt(0)
  v_cmp_gt_u32 vcc, s98, v2
  s_mov_b64 exec, -1
  s_cbranch_vccz L_awkp_121d
  s_sleep 2
  s_sub_u32 s100, s100, 1
  s_cbranch_scc0 L_awkp_121
  s_branch L_end
L_awkp_121d:
  s_mov_b32 m0, s59
  s_nop 0
  buffer_load_dwordx4 v0, s[12:15], s64 offen offset:0 sc1 lds
  buffer_load_dwordx4 v0, s[12:15], s64 offen offset:1024 sc1 lds
  buffer_load_dwordx4 v0, s[12:15], s64 offen offset:2048 sc1 lds
  buffer_load_dwordx4 v0, s[12:15], s64 offen offset:3072 sc1 lds
  s_waitcnt vmcnt(0)
  ds_read2_b64 v[136:139], v10 offset0:0 offset1:16
  ds_read2_b64 v[140:143], v10 offset0:128 offset1:144
  ds_read2_b64 v[144:147], v4 offset0:0 offset1:16
  ds_read2_b64 v[148:151], v4 offset0:128 offset1:144
  s_waitcnt lgkmcnt(3)
  v_mfma_f32_16x16x32_bf16 v[156:159], v[136:139], v[72:75], v[68:71]
  v_mfma_f32_16x16x32_bf16 v[168:171], v[136:139], v[76:79], v[68:71]
  s_waitcnt lgkmcnt(2)
  v_mfma_f32_16x16x32_bf16 v[156:159], v[140:143], v[80:83], v[156:159]
  v_mfma_f32_16x16x32_bf16 v[168:171], v[140:143], v[84:87], v[168:171]
  s_waitcnt lgkmcnt(1)
  v_mfma_f32_16x16x32_bf16 v[156:159], v[144:147], v[88:91], v[156:159]
  v_mfma_f32_16x16x32_bf16 v[168:171], v[144:147], v[92:95], v[168:171]
  s_waitcnt lgkmcnt(0)
  v_mfma_f32_16x16x32_bf16 v[156:159], v[148:151], v[96:99], v[156:159]
  v_mfma_f32_16x16x32_bf16 v[168:171], v[148:151], v[100:103], v[168:171]
  ds_read2st64_b64 v[136:139], v11 offset0:0 offset1:1
  ds_read2st64_b64 v[140:143], v11 offset0:2 offset1:3
  ds_read2st64_b64 v[144:147], v11 offset0:4 offset1:5
  ds_read2st64_b64 v[148:151], v11 offset0:6 offset1:7
  v_max3_f32 v186, v160, v161, v162
  v_max3_f32 v184, v152, v153, v154
  v_max3_f32 v186, v186, v163, v164
  v_max3_f32 v184, v184, v155, v156
  v_max3_f32 v186, v186, v165, v166
  v_max3_f32 v184, v184, v157, v158
  v_max3_f32 v186, v186, v167, v168
  v_max_f32 v184, v184, v159
  v_max3_f32 v186, v186, v169, v170
  v_mov_b32 v185, v184
  v_max_f32 v186, v186, v171
  s_nop 0
  v_permlane16_swap_b32 v184, v185
  v_mov_b32 v187, v186
  v_max_f32 v184, v184, v185
  s_nop 0
  v_permlane16_swap_b32 v186, v187
  v_mov_b32 v185, v184
  v_max_f32 v186, v186, v187
  s_nop 0
  v_permlane32_swap_b32 v184, v185
  v_mov_b32 v187, v186
  v_max_f32 v184, v184, v185
  s_nop 0
  v_permlane32_swap_b32 v186, v187
  v_mul_f32 v184, s94, v184
  v_max_f32 v186, v186, v187
  v_pk_fma_f32 v[152:153], v[152:153], s[94:95], v[184:185] op_sel_hi:[1,1,0] neg_lo:[0,0,1] neg_hi:[0,0,1]
  v_mul_f32 v186, s94, v186
  v_pk_fma_f32 v[154:155], v[154:155], s[94:95], v[184:185] op_sel_hi:[1,1,0] neg_lo:[0,0,1] neg_hi:[0,0,1]
  v_pk_fma_f32 v[160:161], v[160:161], s[94:95], v[186:187] op_sel_hi:[1,1,0] neg_lo:[0,0,1] neg_hi:[0,0,1]
  v_pk_fma_f32 v[156:157], v[156:157], s[94:95], v[184:185] op_sel_hi:[1,1,0] neg_lo:[0,0,1] neg_hi:[0,0,1]
  v_pk_fma_f32 v[162:163], v[162:163], s[94:95], v[186:187] op_sel_hi:[1,1,0] neg_lo:[0,0,1] neg_hi:[0,0,1]
  v_pk_fma_f32 v[158:159], v[158:159], s[94:95], v[184:185] op_sel_hi:[1,1,0] neg_lo:[0,0,1] neg_hi:[0,0,1]
  v_pk_fma_f32 v[164:165], v[164:165], s[94:95], v[186:187] op_sel_hi:[1,1,0] neg_lo:[0,0,1] neg_hi:[0,0,1]
  v_exp_f32 v152, v152
  v_pk_fma_f32 v[166:167], v[166:167], s[94:95], v[186:187] op_sel_hi:[1,1,0] neg_lo:[0,0,1] neg_hi:[0,0,1]
  v_exp_f32 v153, v153
  v_pk_fma_f32 v[168:169], v[168:169], s[94:95], v[186:187] op_sel_hi:[1,1,0] neg_lo:[0,0,1] neg_hi:[0,0,1]
  v_exp_f32 v154, v154
  v_pk_fma_f32 v[170:171], v[170:171], s[94:95], v[186:187] op_sel_hi:[1,1,0] neg_lo:[0,0,1] neg_hi:[0,0,1]
  v_add_f32 v184, v152, v153
  v_exp_f32 v160, v160
  v_exp_f32 v155, v155
  v_exp_f32 v161, v161
  v_add_f32 v184, v184, v154
  v_exp_f32 v162, v162
  v_exp_f32 v156, v156
  v_add_f32 v186, v160, v161
  v_add_f32 v184, v184, v155
  v_exp_f32 v163, v163
  v_exp_f32 v157, v157
  v_add_f32 v186, v186, v162
  v_add_f32 v184, v184, v156
  v_exp_f32 v164, v164
  v_exp_f32 v158, v158
  v_add_f32 v186, v186, v163
  v_add_f32 v184, v184, v157
  v_exp_f32 v165, v165
  v_exp_f32 v159, v159
  v_add_f32 v186, v186, v164
  v_add_f32 v184, v184, v158
  v_exp_f32 v166, v166
  v_add_f32 v184, v184, v159
  v_add_f32 v186, v186, v165
  v_mov_b32 v185, v184
  v_exp_f32 v167, v167
  s_nop 0
  v_permlane16_swap_b32 v184, v185
  v_add_f32 v186, v186, v166
  v_add_f32 v184, v184, v185
  v_exp_f32 v168, v168
  v_mov_b32 v185, v184
  v_add_f32 v186, v186, v167
  s_nop 0
  v_permlane32_swap_b32 v184, v185
  v_exp_f32 v169, v169
  v_add_f32 v184, v184, v185
  v_add_f32 v186, v186, v168
  v_rcp_f32 v184, v184
  v_exp_f32 v170, v170
  v_pk_mul_f32 v[152:153], v[152:153], v[184:185] op_sel_hi:[1,0]
  v_add_f32 v186, v186, v169
  v_pk_mul_f32 v[154:155], v[154:155], v[184:185] op_sel_hi:[1,0]
  v_exp_f32 v171, v171
  v_pk_mul_f32 v[156:157], v[156:157], v[184:185] op_sel_hi:[1,0]
  v_add_f32 v186, v186, v170
  v_pk_mul_f32 v[158:159], v[158:159], v[184:185] op_sel_hi:[1,0]
  v_add_f32 v186, v186, v171
  v_cvt_pk_bf16_f32 v172, v152, v153
  v_mov_b32 v187, v186
  v_cvt_pk_bf16_f32 v173, v154, v155
  s_nop 0
  v_permlane16_swap_b32 v186, v187
  v_cvt_pk_bf16_f32 v174, v156, v157
  v_add_f32 v186, v186, v187
  v_cvt_pk_bf16_f32 v175, v158, v159
  v_mov_b32 v187, v186
  s_nop 1
  v_permlane32_swap_b32 v186, v187
  v_add_f32 v186, v186, v187
  v_rcp_f32 v186, v186
  s_nop 0
  v_pk_mul_f32 v[160:161], v[160:161], v[186:187] op_sel_hi:[1,0]
  v_pk_mul_f32 v[162:163], v[162:163], v[186:187] op_sel_hi:[1,0]
  v_pk_mul_f32 v[164:165], v[164:165], v[186:187] op_sel_hi:[1,0]
  v_pk_mul_f32 v[166:167], v[166:167], v[186:187] op_sel_hi:[1,0]
  v_pk_mul_f32 v[168:169], v[168:169], v[186:187] op_sel_hi:[1,0]
  v_pk_mul_f32 v[170:171], v[170:171], v[186:187] op_sel_hi:[1,0]
  v_cvt_pk_bf16_f32 v176, v160, v161
  v_cvt_pk_bf16_f32 v177, v162, v163
  v_cvt_pk_bf16_f32 v178, v164, v165
  v_cvt_pk_bf16_f32 v179, v166, v167
  v_cvt_pk_bf16_f32 v180, v168, v169
  v_cvt_pk_bf16_f32 v181, v170, v171
  v_mfma_f32_16x16x16_bf16 v[192:195], v[104:105], v[172:173], 0
  v_mfma_f32_16x16x16_bf16 v[196:199], v[108:109], v[172:173], 0
  v_mfma_f32_16x16x16_bf16 v[200:203], v[112:113], v[172:173], 0
  v_mfma_f32_16x16x16_bf16 v[204:207], v[116:117], v[172:173], 0
  v_mfma_f32_16x16x16_bf16 v[208:211], v[120:121], v[172:173], 0
  v_mfma_f32_16x16x16_bf16 v[212:215], v[124:125], v[172:173], 0
  v_mfma_f32_16x16x16_bf16 v[216:219], v[128:129], v[172:173], 0
  v_mfma_f32_16x16x16_bf16 v[220:223], v[132:133], v[172:173], 0
  v_mfma_f32_16x16x32_bf16 v[224:227], v[104:107], v[176:179], 0
  v_mfma_f32_16x16x32_bf16 v[228:231], v[108:111], v[176:179], 0
  v_mfma_f32_16x16x32_bf16 v[232:235], v[112:115], v[176:179], 0
  v_mfma_f32_16x16x32_bf16 v[236:239], v[116:119], v[176:179], 0
  v_mfma_f32_16x16x32_bf16 v[240:243], v[120:123], v[176:179], 0
  v_mfma_f32_16x16x32_bf16 v[244:247], v[124:127], v[176:179], 0
  v_mfma_f32_16x16x32_bf16 v[248:251], v[128:131], v[176:179], 0
  v_mfma_f32_16x16x32_bf16 v[252:255], v[132:135], v[176:179], 0
  s_waitcnt lgkmcnt(3)
  v_mfma_f32_16x16x16_bf16 v[192:195], v[136:137], v[174:175], v[192:195]
  v_mfma_f32_16x16x16_bf16 v[196:199], v[138:139], v[174:175], v[196:199]
  s_waitcnt lgkmcnt(2)
  v_mfma_f32_16x16x16_bf16 v[200:203], v[140:141], v[174:175], v[200:203]
  v_mfma_f32_16x16x16_bf16 v[204:207], v[142:143], v[174:175], v[204:207]
  s_waitcnt lgkmcnt(1)
  v_mfma_f32_16x16x16_bf16 v[208:211], v[144:145], v[174:175], v[208:211]
  v_mfma_f32_16x16x16_bf16 v[212:215], v[146:147], v[174:175], v[212:215]
  s_nop 0
  v_cvt_pk_bf16_f32 v192, v192, v193
  v_cvt_pk_bf16_f32 v193, v194, v195
  v_cvt_pk_bf16_f32 v194, v196, v197
  s_waitcnt lgkmcnt(0)
  v_mfma_f32_16x16x16_bf16 v[216:219], v[148:149], v[174:175], v[216:219]
  v_cvt_pk_bf16_f32 v195, v198, v199
  ds_write_b128 v7, v[192:195] offset:0
  v_mfma_f32_16x16x16_bf16 v[220:223], v[150:151], v[174:175], v[220:223]
  v_cvt_pk_bf16_f32 v200, v200, v201
  v_cvt_pk_bf16_f32 v201, v202, v203
  v_cvt_pk_bf16_f32 v202, v204, v205
  v_mfma_f32_16x16x16_bf16 v[224:227], v[136:137], v[180:181], v[224:227]
  v_cvt_pk_bf16_f32 v203, v206, v207
  ds_write_b128 v7, v[200:203] offset:2048
  v_mfma_f32_16x16x16_bf16 v[228:231], v[138:139], v[180:181], v[228:231]
  v_cvt_pk_bf16_f32 v208, v208, v209
  v_cvt_pk_bf16_f32 v209, v210, v211
  v_cvt_pk_bf16_f32 v210, v212, v213
  v_mfma_f32_16x16x16_bf16 v[232:235], v[140:141], v[180:181], v[232:235]
  v_cvt_pk_bf16_f32 v211, v214, v215
  ds_write_b128 v7, v[208:211] offset:4096
  v_mfma_f32_16x16x16_bf16 v[236:239], v[142:143], v[180:181], v[236:239]
  v_cvt_pk_bf16_f32 v216, v216, v217
  v_cvt_pk_bf16_f32 v217, v218, v219
  v_cvt_pk_bf16_f32 v218, v220, v221
  v_mfma_f32_16x16x16_bf16 v[240:243], v[144:145], v[180:181], v[240:243]
  v_cvt_pk_bf16_f32 v219, v222, v223
  ds_write_b128 v7, v[216:219] offset:6144
  v_mfma_f32_16x16x16_bf16 v[244:247], v[146:147], v[180:181], v[244:247]
  v_cvt_pk_bf16_f32 v224, v224, v225
  v_cvt_pk_bf16_f32 v225, v226, v227
  v_cvt_pk_bf16_f32 v226, v228, v229
  v_mfma_f32_16x16x16_bf16 v[248:251], v[148:149], v[180:181], v[248:251]
  v_cvt_pk_bf16_f32 v227, v230, v231
  ds_write_b128 v7, v[224:227] offset:1024
  v_mfma_f32_16x16x16_bf16 v[252:255], v[150:151], v[180:181], v[252:255]
  v_cvt_pk_bf16_f32 v232, v232, v233
  v_cvt_pk_bf16_f32 v233, v234, v235
  v_cvt_pk_bf16_f32 v234, v236, v237
  v_cvt_pk_bf16_f32 v235, v238, v239
  ds_write_b128 v7, v[232:235] offset:3072
  v_cvt_pk_bf16_f32 v240, v240, v241
  v_cvt_pk_bf16_f32 v241, v242, v243
  v_cvt_pk_bf16_f32 v242, v244, v245
  v_cvt_pk_bf16_f32 v243, v246, v247
  ds_write_b128 v7, v[240:243] offset:5120
  v_cvt_pk_bf16_f32 v248, v248, v249
  v_cvt_pk_bf16_f32 v249, v250, v251
  v_cvt_pk_bf16_f32 v250, v252, v253
  v_cvt_pk_bf16_f32 v251, v254, v255
  ds_write_b128 v7, v[248:251] offset:7168
  v_add_u32 v9, s42, v9
  s_sub_u32 s42, 0, s42
  s_add_u32 s64, s64, 131072
  v_xor_b32 v7, 0x4000, v7
  v_mov_b32 v5, 0
L_awG_loop:
  s_waitcnt lgkmcnt(0)
  s_barrier
  s_bfe_u32 s63, s32, 65537
  ds_read_b128 v[32:35], v6 offset:0
  ds_read_b128 v[36:39], v6 offset:2048
  ds_read_b128 v[40:43], v6 offset:4096
  ds_read_b128 v[44:47], v6 offset:6144
  ds_read_b128 v[48:51], v6 offset:8192
  ds_read_b128 v[52:55], v6 offset:10240
  ds_read_b128 v[56:59], v6 offset:12288
  ds_read_b128 v[60:63], v6 offset:14336
  ds_read_b32 v2, v188
  s_waitcnt lgkmcnt(8)
  v_mfma_f32_16x16x32_bf16 v[16:19], a[0:3], v[32:35], 0
  s_mov_b64 exec, s[66:67]
  buffer_load_dword v5, v1, s[12:15], s93 offen sc1
  s_mov_b64 exec, -1
  v_mfma_f32_16x16x32_bf16 v[20:23], a[4:7], v[32:35], 0
  s_waitcnt lgkmcnt(7)
  v_mfma_f32_16x16x32_bf16 v[16:19], a[32:35], v[36:39], v[16:19]
  s_add_u32 s98, s32, 2
  s_mov_b64 exec, s[40:41]
  s_waitcnt lgkmcnt(0)
  v_cmp_gt_u32 vcc, s98, v2
  s_mov_b64 exec, -1
  s_cmp_eq_u64 vcc, 0
  s_cselect_b32 s68, -1, 0
  s_cmp_eq_u32 s32, 63
  s_cselect_b32 s68, 0, s68
  s_cmp_lg_u32 s68, 0
  s_cbranch_scc1 L_awG_b0
  v_mfma_f32_16x16x32_bf16 v[20:23], a[36:39], v[36:39], v[20:23]
  s_mov_b32 m0, s45
  v_mfma_f32_16x16x32_bf16 v[16:19], a[64:67], v[40:43], v[16:19]
  s_mov_b64 exec, s[40:41]
  buffer_load_dword v1, s[12:15], s65 offen sc1 lds
  s_mov_b64 exec, -1
  v_mfma_f32_16x16x32_bf16 v[20:23], a[68:71], v[40:43], v[20:23]
  ds_read_b128 v[72:75], v9 offset:16384
  ds_read_b128 v[76:79], v9 offset:17408
  v_mfma_f32_16x16x32_bf16 v[16:19], a[96:99], v[44:47], v[16:19]
  ds_read_b128 v[104:107], v9 offset:0
  ds_read_b128 v[108:111], v9 offset:1024
  v_mfma_f32_16x16x32_bf16 v[20:23], a[100:103], v[44:47], v[20:23]
  ds_read_b128 v[80:83], v9 offset:18432
  ds_read_b128 v[84:87], v9 offset:19456
  v_mfma_f32_16x16x32_bf16 v[16:19], a[128:131], v[48:51], v[16:19]
  ds_read_b128 v[112:115], v9 offset:4096
  ds_read_b128 v[116:119], v9 offset:5120
  v_mfma_f32_16x16x32_bf16 v[20:23], a[132:135], v[48:51], v[20:23]
  ds_read_b128 v[88:91], v9 offset:20480
  ds_read_b128 v[92:95], v9 offset:21504
  v_mfma_f32_16x16x32_bf16 v[16:19], a[160:163], v[52:55], v[16:19]
  ds_read_b128 v[120:123], v9 offset:8192
  ds_read_b128 v[124:127], v9 offset:9216
  v_mfma_f32_16x16x32_bf16 v[20:23], a[164:167], v[52:55], v[20:23]
  ds_read_b128 v[96:99], v9 offset:22528
  ds_read_b128 v[100:103], v9 offset:23552
  v_mfma_f32_16x16x32_bf16 v[16:19], a[192:195], v[56:59], v[16:19]
  ds_read_b128 v[128:131], v9 offset:12288
  ds_read_b128 v[132:135], v9 offset:13312
  v_mfma_f32_16x16x32_bf16 v[20:23], a[196:199], v[56:59], v[20:23]
  v_mfma_f32_16x16x32_bf16 v[16:19], a[224:227], v[60:63], v[16:19]
  s_waitcnt lgkmcnt(13)
  v_mfma_f32_16x16x32_bf16 v[152:155], v[104:107], v[72:75], v[64:67]
  v_mfma_f32_16x16x32_bf16 v[20:23], a[228:231], v[60:63], v[20:23]
  v_mfma_f32_16x16x32_bf16 v[160:163], v[104:107], v[76:79], 0
  v_mfma_f32_16x16x32_bf16 v[24:27], a[8:11], v[32:35], 0
  s_waitcnt lgkmcnt(12)
  v_mfma_f32_16x16x32_bf16 v[164:167], v[108:111], v[76:79], v[64:67]
  v_mfma_f32_16x16x32_bf16 v[28:31], a[12:15], v[32:35], 0
  s_waitcnt lgkmcnt(9)
  v_mfma_f32_16x16x32_bf16 v[152:155], v[112:115], v[80:83], v[152:155]
  v_mfma_f32_16x16x32_bf16 v[24:27], a[40:43], v[36:39], v[24:27]
L_bpc_122:
  s_sub_i32 s98, s32, 1
  s_mov_b64 exec, s[66:67]
  s_waitcnt vmcnt(1)
  v_cmp_gt_i32 vcc, s98, v5
  s_mov_b64 exec, -1
  s_cbranch_vccnz L_bpr_123
  v_mfma_f32_16x16x32_bf16 v[160:163], v[112:115], v[84:87], v[160:163]
  v_cvt_pk_bf16_f32 v16, v16, v17
  v_cvt_pk_bf16_f32 v17, v18, v19
  v_mfma_f32_16x16x32_bf16 v[28:31], a[44:47], v[36:39], v[28:31]
  v_cvt_pk_bf16_f32 v18, v20, v21
  v_cvt_pk_bf16_f32 v19, v22, v23
  s_waitcnt lgkmcnt(8)
  v_mfma_f32_16x16x32_bf16 v[164:167], v[116:119], v[84:87], v[164:167]
  v_bfi_b32 v16, 1, s63, v16
  v_bfi_b32 v18, 1, s63, v18
  v_mfma_f32_16x16x32_bf16 v[24:27], a[72:75], v[40:43], v[24:27]
  s_waitcnt lgkmcnt(5)
  v_mfma_f32_16x16x32_bf16 v[152:155], v[120:123], v[88:91], v[152:155]
  v_mfma_f32_16x16x32_bf16 v[28:31], a[76:79], v[40:43], v[28:31]
  v_mfma_f32_16x16x32_bf16 v[160:163], v[120:123], v[92:95], v[160:163]
  v_mfma_f32_16x16x32_bf16 v[24:27], a[104:107], v[44:47], v[24:27]
  buffer_store_dwordx4 v[16:19], v0, s[12:15], s46 offen offset:0
  s_waitcnt lgkmcnt(4)
  v_mfma_f32_16x16x32_bf16 v[164:167], v[124:127], v[92:95], v[164:167]
  v_mfma_f32_16x16x32_bf16 v[28:31], a[108:111], v[44:47], v[28:31]
  ds_read_b128 v[104:107], v9 offset:2048
  ds_read_b128 v[108:111], v9 offset:3072
  s_waitcnt lgkmcnt(3)
  v_mfma_f32_16x16x32_bf16 v[152:155], v[128:131], v[96:99], v[152:155]
  ds_read_b128 v[112:115], v9 offset:6144
  ds_read_b128 v[116:119], v9 offset:7168
  v_mfma_f32_16x16x32_bf16 v[24:27], a[136:139], v[48:51], v[24:27]
  ds_read_b128 v[120:123], v9 offset:10240
  ds_read_b128 v[124:127], v9 offset:11264
  v_mfma_f32_16x16x32_bf16 v[160:163], v[128:131], v[100:103], v[160:163]
  ds_read_b128 v[128:131], v9 offset:14336
  v_mfma_f32_16x16x32_bf16 v[28:31], a[140:143], v[48:51], v[28:31]
  s_waitcnt lgkmcnt(7)
  v_mfma_f32_16x16x32_bf16 v[164:167], v[132:135], v[100:103], v[164:167]
  ds_read_b128 v[132:135], v9 offset:15360
  v_mfma_f32_16x16x32_bf16 v[24:27], a[168:171], v[52:55], v[24:27]
  v_mfma_f32_16x16x32_bf16 v[28:31], a[172:175], v[52:55], v[28:31]
  v_mfma_f32_16x16x32_bf16 v[24:27], a[200:203], v[56:59], v[24:27]
  v_mfma_f32_16x16x32_bf16 v[28:31], a[204:207], v[56:59], v[28:31]
  v_mfma_f32_16x16x32_bf16 v[24:27], a[232:235], v[60:63], v[24:27]
  v_mfma_f32_16x16x32_bf16 v[28:31], a[236:239], v[60:63], v[28:31]
  v_mfma_f32_16x16x32_bf16 v[16:19], a[16:19], v[32:35], 0
  s_nop 5
  v_cvt_pk_bf16_f32 v24, v24, v25
  v_cvt_pk_bf16_f32 v25, v26, v27
  v_mfma_f32_16x16x32_bf16 v[20:23], a[20:23], v[32:35], 0
  ds_read_b32 v2, v188
  v_cvt_pk_bf16_f32 v26, v28, v29
  v_cvt_pk_bf16_f32 v27, v30, v31
  v_mfma_f32_16x16x32_bf16 v[16:19], a[48:51], v[36:39], v[16:19]
  v_bfi_b32 v24, 1, s63, v24
  v_bfi_b32 v26, 1, s63, v26
  v_mfma_f32_16x16x32_bf16 v[20:23], a[52:55], v[36:39], v[20:23]
  v_mfma_f32_16x16x32_bf16 v[16:19], a[80:83], v[40:43], v[16:19]
  v_mfma_f32_16x16x32_bf16 v[20:23], a[84:87], v[40:43], v[20:23]
  v_mfma_f32_16x16x32_bf16 v[16:19], a[112:115], v[44:47], v[16:19]
  buffer_store_dwordx4 v[24:27], v0, s[12:15], s46 offen offset:2048
  v_mfma_f32_16x16x32_bf16 v[20:23], a[116:119], v[44:47], v[20:23]
  s_add_u32 s98, s32, 2
  v_mfma_f32_16x16x32_bf16 v[16:19], a[144:147], v[48:51], v[16:19]
  s_mov_b64 exec, s[40:41]
  s_waitcnt lgkmcnt(0)
  v_cmp_gt_u32 vcc, s98, v2
  s_mov_b64 exec, -1
  s_cmp_eq_u64 vcc, 0
  s_cselect_b32 s68, -1, 0
  s_cmp_eq_u32 s32, 63
  s_cselect_b32 s68, 0, s68
  s_cmp_lg_u32 s68, 0
  s_cbranch_scc1 L_awG_b1
  v_mfma_f32_16x16x32_bf16 v[20:23], a[148:151], v[48:51], v[20:23]
  s_mov_b32 m0, s45
  v_mfma_f32_16x16x32_bf16 v[16:19], a[176:179], v[52:55], v[16:19]
  s_mov_b64 exec, s[40:41]
  buffer_load_dword v1, s[12:15], s65 offen sc1 lds
  s_mov_b64 exec, -1
  v_mfma_f32_16x16x32_bf16 v[20:23], a[180:183], v[52:55], v[20:23]
  v_mfma_f32_16x16x32_bf16 v[16:19], a[208:211], v[56:59], v[16:19]
  v_mfma_f32_16x16x32_bf16 v[20:23], a[212:215], v[56:59], v[20:23]
  v_mfma_f32_16x16x32_bf16 v[16:19], a[240:243], v[60:63], v[16:19]
  v_mfma_f32_16x16x32_bf16 v[20:23], a[244:247], v[60:63], v[20:23]
  v_mfma_f32_16x16x32_bf16 v[24:27], a[24:27], v[32:35], 0
  v_mfma_f32_16x16x32_bf16 v[28:31], a[28:31], v[32:35], 0
  ds_read_b128 v[32:35], v6 offset:1024
  s_nop 3
  v_cvt_pk_bf16_f32 v16, v16, v17
  v_cvt_pk_bf16_f32 v17, v18, v19
  v_mfma_f32_16x16x32_bf16 v[24:27], a[56:59], v[36:39], v[24:27]
  v_mfma_f32_16x16x32_bf16 v[28:31], a[60:63], v[36:39], v[28:31]
  ds_read_b128 v[36:39], v6 offset:3072
  v_cvt_pk_bf16_f32 v18, v20, v21
  v_cvt_pk_bf16_f32 v19, v22, v23
  v_mfma_f32_16x16x32_bf16 v[24:27], a[88:91], v[40:43], v[24:27]
  v_bfi_b32 v16, 1, s63, v16
  v_bfi_b32 v18, 1, s63, v18
  v_mfma_f32_16x16x32_bf16 v[28:31], a[92:95], v[40:43], v[28:31]
  ds_read_b128 v[40:43], v6 offset:5120
  v_mfma_f32_16x16x32_bf16 v[24:27], a[120:123], v[44:47], v[24:27]
  buffer_store_dwordx4 v[16:19], v0, s[12:15], s47 offen offset:0
  v_mfma_f32_16x16x32_bf16 v[28:31], a[124:127], v[44:47], v[28:31]
  ds_read_b128 v[44:47], v6 offset:7168
  v_mfma_f32_16x16x32_bf16 v[24:27], a[152:155], v[48:51], v[24:27]
  v_mfma_f32_16x16x32_bf16 v[28:31], a[156:159], v[48:51], v[28:31]
  ds_read_b128 v[48:51], v6 offset:9216
  v_mfma_f32_16x16x32_bf16 v[24:27], a[184:187], v[52:55], v[24:27]
  v_mfma_f32_16x16x32_bf16 v[28:31], a[188:191], v[52:55], v[28:31]
  ds_read_b128 v[52:55], v6 offset:11264
  v_mfma_f32_16x16x32_bf16 v[24:27], a[216:219], v[56:59], v[24:27]
  v_mfma_f32_16x16x32_bf16 v[28:31], a[220:223], v[56:59], v[28:31]
  ds_read_b128 v[56:59], v6 offset:13312
  v_mfma_f32_16x16x32_bf16 v[24:27], a[248:251], v[60:63], v[24:27]
  v_mfma_f32_16x16x32_bf16 v[28:31], a[252:255], v[60:63], v[28:31]
  ds_read_b128 v[60:63], v6 offset:15360
  v_xor_b32 v6, 0x4000, v6
  s_waitcnt lgkmcnt(7)
  v_mfma_f32_16x16x32_bf16 v[16:19], a[0:3], v[32:35], 0
  s_nop 2
  v_cvt_pk_bf16_f32 v24, v24, v25
  v_cvt_pk_bf16_f32 v25, v26, v27
  v_mfma_f32_16x16x32_bf16 v[20:23], a[4:7], v[32:35], 0
  v_cvt_pk_bf16_f32 v26, v28, v29
  v_cvt_pk_bf16_f32 v27, v30, v31
  s_waitcnt lgkmcnt(6)
  v_mfma_f32_16x16x32_bf16 v[16:19], a[32:35], v[36:39], v[16:19]
  v_bfi_b32 v24, 1, s63, v24
  v_bfi_b32 v26, 1, s63, v26
  v_mfma_f32_16x16x32_bf16 v[20:23], a[36:39], v[36:39], v[20:23]
  s_waitcnt lgkmcnt(5)
  v_mfma_f32_16x16x32_bf16 v[16:19], a[64:67], v[40:43], v[16:19]
  v_mfma_f32_16x16x32_bf16 v[20:23], a[68:71], v[40:43], v[20:23]
  s_waitcnt lgkmcnt(4)
  v_mfma_f32_16x16x32_bf16 v[16:19], a[96:99], v[44:47], v[16:19]
  buffer_store_dwordx4 v[24:27], v0, s[12:15], s47 offen offset:2048
  v_mfma_f32_16x16x32_bf16 v[20:23], a[100:103], v[44:47], v[20:23]
  s_waitcnt lgkmcnt(3)
  v_mfma_f32_16x16x32_bf16 v[16:19], a[128:131], v[48:51], v[16:19]
  v_mfma_f32_16x16x32_bf16 v[20:23], a[132:135], v[48:51], v[20:23]
  s_waitcnt lgkmcnt(2)
  v_mfma_f32_16x16x32_bf16 v[16:19], a[160:163], v[52:55], v[16:19]
  v_mfma_f32_16x16x32_bf16 v[20:23], a[164:167], v[52:55], v[20:23]
  s_waitcnt lgkmcnt(1)
  v_mfma_f32_16x16x32_bf16 v[16:19], a[192:195], v[56:59], v[16:19]
  v_mfma_f32_16x16x32_bf16 v[20:23], a[196:199], v[56:59], v[20:23]
  s_waitcnt lgkmcnt(0)
  v_mfma_f32_16x16x32_bf16 v[16:19], a[224:227], v[60:63], v[16:19]
  v_mfma_f32_16x16x32_bf16 v[20:23], a[228:231], v[60:63], v[20:23]
  v_mfma_f32_16x16x32_bf16 v[24:27], a[8:11], v[32:35], 0
  s_nop 5
  v_cvt_pk_bf16_f32 v16, v16, v17
  v_cvt_pk_bf16_f32 v17, v18, v19
  v_mfma_f32_16x16x32_bf16 v[28:31], a[12:15], v[32:35], 0
  v_cvt_pk_bf16_f32 v18, v20, v21
  v_cvt_pk_bf16_f32 v19, v22, v23
  v_mfma_f32_16x16x32_bf16 v[24:27], a[40:43], v[36:39], v[24:27]
  v_bfi_b32 v16, 1, s63, v16
  v_bfi_b32 v18, 1, s63, v18
  v_mfma_f32_16x16x32_bf16 v[28:31], a[44:47], v[36:39], v[28:31]
  v_mfma_f32_16x16x32_bf16 v[24:27], a[72:75], v[40:43], v[24:27]
  v_mfma_f32_16x16x32_bf16 v[28:31], a[76:79], v[40:43], v[28:31]
  v_mfma_f32_16x16x32_bf16 v[24:27], a[104:107], v[44:47], v[24:27]
  buffer_store_dwordx4 v[16:19], v0, s[12:15], s46 offen offset:1024
  v_mfma_f32_16x16x32_bf16 v[28:31], a[108:111], v[44:47], v[28:31]
  v_mfma_f32_16x16x32_bf16 v[24:27], a[136:139], v[48:51], v[24:27]
  v_mfma_f32_16x16x32_bf16 v[28:31], a[140:143], v[48:51], v[28:31]
  v_mfma_f32_16x16x32_bf16 v[24:27], a[168:171], v[52:55], v[24:27]
  v_mfma_f32_16x16x32_bf16 v[28:31], a[172:175], v[52:55], v[28:31]
  v_mfma_f32_16x16x32_bf16 v[24:27], a[200:203], v[56:59], v[24:27]
  s_mov_b32 m0, s45
  v_mfma_f32_16x16x32_bf16 v[28:31], a[204:207], v[56:59], v[28:31]
  v_mfma_f32_16x16x32_bf16 v[24:27], a[232:235], v[60:63], v[24:27]
  v_mfma_f32_16x16x32_bf16 v[28:31], a[236:239], v[60:63], v[28:31]
  v_mfma_f32_16x16x32_bf16 v[16:19], a[16:19], v[32:35], 0
  v_mfma_f32_16x16x32_bf16 v[20:23], a[20:23], v[32:35], 0
  v_mfma_f32_16x16x32_bf16 v[16:19], a[48:51], v[36:39], v[16:19]
  s_mov_b64 exec, s[40:41]
  buffer_load_dword v1, s[12:15], s65 offen sc1 lds
  s_mov_b64 exec, -1
  v_mfma_f32_16x16x32_bf16 v[20:23], a[52:55], v[36:39], v[20:23]
  v_cvt_pk_bf16_f32 v24, v24, v25
  v_cvt_pk_bf16_f32 v25, v26, v27
  v_mfma_f32_16x16x32_bf16 v[16:19], a[80:83], v[40:43], v[16:19]
  v_cvt_pk_bf16_f32 v26, v28, v29
  v_cvt_pk_bf16_f32 v27, v30, v31
  v_mfma_f32_16x16x32_bf16 v[20:23], a[84:87], v[40:43], v[20:23]
  v_bfi_b32 v24, 1, s63, v24
  v_bfi_b32 v26, 1, s63, v26
  v_mfma_f32_16x16x32_bf16 v[16:19], a[112:115], v[44:47], v[16:19]
  buffer_store_dwordx4 v[24:27], v0, s[12:15], s46 offen offset:3072
  v_mfma_f32_16x16x32_bf16 v[20:23], a[116:119], v[44:47], v[20:23]
  v_mfma_f32_16x16x32_bf16 v[16:19], a[144:147], v[48:51], v[16:19]
  v_mfma_f32_16x16x32_bf16 v[20:23], a[148:151], v[48:51], v[20:23]
  v_mfma_f32_16x16x32_bf16 v[16:19], a[176:179], v[52:55], v[16:19]
  v_mfma_f32_16x16x32_bf16 v[20:23], a[180:183], v[52:55], v[20:23]
  v_mfma_f32_16x16x32_bf16 v[16:19], a[208:211], v[56:59], v[16:19]
  v_mfma_f32_16x16x32_bf16 v[20:23], a[212:215], v[56:59], v[20:23]
  v_mfma_f32_16x16x32_bf16 v[16:19], a[240:243], v[60:63], v[16:19]
  v_mfma_f32_16x16x32_bf16 v[20:23], a[244:247], v[60:63], v[20:23]
  v_mfma_f32_16x16x32_bf16 v[24:27], a[24:27], v[32:35], 0
  s_nop 5
  v_cvt_pk_bf16_f32 v16, v16, v17
  v_cvt_pk_bf16_f32 v17, v18, v19
  v_mfma_f32_16x16x32_bf16 v[28:31], a[28:31], v[32:35], 0
  v_cvt_pk_bf16_f32 v18, v20, v21
  v_cvt_pk_bf16_f32 v19, v22, v23
  v_mfma_f32_16x16x32_bf16 v[24:27], a[56:59], v[36:39], v[24:27]
  v_bfi_b32 v16, 1, s63, v16
  v_bfi_b32 v18, 1, s63, v18
  v_mfma_f32_16x16x32_bf16 v[28:31], a[60:63], v[36:39], v[28:31]
  v_mfma_f32_16x16x32_bf16 v[24:27], a[88:91], v[40:43], v[24:27]
  v_mfma_f32_16x16x32_bf16 v[28:31], a[92:95], v[40:43], v[28:31]
  v_mfma_f32_16x16x32_bf16 v[24:27], a[120:123], v[44:47], v[24:27]
  buffer_store_dwordx4 v[16:19], v0, s[12:15], s47 offen offset:1024
  v_mfma_f32_16x16x32_bf16 v[28:31], a[124:127], v[44:47], v[28:31]
  v_mfma_f32_16x16x32_bf16 v[24:27], a[152:155], v[48:51], v[24:27]
  v_mfma_f32_16x16x32_bf16 v[28:31], a[156:159], v[48:51], v[28:31]
  v_mfma_f32_16x16x32_bf16 v[24:27], a[184:187], v[52:55], v[24:27]
  v_mfma_f32_16x16x32_bf16 v[28:31], a[188:191], v[52:55], v[28:31]
  v_mfma_f32_16x16x32_bf16 v[24:27], a[216:219], v[56:59], v[24:27]
  v_mfma_f32_16x16x32_bf16 v[28:31], a[220:223], v[56:59], v[28:31]
  v_mfma_f32_16x16x32_bf16 v[24:27], a[248:251], v[60:63], v[24:27]
  v_mfma_f32_16x16x32_bf16 v[28:31], a[252:255], v[60:63], v[28:31]
  s_nop 6
  v_cvt_pk_bf16_f32 v24, v24, v25
  v_cvt_pk_bf16_f32 v25, v26, v27
  v_cvt_pk_bf16_f32 v26, v28, v29
  v_cvt_pk_bf16_f32 v27, v30, v31
  v_bfi_b32 v24, 1, s63, v24
  v_bfi_b32 v26, 1, s63, v26
  buffer_store_dwordx4 v[24:27], v0, s[12:15], s47 offen offset:3072
  s_cmp_eq_u32 s32, 63
  s_cbranch_scc1 L_end
L_awkp_124:
  s_mov_b64 exec, s[40:41]
  buffer_load_dword v2, v1, s[12:15], s65 offen sc1
  s_mov_b64 exec, -1
  s_add_u32 s98, s32, 2
  s_mov_b64 exec, s[40:41]
  s_waitcnt vmcnt(0)
  v_cmp_gt_u32 vcc, s98, v2
  s_mov_b64 exec, -1
  s_cbranch_vccz L_awkp_124d
  s_sleep 2
  s_sub_u32 s100, s100, 1
  s_cbranch_scc0 L_awkp_124
  s_branch L_end
L_awkp_124d:
  s_mov_b32 m0, s59
  s_nop 0
  buffer_load_dwordx4 v0, s[12:15], s64 offen offset:0 sc1 lds
  buffer_load_dwordx4 v0, s[12:15], s64 offen offset:1024 sc1 lds
  buffer_load_dwordx4 v0, s[12:15], s64 offen offset:2048 sc1 lds
  buffer_load_dwordx4 v0, s[12:15], s64 offen offset:3072 sc1 lds
  s_waitcnt vmcnt(0)
  ds_read2_b64 v[136:139], v10 offset0:0 offset1:16
  ds_read2_b64 v[140:143], v10 offset0:128 offset1:144
  ds_read2_b64 v[144:147], v4 offset0:0 offset1:16
  ds_read2_b64 v[148:151], v4 offset0:128 offset1:144
  s_waitcnt lgkmcnt(3)
  v_mfma_f32_16x16x32_bf16 v[156:159], v[136:139], v[72:75], v[68:71]
  v_mfma_f32_16x16x32_bf16 v[168:171], v[136:139], v[76:79], v[68:71]
  ds_read2st64_b64 v[136:139], v11 offset0:0 offset1:1
  s_waitcnt lgkmcnt(3)
  v_mfma_f32_16x16x32_bf16 v[156:159], v[140:143], v[80:83], v[156:159]
  v_mfma_f32_16x16x32_bf16 v[168:171], v[140:143], v[84:87], v[168:171]
  ds_read2st64_b64 v[140:143], v11 offset0:2 offset1:3
  s_waitcnt lgkmcnt(3)
  v_mfma_f32_16x16x32_bf16 v[156:159], v[144:147], v[88:91], v[156:159]
  v_mfma_f32_16x16x32_bf16 v[168:171], v[144:147], v[92:95], v[168:171]
  ds_read2st64_b64 v[144:147], v11 offset0:4 offset1:5
  s_waitcnt lgkmcnt(3)
  v_mfma_f32_16x16x32_bf16 v[156:159], v[148:151], v[96:99], v[156:159]
  v_mfma_f32_16x16x32_bf16 v[168:171], v[148:151], v[100:103], v[168:171]
  ds_read2st64_b64 v[148:151], v11 offset0:6 offset1:7
  v_max3_f32 v186, v160, v161, v162
  v_max3_f32 v184, v152, v153, v154
  v_max3_f32 v186, v186, v163, v164
  s_nop 2
  v_max3_f32 v184, v184, v155, v156
  v_max3_f32 v186, v186, v165, v166
  v_max3_f32 v184, v184, v157, v158
  v_max3_f32 v186, v186, v167, v168
  v_max_f32 v184, v184, v159
  v_max3_f32 v186, v186, v169, v170
  v_mov_b32 v185, v184
  v_max_f32 v186, v186, v171
  s_nop 0
  v_permlane16_swap_b32 v184, v185
  v_mov_b32 v187, v186
  v_max_f32 v184, v184, v185
  s_nop 0
  v_permlane16_swap_b32 v186, v187
  v_mov_b32 v185, v184
  v_max_f32 v186, v186, v187
  s_nop 0
  v_permlane32_swap_b32 v184, v185
  v_mov_b32 v187, v186
  v_max_f32 v184, v184, v185
  s_nop 0
  v_permlane32_swap_b32 v186, v187
  v_mul_f32 v184, s94, v184
  v_max_f32 v186, v186, v187
  v_pk_fma_f32 v[152:153], v[152:153], s[94:95], v[184:185] op_sel_hi:[1,1,0] neg_lo:[0,0,1] neg_hi:[0,0,1]
  v_mul_f32 v186, s94, v186
  v_pk_fma_f32 v[154:155], v[154:155], s[94:95], v[184:185] op_sel_hi:[1,1,0] neg_lo:[0,0,1] neg_hi:[0,0,1]
  v_pk_fma_f32 v[160:161], v[160:161], s[94:95], v[186:187] op_sel_hi:[1,1,0] neg_lo:[0,0,1] neg_hi:[0,0,1]
  v_pk_fma_f32 v[156:157], v[156:157], s[94:95], v[184:185] op_sel_hi:[1,1,0] neg_lo:[0,0,1] neg_hi:[0,0,1]
  v_pk_fma_f32 v[162:163], v[162:163], s[94:95], v[186:187] op_sel_hi:[1,1,0] neg_lo:[0,0,1] neg_hi:[0,0,1]
  v_pk_fma_f32 v[158:159], v[158:159], s[94:95], v[184:185] op_sel_hi:[1,1,0] neg_lo:[0,0,1] neg_hi:[0,0,1]
  v_pk_fma_f32 v[164:165], v[164:165], s[94:95], v[186:187] op_sel_hi:[1,1,0] neg_lo:[0,0,1] neg_hi:[0,0,1]
  v_exp_f32 v152, v152
  v_pk_fma_f32 v[166:167], v[166:167], s[94:95], v[186:187] op_sel_hi:[1,1,0] neg_lo:[0,0,1] neg_hi:[0,0,1]
  v_exp_f32 v153, v153
  v_pk_fma_f32 v[168:169], v[168:169], s[94:95], v[186:187] op_sel_hi:[1,1,0] neg_lo:[0,0,1] neg_hi:[0,0,1]
  v_exp_f32 v154, v154
  v_pk_fma_f32 v[170:171], v[170:171], s[94:95], v[186:187] op_sel_hi:[1,1,0] neg_lo:[0,0,1] neg_hi:[0,0,1]
  v_add_f32 v184, v152, v153
  v_exp_f32 v160, v160
  v_exp_f32 v155, v155
  v_exp_f32 v161, v161
  v_add_f32 v184, v184, v154
  v_exp_f32 v162, v162
  v_exp_f32 v156, v156
  v_add_f32 v186, v160, v161
  v_add_f32 v184, v184, v155
  v_exp_f32 v163, v163
  v_exp_f32 v157, v157
  v_add_f32 v186, v186, v162
  v_add_f32 v184, v184, v156
  v_exp_f32 v164, v164
  v_exp_f32 v158, v158
  v_add_f32 v186, v186, v163
  v_add_f32 v184, v184, v157
  v_exp_f32 v165, v165
  v_exp_f32 v159, v159
  v_add_f32 v186, v186, v164
  v_add_f32 v184, v184, v158
  v_exp_f32 v166, v166
  v_add_f32 v184, v184, v159
  v_add_f32 v186, v186, v165
  v_mov_b32 v185, v184
  v_exp_f32 v167, v167
  s_nop 0
  v_permlane16_swap_b32 v184, v185
  v_add_f32 v186, v186, v166
  v_add_f32 v184, v184, v185
  v_exp_f32 v168, v168
  v_mov_b32 v185, v184
  v_add_f32 v186, v186, v167
  s_nop 0
  v_permlane32_swap_b32 v184, v185
  v_exp_f32 v169, v169
  v_add_f32 v184, v184, v185
  v_add_f32 v186, v186, v168
  v_rcp_f32 v184, v184
  v_exp_f32 v170, v170
  v_pk_mul_f32 v[152:153], v[152:153], v[184:185] op_sel_hi:[1,0]
  v_add_f32 v186, v186, v169
  v_pk_mul_f32 v[154:155], v[154:155], v[184:185] op_sel_hi:[1,0]
  v_exp_f32 v171, v171
  v_pk_mul_f32 v[156:157], v[156:157], v[184:185] op_sel_hi:[1,0]
  v_add_f32 v186, v186, v170
  v_pk_mul_f32 v[158:159], v[158:159], v[184:185] op_sel_hi:[1,0]
  v_add_f32 v186, v186, v171
  v_cvt_pk_bf16_f32 v172, v152, v153
  v_mov_b32 v187, v186
  v_cvt_pk_bf16_f32 v173, v154, v155
  s_nop 1
  v_mfma_f32_16x16x16_bf16 v[192:195], v[104:105], v[172:173], 0
  v_permlane16_swap_b32 v186, v187
  v_mfma_f32_16x16x16_bf16 v[196:199], v[108:109], v[172:173], 0
  v_cvt_pk_bf16_f32 v174, v156, v157
  v_add_f32 v186, v186, v187
  v_mfma_f32_16x16x16_bf16 v[200:203], v[112:113], v[172:173], 0
  v_cvt_pk_bf16_f32 v175, v158, v159
  v_mov_b32 v187, v186
  v_mfma_f32_16x16x16_bf16 v[204:207], v[116:117], v[172:173], 0
  s_nop 0
  v_permlane32_swap_b32 v186, v187
  v_mfma_f32_16x16x16_bf16 v[208:211], v[120:121], v[172:173], 0
  v_add_f32 v186, v186, v187
  v_mfma_f32_16x16x16_bf16 v[212:215], v[124:125], v[172:173], 0
  v_rcp_f32 v186, v186
  v_mfma_f32_16x16x16_bf16 v[216:219], v[128:129], v[172:173], 0
  v_pk_mul_f32 v[160:161], v[160:161], v[186:187] op_sel_hi:[1,0]
  v_pk_mul_f32 v[162:163], v[162:163], v[186:187] op_sel_hi:[1,0]
  v_mfma_f32_16x16x16_bf16 v[220:223], v[132:133], v[172:173], 0
  v_pk_mul_f32 v[164:165], v[164:165], v[186:187] op_sel_hi:[1,0]
  v_pk_mul_f32 v[166:167], v[166:167], v[186:187] op_sel_hi:[1,0]
  v_pk_mul_f32 v[168:169], v[168:169], v[186:187] op_sel_hi:[1,0]
  v_pk_mul_f32 v[170:171], v[170:171], v[186:187] op_sel_hi:[1,0]
  v_cvt_pk_bf16_f32 v176, v160, v161
  v_cvt_pk_bf16_f32 v177, v162, v163
  v_cvt_pk_bf16_f32 v178, v164, v165
  v_cvt_pk_bf16_f32 v179, v166, v167
  v_cvt_pk_bf16_f32 v180, v168, v169
  v_cvt_pk_bf16_f32 v181, v170, v171
  v_mfma_f32_16x16x32_bf16 v[224:227], v[104:107], v[176:179], 0
  v_mfma_f32_16x16x32_bf16 v[228:231], v[108:111], v[176:179], 0
  v_mfma_f32_16x16x32_bf16 v[232:235], v[112:115], v[176:179], 0
  v_mfma_f32_16x16x32_bf16 v[236:239], v[116:119], v[176:179], 0
  v_mfma_f32_16x16x32_bf16 v[240:243], v[120:123], v[176:179], 0
  v_mfma_f32_16x16x32_bf16 v[244:247], v[124:127], v[176:179], 0
  v_mfma_f32_16x16x32_bf16 v[248:251], v[128:131], v[176:179], 0
  v_mfma_f32_16x16x32_bf16 v[252:255], v[132:135], v[176:179], 0
  s_waitcnt lgkmcnt(3)
  v_mfma_f32_16x16x16_bf16 v[192:195], v[136:137], v[174:175], v[192:195]
  v_mfma_f32_16x16x16_bf16 v[196:199], v[138:139], v[174:175], v[196:199]
  s_waitcnt lgkmcnt(2)
  v_mfma_f32_16x16x16_bf16 v[200:203], v[140:141], v[174:175], v[200:203]
  s_nop 4
  v_cvt_pk_bf16_f32 v192, v192, v193
  v_cvt_pk_bf16_f32 v193, v194, v195
  v_mfma_f32_16x16x16_bf16 v[204:207], v[142:143], v[174:175], v[204:207]
  v_cvt_pk_bf16_f32 v194, v196, v197
  v_cvt_pk_bf16_f32 v195, v198, v199
  s_waitcnt lgkmcnt(1)
  v_mfma_f32_16x16x16_bf16 v[208:211], v[144:145], v[174:175], v[208:211]
  ds_write_b128 v7, v[192:195] offset:0
  v_mfma_f32_16x16x16_bf16 v[212:215], v[146:147], v[174:175], v[212:215]
  v_cvt_pk_bf16_f32 v200, v200, v201
  v_cvt_pk_bf16_f32 v201, v202, v203
  s_waitcnt lgkmcnt(1)
  v_mfma_f32_16x16x16_bf16 v[216:219], v[148:149], v[174:175], v[216:219]
  v_cvt_pk_bf16_f32 v202, v204, v205
  v_cvt_pk_bf16_f32 v203, v206, v207
  v_mfma_f32_16x16x16_bf16 v[220:223], v[150:151], v[174:175], v[220:223]
  ds_write_b128 v7, v[200:203] offset:2048
  v_mfma_f32_16x16x16_bf16 v[224:227], v[136:137], v[180:181], v[224:227]
  v_cvt_pk_bf16_f32 v208, v208, v209
  v_cvt_pk_bf16_f32 v209, v210, v211
  v_mfma_f32_16x16x16_bf16 v[228:231], v[138:139], v[180:181], v[228:231]
  v_cvt_pk_bf16_f32 v210, v212, v213
  v_cvt_pk_bf16_f32 v211, v214, v215
  v_mfma_f32_16x16x16_bf16 v[232:235], v[140:141], v[180:181], v[232:235]
  ds_write_b128 v7, v[208:211] offset:4096
  v_mfma_f32_16x16x16_bf16 v[236:239], v[142:143], v[180:181], v[236:239]
  v_cvt_pk_bf16_f32 v216, v216, v217
  v_cvt_pk_bf16_f32 v217, v218, v219
  v_mfma_f32_16x16x16_bf16 v[240:243], v[144:145], v[180:181], v[240:243]
  v_cvt_pk_bf16_f32 v218, v220, v221
  v_cvt_pk_bf16_f32 v219, v222, v223
  v_mfma_f32_16x16x16_bf16 v[244:247], v[146:147], v[180:181], v[244:247]
  ds_write_b128 v7, v[216:219] offset:6144
  v_mfma_f32_16x16x16_bf16 v[248:251], v[148:149], v[180:181], v[248:251]
  v_cvt_pk_bf16_f32 v224, v224, v225
  v_cvt_pk_bf16_f32 v225, v226, v227
  v_mfma_f32_16x16x16_bf16 v[252:255], v[150:151], v[180:181], v[252:255]
  v_cvt_pk_bf16_f32 v226, v228, v229
  v_cvt_pk_bf16_f32 v227, v230, v231
  ds_write_b128 v7, v[224:227] offset:1024
  v_cvt_pk_bf16_f32 v232, v232, v233
  v_cvt_pk_bf16_f32 v233, v234, v235
  v_cvt_pk_bf16_f32 v234, v236, v237
  v_cvt_pk_bf16_f32 v235, v238, v239
  ds_write_b128 v7, v[232:235] offset:3072
  v_cvt_pk_bf16_f32 v240, v240, v241
  v_cvt_pk_bf16_f32 v241, v242, v243
  v_cvt_pk_bf16_f32 v242, v244, v245
  v_cvt_pk_bf16_f32 v243, v246, v247
  ds_write_b128 v7, v[240:243] offset:5120
  v_cvt_pk_bf16_f32 v248, v248, v249
  v_cvt_pk_bf16_f32 v249, v250, v251
  v_cvt_pk_bf16_f32 v250, v252, v253
  v_cvt_pk_bf16_f32 v251, v254, v255
  ds_write_b128 v7, v[248:251] offset:7168
  v_add_u32 v9, s42, v9
  s_sub_u32 s42, 0, s42
  s_add_u32 s64, s64, 131072
  v_xor_b32 v7, 0x4000, v7
L_awG_j:
  s_add_u32 s32, s32, 1
  s_and_b32 s98, s32, 1
  s_cselect_b32 s98, 0, 1183744
  s_sub_u32 s98, 591872, s98
  s_add_u32 s46, s46, s98
  s_add_u32 s47, s47, s98
  s_add_u32 s48, s48, s98
  s_branch L_awG_loop
L_awG_b0:
  v_mfma_f32_16x16x32_bf16 v[20:23], a[36:39], v[36:39], v[20:23]
  s_mov_b32 m0, s59
  s_nop 0
  buffer_load_dwordx4 v0, s[12:15], s64 offen offset:0 sc1 lds
  v_mfma_f32_16x16x32_bf16 v[16:19], a[64:67], v[40:43], v[16:19]
  buffer_load_dwordx4 v0, s[12:15], s64 offen offset:1024 sc1 lds
  v_mfma_f32_16x16x32_bf16 v[20:23], a[68:71], v[40:43], v[20:23]
  buffer_load_dwordx4 v0, s[12:15], s64 offen offset:2048 sc1 lds
  v_mfma_f32_16x16x32_bf16 v[16:19], a[96:99], v[44:47], v[16:19]
  buffer_load_dwordx4 v0, s[12:15], s64 offen offset:3072 sc1 lds
  v_mfma_f32_16x16x32_bf16 v[20:23], a[100:103], v[44:47], v[20:23]
  ds_read_b128 v[72:75], v9 offset:16384
  ds_read_b128 v[76:79], v9 offset:17408
  s_add_u32 s98, s32, 1
  v_mfma_f32_16x16x32_bf16 v[16:19], a[128:131], v[48:51], v[16:19]
  v_mov_b32 v12, s98
  ds_write_b32 v8, v12
  v_mfma_f32_16x16x32_bf16 v[20:23], a[132:135], v[48:51], v[20:23]
  ds_read_b128 v[104:107], v9 offset:0
  ds_read_b128 v[108:111], v9 offset:1024
  v_mfma_f32_16x16x32_bf16 v[16:19], a[160:163], v[52:55], v[16:19]
  ds_read_b128 v[80:83], v9 offset:18432
  ds_read_b128 v[84:87], v9 offset:19456
  v_mfma_f32_16x16x32_bf16 v[20:23], a[164:167], v[52:55], v[20:23]
  ds_read_b128 v[112:115], v9 offset:4096
  ds_read_b128 v[116:119], v9 offset:5120
  v_mfma_f32_16x16x32_bf16 v[16:19], a[192:195], v[56:59], v[16:19]
  ds_read_b128 v[88:91], v9 offset:20480
  ds_read_b128 v[92:95], v9 offset:21504
  v_mfma_f32_16x16x32_bf16 v[20:23], a[196:199], v[56:59], v[20:23]
  ds_read_b128 v[120:123], v9 offset:8192
  ds_read_b128 v[124:127], v9 offset:9216
  v_mfma_f32_16x16x32_bf16 v[16:19], a[224:227], v[60:63], v[16:19]
  ds_read_b128 v[96:99], v9 offset:22528
  ds_read_b128 v[100:103], v9 offset:23552
  s_waitcnt lgkmcnt(11)
  v_mfma_f32_16x16x32_bf16 v[152:155], v[104:107], v[72:75], v[64:67]
  ds_read_b128 v[128:131], v9 offset:12288
  ds_read_b128 v[132:135], v9 offset:13312
  v_mfma_f32_16x16x32_bf16 v[20:23], a[228:231], v[60:63], v[20:23]
  v_mfma_f32_16x16x32_bf16 v[160:163], v[104:107], v[76:79], 0
  v_mfma_f32_16x16x32_bf16 v[24:27], a[8:11], v[32:35], 0
  s_waitcnt lgkmcnt(12)
  v_mfma_f32_16x16x32_bf16 v[164:167], v[108:111], v[76:79], v[64:67]
  v_mfma_f32_16x16x32_bf16 v[28:31], a[12:15], v[32:35], 0
  s_waitcnt lgkmcnt(9)
  v_mfma_f32_16x16x32_bf16 v[152:155], v[112:115], v[80:83], v[152:155]
  v_mfma_f32_16x16x32_bf16 v[24:27], a[40:43], v[36:39], v[24:27]
L_bpc_125:
  s_sub_i32 s98, s32, 1
  s_mov_b64 exec, s[66:67]
  s_waitcnt vmcnt(4)
  v_cmp_gt_i32 vcc, s98, v5
  s_mov_b64 exec, -1
  s_cbranch_vccnz L_bpr_126
  v_mfma_f32_16x16x32_bf16 v[160:163], v[112:115], v[84:87], v[160:163]
  v_cvt_pk_bf16_f32 v16, v16, v17
  v_cvt_pk_bf16_f32 v17, v18, v19
  v_mfma_f32_16x16x32_bf16 v[28:31], a[44:47], v[36:39], v[28:31]
  v_cvt_pk_bf16_f32 v18, v20, v21
  v_cvt_pk_bf16_f32 v19, v22, v23
  s_waitcnt lgkmcnt(8)
  v_mfma_f32_16x16x32_bf16 v[164:167], v[116:119], v[84:87], v[164:167]
  v_bfi_b32 v16, 1, s63, v16
  v_bfi_b32 v18, 1, s63, v18
  v_mfma_f32_16x16x32_bf16 v[24:27], a[72:75], v[40:43], v[24:27]
  s_waitcnt lgkmcnt(5)
  v_mfma_f32_16x16x32_bf16 v[152:155], v[120:123], v[88:91], v[152:155]
  v_mfma_f32_16x16x32_bf16 v[28:31], a[76:79], v[40:43], v[28:31]
  v_mfma_f32_16x16x32_bf16 v[160:163], v[120:123], v[92:95], v[160:163]
  v_mfma_f32_16x16x32_bf16 v[24:27], a[104:107], v[44:47], v[24:27]
  buffer_store_dwordx4 v[16:19], v0, s[12:15], s46 offen offset:0
  s_waitcnt lgkmcnt(4)
  v_mfma_f32_16x16x32_bf16 v[164:167], v[124:127], v[92:95], v[164:167]
  v_mfma_f32_16x16x32_bf16 v[28:31], a[108:111], v[44:47], v[28:31]
  ds_read_b128 v[104:107], v9 offset:2048
  ds_read_b128 v[108:111], v9 offset:3072
  s_waitcnt lgkmcnt(3)
  v_mfma_f32_16x16x32_bf16 v[152:155], v[128:131], v[96:99], v[152:155]
  ds_read_b128 v[112:115], v9 offset:6144
  ds_read_b128 v[116:119], v9 offset:7168
  v_mfma_f32_16x16x32_bf16 v[24:27], a[136:139], v[48:51], v[24:27]
  ds_read_b128 v[120:123], v9 offset:10240
  ds_read_b128 v[124:127], v9 offset:11264
  v_mfma_f32_16x16x32_bf16 v[160:163], v[128:131], v[100:103], v[160:163]
  ds_read_b128 v[128:131], v9 offset:14336
  v_mfma_f32_16x16x32_bf16 v[28:31], a[140:143], v[48:51], v[28:31]
  s_waitcnt lgkmcnt(7)
  v_mfma_f32_16x16x32_bf16 v[164:167], v[132:135], v[100:103], v[164:167]
  ds_read_b128 v[132:135], v9 offset:15360
  v_mfma_f32_16x16x32_bf16 v[24:27], a[168:171], v[52:55], v[24:27]
  v_mfma_f32_16x16x32_bf16 v[28:31], a[172:175], v[52:55], v[28:31]
  v_mfma_f32_16x16x32_bf16 v[24:27], a[200:203], v[56:59], v[24:27]
  v_mfma_f32_16x16x32_bf16 v[28:31], a[204:207], v[56:59], v[28:31]
  v_mfma_f32_16x16x32_bf16 v[24:27], a[232:235], v[60:63], v[24:27]
  v_mfma_f32_16x16x32_bf16 v[28:31], a[236:239], v[60:63], v[28:31]
  v_mfma_f32_16x16x32_bf16 v[16:19], a[16:19], v[32:35], 0
  v_mfma_f32_16x16x32_bf16 v[20:23], a[20:23], v[32:35], 0
  s_waitcnt vmcnt(1)
  ds_read2_b64 v[136:139], v10 offset0:0 offset1:16
  ds_read2_b64 v[140:143], v10 offset0:128 offset1:144
  v_mfma_f32_16x16x32_bf16 v[16:19], a[48:51], v[36:39], v[16:19]
  ds_read2_b64 v[144:147], v4 offset0:0 offset1:16
  ds_read2_b64 v[148:151], v4 offset0:128 offset1:144
  v_cvt_pk_bf16_f32 v24, v24, v25
  v_mfma_f32_16x16x32_bf16 v[20:23], a[52:55], v[36:39], v[20:23]
  v_cvt_pk_bf16_f32 v25, v26, v27
  v_cvt_pk_bf16_f32 v26, v28, v29
  v_mfma_f32_16x16x32_bf16 v[16:19], a[80:83], v[40:43], v[16:19]
  v_cvt_pk_bf16_f32 v27, v30, v31
  v_bfi_b32 v24, 1, s63, v24
  v_mfma_f32_16x16x32_bf16 v[20:23], a[84:87], v[40:43], v[20:23]
  v_bfi_b32 v26, 1, s63, v26
  s_waitcnt lgkmcnt(3)
  v_mfma_f32_16x16x32_bf16 v[156:159], v[136:139], v[72:75], v[68:71]
  v_mfma_f32_16x16x32_bf16 v[168:171], v[136:139], v[76:79], v[68:71]
  v_mfma_f32_16x16x32_bf16 v[16:19], a[112:115], v[44:47], v[16:19]
  buffer_store_dwordx4 v[24:27], v0, s[12:15], s46 offen offset:2048
  s_waitcnt lgkmcnt(2)
  v_mfma_f32_16x16x32_bf16 v[156:159], v[140:143], v[80:83], v[156:159]
  v_mfma_f32_16x16x32_bf16 v[168:171], v[140:143], v[84:87], v[168:171]
  v_mfma_f32_16x16x32_bf16 v[20:23], a[116:119], v[44:47], v[20:23]
  ds_read2st64_b64 v[136:139], v11 offset0:0 offset1:1
  ds_read2st64_b64 v[140:143], v11 offset0:2 offset1:3
  s_waitcnt lgkmcnt(3)
  v_mfma_f32_16x16x32_bf16 v[156:159], v[144:147], v[88:91], v[156:159]
  v_mfma_f32_16x16x32_bf16 v[168:171], v[144:147], v[92:95], v[168:171]
  ds_read2st64_b64 v[144:147], v11 offset0:4 offset1:5
  v_mfma_f32_16x16x32_bf16 v[16:19], a[144:147], v[48:51], v[16:19]
  s_waitcnt lgkmcnt(3)
  v_mfma_f32_16x16x32_bf16 v[156:159], v[148:151], v[96:99], v[156:159]
  v_mfma_f32_16x16x32_bf16 v[168:171], v[148:151], v[100:103], v[168:171]
  ds_read2st64_b64 v[148:151], v11 offset0:6 offset1:7
  v_max3_f32 v186, v160, v161, v162
  v_max3_f32 v184, v152, v153, v154
  v_mfma_f32_16x16x32_bf16 v[20:23], a[148:151], v[48:51], v[20:23]
  v_max3_f32 v186, v186, v163, v164
  s_nop 1
  v_max3_f32 v184, v184, v155, v156
  v_mfma_f32_16x16x32_bf16 v[16:19], a[176:179], v[52:55], v[16:19]
  v_max3_f32 v186, v186, v165, v166
  v_max3_f32 v184, v184, v157, v158
  v_mfma_f32_16x16x32_bf16 v[20:23], a[180:183], v[52:55], v[20:23]
  v_max3_f32 v186, v186, v167, v168
  v_max_f32 v184, v184, v159
  v_mfma_f32_16x16x32_bf16 v[16:19], a[208:211], v[56:59], v[16:19]
  v_max3_f32 v186, v186, v169, v170
  v_mov_b32 v185, v184
  v_mfma_f32_16x16x32_bf16 v[20:23], a[212:215], v[56:59], v[20:23]
  v_max_f32 v186, v186, v171
  v_mfma_f32_16x16x32_bf16 v[16:19], a[240:243], v[60:63], v[16:19]
  v_permlane16_swap_b32 v184, v185
  v_mfma_f32_16x16x32_bf16 v[20:23], a[244:247], v[60:63], v[20:23]
  v_mov_b32 v187, v186
  v_mfma_f32_16x16x32_bf16 v[24:27], a[24:27], v[32:35], 0
  v_mfma_f32_16x16x32_bf16 v[28:31], a[28:31], v[32:35], 0
  ds_read_b128 v[32:35], v6 offset:1024
  v_max_f32 v184, v184, v185
  v_mfma_f32_16x16x32_bf16 v[24:27], a[56:59], v[36:39], v[24:27]
  v_permlane16_swap_b32 v186, v187
  v_mfma_f32_16x16x32_bf16 v[28:31], a[60:63], v[36:39], v[28:31]
  v_mov_b32 v185, v184
  v_max_f32 v186, v186, v187
  v_mfma_f32_16x16x32_bf16 v[24:27], a[88:91], v[40:43], v[24:27]
  v_cvt_pk_bf16_f32 v16, v16, v17
  v_cvt_pk_bf16_f32 v17, v18, v19
  v_mfma_f32_16x16x32_bf16 v[28:31], a[92:95], v[40:43], v[28:31]
  ds_read_b128 v[36:39], v6 offset:3072
  v_cvt_pk_bf16_f32 v18, v20, v21
  v_cvt_pk_bf16_f32 v19, v22, v23
  v_mfma_f32_16x16x32_bf16 v[24:27], a[120:123], v[44:47], v[24:27]
  v_bfi_b32 v16, 1, s63, v16
  v_bfi_b32 v18, 1, s63, v18
  v_mfma_f32_16x16x32_bf16 v[28:31], a[124:127], v[44:47], v[28:31]
  ds_read_b128 v[40:43], v6 offset:5120
  v_mfma_f32_16x16x32_bf16 v[24:27], a[152:155], v[48:51], v[24:27]
  buffer_store_dwordx4 v[16:19], v0, s[12:15], s47 offen offset:0
  v_mfma_f32_16x16x32_bf16 v[28:31], a[156:159], v[48:51], v[28:31]
  ds_read_b128 v[44:47], v6 offset:7168
  v_permlane32_swap_b32 v184, v185
  v_mfma_f32_16x16x32_bf16 v[24:27], a[184:187], v[52:55], v[24:27]
  v_mov_b32 v187, v186
  v_max_f32 v184, v184, v185
  v_mfma_f32_16x16x32_bf16 v[28:31], a[188:191], v[52:55], v[28:31]
  v_permlane32_swap_b32 v186, v187
  v_mfma_f32_16x16x32_bf16 v[24:27], a[216:219], v[56:59], v[24:27]
  ds_read_b128 v[48:51], v6 offset:9216
  v_mul_f32 v184, s94, v184
  v_max_f32 v186, v186, v187
  v_mfma_f32_16x16x32_bf16 v[28:31], a[220:223], v[56:59], v[28:31]
  v_fma_f32 v152, v152, s94, -v184
  v_mul_f32 v186, s94, v186
  v_mfma_f32_16x16x32_bf16 v[24:27], a[248:251], v[60:63], v[24:27]
  v_fma_f32 v153, v153, s94, -v184
  v_fma_f32 v160, v160, s94, -v186
  v_mfma_f32_16x16x32_bf16 v[28:31], a[252:255], v[60:63], v[28:31]
  ds_read_b128 v[52:55], v6 offset:11264
  v_fma_f32 v154, v154, s94, -v184
  v_fma_f32 v161, v161, s94, -v186
  s_waitcnt lgkmcnt(5)
  v_mfma_f32_16x16x32_bf16 v[16:19], a[0:3], v[32:35], 0
  v_fma_f32 v155, v155, s94, -v184
  v_fma_f32 v162, v162, s94, -v186
  v_mfma_f32_16x16x32_bf16 v[20:23], a[4:7], v[32:35], 0
  v_fma_f32 v156, v156, s94, -v184
  v_fma_f32 v163, v163, s94, -v186
  s_waitcnt lgkmcnt(4)
  v_mfma_f32_16x16x32_bf16 v[16:19], a[32:35], v[36:39], v[16:19]
  ds_read_b128 v[56:59], v6 offset:13312
  v_fma_f32 v157, v157, s94, -v184
  v_fma_f32 v164, v164, s94, -v186
  v_mfma_f32_16x16x32_bf16 v[20:23], a[36:39], v[36:39], v[20:23]
  v_fma_f32 v158, v158, s94, -v184
  v_fma_f32 v165, v165, s94, -v186
  s_waitcnt lgkmcnt(4)
  v_mfma_f32_16x16x32_bf16 v[16:19], a[64:67], v[40:43], v[16:19]
  v_fma_f32 v159, v159, s94, -v184
  v_fma_f32 v166, v166, s94, -v186
  v_mfma_f32_16x16x32_bf16 v[20:23], a[68:71], v[40:43], v[20:23]
  ds_read_b128 v[60:63], v6 offset:15360
  v_exp_f32 v152, v152
  s_waitcnt lgkmcnt(4)
  v_mfma_f32_16x16x32_bf16 v[16:19], a[96:99], v[44:47], v[16:19]
  v_fma_f32 v167, v167, s94, -v186
  v_xor_b32 v6, 0x4000, v6
  v_mfma_f32_16x16x32_bf16 v[20:23], a[100:103], v[44:47], v[20:23]
  v_exp_f32 v153, v153
  s_waitcnt lgkmcnt(3)
  v_mfma_f32_16x16x32_bf16 v[16:19], a[128:131], v[48:51], v[16:19]
  v_fma_f32 v168, v168, s94, -v186
  v_mfma_f32_16x16x32_bf16 v[20:23], a[132:135], v[48:51], v[20:23]
  v_exp_f32 v154, v154
  s_waitcnt lgkmcnt(2)
  v_mfma_f32_16x16x32_bf16 v[16:19], a[160:163], v[52:55], v[16:19]
  v_fma_f32 v169, v169, s94, -v186
  v_add_f32 v184, v152, v153
  v_fma_f32 v170, v170, s94, -v186
  v_mfma_f32_16x16x32_bf16 v[20:23], a[164:167], v[52:55], v[20:23]
  v_cvt_pk_bf16_f32 v24, v24, v25
  v_cvt_pk_bf16_f32 v25, v26, v27
  s_waitcnt lgkmcnt(1)
  v_mfma_f32_16x16x32_bf16 v[16:19], a[192:195], v[56:59], v[16:19]
  v_cvt_pk_bf16_f32 v26, v28, v29
  v_cvt_pk_bf16_f32 v27, v30, v31
  v_mfma_f32_16x16x32_bf16 v[20:23], a[196:199], v[56:59], v[20:23]
  v_bfi_b32 v24, 1, s63, v24
  v_bfi_b32 v26, 1, s63, v26
  s_waitcnt lgkmcnt(0)
  v_mfma_f32_16x16x32_bf16 v[16:19], a[224:227], v[60:63], v[16:19]
  buffer_store_dwordx4 v[24:27], v0, s[12:15], s47 offen offset:2048
  v_mfma_f32_16x16x32_bf16 v[20:23], a[228:231], v[60:63], v[20:23]
  v_exp_f32 v155, v155
  v_fma_f32 v171, v171, s94, -v186
  v_mfma_f32_16x16x32_bf16 v[24:27], a[8:11], v[32:35], 0
  v_add_f32 v184, v184, v154
  v_exp_f32 v160, v160
  v_mfma_f32_16x16x32_bf16 v[28:31], a[12:15], v[32:35], 0
  v_exp_f32 v156, v156
  v_mfma_f32_16x16x32_bf16 v[24:27], a[40:43], v[36:39], v[24:27]
  v_exp_f32 v161, v161
  v_add_f32 v184, v184, v155
  v_mfma_f32_16x16x32_bf16 v[28:31], a[44:47], v[36:39], v[28:31]
  v_exp_f32 v162, v162
  v_mfma_f32_16x16x32_bf16 v[24:27], a[72:75], v[40:43], v[24:27]
  v_exp_f32 v157, v157
  v_add_f32 v186, v160, v161
  v_mfma_f32_16x16x32_bf16 v[28:31], a[76:79], v[40:43], v[28:31]
  v_add_f32 v184, v184, v156
  v_exp_f32 v163, v163
  v_mfma_f32_16x16x32_bf16 v[24:27], a[104:107], v[44:47], v[24:27]
  v_exp_f32 v158, v158
  v_add_f32 v186, v186, v162
  v_mfma_f32_16x16x32_bf16 v[28:31], a[108:111], v[44:47], v[28:31]
  v_add_f32 v184, v184, v157
  v_exp_f32 v164, v164
  v_mfma_f32_16x16x32_bf16 v[24:27], a[136:139], v[48:51], v[24:27]
  v_exp_f32 v159, v159
  v_mfma_f32_16x16x32_bf16 v[28:31], a[140:143], v[48:51], v[28:31]
  v_add_f32 v186, v186, v163
  v_add_f32 v184, v184, v158
  v_mfma_f32_16x16x32_bf16 v[24:27], a[168:171], v[52:55], v[24:27]
  v_exp_f32 v165, v165
  v_mfma_f32_16x16x32_bf16 v[28:31], a[172:175], v[52:55], v[28:31]
  v_cvt_pk_bf16_f32 v16, v16, v17
  v_cvt_pk_bf16_f32 v17, v18, v19
  v_add_f32 v184, v184, v159
  v_mfma_f32_16x16x32_bf16 v[24:27], a[200:203], v[56:59], v[24:27]
  v_cvt_pk_bf16_f32 v18, v20, v21
  v_cvt_pk_bf16_f32 v19, v22, v23
  v_add_f32 v186, v186, v164
  v_mfma_f32_16x16x32_bf16 v[28:31], a[204:207], v[56:59], v[28:31]
  v_bfi_b32 v16, 1, s63, v16
  v_bfi_b32 v18, 1, s63, v18
  v_mov_b32 v185, v184
  v_mfma_f32_16x16x32_bf16 v[24:27], a[232:235], v[60:63], v[24:27]
  buffer_store_dwordx4 v[16:19], v0, s[12:15], s46 offen offset:1024
  v_mfma_f32_16x16x32_bf16 v[28:31], a[236:239], v[60:63], v[28:31]
  v_exp_f32 v166, v166
  v_mfma_f32_16x16x32_bf16 v[16:19], a[16:19], v[32:35], 0
  v_permlane16_swap_b32 v184, v185
  v_add_f32 v186, v186, v165
  v_mfma_f32_16x16x32_bf16 v[20:23], a[20:23], v[32:35], 0
  v_add_f32 v184, v184, v185
  v_exp_f32 v167, v167
  v_mfma_f32_16x16x32_bf16 v[16:19], a[48:51], v[36:39], v[16:19]
  v_mov_b32 v185, v184
  v_add_f32 v186, v186, v166
  v_mfma_f32_16x16x32_bf16 v[20:23], a[52:55], v[36:39], v[20:23]
  v_permlane32_swap_b32 v184, v185
  v_mfma_f32_16x16x32_bf16 v[16:19], a[80:83], v[40:43], v[16:19]
  v_exp_f32 v168, v168
  v_add_f32 v184, v184, v185
  v_mfma_f32_16x16x32_bf16 v[20:23], a[84:87], v[40:43], v[20:23]
  v_add_f32 v186, v186, v167
  v_rcp_f32 v184, v184
  v_mfma_f32_16x16x32_bf16 v[16:19], a[112:115], v[44:47], v[16:19]
  v_exp_f32 v169, v169
  v_mul_f32 v152, v184, v152
  v_mfma_f32_16x16x32_bf16 v[20:23], a[116:119], v[44:47], v[20:23]
  v_add_f32 v186, v186, v168
  v_mul_f32 v153, v184, v153
  v_mfma_f32_16x16x32_bf16 v[16:19], a[144:147], v[48:51], v[16:19]
  v_exp_f32 v170, v170
  v_mul_f32 v154, v184, v154
  v_mfma_f32_16x16x32_bf16 v[20:23], a[148:151], v[48:51], v[20:23]
  v_add_f32 v186, v186, v169
  v_mul_f32 v155, v184, v155
  v_mfma_f32_16x16x32_bf16 v[16:19], a[176:179], v[52:55], v[16:19]
  s_mov_b32 m0, s45
  s_mov_b64 exec, s[40:41]
  buffer_load_dword v1, s[12:15], s65 offen sc1 lds
  s_mov_b64 exec, -1
  v_mfma_f32_16x16x32_bf16 v[20:23], a[180:183], v[52:55], v[20:23]
  v_cvt_pk_bf16_f32 v24, v24, v25
  v_cvt_pk_bf16_f32 v25, v26, v27
  v_mfma_f32_16x16x32_bf16 v[16:19], a[208:211], v[56:59], v[16:19]
  v_cvt_pk_bf16_f32 v26, v28, v29
  v_cvt_pk_bf16_f32 v27, v30, v31
  v_mfma_f32_16x16x32_bf16 v[20:23], a[212:215], v[56:59], v[20:23]
  v_bfi_b32 v24, 1, s63, v24
  v_bfi_b32 v26, 1, s63, v26
  v_mfma_f32_16x16x32_bf16 v[16:19], a[240:243], v[60:63], v[16:19]
  buffer_store_dwordx4 v[24:27], v0, s[12:15], s46 offen offset:3072
  v_mfma_f32_16x16x32_bf16 v[20:23], a[244:247], v[60:63], v[20:23]
  v_exp_f32 v171, v171
  v_mul_f32 v156, v184, v156
  v_mfma_f32_16x16x32_bf16 v[24:27], a[24:27], v[32:35], 0
  v_add_f32 v186, v186, v170
  v_mul_f32 v157, v184, v157
  v_add_f32 v186, v186, v171
  v_mfma_f32_16x16x32_bf16 v[28:31], a[28:31], v[32:35], 0
  v_mul_f32 v158, v184, v158
  v_mov_b32 v187, v186
  v_mul_f32 v159, v184, v159
  v_mfma_f32_16x16x32_bf16 v[24:27], a[56:59], v[36:39], v[24:27]
  v_permlane16_swap_b32 v186, v187
  v_cvt_pk_bf16_f32 v172, v152, v153
  v_mfma_f32_16x16x32_bf16 v[28:31], a[60:63], v[36:39], v[28:31]
  v_add_f32 v186, v186, v187
  v_cvt_pk_bf16_f32 v173, v154, v155
  v_mov_b32 v187, v186
  v_mfma_f32_16x16x32_bf16 v[24:27], a[88:91], v[40:43], v[24:27]
  v_cvt_pk_bf16_f32 v174, v156, v157
  v_permlane32_swap_b32 v186, v187
  v_mfma_f32_16x16x32_bf16 v[28:31], a[92:95], v[40:43], v[28:31]
  v_cvt_pk_bf16_f32 v175, v158, v159
  v_add_f32 v186, v186, v187
  v_mfma_f32_16x16x32_bf16 v[24:27], a[120:123], v[44:47], v[24:27]
  v_rcp_f32 v186, v186
  s_nop 0
  v_mul_f32 v160, v186, v160
  v_mfma_f32_16x16x32_bf16 v[28:31], a[124:127], v[44:47], v[28:31]
  v_mul_f32 v161, v186, v161
  v_mul_f32 v162, v186, v162
  v_mul_f32 v163, v186, v163
  v_mfma_f32_16x16x32_bf16 v[24:27], a[152:155], v[48:51], v[24:27]
  v_mul_f32 v164, v186, v164
  v_mul_f32 v165, v186, v165
  v_mul_f32 v166, v186, v166
  v_mfma_f32_16x16x16_bf16 v[192:195], v[104:105], v[172:173], 0
  v_mul_f32 v167, v186, v167
  v_mul_f32 v168, v186, v168
  v_mul_f32 v169, v186, v169
  v_mfma_f32_16x16x16_bf16 v[196:199], v[108:109], v[172:173], 0
  v_mul_f32 v170, v186, v170
  v_mul_f32 v171, v186, v171
  v_cvt_pk_bf16_f32 v176, v160, v161
  v_mfma_f32_16x16x16_bf16 v[200:203], v[112:113], v[172:173], 0
  v_cvt_pk_bf16_f32 v16, v16, v17
  v_cvt_pk_bf16_f32 v17, v18, v19
  v_cvt_pk_bf16_f32 v177, v162, v163
  v_mfma_f32_16x16x32_bf16 v[28:31], a[156:159], v[48:51], v[28:31]
  v_cvt_pk_bf16_f32 v18, v20, v21
  v_cvt_pk_bf16_f32 v19, v22, v23
  v_cvt_pk_bf16_f32 v178, v164, v165
  v_mfma_f32_16x16x16_bf16 v[204:207], v[116:117], v[172:173], 0
  v_bfi_b32 v16, 1, s63, v16
  v_bfi_b32 v18, 1, s63, v18
  v_cvt_pk_bf16_f32 v179, v166, v167
  v_mfma_f32_16x16x16_bf16 v[208:211], v[120:121], v[172:173], 0
  buffer_store_dwordx4 v[16:19], v0, s[12:15], s47 offen offset:1024
  v_cvt_pk_bf16_f32 v180, v168, v169
  v_mfma_f32_16x16x16_bf16 v[212:215], v[124:125], v[172:173], 0
  v_cvt_pk_bf16_f32 v181, v170, v171
  v_mfma_f32_16x16x32_bf16 v[24:27], a[184:187], v[52:55], v[24:27]
  v_mfma_f32_16x16x16_bf16 v[216:219], v[128:129], v[172:173], 0
  v_mfma_f32_16x16x16_bf16 v[220:223], v[132:133], v[172:173], 0
  v_mfma_f32_16x16x32_bf16 v[224:227], v[104:107], v[176:179], 0
  v_mfma_f32_16x16x32_bf16 v[28:31], a[188:191], v[52:55], v[28:31]
  v_mfma_f32_16x16x32_bf16 v[228:231], v[108:111], v[176:179], 0
  v_mfma_f32_16x16x32_bf16 v[232:235], v[112:115], v[176:179], 0
  v_mfma_f32_16x16x32_bf16 v[236:239], v[116:119], v[176:179], 0
  v_mfma_f32_16x16x32_bf16 v[24:27], a[216:219], v[56:59], v[24:27]
  v_mfma_f32_16x16x32_bf16 v[240:243], v[120:123], v[176:179], 0
  v_mfma_f32_16x16x32_bf16 v[244:247], v[124:127], v[176:179], 0
  v_mfma_f32_16x16x32_bf16 v[248:251], v[128:131], v[176:179], 0
  v_mfma_f32_16x16x32_bf16 v[28:31], a[220:223], v[56:59], v[28:31]
  v_mfma_f32_16x16x32_bf16 v[252:255], v[132:135], v[176:179], 0
  v_mfma_f32_16x16x32_bf16 v[24:27], a[248:251], v[60:63], v[24:27]
  v_mfma_f32_16x16x16_bf16 v[192:195], v[136:137], v[174:175], v[192:195]
  v_mfma_f32_16x16x16_bf16 v[196:199], v[138:139], v[174:175], v[196:199]
  v_mfma_f32_16x16x32_bf16 v[28:31], a[252:255], v[60:63], v[28:31]
  s_nop 5
  v_cvt_pk_bf16_f32 v192, v192, v193
  v_cvt_pk_bf16_f32 v193, v194, v195
  v_mfma_f32_16x16x16_bf16 v[200:203], v[140:141], v[174:175], v[200:203]
  v_cvt_pk_bf16_f32 v194, v196, v197
  v_cvt_pk_bf16_f32 v195, v198, v199
  v_mfma_f32_16x16x16_bf16 v[204:207], v[142:143], v[174:175], v[204:207]
  ds_write_b128 v7, v[192:195] offset:0
  v_mfma_f32_16x16x16_bf16 v[208:211], v[144:145], v[174:175], v[208:211]
  s_nop 2
  v_cvt_pk_bf16_f32 v200, v200, v201
  v_cvt_pk_bf16_f32 v201, v202, v203
  v_mfma_f32_16x16x16_bf16 v[212:215], v[146:147], v[174:175], v[212:215]
  v_cvt_pk_bf16_f32 v202, v204, v205
  v_cvt_pk_bf16_f32 v203, v206, v207
  v_mfma_f32_16x16x16_bf16 v[216:219], v[148:149], v[174:175], v[216:219]
  ds_write_b128 v7, v[200:203] offset:2048
  v_mfma_f32_16x16x16_bf16 v[220:223], v[150:151], v[174:175], v[220:223]
  v_cvt_pk_bf16_f32 v24, v24, v25
  v_cvt_pk_bf16_f32 v25, v26, v27
  v_mfma_f32_16x16x16_bf16 v[224:227], v[136:137], v[180:181], v[224:227]
  v_cvt_pk_bf16_f32 v208, v208, v209
  v_cvt_pk_bf16_f32 v209, v210, v211
  v_mfma_f32_16x16x16_bf16 v[228:231], v[138:139], v[180:181], v[228:231]
  v_cvt_pk_bf16_f32 v210, v212, v213
  v_cvt_pk_bf16_f32 v211, v214, v215
  v_mfma_f32_16x16x16_bf16 v[232:235], v[140:141], v[180:181], v[232:235]
  ds_write_b128 v7, v[208:211] offset:4096
  v_mfma_f32_16x16x16_bf16 v[236:239], v[142:143], v[180:181], v[236:239]
  v_cvt_pk_bf16_f32 v26, v28, v29
  v_cvt_pk_bf16_f32 v27, v30, v31
  v_mfma_f32_16x16x16_bf16 v[240:243], v[144:145], v[180:181], v[240:243]
  v_cvt_pk_bf16_f32 v216, v216, v217
  v_cvt_pk_bf16_f32 v217, v218, v219
  v_mfma_f32_16x16x16_bf16 v[244:247], v[146:147], v[180:181], v[244:247]
  v_cvt_pk_bf16_f32 v218, v220, v221
  v_cvt_pk_bf16_f32 v219, v222, v223
  v_mfma_f32_16x16x16_bf16 v[248:251], v[148:149], v[180:181], v[248:251]
  ds_write_b128 v7, v[216:219] offset:6144
  v_mfma_f32_16x16x16_bf16 v[252:255], v[150:151], v[180:181], v[252:255]
  v_bfi_b32 v24, 1, s63, v24
  v_bfi_b32 v26, 1, s63, v26
  v_cvt_pk_bf16_f32 v224, v224, v225
  v_cvt_pk_bf16_f32 v225, v226, v227
  v_cvt_pk_bf16_f32 v226, v228, v229
  v_cvt_pk_bf16_f32 v227, v230, v231
  ds_write_b128 v7, v[224:227] offset:1024
  buffer_store_dwordx4 v[24:27], v0, s[12:15], s47 offen offset:3072
  v_cvt_pk_bf16_f32 v232, v232, v233
  v_cvt_pk_bf16_f32 v233, v234, v235
  v_cvt_pk_bf16_f32 v234, v236, v237
  v_cvt_pk_bf16_f32 v235, v238, v239
  ds_write_b128 v7, v[232:235] offset:3072
  v_cvt_pk_bf16_f32 v240, v240, v241
  v_cvt_pk_bf16_f32 v241, v242, v243
  v_cvt_pk_bf16_f32 v242, v244, v245
  v_cvt_pk_bf16_f32 v243, v246, v247
  ds_write_b128 v7, v[240:243] offset:5120
  v_cvt_pk_bf16_f32 v248, v248, v249
  v_cvt_pk_bf16_f32 v249, v250, v251
  v_cvt_pk_bf16_f32 v250, v252, v253
  v_cvt_pk_bf16_f32 v251, v254, v255
  ds_write_b128 v7, v[248:251] offset:7168
  v_add_u32 v9, s42, v9
  s_sub_u32 s42, 0, s42
  s_add_u32 s64, s64, 131072
  v_xor_b32 v7, 0x4000, v7
  s_nop 0
  s_branch L_awG_j
L_bpr_123:
  s_mov_b64 exec, s[66:67]
  buffer_load_dword v5, v1, s[12:15], s93 offen sc1
  s_mov_b64 exec, -1
  s_waitcnt vmcnt(0)
  s_sub_u32 s100, s100, 1
  s_cbranch_scc0 L_bpc_122
  s_branch L_end
L_awG_b1:
  v_mfma_f32_16x16x32_bf16 v[20:23], a[148:151], v[48:51], v[20:23]
  s_mov_b32 m0, s59
  s_nop 0
  buffer_load_dwordx4 v0, s[12:15], s64 offen offset:0 sc1 lds
  v_mfma_f32_16x16x32_bf16 v[16:19], a[176:179], v[52:55], v[16:19]
  buffer_load_dwordx4 v0, s[12:15], s64 offen offset:1024 sc1 lds
  v_mfma_f32_16x16x32_bf16 v[20:23], a[180:183], v[52:55], v[20:23]
  buffer_load_dwordx4 v0, s[12:15], s64 offen offset:2048 sc1 lds
  v_mfma_f32_16x16x32_bf16 v[16:19], a[208:211], v[56:59], v[16:19]
  buffer_load_dwordx4 v0, s[12:15], s64 offen offset:3072 sc1 lds
  s_add_u32 s98, s32, 1
  v_mfma_f32_16x16x32_bf16 v[20:23], a[212:215], v[56:59], v[20:23]
  v_mov_b32 v12, s98
  ds_write_b32 v8, v12
  v_mfma_f32_16x16x32_bf16 v[16:19], a[240:243], v[60:63], v[16:19]
  v_mfma_f32_16x16x32_bf16 v[20:23], a[244:247], v[60:63], v[20:23]
  v_mfma_f32_16x16x32_bf16 v[24:27], a[24:27], v[32:35], 0
  v_mfma_f32_16x16x32_bf16 v[28:31], a[28:31], v[32:35], 0
  ds_read_b128 v[32:35], v6 offset:1024
  s_nop 3
  v_cvt_pk_bf16_f32 v16, v16, v17
  v_cvt_pk_bf16_f32 v17, v18, v19
  v_mfma_f32_16x16x32_bf16 v[24:27], a[56:59], v[36:39], v[24:27]
  v_mfma_f32_16x16x32_bf16 v[28:31], a[60:63], v[36:39], v[28:31]
  ds_read_b128 v[36:39], v6 offset:3072
  v_cvt_pk_bf16_f32 v18, v20, v21
  v_cvt_pk_bf16_f32 v19, v22, v23
  v_mfma_f32_16x16x32_bf16 v[24:27], a[88:91], v[40:43], v[24:27]
  v_bfi_b32 v16, 1, s63, v16
  v_bfi_b32 v18, 1, s63, v18
  v_mfma_f32_16x16x32_bf16 v[28:31], a[92:95], v[40:43], v[28:31]
  ds_read_b128 v[40:43], v6 offset:5120
  v_mfma_f32_16x16x32_bf16 v[24:27], a[120:123], v[44:47], v[24:27]
  buffer_store_dwordx4 v[16:19], v0, s[12:15], s47 offen offset:0
  v_mfma_f32_16x16x32_bf16 v[28:31], a[124:127], v[44:47], v[28:31]
  ds_read_b128 v[44:47], v6 offset:7168
  v_mfma_f32_16x16x32_bf16 v[24:27], a[152:155], v[48:51], v[24:27]
  v_mfma_f32_16x16x32_bf16 v[28:31], a[156:159], v[48:51], v[28:31]
  ds_read_b128 v[48:51], v6 offset:9216
  v_mfma_f32_16x16x32_bf16 v[24:27], a[184:187], v[52:55], v[24:27]
  v_mfma_f32_16x16x32_bf16 v[28:31], a[188:191], v[52:55], v[28:31]
  ds_read_b128 v[52:55], v6 offset:11264
  v_mfma_f32_16x16x32_bf16 v[24:27], a[216:219], v[56:59], v[24:27]
  v_mfma_f32_16x16x32_bf16 v[28:31], a[220:223], v[56:59], v[28:31]
  ds_read_b128 v[56:59], v6 offset:13312
  v_mfma_f32_16x16x32_bf16 v[24:27], a[248:251], v[60:63], v[24:27]
  v_mfma_f32_16x16x32_bf16 v[28:31], a[252:255], v[60:63], v[28:31]
  ds_read_b128 v[60:63], v6 offset:15360
  v_xor_b32 v6, 0x4000, v6
  s_waitcnt lgkmcnt(7)
  v_mfma_f32_16x16x32_bf16 v[16:19], a[0:3], v[32:35], 0
  s_nop 2
  v_cvt_pk_bf16_f32 v24, v24, v25
  v_cvt_pk_bf16_f32 v25, v26, v27
  v_mfma_f32_16x16x32_bf16 v[20:23], a[4:7], v[32:35], 0
  v_cvt_pk_bf16_f32 v26, v28, v29
  v_cvt_pk_bf16_f32 v27, v30, v31
  s_waitcnt lgkmcnt(6)
  v_mfma_f32_16x16x32_bf16 v[16:19], a[32:35], v[36:39], v[16:19]
  v_bfi_b32 v24, 1, s63, v24
  v_bfi_b32 v26, 1, s63, v26
  v_mfma_f32_16x16x32_bf16 v[20:23], a[36:39], v[36:39], v[20:23]
  s_waitcnt lgkmcnt(5)
  v_mfma_f32_16x16x32_bf16 v[16:19], a[64:67], v[40:43], v[16:19]
  v_mfma_f32_16x16x32_bf16 v[20:23], a[68:71], v[40:43], v[20:23]
  s_waitcnt lgkmcnt(4)
  v_mfma_f32_16x16x32_bf16 v[16:19], a[96:99], v[44:47], v[16:19]
  buffer_store_dwordx4 v[24:27], v0, s[12:15], s47 offen offset:2048
  v_mfma_f32_16x16x32_bf16 v[20:23], a[100:103], v[44:47], v[20:23]
  s_waitcnt vmcnt(2)
  ds_read2_b64 v[136:139], v10 offset0:0 offset1:16
  ds_read2_b64 v[140:143], v10 offset0:128 offset1:144
  s_waitcnt lgkmcnt(5)
  v_mfma_f32_16x16x32_bf16 v[16:19], a[128:131], v[48:51], v[16:19]
  ds_read2_b64 v[144:147], v4 offset0:0 offset1:16
  ds_read2_b64 v[148:151], v4 offset0:128 offset1:144
  v_mfma_f32_16x16x32_bf16 v[20:23], a[132:135], v[48:51], v[20:23]
  s_waitcnt lgkmcnt(6)
  v_mfma_f32_16x16x32_bf16 v[16:19], a[160:163], v[52:55], v[16:19]
  v_mfma_f32_16x16x32_bf16 v[20:23], a[164:167], v[52:55], v[20:23]
  s_waitcnt lgkmcnt(3)
  v_mfma_f32_16x16x32_bf16 v[156:159], v[136:139], v[72:75], v[68:71]
  v_mfma_f32_16x16x32_bf16 v[168:171], v[136:139], v[76:79], v[68:71]
  v_mfma_f32_16x16x32_bf16 v[16:19], a[192:195], v[56:59], v[16:19]
  s_waitcnt lgkmcnt(2)
  v_mfma_f32_16x16x32_bf16 v[156:159], v[140:143], v[80:83], v[156:159]
  v_mfma_f32_16x16x32_bf16 v[168:171], v[140:143], v[84:87], v[168:171]
  v_mfma_f32_16x16x32_bf16 v[20:23], a[196:199], v[56:59], v[20:23]
  ds_read2st64_b64 v[136:139], v11 offset0:0 offset1:1
  ds_read2st64_b64 v[140:143], v11 offset0:2 offset1:3
  s_waitcnt lgkmcnt(3)
  v_mfma_f32_16x16x32_bf16 v[156:159], v[144:147], v[88:91], v[156:159]
  v_mfma_f32_16x16x32_bf16 v[168:171], v[144:147], v[92:95], v[168:171]
  ds_read2st64_b64 v[144:147], v11 offset0:4 offset1:5
  v_mfma_f32_16x16x32_bf16 v[16:19], a[224:227], v[60:63], v[16:19]
  s_waitcnt lgkmcnt(3)
  v_mfma_f32_16x16x32_bf16 v[156:159], v[148:151], v[96:99], v[156:159]
  v_mfma_f32_16x16x32_bf16 v[168:171], v[148:151], v[100:103], v[168:171]
  ds_read2st64_b64 v[148:151], v11 offset0:6 offset1:7
  v_max3_f32 v186, v160, v161, v162
  v_max3_f32 v184, v152, v153, v154
  v_mfma_f32_16x16x32_bf16 v[20:23], a[228:231], v[60:63], v[20:23]
  v_max3_f32 v186, v186, v163, v164
  v_cvt_pk_bf16_f32 v16, v16, v17
  v_mfma_f32_16x16x32_bf16 v[24:27], a[8:11], v[32:35], 0
  v_cvt_pk_bf16_f32 v17, v18, v19
  v_max3_f32 v184, v184, v155, v156
  v_mfma_f32_16x16x32_bf16 v[28:31], a[12:15], v[32:35], 0
  s_nop 1
  v_cvt_pk_bf16_f32 v18, v20, v21
  v_cvt_pk_bf16_f32 v19, v22, v23
  v_mfma_f32_16x16x32_bf16 v[24:27], a[40:43], v[36:39], v[24:27]
  v_max3_f32 v186, v186, v165, v166
  v_bfi_b32 v16, 1, s63, v16
  v_mfma_f32_16x16x32_bf16 v[28:31], a[44:47], v[36:39], v[28:31]
  v_bfi_b32 v18, 1, s63, v18
  v_max3_f32 v184, v184, v157, v158
  v_mfma_f32_16x16x32_bf16 v[24:27], a[72:75], v[40:43], v[24:27]
  v_mfma_f32_16x16x32_bf16 v[28:31], a[76:79], v[40:43], v[28:31]
  v_mfma_f32_16x16x32_bf16 v[24:27], a[104:107], v[44:47], v[24:27]
  buffer_store_dwordx4 v[16:19], v0, s[12:15], s46 offen offset:1024
  v_mfma_f32_16x16x32_bf16 v[28:31], a[108:111], v[44:47], v[28:31]
  v_max3_f32 v186, v186, v167, v168
  v_max_f32 v184, v184, v159
  v_mfma_f32_16x16x32_bf16 v[24:27], a[136:139], v[48:51], v[24:27]
  v_max3_f32 v186, v186, v169, v170
  v_mov_b32 v185, v184
  v_mfma_f32_16x16x32_bf16 v[28:31], a[140:143], v[48:51], v[28:31]
  v_max_f32 v186, v186, v171
  v_mfma_f32_16x16x32_bf16 v[24:27], a[168:171], v[52:55], v[24:27]
  v_permlane16_swap_b32 v184, v185
  v_mfma_f32_16x16x32_bf16 v[28:31], a[172:175], v[52:55], v[28:31]
  v_mov_b32 v187, v186
  v_max_f32 v184, v184, v185
  v_mfma_f32_16x16x32_bf16 v[24:27], a[200:203], v[56:59], v[24:27]
  v_permlane16_swap_b32 v186, v187
  v_mfma_f32_16x16x32_bf16 v[28:31], a[204:207], v[56:59], v[28:31]
  v_mov_b32 v185, v184
  v_max_f32 v186, v186, v187
  v_mfma_f32_16x16x32_bf16 v[24:27], a[232:235], v[60:63], v[24:27]
  v_permlane32_swap_b32 v184, v185
  v_mfma_f32_16x16x32_bf16 v[28:31], a[236:239], v[60:63], v[28:31]
  v_mov_b32 v187, v186
  v_max_f32 v184, v184, v185
  v_mfma_f32_16x16x32_bf16 v[16:19], a[16:19], v[32:35], 0
  v_permlane32_swap_b32 v186, v187
  v_mfma_f32_16x16x32_bf16 v[20:23], a[20:23], v[32:35], 0
  v_mul_f32 v184, s94, v184
  v_max_f32 v186, v186, v187
  v_mfma_f32_16x16x32_bf16 v[16:19], a[48:51], v[36:39], v[16:19]
  v_fma_f32 v152, v152, s94, -v184
  v_mul_f32 v186, s94, v186
  v_mfma_f32_16x16x32_bf16 v[20:23], a[52:55], v[36:39], v[20:23]
  v_fma_f32 v153, v153, s94, -v184
  v_fma_f32 v160, v160, s94, -v186
  v_mfma_f32_16x16x32_bf16 v[16:19], a[80:83], v[40:43], v[16:19]
  v_fma_f32 v154, v154, s94, -v184
  v_fma_f32 v161, v161, s94, -v186
  v_mfma_f32_16x16x32_bf16 v[20:23], a[84:87], v[40:43], v[20:23]
  v_fma_f32 v155, v155, s94, -v184
  v_fma_f32 v162, v162, s94, -v186
  v_mfma_f32_16x16x32_bf16 v[16:19], a[112:115], v[44:47], v[16:19]
  v_fma_f32 v156, v156, s94, -v184
  v_fma_f32 v163, v163, s94, -v186
  v_mfma_f32_16x16x32_bf16 v[20:23], a[116:119], v[44:47], v[20:23]
  v_fma_f32 v157, v157, s94, -v184
  s_mov_b32 m0, s45
  v_mfma_f32_16x16x32_bf16 v[16:19], a[144:147], v[48:51], v[16:19]
  s_mov_b64 exec, s[40:41]
  buffer_load_dword v1, s[12:15], s65 offen sc1 lds
  s_mov_b64 exec, -1
  v_mfma_f32_16x16x32_bf16 v[20:23], a[148:151], v[48:51], v[20:23]
  v_fma_f32 v164, v164, s94, -v186
  v_cvt_pk_bf16_f32 v24, v24, v25
  v_mfma_f32_16x16x32_bf16 v[16:19], a[176:179], v[52:55], v[16:19]
  v_cvt_pk_bf16_f32 v25, v26, v27
  v_fma_f32 v158, v158, s94, -v184
  v_mfma_f32_16x16x32_bf16 v[20:23], a[180:183], v[52:55], v[20:23]
  v_cvt_pk_bf16_f32 v26, v28, v29
  v_cvt_pk_bf16_f32 v27, v30, v31
  v_mfma_f32_16x16x32_bf16 v[16:19], a[208:211], v[56:59], v[16:19]
  v_fma_f32 v165, v165, s94, -v186
  v_bfi_b32 v24, 1, s63, v24
  v_mfma_f32_16x16x32_bf16 v[20:23], a[212:215], v[56:59], v[20:23]
  v_bfi_b32 v26, 1, s63, v26
  v_fma_f32 v159, v159, s94, -v184
  v_mfma_f32_16x16x32_bf16 v[16:19], a[240:243], v[60:63], v[16:19]
  buffer_store_dwordx4 v[24:27], v0, s[12:15], s46 offen offset:3072
  v_fma_f32 v166, v166, s94, -v186
  v_mfma_f32_16x16x32_bf16 v[20:23], a[244:247], v[60:63], v[20:23]
  v_exp_f32 v152, v152
  v_fma_f32 v167, v167, s94, -v186
  v_mfma_f32_16x16x32_bf16 v[24:27], a[24:27], v[32:35], 0
  v_exp_f32 v153, v153
  v_fma_f32 v168, v168, s94, -v186
  v_mfma_f32_16x16x32_bf16 v[28:31], a[28:31], v[32:35], 0
  v_exp_f32 v154, v154
  v_fma_f32 v169, v169, s94, -v186
  v_mfma_f32_16x16x32_bf16 v[24:27], a[56:59], v[36:39], v[24:27]
  v_add_f32 v184, v152, v153
  v_fma_f32 v170, v170, s94, -v186
  v_mfma_f32_16x16x32_bf16 v[28:31], a[60:63], v[36:39], v[28:31]
  v_exp_f32 v155, v155
  v_fma_f32 v171, v171, s94, -v186
  v_mfma_f32_16x16x32_bf16 v[24:27], a[88:91], v[40:43], v[24:27]
  v_add_f32 v184, v184, v154
  v_exp_f32 v160, v160
  v_mfma_f32_16x16x32_bf16 v[28:31], a[92:95], v[40:43], v[28:31]
  v_exp_f32 v156, v156
  v_mfma_f32_16x16x32_bf16 v[24:27], a[120:123], v[44:47], v[24:27]
  v_exp_f32 v161, v161
  v_add_f32 v184, v184, v155
  v_mfma_f32_16x16x32_bf16 v[28:31], a[124:127], v[44:47], v[28:31]
  v_exp_f32 v162, v162
  v_mfma_f32_16x16x32_bf16 v[24:27], a[152:155], v[48:51], v[24:27]
  v_exp_f32 v157, v157
  v_add_f32 v186, v160, v161
  v_mfma_f32_16x16x32_bf16 v[28:31], a[156:159], v[48:51], v[28:31]
  v_add_f32 v184, v184, v156
  v_exp_f32 v163, v163
  v_mfma_f32_16x16x32_bf16 v[24:27], a[184:187], v[52:55], v[24:27]
  v_exp_f32 v158, v158
  v_add_f32 v186, v186, v162
  v_mfma_f32_16x16x32_bf16 v[28:31], a[188:191], v[52:55], v[28:31]
  v_cvt_pk_bf16_f32 v16, v16, v17
  v_cvt_pk_bf16_f32 v17, v18, v19
  v_add_f32 v184, v184, v157
  v_mfma_f32_16x16x32_bf16 v[24:27], a[216:219], v[56:59], v[24:27]
  v_cvt_pk_bf16_f32 v18, v20, v21
  v_cvt_pk_bf16_f32 v19, v22, v23
  v_mfma_f32_16x16x32_bf16 v[28:31], a[220:223], v[56:59], v[28:31]
  v_bfi_b32 v16, 1, s63, v16
  v_bfi_b32 v18, 1, s63, v18
  v_mfma_f32_16x16x32_bf16 v[24:27], a[248:251], v[60:63], v[24:27]
  buffer_store_dwordx4 v[16:19], v0, s[12:15], s47 offen offset:1024
  v_mfma_f32_16x16x32_bf16 v[28:31], a[252:255], v[60:63], v[28:31]
  v_exp_f32 v164, v164
  v_exp_f32 v159, v159
  v_add_f32 v186, v186, v163
  v_add_f32 v184, v184, v158
  v_exp_f32 v165, v165
  v_add_f32 v184, v184, v159
  v_add_f32 v186, v186, v164
  v_mov_b32 v185, v184
  v_exp_f32 v166, v166
  s_nop 0
  v_permlane16_swap_b32 v184, v185
  v_add_f32 v186, v186, v165
  v_add_f32 v184, v184, v185
  v_exp_f32 v167, v167
  v_mov_b32 v185, v184
  v_add_f32 v186, v186, v166
  s_nop 0
  v_permlane32_swap_b32 v184, v185
  v_exp_f32 v168, v168
  v_add_f32 v184, v184, v185
  v_add_f32 v186, v186, v167
  v_rcp_f32 v184, v184
  v_exp_f32 v169, v169
  v_mul_f32 v152, v184, v152
  v_cvt_pk_bf16_f32 v24, v24, v25
  v_cvt_pk_bf16_f32 v25, v26, v27
  v_add_f32 v186, v186, v168
  v_cvt_pk_bf16_f32 v26, v28, v29
  v_cvt_pk_bf16_f32 v27, v30, v31
  v_mul_f32 v153, v184, v153
  v_bfi_b32 v24, 1, s63, v24
  v_bfi_b32 v26, 1, s63, v26
  buffer_store_dwordx4 v[24:27], v0, s[12:15], s47 offen offset:3072
  v_exp_f32 v170, v170
  v_mul_f32 v154, v184, v154
  v_add_f32 v186, v186, v169
  v_mul_f32 v155, v184, v155
  v_exp_f32 v171, v171
  v_mul_f32 v156, v184, v156
  v_add_f32 v186, v186, v170
  v_mul_f32 v157, v184, v157
  v_add_f32 v186, v186, v171
  v_mul_f32 v158, v184, v158
  v_mov_b32 v187, v186
  v_mul_f32 v159, v184, v159
  s_nop 0
  v_permlane16_swap_b32 v186, v187
  v_cvt_pk_bf16_f32 v172, v152, v153
  v_add_f32 v186, v186, v187
  v_cvt_pk_bf16_f32 v173, v154, v155
  v_mov_b32 v187, v186
  s_nop 0
  v_mfma_f32_16x16x16_bf16 v[192:195], v[104:105], v[172:173], 0
  v_cvt_pk_bf16_f32 v174, v156, v157
  v_mfma_f32_16x16x16_bf16 v[196:199], v[108:109], v[172:173], 0
  v_permlane32_swap_b32 v186, v187
  v_mfma_f32_16x16x16_bf16 v[200:203], v[112:113], v[172:173], 0
  v_cvt_pk_bf16_f32 v175, v158, v159
  v_add_f32 v186, v186, v187
  v_mfma_f32_16x16x16_bf16 v[204:207], v[116:117], v[172:173], 0
  v_rcp_f32 v186, v186
  v_mfma_f32_16x16x16_bf16 v[208:211], v[120:121], v[172:173], 0
  v_mul_f32 v160, v186, v160
  v_mul_f32 v161, v186, v161
  v_mfma_f32_16x16x16_bf16 v[212:215], v[124:125], v[172:173], 0
  v_mul_f32 v162, v186, v162
  v_mul_f32 v163, v186, v163
  v_mfma_f32_16x16x16_bf16 v[216:219], v[128:129], v[172:173], 0
  v_mul_f32 v164, v186, v164
  v_mul_f32 v165, v186, v165
  v_mfma_f32_16x16x16_bf16 v[220:223], v[132:133], v[172:173], 0
  v_mul_f32 v166, v186, v166
  v_mul_f32 v167, v186, v167
  v_mul_f32 v168, v186, v168
  v_mul_f32 v169, v186, v169
  v_mul_f32 v170, v186, v170
  v_mul_f32 v171, v186, v171
  v_cvt_pk_bf16_f32 v176, v160, v161
  v_cvt_pk_bf16_f32 v177, v162, v163
  v_cvt_pk_bf16_f32 v178, v164, v165
  v_cvt_pk_bf16_f32 v179, v166, v167
  v_cvt_pk_bf16_f32 v180, v168, v169
  v_cvt_pk_bf16_f32 v181, v170, v171
  v_mfma_f32_16x16x32_bf16 v[224:227], v[104:107], v[176:179], 0
  v_mfma_f32_16x16x32_bf16 v[228:231], v[108:111], v[176:179], 0
  v_mfma_f32_16x16x32_bf16 v[232:235], v[112:115], v[176:179], 0
  v_mfma_f32_16x16x32_bf16 v[236:239], v[116:119], v[176:179], 0
  v_mfma_f32_16x16x32_bf16 v[240:243], v[120:123], v[176:179], 0
  v_mfma_f32_16x16x32_bf16 v[244:247], v[124:127], v[176:179], 0
  v_mfma_f32_16x16x32_bf16 v[248:251], v[128:131], v[176:179], 0
  v_mfma_f32_16x16x32_bf16 v[252:255], v[132:135], v[176:179], 0
  s_waitcnt lgkmcnt(3)
  v_mfma_f32_16x16x16_bf16 v[192:195], v[136:137], v[174:175], v[192:195]
  v_mfma_f32_16x16x16_bf16 v[196:199], v[138:139], v[174:175], v[196:199]
  s_waitcnt lgkmcnt(2)
  v_mfma_f32_16x16x16_bf16 v[200:203], v[140:141], v[174:175], v[200:203]
  s_nop 4
  v_cvt_pk_bf16_f32 v192, v192, v193
  v_cvt_pk_bf16_f32 v193, v194, v195
  v_mfma_f32_16x16x16_bf16 v[204:207], v[142:143], v[174:175], v[204:207]
  v_cvt_pk_bf16_f32 v194, v196, v197
  v_cvt_pk_bf16_f32 v195, v198, v199
  s_waitcnt lgkmcnt(1)
  v_mfma_f32_16x16x16_bf16 v[208:211], v[144:145], v[174:175], v[208:211]
  ds_write_b128 v7, v[192:195] offset:0
  v_mfma_f32_16x16x16_bf16 v[212:215], v[146:147], v[174:175], v[212:215]
  v_cvt_pk_bf16_f32 v200, v200, v201
  v_cvt_pk_bf16_f32 v201, v202, v203
  s_waitcnt lgkmcnt(1)
  v_mfma_f32_16x16x16_bf16 v[216:219], v[148:149], v[174:175], v[216:219]
  v_cvt_pk_bf16_f32 v202, v204, v205
  v_cvt_pk_bf16_f32 v203, v206, v207
  v_mfma_f32_16x16x16_bf16 v[220:223], v[150:151], v[174:175], v[220:223]
  ds_write_b128 v7, v[200:203] offset:2048
  v_mfma_f32_16x16x16_bf16 v[224:227], v[136:137], v[180:181], v[224:227]
  v_cvt_pk_bf16_f32 v208, v208, v209
  v_cvt_pk_bf16_f32 v209, v210, v211
  v_mfma_f32_16x16x16_bf16 v[228:231], v[138:139], v[180:181], v[228:231]
  v_cvt_pk_bf16_f32 v210, v212, v213
  v_cvt_pk_bf16_f32 v211, v214, v215
  v_mfma_f32_16x16x16_bf16 v[232:235], v[140:141], v[180:181], v[232:235]
  ds_write_b128 v7, v[208:211] offset:4096
  v_mfma_f32_16x16x16_bf16 v[236:239], v[142:143], v[180:181], v[236:239]
  v_cvt_pk_bf16_f32 v216, v216, v217
  v_cvt_pk_bf16_f32 v217, v218, v219
  v_mfma_f32_16x16x16_bf16 v[240:243], v[144:145], v[180:181], v[240:243]
  v_cvt_pk_bf16_f32 v218, v220, v221
  v_cvt_pk_bf16_f32 v219, v222, v223
  v_mfma_f32_16x16x16_bf16 v[244:247], v[146:147], v[180:181], v[244:247]
  ds_write_b128 v7, v[216:219] offset:6144
  v_mfma_f32_16x16x16_bf16 v[248:251], v[148:149], v[180:181], v[248:251]
  v_cvt_pk_bf16_f32 v224, v224, v225
  v_cvt_pk_bf16_f32 v225, v226, v227
  v_mfma_f32_16x16x16_bf16 v[252:255], v[150:151], v[180:181], v[252:255]
  v_cvt_pk_bf16_f32 v226, v228, v229
  v_cvt_pk_bf16_f32 v227, v230, v231
  ds_write_b128 v7, v[224:227] offset:1024
  v_cvt_pk_bf16_f32 v232, v232, v233
  v_cvt_pk_bf16_f32 v233, v234, v235
  v_cvt_pk_bf16_f32 v234, v236, v237
  v_cvt_pk_bf16_f32 v235, v238, v239
  ds_write_b128 v7, v[232:235] offset:3072
  v_cvt_pk_bf16_f32 v240, v240, v241
  v_cvt_pk_bf16_f32 v241, v242, v243
  v_cvt_pk_bf16_f32 v242, v244, v245
  v_cvt_pk_bf16_f32 v243, v246, v247
  ds_write_b128 v7, v[240:243] offset:5120
  v_cvt_pk_bf16_f32 v248, v248, v249
  v_cvt_pk_bf16_f32 v249, v250, v251
  v_cvt_pk_bf16_f32 v250, v252, v253
  v_cvt_pk_bf16_f32 v251, v254, v255
  ds_write_b128 v7, v[248:251] offset:7168
  v_add_u32 v9, s42, v9
  s_sub_u32 s42, 0, s42
  s_add_u32 s64, s64, 131072
  v_xor_b32 v7, 0x4000, v7
  s_nop 0
  s_branch L_awG_j
L_bpr_126:
  s_mov_b64 exec, s[66:67]
  buffer_load_dword v5, v1, s[12:15], s93 offen sc1
  s_mov_b64 exec, -1
  s_waitcnt vmcnt(0)
  s_sub_u32 s100, s100, 1
  s_cbranch_scc0 L_bpc_125
  s_branch L_end
L_down:
  s_load_dwordx2 s[16:17], s[0:1], 80
  s_mov_b32 s18, 5308416
  s_mov_b32 s19, 0x20000
  s_waitcnt lgkmcnt(0)
  s_and_b32 s17, s17, 0xffff
  s_load_dwordx2 s[20:21], s[0:1], 88
  s_mov_b32 s22, 2359296
  s_mov_b32 s23, 0x20000
  s_waitcnt lgkmcnt(0)
  s_and_b32 s21, s21, 0xffff
  v_lshlrev_b32 v0, 4, v63
  v_lshlrev_b32 v1, 2, v63
  v_lshlrev_b32 v8, 3, v63
  s_and_b32 s64, s10, 7
  s_bfe_u32 s65, s10, 0x10003
  s_and_b32 s60, s9, 1
  s_lshl_b32 s98, s60, 10
  v_add_u32 v2, s98, v0
  s_xor_b32 s98, s98, 1024
  v_add_u32 v3, s98, v0
  s_lshl_b32 s98, s60, 8
  v_add_u32 v4, s98, v1
  s_xor_b32 s98, s98, 256
  v_add_u32 v5, s98, v1
  v_and_b32 v60, 15, v63
  v_mul_u32_u24 v9, 1152, v60
  v_lshrrev_b32 v60, 4, v63
  v_lshl_add_u32 v9, v60, 4, v9
  s_lshl_b32 s98, s64, 2
  s_add_u32 s98, s98, s9
  s_mul_i32 s33, s98, 9216
  s_mul_i32 s99, s11, 18874368
  s_add_u32 s33, s33, s99
  s_add_u32 s33, s33, 138412032
  s_mul_i32 s34, s9, 9216
  s_add_u32 s39, s34, 36864
  s_xor_b32 s39, s39, s34
  s_lshl_b32 s36, s11, 5
  s_add_u32 s36, s36, s98
  s_mul_i32 s36, s36, 256
  s_add_u32 s36, s36, 266240
  s_mov_b32 s40, 0xf
  s_mov_b32 s41, 0
  s_mov_b32 s42, 36864
  s_mul_i32 s61, s11, 0x140000
  s_mul_i32 s98, s65, 148480
  s_add_u32 s61, s61, s98
  s_add_u32 s61, s61, 206569472
  s_mul_i32 s95, s64, 18560
  s_add_u32 s95, s95, s61
  s_lshl_b32 s98, s9, 12
  s_add_u32 s46, s95, s98
  s_lshl_b32 s98, s60, 10
  s_add_u32 s47, s46, 1024
  s_sub_u32 s47, s47, s98
  s_add_u32 s46, s46, s98
  s_add_u32 s48, s95, s98
  s_add_u32 s48, s48, 16384
  s_lshl_b32 s99, s64, 11
  s_add_u32 s49, s61, s99
  s_add_u32 s49, s49, s98
  s_lshl_b32 s99, s64, 7
  s_add_u32 s57, s61, s99
  s_add_u32 s57, s57, s98
  s_add_u32 s57, s57, 16384
  s_mul_i32 s98, s65, 18
  s_add_u32 s98, s98, s60
  s_add_u32 s55, s98, 16
  s_mul_i32 s55, s55, 1152
  s_add_u32 s55, s55, s99
  s_lshl_b32 s99, s64, 1
  s_add_u32 s98, s98, s99
  s_mul_i32 s38, s98, 1152
  s_mul_i32 s99, s11, 2654208
  s_add_u32 s99, s99, 14680064
  s_add_u32 s58, s38, s99
  s_add_u32 s56, s55, s99
  s_add_u32 s38, s38, 11042816
  s_add_u32 s55, s55, 11042816
  s_mul_i32 s37, s60, 256
  s_and_b32 s98, s10, 15
  s_lshl_b32 s98, s98, 2
  s_add_u32 s37, s37, s98
  s_add_u32 s37, s37, 263168
  s_mul_i32 s59, s60, 18432
  s_mul_i32 s98, s65, 576
  s_add_u32 s59, s59, s98
  s_and_b32 s98, s64, 1
  s_mul_i32 s54, s98, 9216
  s_lshr_b32 s98, s64, 1
  s_lshl_b32 s98, s98, 4
  s_add_u32 s54, s54, s98
  s_add_u32 s54, s54, s59
  s_add_u32 s54, s54, 512
  s_lshl_b32 s98, s64, 6
  s_add_u32 s59, s59, s98
  s_mul_i32 s62, s9, 40960
  s_mul_i32 s90, s64, 663552
  s_mul_i32 s98, s65, 576
  s_add_u32 s90, s90, s98
  s_add_u32 s91, s90, 512
  s_lshl_b32 s98, s9, 7
  s_add_u32 s90, s90, s98
  s_mov_b32 s32, 0
  s_mov_b32 s50, 0
  s_mov_b32 s92, 0
  s_mov_b32 s43, 0
  s_lshl_b32 s93, s11, 1
  s_add_u32 s93, s93, s65
  s_lshl_b32 s93, s93, 8
  s_add_u32 s93, s93, 33792
  v_mov_b32 v7, 0
  buffer_store_dword v7, v1, s[12:15], s93 offen
  s_sub_u32 s68, s11, 1
  s_mov_b32 s69, s68
  s_and_b32 s94, s68, 41472
  s_lshr_b32 s98, s9, 1
  s_or_b32 s98, s98, s11
  s_cmp_lg_u32 s98, 0
  s_cbranch_scc1 L_dn_nf
  v_mov_b32 v7, 0
  s_mov_b64 exec, 1
  buffer_store_dword v7, off, s[12:15], s37 sc1
  s_mov_b64 exec, -1
L_dn_nf:
  v_mov_b32 v16, 1
  v_mov_b32 v17, 1
  v_mov_b32 v18, 1
  v_mov_b32 v19, 1
  s_mul_i32 s98, s9, 4608
  s_add_u32 s98, s98, s95
  s_add_u32 s99, s98, 0
  buffer_store_dwordx4 v[16:19], v0, s[12:15], s99 offen offset:0
  buffer_store_dwordx4 v[16:19], v0, s[12:15], s99 offen offset:1024
  buffer_store_dwordx4 v[16:19], v0, s[12:15], s99 offen offset:2048
  buffer_store_dwordx4 v[16:19], v0, s[12:15], s99 offen offset:3072
  buffer_store_dwordx4 v[16:19], v0, s[12:15], s99 offen offset:3584
  s_add_u32 s99, s98, 296960
  buffer_store_dwordx4 v[16:19], v0, s[12:15], s99 offen offset:0
  buffer_store_dwordx4 v[16:19], v0, s[12:15], s99 offen offset:1024
  buffer_store_dwordx4 v[16:19], v0, s[12:15], s99 offen offset:2048
  buffer_store_dwordx4 v[16:19], v0, s[12:15], s99 offen offset:3072
  buffer_store_dwordx4 v[16:19], v0, s[12:15], s99 offen offset:3584
  s_waitcnt vmcnt(0)
  s_barrier
  s_cmp_lg_u32 s9, 0
  s_cbranch_scc1 L_arr_127
  s_mov_b64 exec, 1
  v_mov_b32 v60, 64
  v_mov_b32 v61, 1
  global_atomic_add v60, v61, s[4:5] sc1
  s_mov_b64 exec, -1
L_arr_127:
  v_lshrrev_b32 v60, 4, v63
  v_lshlrev_b32 v32, 9, v60
  v_bfe_u32 v60, v63, 2, 2
  v_lshl_add_u32 v32, v60, 6, v32
  v_and_b32 v60, 3, v63
  v_lshl_add_u32 v32, v60, 4, v32
  v_add_u32 v32, s62, v32
  s_and_b32 s98, s64, 1
  s_lshl_b32 s98, s98, 3
  v_add_u32 v35, s98, v32
  v_xor_b32 v36, 8, v35
  v_lshrrev_b32 v60, 2, v63
  v_mul_u32_u24 v33, 1152, v60
  v_and_b32 v60, 3, v63
  v_lshl_add_u32 v33, v60, 4, v33
  v_bfe_u32 v60, v63, 4, 1
  v_mul_u32_u24 v34, 144, v60
  v_bfe_u32 v60, v63, 3, 1
  v_lshl_add_u32 v34, v60, 3, v34
  v_lshrrev_b32 v60, 5, v63
  v_lshl_add_u32 v34, v60, 2, v34
  v_bfe_u32 v60, v63, 2, 1
  v_lshl_add_u32 v34, v60, 1, v34
  v_mul_u32_u24 v34, 1152, v34
  v_and_b32 v60, 3, v63
  v_lshl_add_u32 v34, v60, 4, v34
  s_cmp_ge_u32 s9, 2
  s_cbranch_scc1 L_dn_G
  v_and_b32 v60, 1, v63
  v_lshlrev_b32 v60, 4, v60
  v_mov_b32 v61, 0x3f80
  v_lshlrev_b32 v61, v60, v61
  v_bfe_u32 v60, v63, 1, 3
  v_lshrrev_b32 v62, 4, v63
  v_lshlrev_b32 v62, 1, v62
  v_sub_u32 v60, v60, v62
  v_cmp_eq_u32 vcc, 0, v60
  s_nop 1
  v_cndmask_b32 v72, 0, v61, vcc
  v_cmp_eq_u32 vcc, 1, v60
  s_nop 1
  v_cndmask_b32 v73, 0, v61, vcc
  v_mov_b32 v74, v72
  v_mov_b32 v75, v73
  v_and_b32 v60, 15, v63
  v_and_b32 v61, 1, v60
  v_lshlrev_b32 v61, 4, v61
  v_mov_b32 v62, 0x3f80
  v_lshlrev_b32 v62, v61, v62
  v_lshrrev_b32 v60, 1, v60
  v_cmp_eq_u32 vcc, 0, v60
  s_nop 1
  v_cndmask_b32 v76, 0, v62, vcc
  v_cmp_eq_u32 vcc, 1, v60
  s_nop 1
  v_cndmask_b32 v77, 0, v62, vcc
  v_cmp_eq_u32 vcc, 2, v60
  s_nop 1
  v_cndmask_b32 v78, 0, v62, vcc
  v_cmp_eq_u32 vcc, 3, v60
  s_nop 1
  v_cndmask_b32 v79, 0, v62, vcc
  v_lshrrev_b32 v60, 3, v63
  v_mul_u32_u24 v11, 18560, v60
  v_and_b32 v60, 7, v63
  v_lshl_add_u32 v11, v60, 4, v11
  s_and_b32 s98, s10, 1
  s_lshl_b32 s98, s98, 3
  s_lshl_b32 s52, 0x00ff00ff, s98
  s_mov_b32 s53, s52
  v_mov_b32 v132, 0
  v_mov_b32 v133, 0
  v_mov_b32 v134, 0
  v_mov_b32 v135, 0
  v_mov_b32 v136, 0x3f803f80
  v_mov_b32 v137, 0x3f803f80
  v_mov_b32 v138, 0x3f803f80
  v_mov_b32 v139, 0x3f803f80
  v_and_b32 v8, 15, v63
  v_lshlrev_b32 v8, 3, v8
  s_mov_b32 s70, 0x00f0000f
  s_mov_b32 s71, 0xf0000f00
  s_mov_b32 s72, 0xaaaaaaaa
  s_mov_b32 s73, 0xaaaaaaaa
  s_mov_b32 s74, 0xcccccccc
  s_mov_b32 s75, 0xcccccccc
  s_cmp_lg_u32 s9, 3
  s_cbranch_scc1 L_gw_128b
  s_cmp_lg_u32 s11, 0
  s_cbranch_scc1 L_gw_128a
  v_mov_b32 v60, 128
  s_mov_b64 exec, 1
L_wa_129:
  global_load_dword v61, v60, s[4:5] sc1
  s_waitcnt vmcnt(0)
  v_readfirstlane_b32 s98, v61
  s_nop 0
  s_cmp_ge_u32 s98, 32
  s_nop 1
  s_cbranch_scc1 L_wa_129d
  s_sleep 24
  s_sub_u32 s100, s100, 1
  s_cbranch_scc0 L_wa_129
  s_branch L_end
L_wa_129d:
  s_mov_b64 exec, -1
  s_branch L_gw_128b
L_gw_128a:
  v_mov_b32 v60, 192
  s_mov_b64 exec, 1
L_wa_130:
  global_load_dword v61, v60, s[4:5] sc1
  s_waitcnt vmcnt(0)
  v_readfirstlane_b32 s98, v61
  s_nop 0
  s_cmp_ge_u32 s98, 32
  s_nop 1
  s_cbranch_scc1 L_wa_130d
  s_sleep 48
  s_sub_u32 s100, s100, 1
  s_cbranch_scc0 L_wa_130
  s_branch L_end
L_wa_130d:
  s_mov_b64 exec, -1
L_gw_128b:
  s_barrier
  s_add_u32 m0, s62, 0
  s_add_u32 s99, s90, 0
  buffer_load_dwordx4 v33, s[16:19], s99 offen  lds
  s_add_u32 m0, s62, 1024
  s_add_u32 s99, s90, 18432
  buffer_load_dwordx4 v33, s[16:19], s99 offen  lds
  s_add_u32 m0, s62, 2048
  s_add_u32 s99, s90, 64
  buffer_load_dwordx4 v33, s[16:19], s99 offen  lds
  s_add_u32 m0, s62, 3072
  s_add_u32 s99, s90, 18496
  buffer_load_dwordx4 v33, s[16:19], s99 offen  lds
  s_add_u32 m0, s62, 4096
  s_add_u32 s99, s90, 36864
  buffer_load_dwordx4 v33, s[16:19], s99 offen  lds
  s_add_u32 m0, s62, 5120
  s_add_u32 s99, s90, 55296
  buffer_load_dwordx4 v33, s[16:19], s99 offen  lds
  s_add_u32 m0, s62, 6144
  s_add_u32 s99, s90, 36928
  buffer_load_dwordx4 v33, s[16:19], s99 offen  lds
  s_add_u32 m0, s62, 7168
  s_add_u32 s99, s90, 55360
  buffer_load_dwordx4 v33, s[16:19], s99 offen  lds
  s_add_u32 m0, s62, 8192
  s_add_u32 s99, s90, 73728
  buffer_load_dwordx4 v33, s[16:19], s99 offen  lds
  s_add_u32 m0, s62, 9216
  s_add_u32 s99, s90, 92160
  buffer_load_dwordx4 v33, s[16:19], s99 offen  lds
  s_add_u32 m0, s62, 10240
  s_add_u32 s99, s90, 73792
  buffer_load_dwordx4 v33, s[16:19], s99 offen  lds
  s_add_u32 m0, s62, 11264
  s_add_u32 s99, s90, 92224
  buffer_load_dwordx4 v33, s[16:19], s99 offen  lds
  s_add_u32 m0, s62, 12288
  s_add_u32 s99, s90, 110592
  buffer_load_dwordx4 v33, s[16:19], s99 offen  lds
  s_add_u32 m0, s62, 13312
  s_add_u32 s99, s90, 129024
  buffer_load_dwordx4 v33, s[16:19], s99 offen  lds
  s_add_u32 m0, s62, 14336
  s_add_u32 s99, s90, 110656
  buffer_load_dwordx4 v33, s[16:19], s99 offen  lds
  s_add_u32 m0, s62, 15360
  s_add_u32 s99, s90, 129088
  buffer_load_dwordx4 v33, s[16:19], s99 offen  lds
  s_add_u32 m0, s62, 16384
  s_add_u32 s99, s90, 165888
  buffer_load_dwordx4 v33, s[16:19], s99 offen  lds
  s_add_u32 m0, s62, 17408
  s_add_u32 s99, s90, 184320
  buffer_load_dwordx4 v33, s[16:19], s99 offen  lds
  s_add_u32 m0, s62, 18432
  s_add_u32 s99, s90, 165952
  buffer_load_dwordx4 v33, s[16:19], s99 offen  lds
  s_add_u32 m0, s62, 19456
  s_add_u32 s99, s90, 184384
  buffer_load_dwordx4 v33, s[16:19], s99 offen  lds
  s_add_u32 m0, s62, 20480
  s_add_u32 s99, s90, 202752
  buffer_load_dwordx4 v33, s[16:19], s99 offen  lds
  s_add_u32 m0, s62, 21504
  s_add_u32 s99, s90, 221184
  buffer_load_dwordx4 v33, s[16:19], s99 offen  lds
  s_add_u32 m0, s62, 22528
  s_add_u32 s99, s90, 202816
  buffer_load_dwordx4 v33, s[16:19], s99 offen  lds
  s_add_u32 m0, s62, 23552
  s_add_u32 s99, s90, 221248
  buffer_load_dwordx4 v33, s[16:19], s99 offen  lds
  s_add_u32 m0, s62, 24576
  s_add_u32 s99, s90, 239616
  buffer_load_dwordx4 v33, s[16:19], s99 offen  lds
  s_add_u32 m0, s62, 25600
  s_add_u32 s99, s90, 258048
  buffer_load_dwordx4 v33, s[16:19], s99 offen  lds
  s_add_u32 m0, s62, 26624
  s_add_u32 s99, s90, 239680
  buffer_load_dwordx4 v33, s[16:19], s99 offen  lds
  s_add_u32 m0, s62, 27648
  s_add_u32 s99, s90, 258112
  buffer_load_dwordx4 v33, s[16:19], s99 offen  lds
  s_add_u32 m0, s62, 28672
  s_add_u32 s99, s90, 276480
  buffer_load_dwordx4 v33, s[16:19], s99 offen  lds
  s_add_u32 m0, s62, 29696
  s_add_u32 s99, s90, 294912
  buffer_load_dwordx4 v33, s[16:19], s99 offen  lds
  s_add_u32 m0, s62, 30720
  s_add_u32 s99, s90, 276544
  buffer_load_dwordx4 v33, s[16:19], s99 offen  lds
  s_add_u32 m0, s62, 31744
  s_add_u32 s99, s90, 294976
  buffer_load_dwordx4 v33, s[16:19], s99 offen  lds
  s_add_u32 m0, s62, 32768
  s_add_u32 s99, s90, 331776
  buffer_load_dwordx4 v33, s[16:19], s99 offen  lds
  s_add_u32 m0, s62, 33792
  s_add_u32 s99, s90, 350208
  buffer_load_dwordx4 v33, s[16:19], s99 offen  lds
  s_add_u32 m0, s62, 34816
  s_add_u32 s99, s90, 331840
  buffer_load_dwordx4 v33, s[16:19], s99 offen  lds
  s_add_u32 m0, s62, 35840
  s_add_u32 s99, s90, 350272
  buffer_load_dwordx4 v33, s[16:19], s99 offen  lds
  s_add_u32 m0, s62, 36864
  s_add_u32 s99, s90, 368640
  buffer_load_dwordx4 v33, s[16:19], s99 offen  lds
  s_add_u32 m0, s62, 37888
  s_add_u32 s99, s90, 387072
  buffer_load_dwordx4 v33, s[16:19], s99 offen  lds
  s_waitcnt vmcnt(36)
  ds_read_b64_tr_b16 a[0:1], v35 offset:0
  ds_read_b64_tr_b16 a[2:3], v35 offset:256
  ds_read_b64_tr_b16 a[4:5], v36 offset:0
  ds_read_b64_tr_b16 a[6:7], v36 offset:256
  s_add_u32 m0, s62, 38912
  s_add_u32 s99, s90, 368704
  buffer_load_dwordx4 v33, s[16:19], s99 offen  lds
  s_add_u32 m0, s62, 39936
  s_add_u32 s99, s90, 387136
  buffer_load_dwordx4 v33, s[16:19], s99 offen  lds
  s_waitcnt vmcnt(36)
  ds_read_b64_tr_b16 a[8:9], v35 offset:2048
  ds_read_b64_tr_b16 a[10:11], v35 offset:2304
  ds_read_b64_tr_b16 a[12:13], v36 offset:2048
  ds_read_b64_tr_b16 a[14:15], v36 offset:2304
  s_waitcnt lgkmcnt(4)
  s_add_u32 m0, s62, 0
  s_add_u32 s99, s90, 405504
  buffer_load_dwordx4 v33, s[16:19], s99 offen  lds
  s_add_u32 m0, s62, 1024
  s_add_u32 s99, s90, 423936
  buffer_load_dwordx4 v33, s[16:19], s99 offen  lds
  s_waitcnt vmcnt(36)
  ds_read_b64_tr_b16 a[16:17], v35 offset:4096
  ds_read_b64_tr_b16 a[18:19], v35 offset:4352
  ds_read_b64_tr_b16 a[20:21], v36 offset:4096
  ds_read_b64_tr_b16 a[22:23], v36 offset:4352
  s_waitcnt lgkmcnt(4)
  s_add_u32 m0, s62, 2048
  s_add_u32 s99, s90, 405568
  buffer_load_dwordx4 v33, s[16:19], s99 offen  lds
  s_add_u32 m0, s62, 3072
  s_add_u32 s99, s90, 424000
  buffer_load_dwordx4 v33, s[16:19], s99 offen  lds
  s_waitcnt vmcnt(36)
  ds_read_b64_tr_b16 a[24:25], v35 offset:6144
  ds_read_b64_tr_b16 a[26:27], v35 offset:6400
  ds_read_b64_tr_b16 a[28:29], v36 offset:6144
  ds_read_b64_tr_b16 a[30:31], v36 offset:6400
  s_waitcnt lgkmcnt(4)
  s_add_u32 m0, s62, 4096
  s_add_u32 s99, s90, 442368
  buffer_load_dwordx4 v33, s[16:19], s99 offen  lds
  s_add_u32 m0, s62, 5120
  s_add_u32 s99, s90, 460800
  buffer_load_dwordx4 v33, s[16:19], s99 offen  lds
  s_waitcnt vmcnt(36)
  ds_read_b64_tr_b16 a[32:33], v35 offset:8192
  ds_read_b64_tr_b16 a[34:35], v35 offset:8448
  ds_read_b64_tr_b16 a[36:37], v36 offset:8192
  ds_read_b64_tr_b16 a[38:39], v36 offset:8448
  s_waitcnt lgkmcnt(4)
  s_add_u32 m0, s62, 6144
  s_add_u32 s99, s90, 442432
  buffer_load_dwordx4 v33, s[16:19], s99 offen  lds
  s_add_u32 m0, s62, 7168
  s_add_u32 s99, s90, 460864
  buffer_load_dwordx4 v33, s[16:19], s99 offen  lds
  s_waitcnt vmcnt(36)
  ds_read_b64_tr_b16 a[40:41], v35 offset:10240
  ds_read_b64_tr_b16 a[42:43], v35 offset:10496
  ds_read_b64_tr_b16 a[44:45], v36 offset:10240
  ds_read_b64_tr_b16 a[46:47], v36 offset:10496
  s_waitcnt lgkmcnt(4)
  s_add_u32 m0, s62, 8192
  s_add_u32 s99, s90, 497664
  buffer_load_dwordx4 v33, s[16:19], s99 offen  lds
  s_add_u32 m0, s62, 9216
  s_add_u32 s99, s90, 516096
  buffer_load_dwordx4 v33, s[16:19], s99 offen  lds
  s_waitcnt vmcnt(36)
  ds_read_b64_tr_b16 a[48:49], v35 offset:12288
  ds_read_b64_tr_b16 a[50:51], v35 offset:12544
  ds_read_b64_tr_b16 a[52:53], v36 offset:12288
  ds_read_b64_tr_b16 a[54:55], v36 offset:12544
  s_waitcnt lgkmcnt(4)
  s_add_u32 m0, s62, 10240
  s_add_u32 s99, s90, 497728
  buffer_load_dwordx4 v33, s[16:19], s99 offen  lds
  s_add_u32 m0, s62, 11264
  s_add_u32 s99, s90, 516160
  buffer_load_dwordx4 v33, s[16:19], s99 offen  lds
  s_waitcnt vmcnt(36)
  ds_read_b64_tr_b16 a[56:57], v35 offset:14336
  ds_read_b64_tr_b16 a[58:59], v35 offset:14592
  ds_read_b64_tr_b16 a[60:61], v36 offset:14336
  ds_read_b64_tr_b16 a[62:63], v36 offset:14592
  s_waitcnt lgkmcnt(4)
  s_add_u32 m0, s62, 12288
  s_add_u32 s99, s90, 534528
  buffer_load_dwordx4 v33, s[16:19], s99 offen  lds
  s_add_u32 m0, s62, 13312
  s_add_u32 s99, s90, 552960
  buffer_load_dwordx4 v33, s[16:19], s99 offen  lds
  s_waitcnt vmcnt(36)
  ds_read_b64_tr_b16 a[64:65], v35 offset:16384
  ds_read_b64_tr_b16 a[66:67], v35 offset:16640
  ds_read_b64_tr_b16 a[68:69], v36 offset:16384
  ds_read_b64_tr_b16 a[70:71], v36 offset:16640
  s_waitcnt lgkmcnt(4)
  s_add_u32 m0, s62, 14336
  s_add_u32 s99, s90, 534592
  buffer_load_dwordx4 v33, s[16:19], s99 offen  lds
  s_add_u32 m0, s62, 15360
  s_add_u32 s99, s90, 553024
  buffer_load_dwordx4 v33, s[16:19], s99 offen  lds
  s_waitcnt vmcnt(36)
  ds_read_b64_tr_b16 a[72:73], v35 offset:18432
  ds_read_b64_tr_b16 a[74:75], v35 offset:18688
  ds_read_b64_tr_b16 a[76:77], v36 offset:18432
  ds_read_b64_tr_b16 a[78:79], v36 offset:18688
  s_waitcnt lgkmcnt(4)
  s_add_u32 m0, s62, 16384
  s_add_u32 s99, s90, 571392
  buffer_load_dwordx4 v33, s[16:19], s99 offen  lds
  s_add_u32 m0, s62, 17408
  s_add_u32 s99, s90, 589824
  buffer_load_dwordx4 v33, s[16:19], s99 offen  lds
  s_waitcnt vmcnt(36)
  ds_read_b64_tr_b16 a[80:81], v35 offset:20480
  ds_read_b64_tr_b16 a[82:83], v35 offset:20736
  ds_read_b64_tr_b16 a[84:85], v36 offset:20480
  ds_read_b64_tr_b16 a[86:87], v36 offset:20736
  s_waitcnt lgkmcnt(4)
  s_add_u32 m0, s62, 18432
  s_add_u32 s99, s90, 571456
  buffer_load_dwordx4 v33, s[16:19], s99 offen  lds
  s_add_u32 m0, s62, 19456
  s_add_u32 s99, s90, 589888
  buffer_load_dwordx4 v33, s[16:19], s99 offen  lds
  s_waitcnt vmcnt(36)
  ds_read_b64_tr_b16 a[88:89], v35 offset:22528
  ds_read_b64_tr_b16 a[90:91], v35 offset:22784
  ds_read_b64_tr_b16 a[92:93], v36 offset:22528
  ds_read_b64_tr_b16 a[94:95], v36 offset:22784
  s_waitcnt lgkmcnt(4)
  s_add_u32 m0, s62, 20480
  s_add_u32 s99, s90, 608256
  buffer_load_dwordx4 v33, s[16:19], s99 offen  lds
  s_add_u32 m0, s62, 21504
  s_add_u32 s99, s90, 626688
  buffer_load_dwordx4 v33, s[16:19], s99 offen  lds
  s_waitcnt vmcnt(36)
  ds_read_b64_tr_b16 a[96:97], v35 offset:24576
  ds_read_b64_tr_b16 a[98:99], v35 offset:24832
  ds_read_b64_tr_b16 a[100:101], v36 offset:24576
  ds_read_b64_tr_b16 a[102:103], v36 offset:24832
  s_waitcnt lgkmcnt(4)
  s_add_u32 m0, s62, 22528
  s_add_u32 s99, s90, 608320
  buffer_load_dwordx4 v33, s[16:19], s99 offen  lds
  s_add_u32 m0, s62, 23552
  s_add_u32 s99, s90, 626752
  buffer_load_dwordx4 v33, s[16:19], s99 offen  lds
  s_waitcnt vmcnt(36)
  ds_read_b64_tr_b16 a[104:105], v35 offset:26624
  ds_read_b64_tr_b16 a[106:107], v35 offset:26880
  ds_read_b64_tr_b16 a[108:109], v36 offset:26624
  ds_read_b64_tr_b16 a[110:111], v36 offset:26880
  s_waitcnt lgkmcnt(4)
  s_add_u32 m0, s62, 24576
  s_add_u32 s99, s90, 147456
  buffer_load_dwordx4 v34, s[16:19], s99 offen  lds
  s_add_u32 m0, s62, 25600
  s_add_u32 s99, s90, 148608
  buffer_load_dwordx4 v34, s[16:19], s99 offen  lds
  s_waitcnt vmcnt(36)
  ds_read_b64_tr_b16 a[112:113], v35 offset:28672
  ds_read_b64_tr_b16 a[114:115], v35 offset:28928
  ds_read_b64_tr_b16 a[116:117], v36 offset:28672
  ds_read_b64_tr_b16 a[118:119], v36 offset:28928
  s_waitcnt lgkmcnt(4)
  s_add_u32 m0, s62, 26624
  s_add_u32 s99, s90, 147520
  buffer_load_dwordx4 v34, s[16:19], s99 offen  lds
  s_add_u32 m0, s62, 27648
  s_add_u32 s99, s90, 148672
  buffer_load_dwordx4 v34, s[16:19], s99 offen  lds
  s_waitcnt vmcnt(36)
  ds_read_b64_tr_b16 a[120:121], v35 offset:30720
  ds_read_b64_tr_b16 a[122:123], v35 offset:30976
  ds_read_b64_tr_b16 a[124:125], v36 offset:30720
  ds_read_b64_tr_b16 a[126:127], v36 offset:30976
  s_waitcnt lgkmcnt(4)
  s_add_u32 m0, s62, 28672
  s_add_u32 s99, s90, 479232
  buffer_load_dwordx4 v34, s[16:19], s99 offen  lds
  s_add_u32 m0, s62, 29696
  s_add_u32 s99, s90, 480384
  buffer_load_dwordx4 v34, s[16:19], s99 offen  lds
  s_waitcnt vmcnt(36)
  ds_read_b64_tr_b16 a[128:129], v35 offset:32768
  ds_read_b64_tr_b16 a[130:131], v35 offset:33024
  ds_read_b64_tr_b16 a[132:133], v36 offset:32768
  ds_read_b64_tr_b16 a[134:135], v36 offset:33024
  s_waitcnt lgkmcnt(4)
  s_add_u32 m0, s62, 30720
  s_add_u32 s99, s90, 479296
  buffer_load_dwordx4 v34, s[16:19], s99 offen  lds
  s_add_u32 m0, s62, 31744
  s_add_u32 s99, s90, 480448
  buffer_load_dwordx4 v34, s[16:19], s99 offen  lds
  s_waitcnt vmcnt(36)
  ds_read_b64_tr_b16 a[136:137], v35 offset:34816
  ds_read_b64_tr_b16 a[138:139], v35 offset:35072
  ds_read_b64_tr_b16 a[140:141], v36 offset:34816
  ds_read_b64_tr_b16 a[142:143], v36 offset:35072
  s_waitcnt vmcnt(34)
  ds_read_b64_tr_b16 a[144:145], v35 offset:36864
  ds_read_b64_tr_b16 a[146:147], v35 offset:37120
  ds_read_b64_tr_b16 a[148:149], v36 offset:36864
  ds_read_b64_tr_b16 a[150:151], v36 offset:37120
  s_waitcnt vmcnt(32)
  ds_read_b64_tr_b16 a[152:153], v35 offset:38912
  ds_read_b64_tr_b16 a[154:155], v35 offset:39168
  ds_read_b64_tr_b16 a[156:157], v36 offset:38912
  ds_read_b64_tr_b16 a[158:159], v36 offset:39168
  s_waitcnt vmcnt(30)
  ds_read_b64_tr_b16 a[160:161], v35 offset:0
  ds_read_b64_tr_b16 a[162:163], v35 offset:256
  ds_read_b64_tr_b16 a[164:165], v36 offset:0
  ds_read_b64_tr_b16 a[166:167], v36 offset:256
  s_waitcnt vmcnt(28)
  ds_read_b64_tr_b16 a[168:169], v35 offset:2048
  ds_read_b64_tr_b16 a[170:171], v35 offset:2304
  ds_read_b64_tr_b16 a[172:173], v36 offset:2048
  ds_read_b64_tr_b16 a[174:175], v36 offset:2304
  s_waitcnt vmcnt(26)
  ds_read_b64_tr_b16 a[176:177], v35 offset:4096
  ds_read_b64_tr_b16 a[178:179], v35 offset:4352
  ds_read_b64_tr_b16 a[180:181], v36 offset:4096
  ds_read_b64_tr_b16 a[182:183], v36 offset:4352
  s_waitcnt vmcnt(24)
  ds_read_b64_tr_b16 a[184:185], v35 offset:6144
  ds_read_b64_tr_b16 a[186:187], v35 offset:6400
  ds_read_b64_tr_b16 a[188:189], v36 offset:6144
  ds_read_b64_tr_b16 a[190:191], v36 offset:6400
  s_waitcnt vmcnt(22)
  ds_read_b64_tr_b16 a[192:193], v35 offset:8192
  ds_read_b64_tr_b16 a[194:195], v35 offset:8448
  ds_read_b64_tr_b16 a[196:197], v36 offset:8192
  ds_read_b64_tr_b16 a[198:199], v36 offset:8448
  s_waitcnt vmcnt(20)
  ds_read_b64_tr_b16 a[200:201], v35 offset:10240
  ds_read_b64_tr_b16 a[202:203], v35 offset:10496
  ds_read_b64_tr_b16 a[204:205], v36 offset:10240
  ds_read_b64_tr_b16 a[206:207], v36 offset:10496
  s_waitcnt vmcnt(18)
  ds_read_b64_tr_b16 a[208:209], v35 offset:12288
  ds_read_b64_tr_b16 a[210:211], v35 offset:12544
  ds_read_b64_tr_b16 a[212:213], v36 offset:12288
  ds_read_b64_tr_b16 a[214:215], v36 offset:12544
  s_waitcnt vmcnt(16)
  ds_read_b64_tr_b16 a[216:217], v35 offset:14336
  ds_read_b64_tr_b16 a[218:219], v35 offset:14592
  ds_read_b64_tr_b16 a[220:221], v36 offset:14336
  ds_read_b64_tr_b16 a[222:223], v36 offset:14592
  s_waitcnt vmcnt(14)
  ds_read_b64_tr_b16 a[224:225], v35 offset:16384
  ds_read_b64_tr_b16 a[226:227], v35 offset:16640
  ds_read_b64_tr_b16 a[228:229], v36 offset:16384
  ds_read_b64_tr_b16 a[230:231], v36 offset:16640
  s_waitcnt vmcnt(12)
  ds_read_b64_tr_b16 a[232:233], v35 offset:18432
  ds_read_b64_tr_b16 a[234:235], v35 offset:18688
  ds_read_b64_tr_b16 a[236:237], v36 offset:18432
  ds_read_b64_tr_b16 a[238:239], v36 offset:18688
  s_waitcnt vmcnt(10)
  ds_read_b64_tr_b16 a[240:241], v35 offset:20480
  ds_read_b64_tr_b16 a[242:243], v35 offset:20736
  ds_read_b64_tr_b16 a[244:245], v36 offset:20480
  ds_read_b64_tr_b16 a[246:247], v36 offset:20736
  s_waitcnt vmcnt(8)
  ds_read_b64_tr_b16 a[248:249], v35 offset:22528
  ds_read_b64_tr_b16 a[250:251], v35 offset:22784
  ds_read_b64_tr_b16 a[252:253], v36 offset:22528
  ds_read_b64_tr_b16 a[254:255], v36 offset:22784
  s_waitcnt vmcnt(6)
  ds_read_b64_tr_b16 v[224:225], v35 offset:24576
  ds_read_b64_tr_b16 v[226:227], v35 offset:24832
  ds_read_b64_tr_b16 v[228:229], v36 offset:24576
  ds_read_b64_tr_b16 v[230:231], v36 offset:24832
  s_waitcnt vmcnt(4)
  ds_read_b64_tr_b16 v[232:233], v35 offset:26624
  ds_read_b64_tr_b16 v[234:235], v35 offset:26880
  ds_read_b64_tr_b16 v[236:237], v36 offset:26624
  ds_read_b64_tr_b16 v[238:239], v36 offset:26880
  s_waitcnt vmcnt(2)
  ds_read_b64_tr_b16 v[240:241], v35 offset:28672
  ds_read_b64_tr_b16 v[242:243], v35 offset:28928
  ds_read_b64_tr_b16 v[244:245], v36 offset:28672
  ds_read_b64_tr_b16 v[246:247], v36 offset:28928
  s_waitcnt vmcnt(0)
  ds_read_b64_tr_b16 v[248:249], v35 offset:30720
  ds_read_b64_tr_b16 v[250:251], v35 offset:30976
  ds_read_b64_tr_b16 v[252:253], v36 offset:30720
  ds_read_b64_tr_b16 v[254:255], v36 offset:30976
  s_waitcnt lgkmcnt(0)
  s_barrier
  v_mov_b32 v32, 64
  s_mov_b64 exec, 1
L_wa_131:
  global_load_dword v33, v32, s[4:5] sc1
  s_waitcnt vmcnt(0)
  v_readfirstlane_b32 s98, v33
  s_nop 0
  s_cmp_ge_u32 s98, 256
  s_nop 1
  s_cbranch_scc1 L_wa_131d
  s_sleep 8
  s_sub_u32 s100, s100, 1
  s_cbranch_scc0 L_wa_131
  s_branch L_end
L_wa_131d:
  s_mov_b64 exec, -1
  s_lshl_b32 s91, s60, 3
  s_add_u32 s91, s91, s64
  s_lshl_b32 s91, s91, 2
  s_add_u32 s91, s91, s93
  s_mov_b32 s66, 0xffff
  s_mov_b32 s67, 0
  s_mov_b32 s28, s12
  s_mov_b32 s29, s13
  s_mov_b32 s30, 0
  s_mov_b32 s31, 0x20000
  s_lshl_b32 s45, s9, 8
  s_add_u32 s45, s45, 73728
  v_mbcnt_lo_u32_b32 v140, -1, 0
  v_mbcnt_hi_u32_b32 v140, -1, v140
  v_lshl_add_u32 v140, v140, 2, s45
  v_mov_b32 v6, 0
  ds_write_b32 v140, v6
L_bk_132:
  s_mov_b64 exec, s[40:41]
  buffer_load_dword v6, v1, s[12:15], s36 offen sc1
  s_mov_b64 exec, -1
  s_add_u32 s98, s32, 1
  s_mov_b64 exec, s[40:41]
  s_waitcnt vmcnt(0)
  v_cmp_gt_u32 vcc, s98, v6
  s_mov_b64 exec, -1
  s_cbranch_vccz L_bk_132d
  s_sleep 1
  s_sub_u32 s100, s100, 1
  s_cbranch_scc0 L_bk_132
  s_branch L_end
L_bk_132d:
  s_add_u32 m0, s34, 0
  s_add_u32 s98, s33, 0
  buffer_load_dwordx4 v0, s[12:15], s98 offen offset:0 sc1 lds
  buffer_load_dwordx4 v0, s[12:15], s98 offen offset:1024 sc1 lds
  buffer_load_dwordx4 v0, s[12:15], s98 offen offset:2048 sc1 lds
  buffer_load_dwordx4 v0, s[12:15], s98 offen offset:3072 sc1 lds
  s_add_u32 m0, s34, 4096
  s_add_u32 s98, s33, 4096
  buffer_load_dwordx4 v0, s[12:15], s98 offen offset:0 sc1 lds
  buffer_load_dwordx4 v0, s[12:15], s98 offen offset:1024 sc1 lds
  buffer_load_dwordx4 v0, s[12:15], s98 offen offset:2048 sc1 lds
  buffer_load_dwordx4 v0, s[12:15], s98 offen offset:3072 sc1 lds
  s_add_u32 m0, s34, 8192
  s_add_u32 s98, s33, 8192
  buffer_load_dwordx4 v0, s[12:15], s98 offen offset:0 sc1 lds
  s_add_u32 s33, s33, 294912
  s_xor_b32 s34, s34, s39
  s_mov_b32 s35, 1
  s_waitcnt vmcnt(0)
L_dnR_loop:
  s_barrier
  s_bfe_u32 s63, s32, 65537
  ds_read_b128 v[16:19], v2 offset:0
  ds_read_b128 v[20:23], v2 offset:2048
  ds_read_b128 v[24:27], v2 offset:4096
  ds_read_b128 v[28:31], v2 offset:6144
  s_cmp_ge_u32 s32, 63
  s_cselect_b32 s35, 1, 0
  s_waitcnt lgkmcnt(3)
  v_mfma_f32_16x16x32_bf16 v[32:35], a[0:3], v[16:19], 0
  v_mfma_f32_16x16x32_bf16 v[36:39], a[4:7], v[16:19], 0
  v_mfma_f32_16x16x32_bf16 v[40:43], a[8:11], v[16:19], 0
  v_mfma_f32_16x16x32_bf16 v[44:47], a[12:15], v[16:19], 0
  s_mov_b64 exec, s[40:41]
  buffer_load_dword v6, v1, s[12:15], s36 offen sc1
  s_mov_b64 exec, -1
  s_waitcnt lgkmcnt(2)
  v_mfma_f32_16x16x32_bf16 v[32:35], a[16:19], v[20:23], v[32:35]
  ds_read_b128 v[16:19], v2 offset:9216
  v_mfma_f32_16x16x32_bf16 v[36:39], a[20:23], v[20:23], v[36:39]
  v_mfma_f32_16x16x32_bf16 v[40:43], a[24:27], v[20:23], v[40:43]
  v_mfma_f32_16x16x32_bf16 v[44:47], a[28:31], v[20:23], v[44:47]
  ds_read_b128 v[20:23], v2 offset:11264
  s_waitcnt lgkmcnt(3)
  v_mfma_f32_16x16x32_bf16 v[32:35], a[32:35], v[24:27], v[32:35]
  v_mfma_f32_16x16x32_bf16 v[36:39], a[36:39], v[24:27], v[36:39]
  v_mfma_f32_16x16x32_bf16 v[40:43], a[40:43], v[24:27], v[40:43]
  v_mfma_f32_16x16x32_bf16 v[44:47], a[44:47], v[24:27], v[44:47]
  ds_read_b128 v[24:27], v2 offset:13312
  s_cmp_lg_u32 s92, 0
  s_waitcnt lgkmcnt(3)
  v_mfma_f32_16x16x32_bf16 v[32:35], a[48:51], v[28:31], v[32:35]
  v_mfma_f32_16x16x32_bf16 v[36:39], a[52:55], v[28:31], v[36:39]
  v_mfma_f32_16x16x32_bf16 v[40:43], a[56:59], v[28:31], v[40:43]
  v_mfma_f32_16x16x32_bf16 v[44:47], a[60:63], v[28:31], v[44:47]
  s_cbranch_scc1 L_dn_hp
  s_waitcnt lgkmcnt(2)
  v_mfma_f32_16x16x32_bf16 v[32:35], a[64:67], v[16:19], v[32:35]
  ds_read_b128 v[28:31], v2 offset:15360
  v_mfma_f32_16x16x32_bf16 v[36:39], a[68:71], v[16:19], v[36:39]
  v_mfma_f32_16x16x32_bf16 v[40:43], a[72:75], v[16:19], v[40:43]
  v_mfma_f32_16x16x32_bf16 v[44:47], a[76:79], v[16:19], v[44:47]
  ds_read_b128 v[16:19], v2 offset:18432
  s_waitcnt lgkmcnt(3)
  v_mfma_f32_16x16x32_bf16 v[32:35], a[80:83], v[20:23], v[32:35]
  v_mfma_f32_16x16x32_bf16 v[36:39], a[84:87], v[20:23], v[36:39]
  v_mfma_f32_16x16x32_bf16 v[40:43], a[88:91], v[20:23], v[40:43]
  v_mfma_f32_16x16x32_bf16 v[44:47], a[92:95], v[20:23], v[44:47]
  ds_read_b128 v[20:23], v2 offset:20480
  s_waitcnt lgkmcnt(3)
  v_mfma_f32_16x16x32_bf16 v[32:35], a[96:99], v[24:27], v[32:35]
  v_mfma_f32_16x16x32_bf16 v[36:39], a[100:103], v[24:27], v[36:39]
  v_mfma_f32_16x16x32_bf16 v[40:43], a[104:107], v[24:27], v[40:43]
  v_mfma_f32_16x16x32_bf16 v[44:47], a[108:111], v[24:27], v[44:47]
  ds_read_b128 v[24:27], v2 offset:22528
  s_waitcnt lgkmcnt(3)
  v_mfma_f32_16x16x32_bf16 v[32:35], a[112:115], v[28:31], v[32:35]
  v_mfma_f32_16x16x32_bf16 v[36:39], a[116:119], v[28:31], v[36:39]
  v_mfma_f32_16x16x32_bf16 v[40:43], a[120:123], v[28:31], v[40:43]
  v_mfma_f32_16x16x32_bf16 v[44:47], a[124:127], v[28:31], v[44:47]
  ds_read_b128 v[28:31], v2 offset:24576
  s_waitcnt lgkmcnt(3)
  v_mfma_f32_16x16x32_bf16 v[32:35], a[128:131], v[16:19], v[32:35]
  v_mfma_f32_16x16x32_bf16 v[36:39], a[132:135], v[16:19], v[36:39]
  v_mfma_f32_16x16x32_bf16 v[40:43], a[136:139], v[16:19], v[40:43]
  v_mfma_f32_16x16x32_bf16 v[44:47], a[140:143], v[16:19], v[44:47]
  ds_read_b128 v[16:19], v2 offset:27648
  s_waitcnt lgkmcnt(3)
  v_mfma_f32_16x16x32_bf16 v[32:35], a[144:147], v[20:23], v[32:35]
  v_mfma_f32_16x16x32_bf16 v[36:39], a[148:151], v[20:23], v[36:39]
  v_mfma_f32_16x16x32_bf16 v[40:43], a[152:155], v[20:23], v[40:43]
  v_mfma_f32_16x16x32_bf16 v[44:47], a[156:159], v[20:23], v[44:47]
  ds_read_b128 v[20:23], v2 offset:29696
  s_waitcnt lgkmcnt(3)
  v_mfma_f32_16x16x32_bf16 v[32:35], a[160:163], v[24:27], v[32:35]
  v_mfma_f32_16x16x32_bf16 v[36:39], a[164:167], v[24:27], v[36:39]
  v_mfma_f32_16x16x32_bf16 v[40:43], a[168:171], v[24:27], v[40:43]
  s_mov_b64 exec, s[66:67]
  buffer_load_dword v10, v1, s[12:15], s93 offen sc1
  s_mov_b64 exec, -1
  v_mfma_f32_16x16x32_bf16 v[44:47], a[172:175], v[24:27], v[44:47]
  ds_read_b128 v[24:27], v2 offset:31744
  s_cmp_lg_u32 s35, 0
  s_waitcnt lgkmcnt(3)
  v_mfma_f32_16x16x32_bf16 v[32:35], a[176:179], v[28:31], v[32:35]
  v_mfma_f32_16x16x32_bf16 v[36:39], a[180:183], v[28:31], v[36:39]
  v_mfma_f32_16x16x32_bf16 v[40:43], a[184:187], v[28:31], v[40:43]
  v_mfma_f32_16x16x32_bf16 v[44:47], a[188:191], v[28:31], v[44:47]
  s_cbranch_scc1 L_ck_133
  s_add_u32 s98, s32, 2
  s_mov_b64 exec, s[40:41]
  s_waitcnt vmcnt(1)
  v_cmp_gt_u32 vcc, s98, v6
  s_mov_b64 exec, -1
  s_cbranch_vccnz L_ck_133r
  s_add_u32 m0, s34, 0
  s_add_u32 s98, s33, 0
  buffer_load_dwordx4 v0, s[12:15], s98 offen offset:0 sc1 lds
  buffer_load_dwordx4 v0, s[12:15], s98 offen offset:1024 sc1 lds
  buffer_load_dwordx4 v0, s[12:15], s98 offen offset:2048 sc1 lds
  buffer_load_dwordx4 v0, s[12:15], s98 offen offset:3072 sc1 lds
  s_add_u32 m0, s34, 4096
  s_add_u32 s98, s33, 4096
  buffer_load_dwordx4 v0, s[12:15], s98 offen offset:0 sc1 lds
  buffer_load_dwordx4 v0, s[12:15], s98 offen offset:1024 sc1 lds
  buffer_load_dwordx4 v0, s[12:15], s98 offen offset:2048 sc1 lds
  buffer_load_dwordx4 v0, s[12:15], s98 offen offset:3072 sc1 lds
  s_add_u32 m0, s34, 8192
  s_add_u32 s98, s33, 8192
  buffer_load_dwordx4 v0, s[12:15], s98 offen offset:0 sc1 lds
  s_add_u32 s33, s33, 294912
  s_xor_b32 s34, s34, s39
  s_mov_b32 s35, 1
  s_branch L_ck_133
L_ck_133r:
  s_mov_b64 exec, s[40:41]
  buffer_load_dword v6, v1, s[12:15], s36 offen sc1
  s_mov_b64 exec, -1
L_ck_133:
  s_waitcnt lgkmcnt(2)
  v_mfma_f32_16x16x32_bf16 v[32:35], a[192:195], v[16:19], v[32:35]
  ds_read_b128 v[28:31], v2 offset:33792
  v_mfma_f32_16x16x32_bf16 v[36:39], a[196:199], v[16:19], v[36:39]
  v_mfma_f32_16x16x32_bf16 v[40:43], a[200:203], v[16:19], v[40:43]
  v_mfma_f32_16x16x32_bf16 v[44:47], a[204:207], v[16:19], v[44:47]
  ds_read2st64_b32 v[16:17], v4 offset0:32 offset1:34
  ds_read2st64_b32 v[18:19], v4 offset0:68 offset1:70
  s_waitcnt lgkmcnt(4)
  v_mfma_f32_16x16x32_bf16 v[32:35], a[208:211], v[20:23], v[32:35]
  v_mfma_f32_16x16x32_bf16 v[36:39], a[212:215], v[20:23], v[36:39]
  v_mfma_f32_16x16x32_bf16 v[40:43], a[216:219], v[20:23], v[40:43]
  v_mfma_f32_16x16x32_bf16 v[44:47], a[220:223], v[20:23], v[44:47]
  ds_read2st64_b32 v[20:21], v4 offset0:104 offset1:106
  ds_read2st64_b32 v[22:23], v4 offset0:140 offset1:142
  s_waitcnt lgkmcnt(5)
  v_mfma_f32_16x16x32_bf16 v[32:35], a[224:227], v[24:27], v[32:35]
  v_mfma_f32_16x16x32_bf16 v[36:39], a[228:231], v[24:27], v[36:39]
  v_mfma_f32_16x16x32_bf16 v[40:43], a[232:235], v[24:27], v[40:43]
  v_mfma_f32_16x16x32_bf16 v[44:47], a[236:239], v[24:27], v[44:47]
  ds_read_b128 v[24:27], v3 offset:0
  s_waitcnt lgkmcnt(5)
  v_mfma_f32_16x16x32_bf16 v[32:35], a[240:243], v[28:31], v[32:35]
  v_mfma_f32_16x16x32_bf16 v[36:39], a[244:247], v[28:31], v[36:39]
  v_mfma_f32_16x16x32_bf16 v[40:43], a[248:251], v[28:31], v[40:43]
  s_branch L_dn_hj
L_dn_hp:
  s_waitcnt lgkmcnt(2)
  v_mfma_f32_16x16x32_bf16 v[32:35], a[64:67], v[16:19], v[32:35]
  ds_read_b128 v[28:31], v2 offset:15360
  s_add_u32 s98, s49, 0
  v_mfma_f32_16x16x32_bf16 v[36:39], a[68:71], v[16:19], v[36:39]
  buffer_load_dwordx4 v[92:95], v0, s[12:15], s98 offen sc1
  s_add_u32 s98, s49, 18560
  v_mfma_f32_16x16x32_bf16 v[40:43], a[72:75], v[16:19], v[40:43]
  buffer_load_dwordx4 v[96:99], v0, s[12:15], s98 offen sc1
  v_mfma_f32_16x16x32_bf16 v[44:47], a[76:79], v[16:19], v[44:47]
  ds_read_b128 v[16:19], v2 offset:18432
  s_add_u32 s98, s49, 37120
  s_waitcnt lgkmcnt(3)
  v_mfma_f32_16x16x32_bf16 v[32:35], a[80:83], v[20:23], v[32:35]
  buffer_load_dwordx4 v[100:103], v0, s[12:15], s98 offen sc1
  s_add_u32 s98, s49, 55680
  v_mfma_f32_16x16x32_bf16 v[36:39], a[84:87], v[20:23], v[36:39]
  v_mfma_f32_16x16x32_bf16 v[40:43], a[88:91], v[20:23], v[40:43]
  buffer_load_dwordx4 v[104:107], v0, s[12:15], s98 offen sc1
  v_mfma_f32_16x16x32_bf16 v[44:47], a[92:95], v[20:23], v[44:47]
  ds_read_b128 v[20:23], v2 offset:20480
  s_add_u32 s98, s49, 74240
  s_waitcnt lgkmcnt(3)
  v_mfma_f32_16x16x32_bf16 v[32:35], a[96:99], v[24:27], v[32:35]
  buffer_load_dwordx4 v[108:111], v0, s[12:15], s98 offen sc1
  s_add_u32 s98, s49, 92800
  v_mfma_f32_16x16x32_bf16 v[36:39], a[100:103], v[24:27], v[36:39]
  v_mfma_f32_16x16x32_bf16 v[40:43], a[104:107], v[24:27], v[40:43]
  buffer_load_dwordx4 v[112:115], v0, s[12:15], s98 offen sc1
  v_mfma_f32_16x16x32_bf16 v[44:47], a[108:111], v[24:27], v[44:47]
  ds_read_b128 v[24:27], v2 offset:22528
  s_add_u32 s98, s49, 111360
  s_waitcnt lgkmcnt(3)
  v_mfma_f32_16x16x32_bf16 v[32:35], a[112:115], v[28:31], v[32:35]
  buffer_load_dwordx4 v[116:119], v0, s[12:15], s98 offen sc1
  s_add_u32 s98, s49, 129920
  v_mfma_f32_16x16x32_bf16 v[36:39], a[116:119], v[28:31], v[36:39]
  v_mfma_f32_16x16x32_bf16 v[40:43], a[120:123], v[28:31], v[40:43]
  buffer_load_dwordx4 v[120:123], v0, s[12:15], s98 offen sc1
  v_mfma_f32_16x16x32_bf16 v[44:47], a[124:127], v[28:31], v[44:47]
  ds_read_b128 v[28:31], v2 offset:24576
  s_add_u32 s98, s57, 0
  s_waitcnt lgkmcnt(3)
  v_mfma_f32_16x16x32_bf16 v[32:35], a[128:131], v[16:19], v[32:35]
  buffer_load_dwordx4 v[128:131], v11, s[12:15], s98 offen sc1
  v_mfma_f32_16x16x32_bf16 v[36:39], a[132:135], v[16:19], v[36:39]
  v_mfma_f32_16x16x32_bf16 v[40:43], a[136:139], v[16:19], v[40:43]
  v_mfma_f32_16x16x32_bf16 v[44:47], a[140:143], v[16:19], v[44:47]
  ds_read_b128 v[16:19], v2 offset:27648
  s_waitcnt lgkmcnt(3)
  v_mfma_f32_16x16x32_bf16 v[32:35], a[144:147], v[20:23], v[32:35]
  v_mfma_f32_16x16x32_bf16 v[36:39], a[148:151], v[20:23], v[36:39]
  v_mfma_f32_16x16x32_bf16 v[40:43], a[152:155], v[20:23], v[40:43]
  v_mfma_f32_16x16x32_bf16 v[44:47], a[156:159], v[20:23], v[44:47]
  ds_read_b128 v[20:23], v2 offset:29696
  s_waitcnt lgkmcnt(3)
  v_mfma_f32_16x16x32_bf16 v[32:35], a[160:163], v[24:27], v[32:35]
  v_mfma_f32_16x16x32_bf16 v[36:39], a[164:167], v[24:27], v[36:39]
  v_mfma_f32_16x16x32_bf16 v[40:43], a[168:171], v[24:27], v[40:43]
  s_mov_b64 exec, s[66:67]
  buffer_load_dword v10, v1, s[12:15], s93 offen sc1
  s_mov_b64 exec, -1
  v_mfma_f32_16x16x32_bf16 v[44:47], a[172:175], v[24:27], v[44:47]
  ds_read_b128 v[24:27], v2 offset:31744
  s_bfe_u32 s97, s50, 65537
  s_waitcnt lgkmcnt(3)
  v_mfma_f32_16x16x32_bf16 v[32:35], a[176:179], v[28:31], v[32:35]
  v_mfma_f32_16x16x32_bf16 v[36:39], a[180:183], v[28:31], v[36:39]
  v_mfma_f32_16x16x32_bf16 v[40:43], a[184:187], v[28:31], v[40:43]
L_dnRr_134:
  v_mfma_f32_16x16x16_bf16 v[84:87], v[72:73], v[126:127], 0
  s_waitcnt vmcnt(9)
  v_bitop3_b32 v12, v92, v94, s97 bitop3:0x7e
  v_lshlrev_b32 v12, 31, v12
  v_mfma_f32_16x16x16_bf16 v[80:83], v[72:73], v[92:93], 0
  s_waitcnt vmcnt(8)
  v_bitop3_b32 v13, v96, v98, s97 bitop3:0x7e
  v_alignbit_b32 v12, v13, v12, 1
  v_mfma_f32_16x16x32_bf16 v[88:91], v[76:79], v[132:135], 0
  s_waitcnt vmcnt(7)
  v_bitop3_b32 v13, v100, v102, s97 bitop3:0x7e
  v_alignbit_b32 v12, v13, v12, 1
  v_mfma_f32_16x16x32_bf16 v[84:87], v[72:75], v[94:97], v[84:87]
  s_waitcnt vmcnt(6)
  v_bitop3_b32 v13, v104, v106, s97 bitop3:0x7e
  v_alignbit_b32 v12, v13, v12, 1
  v_mfma_f32_16x16x32_bf16 v[80:83], v[72:75], v[98:101], v[80:83]
  s_waitcnt vmcnt(5)
  v_bitop3_b32 v13, v108, v110, s97 bitop3:0x7e
  v_alignbit_b32 v12, v13, v12, 1
  v_mfma_f32_16x16x32_bf16 v[84:87], v[72:75], v[102:105], v[84:87]
  s_waitcnt vmcnt(4)
  v_bitop3_b32 v13, v112, v114, s97 bitop3:0x7e
  v_alignbit_b32 v12, v13, v12, 1
  v_mfma_f32_16x16x32_bf16 v[80:83], v[72:75], v[106:109], v[80:83]
  s_waitcnt vmcnt(3)
  v_bitop3_b32 v13, v116, v118, s97 bitop3:0x7e
  v_alignbit_b32 v12, v13, v12, 1
  v_mfma_f32_16x16x32_bf16 v[84:87], v[72:75], v[110:113], v[84:87]
  s_waitcnt vmcnt(2)
  v_bitop3_b32 v13, v120, v122, s97 bitop3:0x7e
  v_alignbit_b32 v12, v13, v12, 1
  v_mfma_f32_16x16x32_bf16 v[80:83], v[72:75], v[114:117], v[80:83]
  s_waitcnt vmcnt(1)
  v_bitop3_b32 v13, v128, v130, s97 bitop3:0x7e
  v_alignbit_b32 v12, v13, v12, 1
  v_mfma_f32_16x16x32_bf16 v[84:87], v[72:75], v[118:121], v[84:87]
  v_cmp_ne_u32 vcc, 0, v12
  v_mfma_f32_16x16x32_bf16 v[80:83], v[72:75], v[122:125], v[80:83]
  v_mfma_f32_16x16x32_bf16 v[88:91], v[76:79], v[128:131], v[88:91]
  s_cbranch_vccz L_dnRr_135
  s_mov_b64 exec, vcc
  v_readfirstlane_b32 s99, v12
  s_mov_b64 exec, -1
  s_bitcmp0_b32 s99, 23
  s_cbranch_scc1 L_dnRr_136_0
  s_add_u32 s98, s49, 0
  buffer_load_dwordx4 v[92:95], v0, s[12:15], s98 offen sc1
L_dnRr_136_0:
  s_bitcmp0_b32 s99, 24
  s_cbranch_scc1 L_dnRr_136_1
  s_add_u32 s98, s49, 18560
  buffer_load_dwordx4 v[96:99], v0, s[12:15], s98 offen sc1
L_dnRr_136_1:
  s_bitcmp0_b32 s99, 25
  s_cbranch_scc1 L_dnRr_136_2
  s_add_u32 s98, s49, 37120
  buffer_load_dwordx4 v[100:103], v0, s[12:15], s98 offen sc1
L_dnRr_136_2:
  s_bitcmp0_b32 s99, 26
  s_cbranch_scc1 L_dnRr_136_3
  s_add_u32 s98, s49, 55680
  buffer_load_dwordx4 v[104:107], v0, s[12:15], s98 offen sc1
L_dnRr_136_3:
  s_bitcmp0_b32 s99, 27
  s_cbranch_scc1 L_dnRr_136_4
  s_add_u32 s98, s49, 74240
  buffer_load_dwordx4 v[108:111], v0, s[12:15], s98 offen sc1
L_dnRr_136_4:
  s_bitcmp0_b32 s99, 28
  s_cbranch_scc1 L_dnRr_136_5
  s_add_u32 s98, s49, 92800
  buffer_load_dwordx4 v[112:115], v0, s[12:15], s98 offen sc1
L_dnRr_136_5:
  s_bitcmp0_b32 s99, 29
  s_cbranch_scc1 L_dnRr_136_6
  s_add_u32 s98, s49, 111360
  buffer_load_dwordx4 v[116:119], v0, s[12:15], s98 offen sc1
L_dnRr_136_6:
  s_bitcmp0_b32 s99, 30
  s_cbranch_scc1 L_dnRr_136_7
  s_add_u32 s98, s49, 129920
  buffer_load_dwordx4 v[120:123], v0, s[12:15], s98 offen sc1
L_dnRr_136_7:
  s_bitcmp0_b32 s99, 31
  s_cbranch_scc1 L_dnRr_136_8
  s_add_u32 s98, s57, 0
  buffer_load_dwordx4 v[128:131], v11, s[12:15], s98 offen sc1
L_dnRr_136_8:
  s_waitcnt vmcnt(0)
  s_sub_u32 s100, s100, 1
  s_cbranch_scc0 L_dnRr_134
  s_branch L_end
L_dnRr_135:
  v_mfma_f32_16x16x32_bf16 v[44:47], a[188:191], v[28:31], v[44:47]
  s_cmp_lg_u32 s35, 0
  s_cbranch_scc1 L_ck_137
  s_add_u32 s98, s32, 2
  s_mov_b64 exec, s[40:41]
  v_cmp_gt_u32 vcc, s98, v6
  s_mov_b64 exec, -1
  s_cbranch_vccnz L_ck_137r
  s_add_u32 m0, s34, 0
  s_add_u32 s98, s33, 0
  buffer_load_dwordx4 v0, s[12:15], s98 offen offset:0 sc1 lds
  buffer_load_dwordx4 v0, s[12:15], s98 offen offset:1024 sc1 lds
  buffer_load_dwordx4 v0, s[12:15], s98 offen offset:2048 sc1 lds
  buffer_load_dwordx4 v0, s[12:15], s98 offen offset:3072 sc1 lds
  s_add_u32 m0, s34, 4096
  s_add_u32 s98, s33, 4096
  buffer_load_dwordx4 v0, s[12:15], s98 offen offset:0 sc1 lds
  buffer_load_dwordx4 v0, s[12:15], s98 offen offset:1024 sc1 lds
  buffer_load_dwordx4 v0, s[12:15], s98 offen offset:2048 sc1 lds
  buffer_load_dwordx4 v0, s[12:15], s98 offen offset:3072 sc1 lds
  s_add_u32 m0, s34, 8192
  s_add_u32 s98, s33, 8192
  buffer_load_dwordx4 v0, s[12:15], s98 offen offset:0 sc1 lds
  s_add_u32 s33, s33, 294912
  s_xor_b32 s34, s34, s39
  s_mov_b32 s35, 1
  s_branch L_ck_137
L_ck_137r:
  s_mov_b64 exec, s[40:41]
  buffer_load_dword v6, v1, s[12:15], s36 offen sc1
  s_mov_b64 exec, -1
L_ck_137:
  s_waitcnt lgkmcnt(2)
  v_mfma_f32_16x16x32_bf16 v[32:35], a[192:195], v[16:19], v[32:35]
  ds_read_b128 v[28:31], v2 offset:33792
  s_add_u32 s98, s50, 1
  v_mov_b32 v7, s98
  v_mfma_f32_16x16x32_bf16 v[36:39], a[196:199], v[16:19], v[36:39]
  s_mov_b64 exec, 1
  buffer_store_dword v7, off, s[12:15], s91
  s_mov_b64 exec, -1
  v_mfma_f32_16x16x32_bf16 v[40:43], a[200:203], v[16:19], v[40:43]
  v_cvt_pk_bf16_f32 v80, v80, v81
  v_cvt_pk_bf16_f32 v81, v82, v83
  v_mfma_f32_16x16x32_bf16 v[44:47], a[204:207], v[16:19], v[44:47]
  v_cvt_pk_bf16_f32 v82, v84, v85
  v_cvt_pk_bf16_f32 v83, v86, v87
  s_waitcnt lgkmcnt(2)
  v_mfma_f32_16x16x32_bf16 v[32:35], a[208:211], v[20:23], v[32:35]
  ds_read2st64_b32 v[16:17], v4 offset0:32 offset1:34
  ds_read2st64_b32 v[18:19], v4 offset0:68 offset1:70
  v_add_f32 v88, v88, v88 row_ror:8 row_mask:0xf bank_mask:0xf
  v_mfma_f32_16x16x32_bf16 v[36:39], a[212:215], v[20:23], v[36:39]
  v_add_f32 v89, v89, v89 row_ror:8 row_mask:0xf bank_mask:0xf
  v_add_f32 v90, v90, v90 row_ror:8 row_mask:0xf bank_mask:0xf
  v_mfma_f32_16x16x32_bf16 v[40:43], a[216:219], v[20:23], v[40:43]
  v_add_f32 v91, v91, v91 row_ror:8 row_mask:0xf bank_mask:0xf
  v_mfma_f32_16x16x32_bf16 v[44:47], a[220:223], v[20:23], v[44:47]
  s_mov_b64 exec, s[68:69]
  buffer_store_dwordx4 v[80:83], v0, s[12:15], s38 offen sc1
  s_not_b64 exec, exec
  buffer_store_dwordx4 v[80:83], v9, s[20:23], s59 offen
  s_mov_b64 exec, -1
  s_waitcnt lgkmcnt(3)
  v_mfma_f32_16x16x32_bf16 v[32:35], a[224:227], v[24:27], v[32:35]
  ds_read2st64_b32 v[20:21], v4 offset0:104 offset1:106
  ds_read2st64_b32 v[22:23], v4 offset0:140 offset1:142
  v_cvt_pk_bf16_f32 v88, v88, v89
  v_mfma_f32_16x16x32_bf16 v[92:95], v[136:139], v[80:83], 0
  v_cvt_pk_bf16_f32 v89, v90, v91
  v_cndmask_b32 v100, 0, v88, s[52:53]
  v_mfma_f32_16x16x32_bf16 v[96:99], v[80:83], v[80:83], 0
  v_cndmask_b32 v101, 0, v89, s[52:53]
  v_mfma_f32_16x16x32_bf16 v[36:39], a[228:231], v[24:27], v[36:39]
  v_permlane16_swap_b32 v88, v90
  v_mfma_f32_16x16x16_bf16 v[92:95], v[136:137], v[100:101], v[92:95]
  v_permlane16_swap_b32 v89, v91
  s_nop 0
  v_mfma_f32_16x16x16_bf16 v[96:99], v[100:101], v[100:101], v[96:99]
  s_and_b64 exec, s[68:69], 0xff
  buffer_store_dwordx4 v[88:91], v0, s[12:15], s55 offen sc1
  s_andn2_b64 exec, 0xff, s[68:69]
  buffer_store_dwordx4 v[88:91], v9, s[20:23], s54 offen
  s_mov_b64 exec, -1
  v_mfma_f32_16x16x32_bf16 v[40:43], a[232:235], v[24:27], v[40:43]
  s_nop 1
  v_cndmask_b32 v96, v96, v97, s[72:73]
  v_cndmask_b32 v98, v98, v99, s[72:73]
  v_mfma_f32_16x16x32_bf16 v[44:47], a[236:239], v[24:27], v[44:47]
  ds_read_b128 v[24:27], v3 offset:0
  v_cndmask_b32 v93, v96, v98, s[74:75]
  s_waitcnt lgkmcnt(5)
  v_mfma_f32_16x16x32_bf16 v[32:35], a[240:243], v[28:31], v[32:35]
  v_mfma_f32_16x16x32_bf16 v[36:39], a[244:247], v[28:31], v[36:39]
  s_and_b64 exec, s[68:69], s[70:71]
  buffer_store_dwordx2 v[92:93], v8, s[12:15], s38 offen offset:1024 sc1
  s_mov_b64 exec, -1
  v_mfma_f32_16x16x32_bf16 v[40:43], a[248:251], v[28:31], v[40:43]
  s_add_u32 s50, s50, 1
  s_add_u32 s38, s38, s94
  s_add_u32 s55, s55, s94
  s_add_u32 s59, s59, 36864
  s_add_u32 s54, s54, 36864
  s_mov_b32 s92, 0
  s_and_b32 s43, s50, s68
  s_and_b32 s98, s50, 1
  s_cselect_b32 s98, 0, 593920
  s_sub_u32 s98, 296960, s98
  s_add_u32 s49, s49, s98
  s_add_u32 s57, s57, s98
L_dn_hj:
  v_mfma_f32_16x16x32_bf16 v[44:47], a[252:255], v[28:31], v[44:47]
  ds_read_b128 v[28:31], v3 offset:2048
  s_waitcnt lgkmcnt(4)
  v_mfma_f32_16x16x32_bf16 v[32:35], v[224:227], v[16:19], v[32:35]
  buffer_load_dwordx4 v[124:127], v0, s[12:15], s58 offen sc1
  s_add_u32 s58, s58, 41472
  v_mfma_f32_16x16x32_bf16 v[36:39], v[228:231], v[16:19], v[36:39]
  v_mfma_f32_16x16x32_bf16 v[40:43], v[232:235], v[16:19], v[40:43]
  s_mov_b64 exec, 0xff
  buffer_load_dwordx4 v[132:135], v0, s[12:15], s56 offen sc1
  s_mov_b64 exec, -1
  v_mfma_f32_16x16x32_bf16 v[44:47], v[236:239], v[16:19], v[44:47]
  s_add_u32 s56, s56, 41472
  ds_read_b128 v[16:19], v3 offset:4096
  s_waitcnt lgkmcnt(3)
  v_mfma_f32_16x16x32_bf16 v[32:35], v[240:243], v[20:23], v[32:35]
  v_mfma_f32_16x16x32_bf16 v[36:39], v[244:247], v[20:23], v[36:39]
  v_mfma_f32_16x16x32_bf16 v[40:43], v[248:251], v[20:23], v[40:43]
  v_mfma_f32_16x16x32_bf16 v[44:47], v[252:255], v[20:23], v[44:47]
  ds_read_b128 v[20:23], v3 offset:6144
  s_waitcnt lgkmcnt(3)
  v_mfma_f32_16x16x32_bf16 v[56:59], a[0:3], v[24:27], 0
  v_mfma_f32_16x16x32_bf16 v[60:63], a[4:7], v[24:27], 0
L_bpc_138:
  s_sub_i32 s98, s32, 1
  s_mov_b64 exec, s[66:67]
  s_waitcnt vmcnt(2)
  v_cmp_gt_i32 vcc, s98, v10
  s_mov_b64 exec, -1
  s_cbranch_vccnz L_bpr_139
  v_mfma_f32_16x16x32_bf16 v[64:67], a[8:11], v[24:27], 0
  v_mfma_f32_16x16x32_bf16 v[68:71], a[12:15], v[24:27], 0
  ds_read_b128 v[24:27], v3 offset:9216
  v_cvt_pk_bf16_f32 v32, v32, v33
  v_cvt_pk_bf16_f32 v33, v34, v35
  s_waitcnt lgkmcnt(3)
  v_mfma_f32_16x16x32_bf16 v[56:59], a[16:19], v[28:31], v[56:59]
  v_cvt_pk_bf16_f32 v34, v36, v37
  v_cvt_pk_bf16_f32 v35, v38, v39
  v_mfma_f32_16x16x32_bf16 v[60:63], a[20:23], v[28:31], v[60:63]
  v_bfi_b32 v32, 1, s63, v32
  v_bfi_b32 v34, 1, s63, v34
  v_mfma_f32_16x16x32_bf16 v[64:67], a[24:27], v[28:31], v[64:67]
  v_mfma_f32_16x16x32_bf16 v[68:71], a[28:31], v[28:31], v[68:71]
  buffer_store_dwordx4 v[32:35], v0, s[12:15], s46 offen offset:0
  s_cmp_lg_u32 s35, 0
  s_cbranch_scc1 L_ck_140
  s_add_u32 s98, s32, 2
  s_mov_b64 exec, s[40:41]
  s_waitcnt vmcnt(3)
  v_cmp_gt_u32 vcc, s98, v6
  s_mov_b64 exec, -1
  s_cbranch_vccnz L_ck_140r
  s_add_u32 m0, s34, 0
  s_add_u32 s98, s33, 0
  buffer_load_dwordx4 v0, s[12:15], s98 offen offset:0 sc1 lds
  buffer_load_dwordx4 v0, s[12:15], s98 offen offset:1024 sc1 lds
  buffer_load_dwordx4 v0, s[12:15], s98 offen offset:2048 sc1 lds
  buffer_load_dwordx4 v0, s[12:15], s98 offen offset:3072 sc1 lds
  s_add_u32 m0, s34, 4096
  s_add_u32 s98, s33, 4096
  buffer_load_dwordx4 v0, s[12:15], s98 offen offset:0 sc1 lds
  buffer_load_dwordx4 v0, s[12:15], s98 offen offset:1024 sc1 lds
  buffer_load_dwordx4 v0, s[12:15], s98 offen offset:2048 sc1 lds
  buffer_load_dwordx4 v0, s[12:15], s98 offen offset:3072 sc1 lds
  s_add_u32 m0, s34, 8192
  s_add_u32 s98, s33, 8192
  buffer_load_dwordx4 v0, s[12:15], s98 offen offset:0 sc1 lds
  s_add_u32 s33, s33, 294912
  s_xor_b32 s34, s34, s39
  s_mov_b32 s35, 1
  s_branch L_ck_140
L_ck_140r:
  s_mov_b64 exec, s[40:41]
  buffer_load_dword v6, v1, s[12:15], s36 offen sc1
  s_mov_b64 exec, -1
L_ck_140:
  s_waitcnt lgkmcnt(2)
  v_mfma_f32_16x16x32_bf16 v[56:59], a[32:35], v[16:19], v[56:59]
  ds_read_b128 v[28:31], v3 offset:11264
  v_cvt_pk_bf16_f32 v40, v40, v41
  v_cvt_pk_bf16_f32 v41, v42, v43
  v_mfma_f32_16x16x32_bf16 v[60:63], a[36:39], v[16:19], v[60:63]
  v_cvt_pk_bf16_f32 v42, v44, v45
  v_cvt_pk_bf16_f32 v43, v46, v47
  v_mfma_f32_16x16x32_bf16 v[64:67], a[40:43], v[16:19], v[64:67]
  v_bfi_b32 v40, 1, s63, v40
  v_bfi_b32 v42, 1, s63, v42
  v_mfma_f32_16x16x32_bf16 v[68:71], a[44:47], v[16:19], v[68:71]
  buffer_store_dwordx4 v[40:43], v0, s[12:15], s46 offen offset:2048
  s_waitcnt lgkmcnt(2)
  v_mfma_f32_16x16x32_bf16 v[56:59], a[48:51], v[20:23], v[56:59]
  ds_read_b128 v[16:19], v3 offset:13312
  v_mfma_f32_16x16x32_bf16 v[60:63], a[52:55], v[20:23], v[60:63]
  v_mfma_f32_16x16x32_bf16 v[64:67], a[56:59], v[20:23], v[64:67]
  v_mfma_f32_16x16x32_bf16 v[68:71], a[60:63], v[20:23], v[68:71]
  ds_read_b128 v[20:23], v3 offset:15360
  s_waitcnt lgkmcnt(3)
  v_mfma_f32_16x16x32_bf16 v[56:59], a[64:67], v[24:27], v[56:59]
  v_mfma_f32_16x16x32_bf16 v[60:63], a[68:71], v[24:27], v[60:63]
  v_mfma_f32_16x16x32_bf16 v[64:67], a[72:75], v[24:27], v[64:67]
  v_mfma_f32_16x16x32_bf16 v[68:71], a[76:79], v[24:27], v[68:71]
  s_cmp_eq_u32 s43, 0
  s_cbranch_scc1 L_fl_141
  v_mov_b32 v7, s43
  s_mov_b64 exec, 1
  buffer_store_dword v7, off, s[12:15], s37 sc1
  s_mov_b64 exec, -1
  s_mov_b32 s43, 0
L_fl_141:
  s_waitcnt lgkmcnt(2)
  v_mfma_f32_16x16x32_bf16 v[56:59], a[80:83], v[28:31], v[56:59]
  ds_read_b128 v[24:27], v3 offset:18432
  v_mfma_f32_16x16x32_bf16 v[60:63], a[84:87], v[28:31], v[60:63]
  v_mfma_f32_16x16x32_bf16 v[64:67], a[88:91], v[28:31], v[64:67]
  v_mfma_f32_16x16x32_bf16 v[68:71], a[92:95], v[28:31], v[68:71]
  ds_read_b128 v[28:31], v3 offset:20480
  s_waitcnt lgkmcnt(3)
  v_mfma_f32_16x16x32_bf16 v[56:59], a[96:99], v[16:19], v[56:59]
  v_mfma_f32_16x16x32_bf16 v[60:63], a[100:103], v[16:19], v[60:63]
  v_mfma_f32_16x16x32_bf16 v[64:67], a[104:107], v[16:19], v[64:67]
  v_mfma_f32_16x16x32_bf16 v[68:71], a[108:111], v[16:19], v[68:71]
  ds_read_b128 v[16:19], v3 offset:22528
  s_waitcnt lgkmcnt(3)
  v_mfma_f32_16x16x32_bf16 v[56:59], a[112:115], v[20:23], v[56:59]
  v_mfma_f32_16x16x32_bf16 v[60:63], a[116:119], v[20:23], v[60:63]
  v_mfma_f32_16x16x32_bf16 v[64:67], a[120:123], v[20:23], v[64:67]
  v_mfma_f32_16x16x32_bf16 v[68:71], a[124:127], v[20:23], v[68:71]
  ds_read_b128 v[20:23], v3 offset:24576
  s_waitcnt lgkmcnt(3)
  v_mfma_f32_16x16x32_bf16 v[56:59], a[128:131], v[24:27], v[56:59]
  v_mfma_f32_16x16x32_bf16 v[60:63], a[132:135], v[24:27], v[60:63]
  v_mfma_f32_16x16x32_bf16 v[64:67], a[136:139], v[24:27], v[64:67]
  v_mfma_f32_16x16x32_bf16 v[68:71], a[140:143], v[24:27], v[68:71]
  ds_read_b128 v[24:27], v3 offset:27648
  s_waitcnt lgkmcnt(3)
  v_mfma_f32_16x16x32_bf16 v[56:59], a[144:147], v[28:31], v[56:59]
  v_mfma_f32_16x16x32_bf16 v[60:63], a[148:151], v[28:31], v[60:63]
  v_mfma_f32_16x16x32_bf16 v[64:67], a[152:155], v[28:31], v[64:67]
  v_mfma_f32_16x16x32_bf16 v[68:71], a[156:159], v[28:31], v[68:71]
  ds_read_b128 v[28:31], v3 offset:29696
  s_cmp_lg_u32 s35, 0
  s_waitcnt lgkmcnt(3)
  v_mfma_f32_16x16x32_bf16 v[56:59], a[160:163], v[16:19], v[56:59]
  v_mfma_f32_16x16x32_bf16 v[60:63], a[164:167], v[16:19], v[60:63]
  v_mfma_f32_16x16x32_bf16 v[64:67], a[168:171], v[16:19], v[64:67]
  v_mfma_f32_16x16x32_bf16 v[68:71], a[172:175], v[16:19], v[68:71]
  s_cbranch_scc1 L_ck_142
  s_add_u32 s98, s32, 2
  s_mov_b64 exec, s[40:41]
  s_waitcnt vmcnt(1)
  v_cmp_gt_u32 vcc, s98, v6
  s_mov_b64 exec, -1
  s_cbranch_vccnz L_ck_142r
  s_add_u32 m0, s34, 0
  s_add_u32 s98, s33, 0
  buffer_load_dwordx4 v0, s[12:15], s98 offen offset:0 sc1 lds
  buffer_load_dwordx4 v0, s[12:15], s98 offen offset:1024 sc1 lds
  buffer_load_dwordx4 v0, s[12:15], s98 offen offset:2048 sc1 lds
  buffer_load_dwordx4 v0, s[12:15], s98 offen offset:3072 sc1 lds
  s_add_u32 m0, s34, 4096
  s_add_u32 s98, s33, 4096
  buffer_load_dwordx4 v0, s[12:15], s98 offen offset:0 sc1 lds
  buffer_load_dwordx4 v0, s[12:15], s98 offen offset:1024 sc1 lds
  buffer_load_dwordx4 v0, s[12:15], s98 offen offset:2048 sc1 lds
  buffer_load_dwordx4 v0, s[12:15], s98 offen offset:3072 sc1 lds
  s_add_u32 m0, s34, 8192
  s_add_u32 s98, s33, 8192
  buffer_load_dwordx4 v0, s[12:15], s98 offen offset:0 sc1 lds
  s_add_u32 s33, s33, 294912
  s_xor_b32 s34, s34, s39
  s_mov_b32 s35, 1
  s_branch L_ck_142
L_ck_142r:
  s_mov_b64 exec, s[40:41]
  buffer_load_dword v6, v1, s[12:15], s36 offen sc1
  s_mov_b64 exec, -1
L_ck_142:
  s_waitcnt lgkmcnt(2)
  v_mfma_f32_16x16x32_bf16 v[56:59], a[176:179], v[20:23], v[56:59]
  ds_read_b128 v[16:19], v3 offset:31744
  v_mfma_f32_16x16x32_bf16 v[60:63], a[180:183], v[20:23], v[60:63]
  v_mfma_f32_16x16x32_bf16 v[64:67], a[184:187], v[20:23], v[64:67]
  v_mfma_f32_16x16x32_bf16 v[68:71], a[188:191], v[20:23], v[68:71]
  ds_read_b128 v[20:23], v3 offset:33792
  s_waitcnt lgkmcnt(3)
  v_mfma_f32_16x16x32_bf16 v[56:59], a[192:195], v[24:27], v[56:59]
  v_mfma_f32_16x16x32_bf16 v[60:63], a[196:199], v[24:27], v[60:63]
  v_mfma_f32_16x16x32_bf16 v[64:67], a[200:203], v[24:27], v[64:67]
  v_mfma_f32_16x16x32_bf16 v[68:71], a[204:207], v[24:27], v[68:71]
  ds_read2st64_b32 v[24:25], v5 offset0:32 offset1:34
  ds_read2st64_b32 v[26:27], v5 offset0:68 offset1:70
  s_waitcnt lgkmcnt(4)
  v_mfma_f32_16x16x32_bf16 v[56:59], a[208:211], v[28:31], v[56:59]
  v_mfma_f32_16x16x32_bf16 v[60:63], a[212:215], v[28:31], v[60:63]
  v_mfma_f32_16x16x32_bf16 v[64:67], a[216:219], v[28:31], v[64:67]
  v_mfma_f32_16x16x32_bf16 v[68:71], a[220:223], v[28:31], v[68:71]
  ds_read2st64_b32 v[28:29], v5 offset0:104 offset1:106
  ds_read2st64_b32 v[30:31], v5 offset0:140 offset1:142
  s_waitcnt lgkmcnt(5)
  v_mfma_f32_16x16x32_bf16 v[56:59], a[224:227], v[16:19], v[56:59]
  v_mfma_f32_16x16x32_bf16 v[60:63], a[228:231], v[16:19], v[60:63]
  v_mfma_f32_16x16x32_bf16 v[64:67], a[232:235], v[16:19], v[64:67]
  v_mfma_f32_16x16x32_bf16 v[68:71], a[236:239], v[16:19], v[68:71]
  s_waitcnt lgkmcnt(4)
  v_mfma_f32_16x16x32_bf16 v[56:59], a[240:243], v[20:23], v[56:59]
  v_mfma_f32_16x16x32_bf16 v[60:63], a[244:247], v[20:23], v[60:63]
  v_mfma_f32_16x16x32_bf16 v[64:67], a[248:251], v[20:23], v[64:67]
  v_mfma_f32_16x16x32_bf16 v[68:71], a[252:255], v[20:23], v[68:71]
  s_waitcnt lgkmcnt(2)
  v_mfma_f32_16x16x32_bf16 v[56:59], v[224:227], v[24:27], v[56:59]
  s_cmp_lg_u32 s35, 0
  v_mfma_f32_16x16x32_bf16 v[60:63], v[228:231], v[24:27], v[60:63]
  v_mfma_f32_16x16x32_bf16 v[64:67], v[232:235], v[24:27], v[64:67]
  v_mfma_f32_16x16x32_bf16 v[68:71], v[236:239], v[24:27], v[68:71]
  s_waitcnt lgkmcnt(0)
  v_mfma_f32_16x16x32_bf16 v[56:59], v[240:243], v[28:31], v[56:59]
  v_mfma_f32_16x16x32_bf16 v[60:63], v[244:247], v[28:31], v[60:63]
  v_mfma_f32_16x16x32_bf16 v[64:67], v[248:251], v[28:31], v[64:67]
  s_cbranch_scc1 L_ck_143
  s_add_u32 s98, s32, 2
  s_mov_b64 exec, s[40:41]
  s_waitcnt vmcnt(0)
  v_cmp_gt_u32 vcc, s98, v6
  s_mov_b64 exec, -1
  s_cbranch_vccnz L_ck_143r
  s_add_u32 m0, s34, 0
  s_add_u32 s98, s33, 0
  buffer_load_dwordx4 v0, s[12:15], s98 offen offset:0 sc1 lds
  buffer_load_dwordx4 v0, s[12:15], s98 offen offset:1024 sc1 lds
  buffer_load_dwordx4 v0, s[12:15], s98 offen offset:2048 sc1 lds
  buffer_load_dwordx4 v0, s[12:15], s98 offen offset:3072 sc1 lds
  s_add_u32 m0, s34, 4096
  s_add_u32 s98, s33, 4096
  buffer_load_dwordx4 v0, s[12:15], s98 offen offset:0 sc1 lds
  buffer_load_dwordx4 v0, s[12:15], s98 offen offset:1024 sc1 lds
  buffer_load_dwordx4 v0, s[12:15], s98 offen offset:2048 sc1 lds
  buffer_load_dwordx4 v0, s[12:15], s98 offen offset:3072 sc1 lds
  s_add_u32 m0, s34, 8192
  s_add_u32 s98, s33, 8192
  buffer_load_dwordx4 v0, s[12:15], s98 offen offset:0 sc1 lds
  s_add_u32 s33, s33, 294912
  s_xor_b32 s34, s34, s39
  s_mov_b32 s35, 1
  s_branch L_ck_143
L_ck_143r:
L_ck_143:
  v_mfma_f32_16x16x32_bf16 v[68:71], v[252:255], v[28:31], v[68:71]
  s_nop 3
  v_cvt_pk_bf16_f32 v56, v56, v57
  v_cvt_pk_bf16_f32 v57, v58, v59
  v_cvt_pk_bf16_f32 v58, v60, v61
  v_cvt_pk_bf16_f32 v59, v62, v63
  v_bfi_b32 v56, 1, s63, v56
  v_bfi_b32 v58, 1, s63, v58
  buffer_store_dwordx4 v[56:59], v0, s[12:15], s47 offen offset:0
  v_cvt_pk_bf16_f32 v64, v64, v65
  v_cvt_pk_bf16_f32 v65, v66, v67
  v_cvt_pk_bf16_f32 v66, v68, v69
  v_cvt_pk_bf16_f32 v67, v70, v71
  v_bfi_b32 v64, 1, s63, v64
  v_bfi_b32 v66, 1, s63, v66
  buffer_store_dwordx4 v[64:67], v0, s[12:15], s47 offen offset:2048
  s_cmp_eq_u32 s32, 63
  s_cselect_b32 s35, 0, s35
  s_mov_b32 s92, s35
  s_cmp_lg_u32 s35, 0
  s_cbranch_scc1 L_dnR_j
  s_add_u32 s98, s49, 0
  buffer_load_dwordx4 v[92:95], v0, s[12:15], s98 offen sc1
  s_add_u32 s98, s49, 18560
  buffer_load_dwordx4 v[96:99], v0, s[12:15], s98 offen sc1
  s_add_u32 s98, s49, 37120
  buffer_load_dwordx4 v[100:103], v0, s[12:15], s98 offen sc1
  s_add_u32 s98, s49, 55680
  buffer_load_dwordx4 v[104:107], v0, s[12:15], s98 offen sc1
  s_add_u32 s98, s49, 74240
  buffer_load_dwordx4 v[108:111], v0, s[12:15], s98 offen sc1
  s_add_u32 s98, s49, 92800
  buffer_load_dwordx4 v[112:115], v0, s[12:15], s98 offen sc1
  s_add_u32 s98, s49, 111360
  buffer_load_dwordx4 v[116:119], v0, s[12:15], s98 offen sc1
  s_add_u32 s98, s49, 129920
  buffer_load_dwordx4 v[120:123], v0, s[12:15], s98 offen sc1
  s_add_u32 s98, s57, 0
  buffer_load_dwordx4 v[128:131], v11, s[12:15], s98 offen sc1
  s_bfe_u32 s97, s50, 65537
L_dnRr_144:
  s_waitcnt vmcnt(14)
  v_mfma_f32_16x16x16_bf16 v[84:87], v[72:73], v[126:127], 0
  s_waitcnt vmcnt(8)
  v_bitop3_b32 v12, v92, v94, s97 bitop3:0x7e
  v_lshlrev_b32 v12, 31, v12
  v_mfma_f32_16x16x16_bf16 v[80:83], v[72:73], v[92:93], 0
  s_waitcnt vmcnt(7)
  v_bitop3_b32 v13, v96, v98, s97 bitop3:0x7e
  v_alignbit_b32 v12, v13, v12, 1
  v_mfma_f32_16x16x32_bf16 v[88:91], v[76:79], v[132:135], 0
  s_waitcnt vmcnt(6)
  v_bitop3_b32 v13, v100, v102, s97 bitop3:0x7e
  v_alignbit_b32 v12, v13, v12, 1
  v_mfma_f32_16x16x32_bf16 v[84:87], v[72:75], v[94:97], v[84:87]
  s_waitcnt vmcnt(5)
  v_bitop3_b32 v13, v104, v106, s97 bitop3:0x7e
  v_alignbit_b32 v12, v13, v12, 1
  v_mfma_f32_16x16x32_bf16 v[80:83], v[72:75], v[98:101], v[80:83]
  s_waitcnt vmcnt(4)
  v_bitop3_b32 v13, v108, v110, s97 bitop3:0x7e
  v_alignbit_b32 v12, v13, v12, 1
  v_mfma_f32_16x16x32_bf16 v[84:87], v[72:75], v[102:105], v[84:87]
  s_waitcnt vmcnt(3)
  v_bitop3_b32 v13, v112, v114, s97 bitop3:0x7e
  v_alignbit_b32 v12, v13, v12, 1
  v_mfma_f32_16x16x32_bf16 v[80:83], v[72:75], v[106:109], v[80:83]
  s_waitcnt vmcnt(2)
  v_bitop3_b32 v13, v116, v118, s97 bitop3:0x7e
  v_alignbit_b32 v12, v13, v12, 1
  v_mfma_f32_16x16x32_bf16 v[84:87], v[72:75], v[110:113], v[84:87]
  s_waitcnt vmcnt(1)
  v_bitop3_b32 v13, v120, v122, s97 bitop3:0x7e
  v_alignbit_b32 v12, v13, v12, 1
  v_mfma_f32_16x16x32_bf16 v[80:83], v[72:75], v[114:117], v[80:83]
  s_waitcnt vmcnt(0)
  v_bitop3_b32 v13, v128, v130, s97 bitop3:0x7e
  v_alignbit_b32 v12, v13, v12, 1
  v_mfma_f32_16x16x32_bf16 v[84:87], v[72:75], v[118:121], v[84:87]
  v_cmp_ne_u32 vcc, 0, v12
  v_mfma_f32_16x16x32_bf16 v[80:83], v[72:75], v[122:125], v[80:83]
  v_mfma_f32_16x16x32_bf16 v[88:91], v[76:79], v[128:131], v[88:91]
  s_cbranch_vccz L_dnRr_145
  s_mov_b64 exec, vcc
  v_readfirstlane_b32 s99, v12
  s_mov_b64 exec, -1
  s_bitcmp0_b32 s99, 23
  s_cbranch_scc1 L_dnRr_146_0
  s_add_u32 s98, s49, 0
  buffer_load_dwordx4 v[92:95], v0, s[12:15], s98 offen sc1
L_dnRr_146_0:
  s_bitcmp0_b32 s99, 24
  s_cbranch_scc1 L_dnRr_146_1
  s_add_u32 s98, s49, 18560
  buffer_load_dwordx4 v[96:99], v0, s[12:15], s98 offen sc1
L_dnRr_146_1:
  s_bitcmp0_b32 s99, 25
  s_cbranch_scc1 L_dnRr_146_2
  s_add_u32 s98, s49, 37120
  buffer_load_dwordx4 v[100:103], v0, s[12:15], s98 offen sc1
L_dnRr_146_2:
  s_bitcmp0_b32 s99, 26
  s_cbranch_scc1 L_dnRr_146_3
  s_add_u32 s98, s49, 55680
  buffer_load_dwordx4 v[104:107], v0, s[12:15], s98 offen sc1
L_dnRr_146_3:
  s_bitcmp0_b32 s99, 27
  s_cbranch_scc1 L_dnRr_146_4
  s_add_u32 s98, s49, 74240
  buffer_load_dwordx4 v[108:111], v0, s[12:15], s98 offen sc1
L_dnRr_146_4:
  s_bitcmp0_b32 s99, 28
  s_cbranch_scc1 L_dnRr_146_5
  s_add_u32 s98, s49, 92800
  buffer_load_dwordx4 v[112:115], v0, s[12:15], s98 offen sc1
L_dnRr_146_5:
  s_bitcmp0_b32 s99, 29
  s_cbranch_scc1 L_dnRr_146_6
  s_add_u32 s98, s49, 111360
  buffer_load_dwordx4 v[116:119], v0, s[12:15], s98 offen sc1
L_dnRr_146_6:
  s_bitcmp0_b32 s99, 30
  s_cbranch_scc1 L_dnRr_146_7
  s_add_u32 s98, s49, 129920
  buffer_load_dwordx4 v[120:123], v0, s[12:15], s98 offen sc1
L_dnRr_146_7:
  s_bitcmp0_b32 s99, 31
  s_cbranch_scc1 L_dnRr_146_8
  s_add_u32 s98, s57, 0
  buffer_load_dwordx4 v[128:131], v11, s[12:15], s98 offen sc1
L_dnRr_146_8:
  s_waitcnt vmcnt(0)
  s_sub_u32 s100, s100, 1
  s_cbranch_scc0 L_dnRr_144
  s_branch L_end
L_dnRr_145:
  s_add_u32 s98, s50, 1
  v_mov_b32 v7, s98
  s_mov_b64 exec, 1
  buffer_store_dword v7, off, s[12:15], s91
  s_mov_b64 exec, -1
  s_nop 0
  v_cvt_pk_bf16_f32 v80, v80, v81
  v_cvt_pk_bf16_f32 v81, v82, v83
  v_cvt_pk_bf16_f32 v82, v84, v85
  v_cvt_pk_bf16_f32 v83, v86, v87
  v_add_f32 v88, v88, v88 row_ror:8 row_mask:0xf bank_mask:0xf
  s_nop 0
  v_mfma_f32_16x16x32_bf16 v[92:95], v[136:139], v[80:83], 0
  v_add_f32 v89, v89, v89 row_ror:8 row_mask:0xf bank_mask:0xf
  v_add_f32 v90, v90, v90 row_ror:8 row_mask:0xf bank_mask:0xf
  v_mfma_f32_16x16x32_bf16 v[96:99], v[80:83], v[80:83], 0
  v_add_f32 v91, v91, v91 row_ror:8 row_mask:0xf bank_mask:0xf
  s_mov_b64 exec, s[68:69]
  buffer_store_dwordx4 v[80:83], v0, s[12:15], s38 offen sc1
  s_not_b64 exec, exec
  buffer_store_dwordx4 v[80:83], v9, s[20:23], s59 offen
  s_mov_b64 exec, -1
  v_cvt_pk_bf16_f32 v88, v88, v89
  v_cvt_pk_bf16_f32 v89, v90, v91
  v_cndmask_b32 v100, 0, v88, s[52:53]
  v_cndmask_b32 v101, 0, v89, s[52:53]
  s_nop 1
  v_mfma_f32_16x16x16_bf16 v[92:95], v[136:137], v[100:101], v[92:95]
  v_permlane16_swap_b32 v88, v90
  v_mfma_f32_16x16x16_bf16 v[96:99], v[100:101], v[100:101], v[96:99]
  v_permlane16_swap_b32 v89, v91
  s_and_b64 exec, s[68:69], 0xff
  buffer_store_dwordx4 v[88:91], v0, s[12:15], s55 offen sc1
  s_andn2_b64 exec, 0xff, s[68:69]
  buffer_store_dwordx4 v[88:91], v9, s[20:23], s54 offen
  s_mov_b64 exec, -1
  s_nop 1
  v_cndmask_b32 v96, v96, v97, s[72:73]
  v_cndmask_b32 v98, v98, v99, s[72:73]
  v_cndmask_b32 v93, v96, v98, s[74:75]
  s_and_b64 exec, s[68:69], s[70:71]
  buffer_store_dwordx2 v[92:93], v8, s[12:15], s38 offen offset:1024 sc1
  s_mov_b64 exec, -1
  s_add_u32 s50, s50, 1
  s_add_u32 s38, s38, s94
  s_add_u32 s55, s55, s94
  s_add_u32 s59, s59, 36864
  s_add_u32 s54, s54, 36864
  s_mov_b32 s92, 0
  s_and_b32 s43, s50, s68
  s_and_b32 s98, s50, 1
  s_cselect_b32 s98, 0, 593920
  s_sub_u32 s98, 296960, s98
  s_add_u32 s49, s49, s98
  s_add_u32 s57, s57, s98
L_dnR_j:
  v_add_u32 v2, s42, v2
  v_add_u32 v3, s42, v3
  v_add_u32 v4, s42, v4
  v_add_u32 v5, s42, v5
  s_sub_u32 s42, 0, s42
  s_add_u32 s32, s32, 1
  s_and_b32 s98, s32, 1
  s_cselect_b32 s98, 0, 593920
  s_sub_u32 s98, 296960, s98
  s_add_u32 s46, s46, s98
  s_add_u32 s47, s47, s98
  s_add_u32 s48, s48, s98
  s_cmp_eq_u32 s32, 64
  s_cbranch_scc1 L_dnR_done
  s_cmp_eq_u32 s35, 0
  s_cbranch_scc1 L_dnR_late
  s_waitcnt vmcnt(2)
  s_branch L_dnR_loop
L_dnR_late:
  s_mov_b64 exec, s[40:41]
  buffer_load_dword v6, v1, s[12:15], s36 offen sc1
  s_mov_b64 exec, -1
  s_add_u32 s98, s32, 1
  s_mov_b64 exec, s[40:41]
  s_waitcnt vmcnt(0)
  v_cmp_gt_u32 vcc, s98, v6
  s_mov_b64 exec, -1
  s_cbranch_vccnz L_lt_147s
  s_cmp_eq_u32 s43, 0
  s_cbranch_scc1 L_fl_148
  v_mov_b32 v7, s43
  s_mov_b64 exec, 1
  buffer_store_dword v7, off, s[12:15], s37 sc1
  s_mov_b64 exec, -1
  s_mov_b32 s43, 0
L_fl_148:
  s_add_u32 m0, s34, 0
  s_add_u32 s98, s33, 0
  buffer_load_dwordx4 v0, s[12:15], s98 offen offset:0 sc1 lds
  buffer_load_dwordx4 v0, s[12:15], s98 offen offset:1024 sc1 lds
  buffer_load_dwordx4 v0, s[12:15], s98 offen offset:2048 sc1 lds
  buffer_load_dwordx4 v0, s[12:15], s98 offen offset:3072 sc1 lds
  s_add_u32 m0, s34, 4096
  s_add_u32 s98, s33, 4096
  buffer_load_dwordx4 v0, s[12:15], s98 offen offset:0 sc1 lds
  buffer_load_dwordx4 v0, s[12:15], s98 offen offset:1024 sc1 lds
  buffer_load_dwordx4 v0, s[12:15], s98 offen offset:2048 sc1 lds
  buffer_load_dwordx4 v0, s[12:15], s98 offen offset:3072 sc1 lds
  s_add_u32 m0, s34, 8192
  s_add_u32 s98, s33, 8192
  buffer_load_dwordx4 v0, s[12:15], s98 offen offset:0 sc1 lds
  s_add_u32 s33, s33, 294912
  s_xor_b32 s34, s34, s39
  s_mov_b32 s35, 1
  s_branch L_lt_147e
L_lt_147s:
  s_cmp_eq_u32 s43, 0
  s_cbranch_scc1 L_fl_149
  v_mov_b32 v7, s43
  s_mov_b64 exec, 1
  buffer_store_dword v7, off, s[12:15], s37 sc1
  s_mov_b64 exec, -1
  s_mov_b32 s43, 0
L_fl_149:
L_bk_150:
  s_mov_b64 exec, s[40:41]
  buffer_load_dword v6, v1, s[12:15], s36 offen sc1
  s_mov_b64 exec, -1
  s_add_u32 s98, s32, 1
  s_mov_b64 exec, s[40:41]
  s_waitcnt vmcnt(0)
  v_cmp_gt_u32 vcc, s98, v6
  s_mov_b64 exec, -1
  s_cbranch_vccz L_bk_150d
  s_sleep 1
  s_sub_u32 s100, s100, 1
  s_cbranch_scc0 L_bk_150
  s_branch L_end
L_bk_150d:
  s_add_u32 m0, s34, 0
  s_add_u32 s98, s33, 0
  buffer_load_dwordx4 v0, s[12:15], s98 offen offset:0 sc1 lds
  buffer_load_dwordx4 v0, s[12:15], s98 offen offset:1024 sc1 lds
  buffer_load_dwordx4 v0, s[12:15], s98 offen offset:2048 sc1 lds
  buffer_load_dwordx4 v0, s[12:15], s98 offen offset:3072 sc1 lds
  s_add_u32 m0, s34, 4096
  s_add_u32 s98, s33, 4096
  buffer_load_dwordx4 v0, s[12:15], s98 offen offset:0 sc1 lds
  buffer_load_dwordx4 v0, s[12:15], s98 offen offset:1024 sc1 lds
  buffer_load_dwordx4 v0, s[12:15], s98 offen offset:2048 sc1 lds
  buffer_load_dwordx4 v0, s[12:15], s98 offen offset:3072 sc1 lds
  s_add_u32 m0, s34, 8192
  s_add_u32 s98, s33, 8192
  buffer_load_dwordx4 v0, s[12:15], s98 offen offset:0 sc1 lds
  s_add_u32 s33, s33, 294912
  s_xor_b32 s34, s34, s39
  s_mov_b32 s35, 1
L_lt_147e:
  s_waitcnt vmcnt(0)
  s_branch L_dnR_loop
L_dnR_done:
  s_waitcnt vmcnt(0)
  s_cmp_eq_u32 s43, 0
  s_cbranch_scc1 L_fl_151
  v_mov_b32 v7, s43
  s_mov_b64 exec, 1
  buffer_store_dword v7, off, s[12:15], s37 sc1
  s_mov_b64 exec, -1
  s_mov_b32 s43, 0
L_fl_151:
  s_branch L_end
L_bpr_139:
  s_mov_b64 exec, s[66:67]
  buffer_load_dword v10, v1, s[12:15], s93 offen sc1
  s_mov_b64 exec, -1
  s_waitcnt vmcnt(0)
  s_sub_u32 s100, s100, 1
  s_cbranch_scc0 L_bpc_138
  s_branch L_end
L_dn_G:
  s_cmp_lg_u32 s9, 3
  s_cbranch_scc1 L_gw_152b
  s_cmp_lg_u32 s11, 0
  s_cbranch_scc1 L_gw_152a
  v_mov_b32 v60, 128
  s_mov_b64 exec, 1
L_wa_153:
  global_load_dword v61, v60, s[4:5] sc1
  s_waitcnt vmcnt(0)
  v_readfirstlane_b32 s98, v61
  s_nop 0
  s_cmp_ge_u32 s98, 32
  s_nop 1
  s_cbranch_scc1 L_wa_153d
  s_sleep 24
  s_sub_u32 s100, s100, 1
  s_cbranch_scc0 L_wa_153
  s_branch L_end
L_wa_153d:
  s_mov_b64 exec, -1
  s_branch L_gw_152b
L_gw_152a:
  v_mov_b32 v60, 192
  s_mov_b64 exec, 1
L_wa_154:
  global_load_dword v61, v60, s[4:5] sc1
  s_waitcnt vmcnt(0)
  v_readfirstlane_b32 s98, v61
  s_nop 0
  s_cmp_ge_u32 s98, 32
  s_nop 1
  s_cbranch_scc1 L_wa_154d
  s_sleep 48
  s_sub_u32 s100, s100, 1
  s_cbranch_scc0 L_wa_154
  s_branch L_end
L_wa_154d:
  s_mov_b64 exec, -1
L_gw_152b:
  s_barrier
  s_add_u32 m0, s62, 0
  s_add_u32 s99, s90, 0
  buffer_load_dwordx4 v33, s[16:19], s99 offen  lds
  s_add_u32 m0, s62, 1024
  s_add_u32 s99, s90, 18432
  buffer_load_dwordx4 v33, s[16:19], s99 offen  lds
  s_add_u32 m0, s62, 2048
  s_add_u32 s99, s90, 64
  buffer_load_dwordx4 v33, s[16:19], s99 offen  lds
  s_add_u32 m0, s62, 3072
  s_add_u32 s99, s90, 18496
  buffer_load_dwordx4 v33, s[16:19], s99 offen  lds
  s_add_u32 m0, s62, 4096
  s_add_u32 s99, s91, 0
  buffer_load_dwordx4 v33, s[16:19], s99 offen  lds
  s_add_u32 m0, s62, 5120
  s_add_u32 s99, s91, 18432
  buffer_load_dwordx4 v33, s[16:19], s99 offen  lds
  s_add_u32 m0, s62, 6144
  s_add_u32 s99, s90, 36864
  buffer_load_dwordx4 v33, s[16:19], s99 offen  lds
  s_add_u32 m0, s62, 7168
  s_add_u32 s99, s90, 55296
  buffer_load_dwordx4 v33, s[16:19], s99 offen  lds
  s_add_u32 m0, s62, 8192
  s_add_u32 s99, s90, 36928
  buffer_load_dwordx4 v33, s[16:19], s99 offen  lds
  s_add_u32 m0, s62, 9216
  s_add_u32 s99, s90, 55360
  buffer_load_dwordx4 v33, s[16:19], s99 offen  lds
  s_add_u32 m0, s62, 10240
  s_add_u32 s99, s91, 36864
  buffer_load_dwordx4 v33, s[16:19], s99 offen  lds
  s_add_u32 m0, s62, 11264
  s_add_u32 s99, s91, 55296
  buffer_load_dwordx4 v33, s[16:19], s99 offen  lds
  s_add_u32 m0, s62, 12288
  s_add_u32 s99, s90, 73728
  buffer_load_dwordx4 v33, s[16:19], s99 offen  lds
  s_add_u32 m0, s62, 13312
  s_add_u32 s99, s90, 92160
  buffer_load_dwordx4 v33, s[16:19], s99 offen  lds
  s_add_u32 m0, s62, 14336
  s_add_u32 s99, s90, 73792
  buffer_load_dwordx4 v33, s[16:19], s99 offen  lds
  s_add_u32 m0, s62, 15360
  s_add_u32 s99, s90, 92224
  buffer_load_dwordx4 v33, s[16:19], s99 offen  lds
  s_add_u32 m0, s62, 16384
  s_add_u32 s99, s91, 73728
  buffer_load_dwordx4 v33, s[16:19], s99 offen  lds
  s_add_u32 m0, s62, 17408
  s_add_u32 s99, s91, 92160
  buffer_load_dwordx4 v33, s[16:19], s99 offen  lds
  s_add_u32 m0, s62, 18432
  s_add_u32 s99, s90, 110592
  buffer_load_dwordx4 v33, s[16:19], s99 offen  lds
  s_add_u32 m0, s62, 19456
  s_add_u32 s99, s90, 129024
  buffer_load_dwordx4 v33, s[16:19], s99 offen  lds
  s_add_u32 m0, s62, 20480
  s_add_u32 s99, s90, 110656
  buffer_load_dwordx4 v33, s[16:19], s99 offen  lds
  s_add_u32 m0, s62, 21504
  s_add_u32 s99, s90, 129088
  buffer_load_dwordx4 v33, s[16:19], s99 offen  lds
  s_add_u32 m0, s62, 22528
  s_add_u32 s99, s91, 110592
  buffer_load_dwordx4 v33, s[16:19], s99 offen  lds
  s_add_u32 m0, s62, 23552
  s_add_u32 s99, s91, 129024
  buffer_load_dwordx4 v33, s[16:19], s99 offen  lds
  s_add_u32 m0, s62, 24576
  s_add_u32 s99, s90, 165888
  buffer_load_dwordx4 v33, s[16:19], s99 offen  lds
  s_add_u32 m0, s62, 25600
  s_add_u32 s99, s90, 184320
  buffer_load_dwordx4 v33, s[16:19], s99 offen  lds
  s_add_u32 m0, s62, 26624
  s_add_u32 s99, s90, 165952
  buffer_load_dwordx4 v33, s[16:19], s99 offen  lds
  s_add_u32 m0, s62, 27648
  s_add_u32 s99, s90, 184384
  buffer_load_dwordx4 v33, s[16:19], s99 offen  lds
  s_add_u32 m0, s62, 28672
  s_add_u32 s99, s91, 165888
  buffer_load_dwordx4 v33, s[16:19], s99 offen  lds
  s_add_u32 m0, s62, 29696
  s_add_u32 s99, s91, 184320
  buffer_load_dwordx4 v33, s[16:19], s99 offen  lds
  s_add_u32 m0, s62, 30720
  s_add_u32 s99, s90, 202752
  buffer_load_dwordx4 v33, s[16:19], s99 offen  lds
  s_add_u32 m0, s62, 31744
  s_add_u32 s99, s90, 221184
  buffer_load_dwordx4 v33, s[16:19], s99 offen  lds
  s_add_u32 m0, s62, 32768
  s_add_u32 s99, s90, 202816
  buffer_load_dwordx4 v33, s[16:19], s99 offen  lds
  s_add_u32 m0, s62, 33792
  s_add_u32 s99, s90, 221248
  buffer_load_dwordx4 v33, s[16:19], s99 offen  lds
  s_add_u32 m0, s62, 34816
  s_add_u32 s99, s91, 202752
  buffer_load_dwordx4 v33, s[16:19], s99 offen  lds
  s_add_u32 m0, s62, 35840
  s_add_u32 s99, s91, 221184
  buffer_load_dwordx4 v33, s[16:19], s99 offen  lds
  s_add_u32 m0, s62, 36864
  s_add_u32 s99, s90, 239616
  buffer_load_dwordx4 v33, s[16:19], s99 offen  lds
  s_add_u32 m0, s62, 37888
  s_add_u32 s99, s90, 258048
  buffer_load_dwordx4 v33, s[16:19], s99 offen  lds
  s_waitcnt vmcnt(36)
  ds_read_b64_tr_b16 a[0:1], v35 offset:0
  ds_read_b64_tr_b16 a[2:3], v35 offset:256
  ds_read_b64_tr_b16 a[4:5], v36 offset:0
  ds_read_b64_tr_b16 a[6:7], v36 offset:256
  s_add_u32 m0, s62, 38912
  s_add_u32 s99, s90, 239680
  buffer_load_dwordx4 v33, s[16:19], s99 offen  lds
  s_add_u32 m0, s62, 39936
  s_add_u32 s99, s90, 258112
  buffer_load_dwordx4 v33, s[16:19], s99 offen  lds
  s_waitcnt vmcnt(36)
  ds_read_b64_tr_b16 a[8:9], v35 offset:2048
  ds_read_b64_tr_b16 a[10:11], v35 offset:2304
  ds_read_b64_tr_b16 a[12:13], v36 offset:2048
  ds_read_b64_tr_b16 a[14:15], v36 offset:2304
  s_waitcnt lgkmcnt(4)
  s_add_u32 m0, s62, 0
  s_add_u32 s99, s91, 239616
  buffer_load_dwordx4 v33, s[16:19], s99 offen  lds
  s_add_u32 m0, s62, 1024
  s_add_u32 s99, s91, 258048
  buffer_load_dwordx4 v33, s[16:19], s99 offen  lds
  s_waitcnt vmcnt(36)
  ds_read_b64_tr_b16 a[16:17], v32 offset:4096
  ds_read_b64_tr_b16 a[18:19], v32 offset:4352
  ds_read_b64_tr_b16 a[20:21], v32 offset:4104
  ds_read_b64_tr_b16 a[22:23], v32 offset:4360
  s_waitcnt lgkmcnt(4)
  s_add_u32 m0, s62, 2048
  s_add_u32 s99, s90, 276480
  buffer_load_dwordx4 v33, s[16:19], s99 offen  lds
  s_add_u32 m0, s62, 3072
  s_add_u32 s99, s90, 294912
  buffer_load_dwordx4 v33, s[16:19], s99 offen  lds
  s_waitcnt vmcnt(36)
  ds_read_b64_tr_b16 a[24:25], v35 offset:6144
  ds_read_b64_tr_b16 a[26:27], v35 offset:6400
  ds_read_b64_tr_b16 a[28:29], v36 offset:6144
  ds_read_b64_tr_b16 a[30:31], v36 offset:6400
  s_waitcnt lgkmcnt(4)
  s_add_u32 m0, s62, 4096
  s_add_u32 s99, s90, 276544
  buffer_load_dwordx4 v33, s[16:19], s99 offen  lds
  s_add_u32 m0, s62, 5120
  s_add_u32 s99, s90, 294976
  buffer_load_dwordx4 v33, s[16:19], s99 offen  lds
  s_waitcnt vmcnt(36)
  ds_read_b64_tr_b16 a[32:33], v35 offset:8192
  ds_read_b64_tr_b16 a[34:35], v35 offset:8448
  ds_read_b64_tr_b16 a[36:37], v36 offset:8192
  ds_read_b64_tr_b16 a[38:39], v36 offset:8448
  s_waitcnt lgkmcnt(4)
  s_add_u32 m0, s62, 6144
  s_add_u32 s99, s91, 276480
  buffer_load_dwordx4 v33, s[16:19], s99 offen  lds
  s_add_u32 m0, s62, 7168
  s_add_u32 s99, s91, 294912
  buffer_load_dwordx4 v33, s[16:19], s99 offen  lds
  s_waitcnt vmcnt(36)
  ds_read_b64_tr_b16 a[40:41], v32 offset:10240
  ds_read_b64_tr_b16 a[42:43], v32 offset:10496
  ds_read_b64_tr_b16 a[44:45], v32 offset:10248
  ds_read_b64_tr_b16 a[46:47], v32 offset:10504
  s_waitcnt lgkmcnt(4)
  s_add_u32 m0, s62, 8192
  s_add_u32 s99, s90, 331776
  buffer_load_dwordx4 v33, s[16:19], s99 offen  lds
  s_add_u32 m0, s62, 9216
  s_add_u32 s99, s90, 350208
  buffer_load_dwordx4 v33, s[16:19], s99 offen  lds
  s_waitcnt vmcnt(36)
  ds_read_b64_tr_b16 a[48:49], v35 offset:12288
  ds_read_b64_tr_b16 a[50:51], v35 offset:12544
  ds_read_b64_tr_b16 a[52:53], v36 offset:12288
  ds_read_b64_tr_b16 a[54:55], v36 offset:12544
  s_waitcnt lgkmcnt(4)
  s_add_u32 m0, s62, 10240
  s_add_u32 s99, s90, 331840
  buffer_load_dwordx4 v33, s[16:19], s99 offen  lds
  s_add_u32 m0, s62, 11264
  s_add_u32 s99, s90, 350272
  buffer_load_dwordx4 v33, s[16:19], s99 offen  lds
  s_waitcnt vmcnt(36)
  ds_read_b64_tr_b16 a[56:57], v35 offset:14336
  ds_read_b64_tr_b16 a[58:59], v35 offset:14592
  ds_read_b64_tr_b16 a[60:61], v36 offset:14336
  ds_read_b64_tr_b16 a[62:63], v36 offset:14592
  s_waitcnt lgkmcnt(4)
  s_add_u32 m0, s62, 12288
  s_add_u32 s99, s91, 331776
  buffer_load_dwordx4 v33, s[16:19], s99 offen  lds
  s_add_u32 m0, s62, 13312
  s_add_u32 s99, s91, 350208
  buffer_load_dwordx4 v33, s[16:19], s99 offen  lds
  s_waitcnt vmcnt(36)
  ds_read_b64_tr_b16 a[64:65], v32 offset:16384
  ds_read_b64_tr_b16 a[66:67], v32 offset:16640
  ds_read_b64_tr_b16 a[68:69], v32 offset:16392
  ds_read_b64_tr_b16 a[70:71], v32 offset:16648
  s_waitcnt lgkmcnt(4)
  s_add_u32 m0, s62, 14336
  s_add_u32 s99, s90, 368640
  buffer_load_dwordx4 v33, s[16:19], s99 offen  lds
  s_add_u32 m0, s62, 15360
  s_add_u32 s99, s90, 387072
  buffer_load_dwordx4 v33, s[16:19], s99 offen  lds
  s_waitcnt vmcnt(36)
  ds_read_b64_tr_b16 a[72:73], v35 offset:18432
  ds_read_b64_tr_b16 a[74:75], v35 offset:18688
  ds_read_b64_tr_b16 a[76:77], v36 offset:18432
  ds_read_b64_tr_b16 a[78:79], v36 offset:18688
  s_waitcnt lgkmcnt(4)
  s_add_u32 m0, s62, 16384
  s_add_u32 s99, s90, 368704
  buffer_load_dwordx4 v33, s[16:19], s99 offen  lds
  s_add_u32 m0, s62, 17408
  s_add_u32 s99, s90, 387136
  buffer_load_dwordx4 v33, s[16:19], s99 offen  lds
  s_waitcnt vmcnt(36)
  ds_read_b64_tr_b16 a[80:81], v35 offset:20480
  ds_read_b64_tr_b16 a[82:83], v35 offset:20736
  ds_read_b64_tr_b16 a[84:85], v36 offset:20480
  ds_read_b64_tr_b16 a[86:87], v36 offset:20736
  s_waitcnt lgkmcnt(4)
  s_add_u32 m0, s62, 18432
  s_add_u32 s99, s91, 368640
  buffer_load_dwordx4 v33, s[16:19], s99 offen  lds
  s_add_u32 m0, s62, 19456
  s_add_u32 s99, s91, 387072
  buffer_load_dwordx4 v33, s[16:19], s99 offen  lds
  s_waitcnt vmcnt(36)
  ds_read_b64_tr_b16 a[88:89], v32 offset:22528
  ds_read_b64_tr_b16 a[90:91], v32 offset:22784
  ds_read_b64_tr_b16 a[92:93], v32 offset:22536
  ds_read_b64_tr_b16 a[94:95], v32 offset:22792
  s_waitcnt lgkmcnt(4)
  s_add_u32 m0, s62, 20480
  s_add_u32 s99, s90, 405504
  buffer_load_dwordx4 v33, s[16:19], s99 offen  lds
  s_add_u32 m0, s62, 21504
  s_add_u32 s99, s90, 423936
  buffer_load_dwordx4 v33, s[16:19], s99 offen  lds
  s_waitcnt vmcnt(36)
  ds_read_b64_tr_b16 a[96:97], v35 offset:24576
  ds_read_b64_tr_b16 a[98:99], v35 offset:24832
  ds_read_b64_tr_b16 a[100:101], v36 offset:24576
  ds_read_b64_tr_b16 a[102:103], v36 offset:24832
  s_waitcnt lgkmcnt(4)
  s_add_u32 m0, s62, 22528
  s_add_u32 s99, s90, 405568
  buffer_load_dwordx4 v33, s[16:19], s99 offen  lds
  s_add_u32 m0, s62, 23552
  s_add_u32 s99, s90, 424000
  buffer_load_dwordx4 v33, s[16:19], s99 offen  lds
  s_waitcnt vmcnt(36)
  ds_read_b64_tr_b16 a[104:105], v35 offset:26624
  ds_read_b64_tr_b16 a[106:107], v35 offset:26880
  ds_read_b64_tr_b16 a[108:109], v36 offset:26624
  ds_read_b64_tr_b16 a[110:111], v36 offset:26880
  s_waitcnt lgkmcnt(4)
  s_add_u32 m0, s62, 24576
  s_add_u32 s99, s91, 405504
  buffer_load_dwordx4 v33, s[16:19], s99 offen  lds
  s_add_u32 m0, s62, 25600
  s_add_u32 s99, s91, 423936
  buffer_load_dwordx4 v33, s[16:19], s99 offen  lds
  s_waitcnt vmcnt(36)
  ds_read_b64_tr_b16 a[112:113], v32 offset:28672
  ds_read_b64_tr_b16 a[114:115], v32 offset:28928
  ds_read_b64_tr_b16 a[116:117], v32 offset:28680
  ds_read_b64_tr_b16 a[118:119], v32 offset:28936
  s_waitcnt lgkmcnt(4)
  s_add_u32 m0, s62, 26624
  s_add_u32 s99, s90, 442368
  buffer_load_dwordx4 v33, s[16:19], s99 offen  lds
  s_add_u32 m0, s62, 27648
  s_add_u32 s99, s90, 460800
  buffer_load_dwordx4 v33, s[16:19], s99 offen  lds
  s_waitcnt vmcnt(36)
  ds_read_b64_tr_b16 a[120:121], v35 offset:30720
  ds_read_b64_tr_b16 a[122:123], v35 offset:30976
  ds_read_b64_tr_b16 a[124:125], v36 offset:30720
  ds_read_b64_tr_b16 a[126:127], v36 offset:30976
  s_waitcnt lgkmcnt(4)
  s_add_u32 m0, s62, 28672
  s_add_u32 s99, s90, 442432
  buffer_load_dwordx4 v33, s[16:19], s99 offen  lds
  s_add_u32 m0, s62, 29696
  s_add_u32 s99, s90, 460864
  buffer_load_dwordx4 v33, s[16:19], s99 offen  lds
  s_waitcnt vmcnt(36)
  ds_read_b64_tr_b16 a[128:129], v35 offset:32768
  ds_read_b64_tr_b16 a[130:131], v35 offset:33024
  ds_read_b64_tr_b16 a[132:133], v36 offset:32768
  ds_read_b64_tr_b16 a[134:135], v36 offset:33024
  s_waitcnt lgkmcnt(4)
  s_add_u32 m0, s62, 30720
  s_add_u32 s99, s91, 442368
  buffer_load_dwordx4 v33, s[16:19], s99 offen  lds
  s_add_u32 m0, s62, 31744
  s_add_u32 s99, s91, 460800
  buffer_load_dwordx4 v33, s[16:19], s99 offen  lds
  s_waitcnt vmcnt(36)
  ds_read_b64_tr_b16 a[136:137], v32 offset:34816
  ds_read_b64_tr_b16 a[138:139], v32 offset:35072
  ds_read_b64_tr_b16 a[140:141], v32 offset:34824
  ds_read_b64_tr_b16 a[142:143], v32 offset:35080
  s_waitcnt lgkmcnt(4)
  s_add_u32 m0, s62, 32768
  s_add_u32 s99, s90, 497664
  buffer_load_dwordx4 v33, s[16:19], s99 offen  lds
  s_add_u32 m0, s62, 33792
  s_add_u32 s99, s90, 516096
  buffer_load_dwordx4 v33, s[16:19], s99 offen  lds
  s_waitcnt vmcnt(36)
  ds_read_b64_tr_b16 a[144:145], v35 offset:36864
  ds_read_b64_tr_b16 a[146:147], v35 offset:37120
  ds_read_b64_tr_b16 a[148:149], v36 offset:36864
  ds_read_b64_tr_b16 a[150:151], v36 offset:37120
  s_waitcnt lgkmcnt(4)
  s_add_u32 m0, s62, 34816
  s_add_u32 s99, s90, 497728
  buffer_load_dwordx4 v33, s[16:19], s99 offen  lds
  s_add_u32 m0, s62, 35840
  s_add_u32 s99, s90, 516160
  buffer_load_dwordx4 v33, s[16:19], s99 offen  lds
  s_waitcnt vmcnt(36)
  ds_read_b64_tr_b16 a[152:153], v35 offset:38912
  ds_read_b64_tr_b16 a[154:155], v35 offset:39168
  ds_read_b64_tr_b16 a[156:157], v36 offset:38912
  ds_read_b64_tr_b16 a[158:159], v36 offset:39168
  s_waitcnt lgkmcnt(4)
  s_add_u32 m0, s62, 36864
  s_add_u32 s99, s91, 497664
  buffer_load_dwordx4 v33, s[16:19], s99 offen  lds
  s_add_u32 m0, s62, 37888
  s_add_u32 s99, s91, 516096
  buffer_load_dwordx4 v33, s[16:19], s99 offen  lds
  s_waitcnt vmcnt(36)
  ds_read_b64_tr_b16 a[160:161], v32 offset:0
  ds_read_b64_tr_b16 a[162:163], v32 offset:256
  ds_read_b64_tr_b16 a[164:165], v32 offset:8
  ds_read_b64_tr_b16 a[166:167], v32 offset:264
  s_waitcnt lgkmcnt(4)
  s_add_u32 m0, s62, 38912
  s_add_u32 s99, s90, 534528
  buffer_load_dwordx4 v33, s[16:19], s99 offen  lds
  s_add_u32 m0, s62, 39936
  s_add_u32 s99, s90, 552960
  buffer_load_dwordx4 v33, s[16:19], s99 offen  lds
  s_waitcnt vmcnt(36)
  ds_read_b64_tr_b16 a[168:169], v35 offset:2048
  ds_read_b64_tr_b16 a[170:171], v35 offset:2304
  ds_read_b64_tr_b16 a[172:173], v36 offset:2048
  ds_read_b64_tr_b16 a[174:175], v36 offset:2304
  s_waitcnt lgkmcnt(4)
  s_add_u32 m0, s62, 0
  s_add_u32 s99, s90, 534592
  buffer_load_dwordx4 v33, s[16:19], s99 offen  lds
  s_add_u32 m0, s62, 1024
  s_add_u32 s99, s90, 553024
  buffer_load_dwordx4 v33, s[16:19], s99 offen  lds
  s_waitcnt vmcnt(36)
  ds_read_b64_tr_b16 a[176:177], v35 offset:4096
  ds_read_b64_tr_b16 a[178:179], v35 offset:4352
  ds_read_b64_tr_b16 a[180:181], v36 offset:4096
  ds_read_b64_tr_b16 a[182:183], v36 offset:4352
  s_waitcnt lgkmcnt(4)
  s_add_u32 m0, s62, 2048
  s_add_u32 s99, s91, 534528
  buffer_load_dwordx4 v33, s[16:19], s99 offen  lds
  s_add_u32 m0, s62, 3072
  s_add_u32 s99, s91, 552960
  buffer_load_dwordx4 v33, s[16:19], s99 offen  lds
  s_waitcnt vmcnt(36)
  ds_read_b64_tr_b16 a[184:185], v32 offset:6144
  ds_read_b64_tr_b16 a[186:187], v32 offset:6400
  ds_read_b64_tr_b16 a[188:189], v32 offset:6152
  ds_read_b64_tr_b16 a[190:191], v32 offset:6408
  s_waitcnt lgkmcnt(4)
  s_add_u32 m0, s62, 4096
  s_add_u32 s99, s90, 571392
  buffer_load_dwordx4 v33, s[16:19], s99 offen  lds
  s_add_u32 m0, s62, 5120
  s_add_u32 s99, s90, 589824
  buffer_load_dwordx4 v33, s[16:19], s99 offen  lds
  s_waitcnt vmcnt(36)
  ds_read_b64_tr_b16 a[192:193], v35 offset:8192
  ds_read_b64_tr_b16 a[194:195], v35 offset:8448
  ds_read_b64_tr_b16 a[196:197], v36 offset:8192
  ds_read_b64_tr_b16 a[198:199], v36 offset:8448
  s_waitcnt lgkmcnt(4)
  s_add_u32 m0, s62, 6144
  s_add_u32 s99, s90, 571456
  buffer_load_dwordx4 v33, s[16:19], s99 offen  lds
  s_add_u32 m0, s62, 7168
  s_add_u32 s99, s90, 589888
  buffer_load_dwordx4 v33, s[16:19], s99 offen  lds
  s_waitcnt vmcnt(36)
  ds_read_b64_tr_b16 a[200:201], v35 offset:10240
  ds_read_b64_tr_b16 a[202:203], v35 offset:10496
  ds_read_b64_tr_b16 a[204:205], v36 offset:10240
  ds_read_b64_tr_b16 a[206:207], v36 offset:10496
  s_waitcnt lgkmcnt(4)
  s_add_u32 m0, s62, 8192
  s_add_u32 s99, s91, 571392
  buffer_load_dwordx4 v33, s[16:19], s99 offen  lds
  s_add_u32 m0, s62, 9216
  s_add_u32 s99, s91, 589824
  buffer_load_dwordx4 v33, s[16:19], s99 offen  lds
  s_waitcnt vmcnt(36)
  ds_read_b64_tr_b16 a[208:209], v32 offset:12288
  ds_read_b64_tr_b16 a[210:211], v32 offset:12544
  ds_read_b64_tr_b16 a[212:213], v32 offset:12296
  ds_read_b64_tr_b16 a[214:215], v32 offset:12552
  s_waitcnt lgkmcnt(4)
  s_add_u32 m0, s62, 10240
  s_add_u32 s99, s90, 608256
  buffer_load_dwordx4 v33, s[16:19], s99 offen  lds
  s_add_u32 m0, s62, 11264
  s_add_u32 s99, s90, 626688
  buffer_load_dwordx4 v33, s[16:19], s99 offen  lds
  s_waitcnt vmcnt(36)
  ds_read_b64_tr_b16 a[216:217], v35 offset:14336
  ds_read_b64_tr_b16 a[218:219], v35 offset:14592
  ds_read_b64_tr_b16 a[220:221], v36 offset:14336
  ds_read_b64_tr_b16 a[222:223], v36 offset:14592
  s_waitcnt lgkmcnt(4)
  s_add_u32 m0, s62, 12288
  s_add_u32 s99, s90, 608320
  buffer_load_dwordx4 v33, s[16:19], s99 offen  lds
  s_add_u32 m0, s62, 13312
  s_add_u32 s99, s90, 626752
  buffer_load_dwordx4 v33, s[16:19], s99 offen  lds
  s_waitcnt vmcnt(36)
  ds_read_b64_tr_b16 a[224:225], v35 offset:16384
  ds_read_b64_tr_b16 a[226:227], v35 offset:16640
  ds_read_b64_tr_b16 a[228:229], v36 offset:16384
  ds_read_b64_tr_b16 a[230:231], v36 offset:16640
  s_waitcnt lgkmcnt(4)
  s_add_u32 m0, s62, 14336
  s_add_u32 s99, s91, 608256
  buffer_load_dwordx4 v33, s[16:19], s99 offen  lds
  s_add_u32 m0, s62, 15360
  s_add_u32 s99, s91, 626688
  buffer_load_dwordx4 v33, s[16:19], s99 offen  lds
  s_waitcnt vmcnt(36)
  ds_read_b64_tr_b16 a[232:233], v32 offset:18432
  ds_read_b64_tr_b16 a[234:235], v32 offset:18688
  ds_read_b64_tr_b16 a[236:237], v32 offset:18440
  ds_read_b64_tr_b16 a[238:239], v32 offset:18696
  s_waitcnt lgkmcnt(4)
  s_add_u32 m0, s62, 16384
  s_add_u32 s99, s90, 147456
  buffer_load_dwordx4 v34, s[16:19], s99 offen  lds
  s_add_u32 m0, s62, 17408
  s_add_u32 s99, s90, 148608
  buffer_load_dwordx4 v34, s[16:19], s99 offen  lds
  s_waitcnt vmcnt(36)
  ds_read_b64_tr_b16 a[240:241], v35 offset:20480
  ds_read_b64_tr_b16 a[242:243], v35 offset:20736
  ds_read_b64_tr_b16 a[244:245], v36 offset:20480
  ds_read_b64_tr_b16 a[246:247], v36 offset:20736
  s_waitcnt lgkmcnt(4)
  s_add_u32 m0, s62, 18432
  s_add_u32 s99, s90, 147520
  buffer_load_dwordx4 v34, s[16:19], s99 offen  lds
  s_add_u32 m0, s62, 19456
  s_add_u32 s99, s90, 148672
  buffer_load_dwordx4 v34, s[16:19], s99 offen  lds
  s_waitcnt vmcnt(36)
  ds_read_b64_tr_b16 a[248:249], v35 offset:22528
  ds_read_b64_tr_b16 a[250:251], v35 offset:22784
  ds_read_b64_tr_b16 a[252:253], v36 offset:22528
  ds_read_b64_tr_b16 a[254:255], v36 offset:22784
  s_waitcnt lgkmcnt(4)
  s_add_u32 m0, s62, 20480
  s_add_u32 s99, s91, 147456
  buffer_load_dwordx4 v34, s[16:19], s99 offen  lds
  s_add_u32 m0, s62, 21504
  s_add_u32 s99, s91, 148608
  buffer_load_dwordx4 v34, s[16:19], s99 offen  lds
  s_waitcnt vmcnt(36)
  ds_read_b64_tr_b16 v[80:81], v32 offset:24576
  ds_read_b64_tr_b16 v[82:83], v32 offset:24832
  ds_read_b64_tr_b16 v[84:85], v32 offset:24584
  ds_read_b64_tr_b16 v[86:87], v32 offset:24840
  s_waitcnt lgkmcnt(4)
  s_add_u32 m0, s62, 22528
  s_add_u32 s99, s90, 479232
  buffer_load_dwordx4 v34, s[16:19], s99 offen  lds
  s_add_u32 m0, s62, 23552
  s_add_u32 s99, s90, 480384
  buffer_load_dwordx4 v34, s[16:19], s99 offen  lds
  s_waitcnt vmcnt(36)
  ds_read_b64_tr_b16 v[88:89], v35 offset:26624
  ds_read_b64_tr_b16 v[90:91], v35 offset:26880
  ds_read_b64_tr_b16 v[92:93], v36 offset:26624
  ds_read_b64_tr_b16 v[94:95], v36 offset:26880
  s_waitcnt lgkmcnt(4)
  s_add_u32 m0, s62, 24576
  s_add_u32 s99, s90, 479296
  buffer_load_dwordx4 v34, s[16:19], s99 offen  lds
  s_add_u32 m0, s62, 25600
  s_add_u32 s99, s90, 480448
  buffer_load_dwordx4 v34, s[16:19], s99 offen  lds
  s_waitcnt vmcnt(36)
  ds_read_b64_tr_b16 v[96:97], v35 offset:28672
  ds_read_b64_tr_b16 v[98:99], v35 offset:28928
  ds_read_b64_tr_b16 v[100:101], v36 offset:28672
  ds_read_b64_tr_b16 v[102:103], v36 offset:28928
  s_waitcnt lgkmcnt(4)
  s_add_u32 m0, s62, 26624
  s_add_u32 s99, s91, 479232
  buffer_load_dwordx4 v34, s[16:19], s99 offen  lds
  s_add_u32 m0, s62, 27648
  s_add_u32 s99, s91, 480384
  buffer_load_dwordx4 v34, s[16:19], s99 offen  lds
  s_waitcnt vmcnt(36)
  ds_read_b64_tr_b16 v[104:105], v32 offset:30720
  ds_read_b64_tr_b16 v[106:107], v32 offset:30976
  ds_read_b64_tr_b16 v[108:109], v32 offset:30728
  ds_read_b64_tr_b16 v[110:111], v32 offset:30984
  s_waitcnt vmcnt(34)
  ds_read_b64_tr_b16 v[112:113], v35 offset:32768
  ds_read_b64_tr_b16 v[114:115], v35 offset:33024
  ds_read_b64_tr_b16 v[116:117], v36 offset:32768
  ds_read_b64_tr_b16 v[118:119], v36 offset:33024
  s_waitcnt vmcnt(32)
  ds_read_b64_tr_b16 v[120:121], v35 offset:34816
  ds_read_b64_tr_b16 v[122:123], v35 offset:35072
  ds_read_b64_tr_b16 v[124:125], v36 offset:34816
  ds_read_b64_tr_b16 v[126:127], v36 offset:35072
  s_waitcnt vmcnt(30)
  ds_read_b64_tr_b16 v[128:129], v32 offset:36864
  ds_read_b64_tr_b16 v[130:131], v32 offset:37120
  ds_read_b64_tr_b16 v[132:133], v32 offset:36872
  ds_read_b64_tr_b16 v[134:135], v32 offset:37128
  s_waitcnt vmcnt(28)
  ds_read_b64_tr_b16 v[136:137], v35 offset:38912
  ds_read_b64_tr_b16 v[138:139], v35 offset:39168
  ds_read_b64_tr_b16 v[140:141], v36 offset:38912
  ds_read_b64_tr_b16 v[142:143], v36 offset:39168
  s_waitcnt vmcnt(26)
  ds_read_b64_tr_b16 v[144:145], v35 offset:0
  ds_read_b64_tr_b16 v[146:147], v35 offset:256
  ds_read_b64_tr_b16 v[148:149], v36 offset:0
  ds_read_b64_tr_b16 v[150:151], v36 offset:256
  s_waitcnt vmcnt(24)
  ds_read_b64_tr_b16 v[152:153], v32 offset:2048
  ds_read_b64_tr_b16 v[154:155], v32 offset:2304
  ds_read_b64_tr_b16 v[156:157], v32 offset:2056
  ds_read_b64_tr_b16 v[158:159], v32 offset:2312
  s_waitcnt vmcnt(22)
  ds_read_b64_tr_b16 v[160:161], v35 offset:4096
  ds_read_b64_tr_b16 v[162:163], v35 offset:4352
  ds_read_b64_tr_b16 v[164:165], v36 offset:4096
  ds_read_b64_tr_b16 v[166:167], v36 offset:4352
  s_waitcnt vmcnt(20)
  ds_read_b64_tr_b16 v[168:169], v35 offset:6144
  ds_read_b64_tr_b16 v[170:171], v35 offset:6400
  ds_read_b64_tr_b16 v[172:173], v36 offset:6144
  ds_read_b64_tr_b16 v[174:175], v36 offset:6400
  s_waitcnt vmcnt(18)
  ds_read_b64_tr_b16 v[176:177], v32 offset:8192
  ds_read_b64_tr_b16 v[178:179], v32 offset:8448
  ds_read_b64_tr_b16 v[180:181], v32 offset:8200
  ds_read_b64_tr_b16 v[182:183], v32 offset:8456
  s_waitcnt vmcnt(16)
  ds_read_b64_tr_b16 v[184:185], v35 offset:10240
  ds_read_b64_tr_b16 v[186:187], v35 offset:10496
  ds_read_b64_tr_b16 v[188:189], v36 offset:10240
  ds_read_b64_tr_b16 v[190:191], v36 offset:10496
  s_waitcnt vmcnt(14)
  ds_read_b64_tr_b16 v[192:193], v35 offset:12288
  ds_read_b64_tr_b16 v[194:195], v35 offset:12544
  ds_read_b64_tr_b16 v[196:197], v36 offset:12288
  ds_read_b64_tr_b16 v[198:199], v36 offset:12544
  s_waitcnt vmcnt(12)
  ds_read_b64_tr_b16 v[200:201], v32 offset:14336
  ds_read_b64_tr_b16 v[202:203], v32 offset:14592
  ds_read_b64_tr_b16 v[204:205], v32 offset:14344
  ds_read_b64_tr_b16 v[206:207], v32 offset:14600
  s_waitcnt vmcnt(10)
  ds_read_b64_tr_b16 v[208:209], v35 offset:16384
  ds_read_b64_tr_b16 v[210:211], v35 offset:16640
  ds_read_b64_tr_b16 v[212:213], v36 offset:16384
  ds_read_b64_tr_b16 v[214:215], v36 offset:16640
  s_waitcnt vmcnt(8)
  ds_read_b64_tr_b16 v[216:217], v35 offset:18432
  ds_read_b64_tr_b16 v[218:219], v35 offset:18688
  ds_read_b64_tr_b16 v[220:221], v36 offset:18432
  ds_read_b64_tr_b16 v[222:223], v36 offset:18688
  s_waitcnt vmcnt(6)
  ds_read_b64_tr_b16 v[224:225], v32 offset:20480
  ds_read_b64_tr_b16 v[226:227], v32 offset:20736
  ds_read_b64_tr_b16 v[228:229], v32 offset:20488
  ds_read_b64_tr_b16 v[230:231], v32 offset:20744
  s_waitcnt vmcnt(4)
  ds_read_b64_tr_b16 v[232:233], v35 offset:22528
  ds_read_b64_tr_b16 v[234:235], v35 offset:22784
  ds_read_b64_tr_b16 v[236:237], v36 offset:22528
  ds_read_b64_tr_b16 v[238:239], v36 offset:22784
  s_waitcnt vmcnt(2)
  ds_read_b64_tr_b16 v[240:241], v35 offset:24576
  ds_read_b64_tr_b16 v[242:243], v35 offset:24832
  ds_read_b64_tr_b16 v[244:245], v36 offset:24576
  ds_read_b64_tr_b16 v[246:247], v36 offset:24832
  s_waitcnt vmcnt(0)
  ds_read_b64_tr_b16 v[248:249], v32 offset:26624
  ds_read_b64_tr_b16 v[250:251], v32 offset:26880
  ds_read_b64_tr_b16 v[252:253], v32 offset:26632
  ds_read_b64_tr_b16 v[254:255], v32 offset:26888
  s_waitcnt lgkmcnt(0)
  s_barrier
  v_mov_b32 v32, 64
  s_mov_b64 exec, 1
L_wa_155:
  global_load_dword v33, v32, s[4:5] sc1
  s_waitcnt vmcnt(0)
  v_readfirstlane_b32 s98, v33
  s_nop 0
  s_cmp_ge_u32 s98, 256
  s_nop 1
  s_cbranch_scc1 L_wa_155d
  s_sleep 8
  s_sub_u32 s100, s100, 1
  s_cbranch_scc0 L_wa_155
  s_branch L_end
L_wa_155d:
  s_mov_b64 exec, -1
  s_lshl_b32 s91, s60, 3
  s_add_u32 s91, s91, s64
  s_lshl_b32 s91, s91, 2
  s_add_u32 s91, s91, s93
  s_mov_b32 s66, 0xffff
  s_mov_b32 s67, 0
  s_mov_b32 s28, s12
  s_mov_b32 s29, s13
  s_mov_b32 s30, 0
  s_mov_b32 s31, 0x20000
  s_lshl_b32 s45, s9, 8
  s_add_u32 s45, s45, 73728
  v_mbcnt_lo_u32_b32 v72, -1, 0
  v_mbcnt_hi_u32_b32 v72, -1, v72
  v_lshl_add_u32 v72, v72, 2, s45
  v_mov_b32 v6, 0
  ds_write_b32 v72, v6
L_bk_156:
  s_mov_b64 exec, s[40:41]
  buffer_load_dword v6, v1, s[12:15], s36 offen sc1
  s_mov_b64 exec, -1
  s_add_u32 s98, s32, 1
  s_mov_b64 exec, s[40:41]
  s_waitcnt vmcnt(0)
  v_cmp_gt_u32 vcc, s98, v6
  s_mov_b64 exec, -1
  s_cbranch_vccz L_bk_156d
  s_sleep 1
  s_sub_u32 s100, s100, 1
  s_cbranch_scc0 L_bk_156
  s_branch L_end
L_bk_156d:
  s_add_u32 m0, s34, 0
  s_add_u32 s98, s33, 0
  buffer_load_dwordx4 v0, s[12:15], s98 offen offset:0 sc1 lds
  buffer_load_dwordx4 v0, s[12:15], s98 offen offset:1024 sc1 lds
  buffer_load_dwordx4 v0, s[12:15], s98 offen offset:2048 sc1 lds
  buffer_load_dwordx4 v0, s[12:15], s98 offen offset:3072 sc1 lds
  s_add_u32 m0, s34, 4096
  s_add_u32 s98, s33, 4096
  buffer_load_dwordx4 v0, s[12:15], s98 offen offset:0 sc1 lds
  buffer_load_dwordx4 v0, s[12:15], s98 offen offset:1024 sc1 lds
  buffer_load_dwordx4 v0, s[12:15], s98 offen offset:2048 sc1 lds
  buffer_load_dwordx4 v0, s[12:15], s98 offen offset:3072 sc1 lds
  s_add_u32 m0, s34, 8192
  s_add_u32 s98, s33, 8192
  buffer_load_dwordx4 v0, s[12:15], s98 offen offset:0 sc1 lds
  s_add_u32 s33, s33, 294912
  s_xor_b32 s34, s34, s39
  s_mov_b32 s35, 1
  s_waitcnt vmcnt(0)
L_dnG_loop:
  s_barrier
  s_bfe_u32 s63, s32, 65537
  ds_read_b128 v[16:19], v2 offset:0
  ds_read_b128 v[20:23], v2 offset:2048
  ds_read_b128 v[24:27], v2 offset:4096
  ds_read_b128 v[28:31], v2 offset:6144
  s_cmp_ge_u32 s32, 63
  s_cselect_b32 s35, 1, 0
  s_waitcnt lgkmcnt(3)
  v_mfma_f32_16x16x32_bf16 v[32:35], a[0:3], v[16:19], 0
  v_mfma_f32_16x16x32_bf16 v[36:39], a[4:7], v[16:19], 0
  v_mfma_f32_16x16x32_bf16 v[40:43], a[8:11], v[16:19], 0
  v_mfma_f32_16x16x32_bf16 v[44:47], a[12:15], v[16:19], 0
  s_mov_b64 exec, s[40:41]
  buffer_load_dword v6, v1, s[12:15], s36 offen sc1
  s_mov_b64 exec, -1
  v_mfma_f32_16x16x32_bf16 v[48:51], a[16:19], v[16:19], 0
  v_mfma_f32_16x16x32_bf16 v[52:55], a[20:23], v[16:19], 0
  ds_read_b128 v[16:19], v2 offset:9216
  s_waitcnt lgkmcnt(3)
  v_mfma_f32_16x16x32_bf16 v[32:35], a[24:27], v[20:23], v[32:35]
  v_mfma_f32_16x16x32_bf16 v[36:39], a[28:31], v[20:23], v[36:39]
  v_mfma_f32_16x16x32_bf16 v[40:43], a[32:35], v[20:23], v[40:43]
  v_mfma_f32_16x16x32_bf16 v[44:47], a[36:39], v[20:23], v[44:47]
  v_mfma_f32_16x16x32_bf16 v[48:51], a[40:43], v[20:23], v[48:51]
  v_mfma_f32_16x16x32_bf16 v[52:55], a[44:47], v[20:23], v[52:55]
  ds_read_b128 v[20:23], v2 offset:11264
  s_waitcnt lgkmcnt(3)
  v_mfma_f32_16x16x32_bf16 v[32:35], a[48:51], v[24:27], v[32:35]
  v_mfma_f32_16x16x32_bf16 v[36:39], a[52:55], v[24:27], v[36:39]
  v_mfma_f32_16x16x32_bf16 v[40:43], a[56:59], v[24:27], v[40:43]
  v_mfma_f32_16x16x32_bf16 v[44:47], a[60:63], v[24:27], v[44:47]
  v_mfma_f32_16x16x32_bf16 v[48:51], a[64:67], v[24:27], v[48:51]
  v_mfma_f32_16x16x32_bf16 v[52:55], a[68:71], v[24:27], v[52:55]
  ds_read_b128 v[24:27], v2 offset:13312
  s_waitcnt lgkmcnt(3)
  v_mfma_f32_16x16x32_bf16 v[32:35], a[72:75], v[28:31], v[32:35]
  v_mfma_f32_16x16x32_bf16 v[36:39], a[76:79], v[28:31], v[36:39]
  v_mfma_f32_16x16x32_bf16 v[40:43], a[80:83], v[28:31], v[40:43]
  v_mfma_f32_16x16x32_bf16 v[44:47], a[84:87], v[28:31], v[44:47]
  v_mfma_f32_16x16x32_bf16 v[48:51], a[88:91], v[28:31], v[48:51]
  v_mfma_f32_16x16x32_bf16 v[52:55], a[92:95], v[28:31], v[52:55]
  ds_read_b128 v[28:31], v2 offset:15360
  s_waitcnt lgkmcnt(3)
  v_mfma_f32_16x16x32_bf16 v[32:35], a[96:99], v[16:19], v[32:35]
  v_mfma_f32_16x16x32_bf16 v[36:39], a[100:103], v[16:19], v[36:39]
  v_mfma_f32_16x16x32_bf16 v[40:43], a[104:107], v[16:19], v[40:43]
  v_mfma_f32_16x16x32_bf16 v[44:47], a[108:111], v[16:19], v[44:47]
  v_mfma_f32_16x16x32_bf16 v[48:51], a[112:115], v[16:19], v[48:51]
  v_mfma_f32_16x16x32_bf16 v[52:55], a[116:119], v[16:19], v[52:55]
  ds_read_b128 v[16:19], v2 offset:18432
  s_waitcnt lgkmcnt(3)
  v_mfma_f32_16x16x32_bf16 v[32:35], a[120:123], v[20:23], v[32:35]
  v_mfma_f32_16x16x32_bf16 v[36:39], a[124:127], v[20:23], v[36:39]
  v_mfma_f32_16x16x32_bf16 v[40:43], a[128:131], v[20:23], v[40:43]
  v_mfma_f32_16x16x32_bf16 v[44:47], a[132:135], v[20:23], v[44:47]
  v_mfma_f32_16x16x32_bf16 v[48:51], a[136:139], v[20:23], v[48:51]
  v_mfma_f32_16x16x32_bf16 v[52:55], a[140:143], v[20:23], v[52:55]
  ds_read_b128 v[20:23], v2 offset:20480
  s_waitcnt lgkmcnt(3)
  v_mfma_f32_16x16x32_bf16 v[32:35], a[144:147], v[24:27], v[32:35]
  v_mfma_f32_16x16x32_bf16 v[36:39], a[148:151], v[24:27], v[36:39]
  v_mfma_f32_16x16x32_bf16 v[40:43], a[152:155], v[24:27], v[40:43]
  v_mfma_f32_16x16x32_bf16 v[44:47], a[156:159], v[24:27], v[44:47]
  v_mfma_f32_16x16x32_bf16 v[48:51], a[160:163], v[24:27], v[48:51]
  v_mfma_f32_16x16x32_bf16 v[52:55], a[164:167], v[24:27], v[52:55]
  ds_read_b128 v[24:27], v2 offset:22528
  s_waitcnt lgkmcnt(3)
  v_mfma_f32_16x16x32_bf16 v[32:35], a[168:171], v[28:31], v[32:35]
  v_mfma_f32_16x16x32_bf16 v[36:39], a[172:175], v[28:31], v[36:39]
  v_mfma_f32_16x16x32_bf16 v[40:43], a[176:179], v[28:31], v[40:43]
  v_mfma_f32_16x16x32_bf16 v[44:47], a[180:183], v[28:31], v[44:47]
  v_mfma_f32_16x16x32_bf16 v[48:51], a[184:187], v[28:31], v[48:51]
  v_mfma_f32_16x16x32_bf16 v[52:55], a[188:191], v[28:31], v[52:55]
  ds_read_b128 v[28:31], v2 offset:24576
  s_waitcnt lgkmcnt(3)
  v_mfma_f32_16x16x32_bf16 v[32:35], a[192:195], v[16:19], v[32:35]
  v_mfma_f32_16x16x32_bf16 v[36:39], a[196:199], v[16:19], v[36:39]
  v_mfma_f32_16x16x32_bf16 v[40:43], a[200:203], v[16:19], v[40:43]
  v_mfma_f32_16x16x32_bf16 v[44:47], a[204:207], v[16:19], v[44:47]
  v_mfma_f32_16x16x32_bf16 v[48:51], a[208:211], v[16:19], v[48:51]
  v_mfma_f32_16x16x32_bf16 v[52:55], a[212:215], v[16:19], v[52:55]
  ds_read_b128 v[16:19], v2 offset:27648
  s_cmp_lg_u32 s35, 0
  s_waitcnt lgkmcnt(3)
  v_mfma_f32_16x16x32_bf16 v[32:35], a[216:219], v[20:23], v[32:35]
  s_cbranch_scc1 L_ck_157
  s_add_u32 s98, s32, 2
  s_mov_b64 exec, s[40:41]
  s_waitcnt vmcnt(0)
  v_cmp_gt_u32 vcc, s98, v6
  s_mov_b64 exec, -1
  s_cbranch_vccnz L_ck_157r
  s_add_u32 m0, s34, 0
  s_add_u32 s98, s33, 0
  buffer_load_dwordx4 v0, s[12:15], s98 offen offset:0 sc1 lds
  buffer_load_dwordx4 v0, s[12:15], s98 offen offset:1024 sc1 lds
  buffer_load_dwordx4 v0, s[12:15], s98 offen offset:2048 sc1 lds
  buffer_load_dwordx4 v0, s[12:15], s98 offen offset:3072 sc1 lds
  s_add_u32 m0, s34, 4096
  s_add_u32 s98, s33, 4096
  buffer_load_dwordx4 v0, s[12:15], s98 offen offset:0 sc1 lds
  buffer_load_dwordx4 v0, s[12:15], s98 offen offset:1024 sc1 lds
  buffer_load_dwordx4 v0, s[12:15], s98 offen offset:2048 sc1 lds
  buffer_load_dwordx4 v0, s[12:15], s98 offen offset:3072 sc1 lds
  s_add_u32 m0, s34, 8192
  s_add_u32 s98, s33, 8192
  buffer_load_dwordx4 v0, s[12:15], s98 offen offset:0 sc1 lds
  s_add_u32 s33, s33, 294912
  s_xor_b32 s34, s34, s39
  s_mov_b32 s35, 1
  s_branch L_ck_157
L_ck_157r:
  s_mov_b64 exec, s[40:41]
  buffer_load_dword v6, v1, s[12:15], s36 offen sc1
  s_mov_b64 exec, -1
L_ck_157:
  v_mfma_f32_16x16x32_bf16 v[36:39], a[220:223], v[20:23], v[36:39]
  v_mfma_f32_16x16x32_bf16 v[40:43], a[224:227], v[20:23], v[40:43]
  v_mfma_f32_16x16x32_bf16 v[44:47], a[228:231], v[20:23], v[44:47]
  v_mfma_f32_16x16x32_bf16 v[48:51], a[232:235], v[20:23], v[48:51]
  v_mfma_f32_16x16x32_bf16 v[52:55], a[236:239], v[20:23], v[52:55]
  ds_read_b128 v[20:23], v2 offset:29696
  s_waitcnt lgkmcnt(3)
  v_mfma_f32_16x16x32_bf16 v[32:35], a[240:243], v[24:27], v[32:35]
  v_mfma_f32_16x16x32_bf16 v[36:39], a[244:247], v[24:27], v[36:39]
  v_mfma_f32_16x16x32_bf16 v[40:43], a[248:251], v[24:27], v[40:43]
  v_mfma_f32_16x16x32_bf16 v[44:47], a[252:255], v[24:27], v[44:47]
  v_mfma_f32_16x16x32_bf16 v[48:51], v[80:83], v[24:27], v[48:51]
  v_mfma_f32_16x16x32_bf16 v[52:55], v[84:87], v[24:27], v[52:55]
  ds_read_b128 v[24:27], v2 offset:31744
  s_waitcnt lgkmcnt(3)
  v_mfma_f32_16x16x32_bf16 v[32:35], v[88:91], v[28:31], v[32:35]
  v_mfma_f32_16x16x32_bf16 v[36:39], v[92:95], v[28:31], v[36:39]
  v_mfma_f32_16x16x32_bf16 v[40:43], v[96:99], v[28:31], v[40:43]
  v_mfma_f32_16x16x32_bf16 v[44:47], v[100:103], v[28:31], v[44:47]
  v_mfma_f32_16x16x32_bf16 v[48:51], v[104:107], v[28:31], v[48:51]
  v_mfma_f32_16x16x32_bf16 v[52:55], v[108:111], v[28:31], v[52:55]
  ds_read_b128 v[28:31], v2 offset:33792
  s_waitcnt lgkmcnt(3)
  v_mfma_f32_16x16x32_bf16 v[32:35], v[112:115], v[16:19], v[32:35]
  v_mfma_f32_16x16x32_bf16 v[36:39], v[116:119], v[16:19], v[36:39]
  v_mfma_f32_16x16x32_bf16 v[40:43], v[120:123], v[16:19], v[40:43]
  v_mfma_f32_16x16x32_bf16 v[44:47], v[124:127], v[16:19], v[44:47]
  v_mfma_f32_16x16x32_bf16 v[48:51], v[128:131], v[16:19], v[48:51]
  v_mfma_f32_16x16x32_bf16 v[52:55], v[132:135], v[16:19], v[52:55]
  ds_read2st64_b32 v[16:17], v4 offset0:32 offset1:34
  ds_read2st64_b32 v[18:19], v4 offset0:68 offset1:70
  s_waitcnt lgkmcnt(4)
  v_mfma_f32_16x16x32_bf16 v[32:35], v[136:139], v[20:23], v[32:35]
  s_mov_b64 exec, s[66:67]
  buffer_load_dword v10, v1, s[12:15], s93 offen sc1
  s_mov_b64 exec, -1
  v_mfma_f32_16x16x32_bf16 v[36:39], v[140:143], v[20:23], v[36:39]
  v_mfma_f32_16x16x32_bf16 v[40:43], v[144:147], v[20:23], v[40:43]
  v_mfma_f32_16x16x32_bf16 v[44:47], v[148:151], v[20:23], v[44:47]
  v_mfma_f32_16x16x32_bf16 v[48:51], v[152:155], v[20:23], v[48:51]
  v_mfma_f32_16x16x32_bf16 v[52:55], v[156:159], v[20:23], v[52:55]
  ds_read2st64_b32 v[20:21], v4 offset0:104 offset1:106
  ds_read2st64_b32 v[22:23], v4 offset0:140 offset1:142
  s_waitcnt lgkmcnt(5)
  v_mfma_f32_16x16x32_bf16 v[32:35], v[160:163], v[24:27], v[32:35]
  v_mfma_f32_16x16x32_bf16 v[36:39], v[164:167], v[24:27], v[36:39]
  v_mfma_f32_16x16x32_bf16 v[40:43], v[168:171], v[24:27], v[40:43]
  v_mfma_f32_16x16x32_bf16 v[44:47], v[172:175], v[24:27], v[44:47]
  v_mfma_f32_16x16x32_bf16 v[48:51], v[176:179], v[24:27], v[48:51]
  v_mfma_f32_16x16x32_bf16 v[52:55], v[180:183], v[24:27], v[52:55]
  ds_read_b128 v[24:27], v3 offset:0
  s_waitcnt lgkmcnt(5)
  v_mfma_f32_16x16x32_bf16 v[32:35], v[184:187], v[28:31], v[32:35]
  v_mfma_f32_16x16x32_bf16 v[36:39], v[188:191], v[28:31], v[36:39]
  v_mfma_f32_16x16x32_bf16 v[40:43], v[192:195], v[28:31], v[40:43]
  v_mfma_f32_16x16x32_bf16 v[44:47], v[196:199], v[28:31], v[44:47]
  v_mfma_f32_16x16x32_bf16 v[48:51], v[200:203], v[28:31], v[48:51]
  v_mfma_f32_16x16x32_bf16 v[52:55], v[204:207], v[28:31], v[52:55]
  ds_read_b128 v[28:31], v3 offset:2048
  s_cmp_lg_u32 s35, 0
  s_waitcnt lgkmcnt(4)
  v_mfma_f32_16x16x32_bf16 v[32:35], v[208:211], v[16:19], v[32:35]
  v_mfma_f32_16x16x32_bf16 v[36:39], v[212:215], v[16:19], v[36:39]
  v_mfma_f32_16x16x32_bf16 v[40:43], v[216:219], v[16:19], v[40:43]
  v_mfma_f32_16x16x32_bf16 v[44:47], v[220:223], v[16:19], v[44:47]
  s_cbranch_scc1 L_ck_158
  s_add_u32 s98, s32, 2
  s_mov_b64 exec, s[40:41]
  s_waitcnt vmcnt(1)
  v_cmp_gt_u32 vcc, s98, v6
  s_mov_b64 exec, -1
  s_cbranch_vccnz L_ck_158r
  s_add_u32 m0, s34, 0
  s_add_u32 s98, s33, 0
  buffer_load_dwordx4 v0, s[12:15], s98 offen offset:0 sc1 lds
  buffer_load_dwordx4 v0, s[12:15], s98 offen offset:1024 sc1 lds
  buffer_load_dwordx4 v0, s[12:15], s98 offen offset:2048 sc1 lds
  buffer_load_dwordx4 v0, s[12:15], s98 offen offset:3072 sc1 lds
  s_add_u32 m0, s34, 4096
  s_add_u32 s98, s33, 4096
  buffer_load_dwordx4 v0, s[12:15], s98 offen offset:0 sc1 lds
  buffer_load_dwordx4 v0, s[12:15], s98 offen offset:1024 sc1 lds
  buffer_load_dwordx4 v0, s[12:15], s98 offen offset:2048 sc1 lds
  buffer_load_dwordx4 v0, s[12:15], s98 offen offset:3072 sc1 lds
  s_add_u32 m0, s34, 8192
  s_add_u32 s98, s33, 8192
  buffer_load_dwordx4 v0, s[12:15], s98 offen offset:0 sc1 lds
  s_add_u32 s33, s33, 294912
  s_xor_b32 s34, s34, s39
  s_mov_b32 s35, 1
  s_branch L_ck_158
L_ck_158r:
  s_mov_b64 exec, s[40:41]
  buffer_load_dword v6, v1, s[12:15], s36 offen sc1
  s_mov_b64 exec, -1
L_ck_158:
  v_mfma_f32_16x16x32_bf16 v[48:51], v[224:227], v[16:19], v[48:51]
  v_mfma_f32_16x16x32_bf16 v[52:55], v[228:231], v[16:19], v[52:55]
  ds_read_b128 v[16:19], v3 offset:4096
  s_waitcnt lgkmcnt(3)
  v_mfma_f32_16x16x32_bf16 v[32:35], v[232:235], v[20:23], v[32:35]
  v_mfma_f32_16x16x32_bf16 v[36:39], v[236:239], v[20:23], v[36:39]
  v_mfma_f32_16x16x32_bf16 v[40:43], v[240:243], v[20:23], v[40:43]
  v_mfma_f32_16x16x32_bf16 v[44:47], v[244:247], v[20:23], v[44:47]
  v_mfma_f32_16x16x32_bf16 v[48:51], v[248:251], v[20:23], v[48:51]
  v_mfma_f32_16x16x32_bf16 v[52:55], v[252:255], v[20:23], v[52:55]
  ds_read_b128 v[20:23], v3 offset:6144
  s_waitcnt lgkmcnt(3)
  v_mfma_f32_16x16x32_bf16 v[56:59], a[0:3], v[24:27], 0
  v_mfma_f32_16x16x32_bf16 v[60:63], a[4:7], v[24:27], 0
L_bpc_159:
  s_sub_i32 s98, s32, 1
  s_mov_b64 exec, s[66:67]
  s_waitcnt vmcnt(0)
  v_cmp_gt_i32 vcc, s98, v10
  s_mov_b64 exec, -1
  s_cbranch_vccnz L_bpr_160
  v_mfma_f32_16x16x32_bf16 v[64:67], a[8:11], v[24:27], 0
  v_mfma_f32_16x16x32_bf16 v[68:71], a[12:15], v[24:27], 0
  ds_read_b128 v[24:27], v3 offset:9216
  v_cvt_pk_bf16_f32 v32, v32, v33
  v_cvt_pk_bf16_f32 v33, v34, v35
  s_waitcnt lgkmcnt(3)
  v_mfma_f32_16x16x32_bf16 v[56:59], a[24:27], v[28:31], v[56:59]
  v_cvt_pk_bf16_f32 v34, v36, v37
  v_cvt_pk_bf16_f32 v35, v38, v39
  v_mfma_f32_16x16x32_bf16 v[60:63], a[28:31], v[28:31], v[60:63]
  v_bfi_b32 v32, 1, s63, v32
  v_bfi_b32 v34, 1, s63, v34
  v_mfma_f32_16x16x32_bf16 v[64:67], a[32:35], v[28:31], v[64:67]
  v_mfma_f32_16x16x32_bf16 v[68:71], a[36:39], v[28:31], v[68:71]
  buffer_store_dwordx4 v[32:35], v0, s[12:15], s46 offen offset:0
  s_waitcnt lgkmcnt(2)
  v_mfma_f32_16x16x32_bf16 v[56:59], a[48:51], v[16:19], v[56:59]
  ds_read_b128 v[28:31], v3 offset:11264
  v_cvt_pk_bf16_f32 v40, v40, v41
  v_cvt_pk_bf16_f32 v41, v42, v43
  v_mfma_f32_16x16x32_bf16 v[60:63], a[52:55], v[16:19], v[60:63]
  v_cvt_pk_bf16_f32 v42, v44, v45
  v_cvt_pk_bf16_f32 v43, v46, v47
  v_mfma_f32_16x16x32_bf16 v[64:67], a[56:59], v[16:19], v[64:67]
  v_bfi_b32 v40, 1, s63, v40
  v_bfi_b32 v42, 1, s63, v42
  v_mfma_f32_16x16x32_bf16 v[68:71], a[60:63], v[16:19], v[68:71]
  buffer_store_dwordx4 v[40:43], v0, s[12:15], s46 offen offset:2048
  s_waitcnt lgkmcnt(2)
  v_mfma_f32_16x16x32_bf16 v[56:59], a[72:75], v[20:23], v[56:59]
  ds_read_b128 v[16:19], v3 offset:13312
  v_cvt_pk_bf16_f32 v48, v48, v49
  v_cvt_pk_bf16_f32 v49, v50, v51
  v_mfma_f32_16x16x32_bf16 v[60:63], a[76:79], v[20:23], v[60:63]
  v_cvt_pk_bf16_f32 v50, v52, v53
  v_cvt_pk_bf16_f32 v51, v54, v55
  v_mfma_f32_16x16x32_bf16 v[64:67], a[80:83], v[20:23], v[64:67]
  v_bfi_b32 v48, 1, s63, v48
  v_bfi_b32 v50, 1, s63, v50
  v_mfma_f32_16x16x32_bf16 v[68:71], a[84:87], v[20:23], v[68:71]
  buffer_store_dwordx4 v[48:51], v0, s[12:15], s48 offen
  s_waitcnt lgkmcnt(2)
  v_mfma_f32_16x16x32_bf16 v[56:59], a[96:99], v[24:27], v[56:59]
  ds_read_b128 v[20:23], v3 offset:15360
  v_mfma_f32_16x16x32_bf16 v[60:63], a[100:103], v[24:27], v[60:63]
  v_mfma_f32_16x16x32_bf16 v[64:67], a[104:107], v[24:27], v[64:67]
  v_mfma_f32_16x16x32_bf16 v[68:71], a[108:111], v[24:27], v[68:71]
  ds_read_b128 v[24:27], v3 offset:18432
  s_waitcnt lgkmcnt(3)
  v_mfma_f32_16x16x32_bf16 v[56:59], a[120:123], v[28:31], v[56:59]
  v_mfma_f32_16x16x32_bf16 v[60:63], a[124:127], v[28:31], v[60:63]
  v_mfma_f32_16x16x32_bf16 v[64:67], a[128:131], v[28:31], v[64:67]
  v_mfma_f32_16x16x32_bf16 v[68:71], a[132:135], v[28:31], v[68:71]
  ds_read_b128 v[28:31], v3 offset:20480
  s_waitcnt lgkmcnt(3)
  v_mfma_f32_16x16x32_bf16 v[56:59], a[144:147], v[16:19], v[56:59]
  v_mfma_f32_16x16x32_bf16 v[60:63], a[148:151], v[16:19], v[60:63]
  v_mfma_f32_16x16x32_bf16 v[64:67], a[152:155], v[16:19], v[64:67]
  v_mfma_f32_16x16x32_bf16 v[68:71], a[156:159], v[16:19], v[68:71]
  ds_read_b128 v[16:19], v3 offset:22528
  s_waitcnt lgkmcnt(3)
  v_mfma_f32_16x16x32_bf16 v[56:59], a[168:171], v[20:23], v[56:59]
  v_mfma_f32_16x16x32_bf16 v[60:63], a[172:175], v[20:23], v[60:63]
  v_mfma_f32_16x16x32_bf16 v[64:67], a[176:179], v[20:23], v[64:67]
  v_mfma_f32_16x16x32_bf16 v[68:71], a[180:183], v[20:23], v[68:71]
  ds_read_b128 v[20:23], v3 offset:24576
  s_waitcnt lgkmcnt(3)
  v_mfma_f32_16x16x32_bf16 v[56:59], a[192:195], v[24:27], v[56:59]
  v_mfma_f32_16x16x32_bf16 v[60:63], a[196:199], v[24:27], v[60:63]
  v_mfma_f32_16x16x32_bf16 v[64:67], a[200:203], v[24:27], v[64:67]
  v_mfma_f32_16x16x32_bf16 v[68:71], a[204:207], v[24:27], v[68:71]
  ds_read_b128 v[24:27], v3 offset:27648
  s_cmp_lg_u32 s35, 0
  s_waitcnt lgkmcnt(3)
  v_mfma_f32_16x16x32_bf16 v[56:59], a[216:219], v[28:31], v[56:59]
  s_cbranch_scc1 L_ck_161
  s_add_u32 s98, s32, 2
  s_mov_b64 exec, s[40:41]
  s_waitcnt vmcnt(3)
  v_cmp_gt_u32 vcc, s98, v6
  s_mov_b64 exec, -1
  s_cbranch_vccnz L_ck_161r
  s_add_u32 m0, s34, 0
  s_add_u32 s98, s33, 0
  buffer_load_dwordx4 v0, s[12:15], s98 offen offset:0 sc1 lds
  buffer_load_dwordx4 v0, s[12:15], s98 offen offset:1024 sc1 lds
  buffer_load_dwordx4 v0, s[12:15], s98 offen offset:2048 sc1 lds
  buffer_load_dwordx4 v0, s[12:15], s98 offen offset:3072 sc1 lds
  s_add_u32 m0, s34, 4096
  s_add_u32 s98, s33, 4096
  buffer_load_dwordx4 v0, s[12:15], s98 offen offset:0 sc1 lds
  buffer_load_dwordx4 v0, s[12:15], s98 offen offset:1024 sc1 lds
  buffer_load_dwordx4 v0, s[12:15], s98 offen offset:2048 sc1 lds
  buffer_load_dwordx4 v0, s[12:15], s98 offen offset:3072 sc1 lds
  s_add_u32 m0, s34, 8192
  s_add_u32 s98, s33, 8192
  buffer_load_dwordx4 v0, s[12:15], s98 offen offset:0 sc1 lds
  s_add_u32 s33, s33, 294912
  s_xor_b32 s34, s34, s39
  s_mov_b32 s35, 1
  s_branch L_ck_161
L_ck_161r:
  s_mov_b64 exec, s[40:41]
  buffer_load_dword v6, v1, s[12:15], s36 offen sc1
  s_mov_b64 exec, -1
L_ck_161:
  v_mfma_f32_16x16x32_bf16 v[60:63], a[220:223], v[28:31], v[60:63]
  v_mfma_f32_16x16x32_bf16 v[64:67], a[224:227], v[28:31], v[64:67]
  v_mfma_f32_16x16x32_bf16 v[68:71], a[228:231], v[28:31], v[68:71]
  ds_read_b128 v[28:31], v3 offset:29696
  s_waitcnt lgkmcnt(3)
  v_mfma_f32_16x16x32_bf16 v[56:59], a[240:243], v[16:19], v[56:59]
  v_mfma_f32_16x16x32_bf16 v[60:63], a[244:247], v[16:19], v[60:63]
  v_mfma_f32_16x16x32_bf16 v[64:67], a[248:251], v[16:19], v[64:67]
  v_mfma_f32_16x16x32_bf16 v[68:71], a[252:255], v[16:19], v[68:71]
  ds_read_b128 v[16:19], v3 offset:31744
  s_waitcnt lgkmcnt(3)
  v_mfma_f32_16x16x32_bf16 v[56:59], v[88:91], v[20:23], v[56:59]
  v_mfma_f32_16x16x32_bf16 v[60:63], v[92:95], v[20:23], v[60:63]
  v_mfma_f32_16x16x32_bf16 v[64:67], v[96:99], v[20:23], v[64:67]
  v_mfma_f32_16x16x32_bf16 v[68:71], v[100:103], v[20:23], v[68:71]
  ds_read_b128 v[20:23], v3 offset:33792
  s_waitcnt lgkmcnt(3)
  v_mfma_f32_16x16x32_bf16 v[56:59], v[112:115], v[24:27], v[56:59]
  v_mfma_f32_16x16x32_bf16 v[60:63], v[116:119], v[24:27], v[60:63]
  v_mfma_f32_16x16x32_bf16 v[64:67], v[120:123], v[24:27], v[64:67]
  v_mfma_f32_16x16x32_bf16 v[68:71], v[124:127], v[24:27], v[68:71]
  ds_read2st64_b32 v[24:25], v5 offset0:32 offset1:34
  ds_read2st64_b32 v[26:27], v5 offset0:68 offset1:70
  s_waitcnt lgkmcnt(4)
  v_mfma_f32_16x16x32_bf16 v[56:59], v[136:139], v[28:31], v[56:59]
  v_mfma_f32_16x16x32_bf16 v[60:63], v[140:143], v[28:31], v[60:63]
  v_mfma_f32_16x16x32_bf16 v[64:67], v[144:147], v[28:31], v[64:67]
  v_mfma_f32_16x16x32_bf16 v[68:71], v[148:151], v[28:31], v[68:71]
  ds_read2st64_b32 v[28:29], v5 offset0:104 offset1:106
  ds_read2st64_b32 v[30:31], v5 offset0:140 offset1:142
  s_waitcnt lgkmcnt(5)
  v_mfma_f32_16x16x32_bf16 v[56:59], v[160:163], v[16:19], v[56:59]
  v_mfma_f32_16x16x32_bf16 v[60:63], v[164:167], v[16:19], v[60:63]
  v_mfma_f32_16x16x32_bf16 v[64:67], v[168:171], v[16:19], v[64:67]
  v_mfma_f32_16x16x32_bf16 v[68:71], v[172:175], v[16:19], v[68:71]
  s_waitcnt lgkmcnt(4)
  v_mfma_f32_16x16x32_bf16 v[56:59], v[184:187], v[20:23], v[56:59]
  v_mfma_f32_16x16x32_bf16 v[60:63], v[188:191], v[20:23], v[60:63]
  v_mfma_f32_16x16x32_bf16 v[64:67], v[192:195], v[20:23], v[64:67]
  v_mfma_f32_16x16x32_bf16 v[68:71], v[196:199], v[20:23], v[68:71]
  s_waitcnt lgkmcnt(2)
  v_mfma_f32_16x16x32_bf16 v[56:59], v[208:211], v[24:27], v[56:59]
  s_cmp_lg_u32 s35, 0
  v_mfma_f32_16x16x32_bf16 v[60:63], v[212:215], v[24:27], v[60:63]
  v_mfma_f32_16x16x32_bf16 v[64:67], v[216:219], v[24:27], v[64:67]
  v_mfma_f32_16x16x32_bf16 v[68:71], v[220:223], v[24:27], v[68:71]
  s_waitcnt lgkmcnt(0)
  v_mfma_f32_16x16x32_bf16 v[56:59], v[232:235], v[28:31], v[56:59]
  v_mfma_f32_16x16x32_bf16 v[60:63], v[236:239], v[28:31], v[60:63]
  v_mfma_f32_16x16x32_bf16 v[64:67], v[240:243], v[28:31], v[64:67]
  s_cbranch_scc1 L_ck_162
  s_add_u32 s98, s32, 2
  s_mov_b64 exec, s[40:41]
  s_waitcnt vmcnt(0)
  v_cmp_gt_u32 vcc, s98, v6
  s_mov_b64 exec, -1
  s_cbranch_vccnz L_ck_162r
  s_add_u32 m0, s34, 0
  s_add_u32 s98, s33, 0
  buffer_load_dwordx4 v0, s[12:15], s98 offen offset:0 sc1 lds
  buffer_load_dwordx4 v0, s[12:15], s98 offen offset:1024 sc1 lds
  buffer_load_dwordx4 v0, s[12:15], s98 offen offset:2048 sc1 lds
  buffer_load_dwordx4 v0, s[12:15], s98 offen offset:3072 sc1 lds
  s_add_u32 m0, s34, 4096
  s_add_u32 s98, s33, 4096
  buffer_load_dwordx4 v0, s[12:15], s98 offen offset:0 sc1 lds
  buffer_load_dwordx4 v0, s[12:15], s98 offen offset:1024 sc1 lds
  buffer_load_dwordx4 v0, s[12:15], s98 offen offset:2048 sc1 lds
  buffer_load_dwordx4 v0, s[12:15], s98 offen offset:3072 sc1 lds
  s_add_u32 m0, s34, 8192
  s_add_u32 s98, s33, 8192
  buffer_load_dwordx4 v0, s[12:15], s98 offen offset:0 sc1 lds
  s_add_u32 s33, s33, 294912
  s_xor_b32 s34, s34, s39
  s_mov_b32 s35, 1
  s_branch L_ck_162
L_ck_162r:
L_ck_162:
  v_mfma_f32_16x16x32_bf16 v[68:71], v[244:247], v[28:31], v[68:71]
  s_nop 3
  v_cvt_pk_bf16_f32 v56, v56, v57
  v_cvt_pk_bf16_f32 v57, v58, v59
  v_cvt_pk_bf16_f32 v58, v60, v61
  v_cvt_pk_bf16_f32 v59, v62, v63
  v_bfi_b32 v56, 1, s63, v56
  v_bfi_b32 v58, 1, s63, v58
  buffer_store_dwordx4 v[56:59], v0, s[12:15], s47 offen offset:0
  v_cvt_pk_bf16_f32 v64, v64, v65
  v_cvt_pk_bf16_f32 v65, v66, v67
  v_cvt_pk_bf16_f32 v66, v68, v69
  v_cvt_pk_bf16_f32 v67, v70, v71
  v_bfi_b32 v64, 1, s63, v64
  v_bfi_b32 v66, 1, s63, v66
  buffer_store_dwordx4 v[64:67], v0, s[12:15], s47 offen offset:2048
  s_cmp_eq_u32 s32, 63
  s_cselect_b32 s35, 0, s35
  s_mov_b32 s92, s35
  s_cmp_lg_u32 s35, 0
  s_cbranch_scc1 L_dnG_j
  s_sleep 6
L_dnG_j:
  v_add_u32 v2, s42, v2
  v_add_u32 v3, s42, v3
  v_add_u32 v4, s42, v4
  v_add_u32 v5, s42, v5
  s_sub_u32 s42, 0, s42
  s_add_u32 s32, s32, 1
  s_and_b32 s98, s32, 1
  s_cselect_b32 s98, 0, 593920
  s_sub_u32 s98, 296960, s98
  s_add_u32 s46, s46, s98
  s_add_u32 s47, s47, s98
  s_add_u32 s48, s48, s98
  s_cmp_eq_u32 s32, 64
  s_cbranch_scc1 L_dnG_done
  s_cmp_eq_u32 s35, 0
  s_cbranch_scc1 L_dnG_late
  s_waitcnt vmcnt(2)
  s_branch L_dnG_loop
L_dnG_late:
  s_mov_b64 exec, s[40:41]
  buffer_load_dword v6, v1, s[12:15], s36 offen sc1
  s_mov_b64 exec, -1
  s_add_u32 s98, s32, 1
  s_mov_b64 exec, s[40:41]
  s_waitcnt vmcnt(0)
  v_cmp_gt_u32 vcc, s98, v6
  s_mov_b64 exec, -1
  s_cbranch_vccnz L_lt_163s
  s_cmp_eq_u32 s43, 0
  s_cbranch_scc1 L_fl_164
  v_mov_b32 v7, s43
  s_mov_b64 exec, 1
  buffer_store_dword v7, off, s[12:15], s37 sc1
  s_mov_b64 exec, -1
  s_mov_b32 s43, 0
L_fl_164:
  s_add_u32 m0, s34, 0
  s_add_u32 s98, s33, 0
  buffer_load_dwordx4 v0, s[12:15], s98 offen offset:0 sc1 lds
  buffer_load_dwordx4 v0, s[12:15], s98 offen offset:1024 sc1 lds
  buffer_load_dwordx4 v0, s[12:15], s98 offen offset:2048 sc1 lds
  buffer_load_dwordx4 v0, s[12:15], s98 offen offset:3072 sc1 lds
  s_add_u32 m0, s34, 4096
  s_add_u32 s98, s33, 4096
  buffer_load_dwordx4 v0, s[12:15], s98 offen offset:0 sc1 lds
  buffer_load_dwordx4 v0, s[12:15], s98 offen offset:1024 sc1 lds
  buffer_load_dwordx4 v0, s[12:15], s98 offen offset:2048 sc1 lds
  buffer_load_dwordx4 v0, s[12:15], s98 offen offset:3072 sc1 lds
  s_add_u32 m0, s34, 8192
  s_add_u32 s98, s33, 8192
  buffer_load_dwordx4 v0, s[12:15], s98 offen offset:0 sc1 lds
  s_add_u32 s33, s33, 294912
  s_xor_b32 s34, s34, s39
  s_mov_b32 s35, 1
  s_branch L_lt_163e
L_lt_163s:
  s_cmp_eq_u32 s43, 0
  s_cbranch_scc1 L_fl_165
  v_mov_b32 v7, s43
  s_mov_b64 exec, 1
  buffer_store_dword v7, off, s[12:15], s37 sc1
  s_mov_b64 exec, -1
  s_mov_b32 s43, 0
L_fl_165:
L_bk_166:
  s_mov_b64 exec, s[40:41]
  buffer_load_dword v6, v1, s[12:15], s36 offen sc1
  s_mov_b64 exec, -1
  s_add_u32 s98, s32, 1
  s_mov_b64 exec, s[40:41]
  s_waitcnt vmcnt(0)
  v_cmp_gt_u32 vcc, s98, v6
  s_mov_b64 exec, -1
  s_cbranch_vccz L_bk_166d
  s_sleep 1
  s_sub_u32 s100, s100, 1
  s_cbranch_scc0 L_bk_166
  s_branch L_end
L_bk_166d:
  s_add_u32 m0, s34, 0
  s_add_u32 s98, s33, 0
  buffer_load_dwordx4 v0, s[12:15], s98 offen offset:0 sc1 lds
  buffer_load_dwordx4 v0, s[12:15], s98 offen offset:1024 sc1 lds
  buffer_load_dwordx4 v0, s[12:15], s98 offen offset:2048 sc1 lds
  buffer_load_dwordx4 v0, s[12:15], s98 offen offset:3072 sc1 lds
  s_add_u32 m0, s34, 4096
  s_add_u32 s98, s33, 4096
  buffer_load_dwordx4 v0, s[12:15], s98 offen offset:0 sc1 lds
  buffer_load_dwordx4 v0, s[12:15], s98 offen offset:1024 sc1 lds
  buffer_load_dwordx4 v0, s[12:15], s98 offen offset:2048 sc1 lds
  buffer_load_dwordx4 v0, s[12:15], s98 offen offset:3072 sc1 lds
  s_add_u32 m0, s34, 8192
  s_add_u32 s98, s33, 8192
  buffer_load_dwordx4 v0, s[12:15], s98 offen offset:0 sc1 lds
  s_add_u32 s33, s33, 294912
  s_xor_b32 s34, s34, s39
  s_mov_b32 s35, 1
L_lt_163e:
  s_waitcnt vmcnt(0)
  s_branch L_dnG_loop
L_dnG_done:
  s_waitcnt vmcnt(0)
  s_cmp_eq_u32 s43, 0
  s_cbranch_scc1 L_fl_167
  v_mov_b32 v7, s43
  s_mov_b64 exec, 1
  buffer_store_dword v7, off, s[12:15], s37 sc1
  s_mov_b64 exec, -1
  s_mov_b32 s43, 0
L_fl_167:
  s_branch L_end
L_bpr_160:
  s_mov_b64 exec, s[66:67]
  buffer_load_dword v10, v1, s[12:15], s93 offen sc1
  s_mov_b64 exec, -1
  s_waitcnt vmcnt(0)
  s_sub_u32 s100, s100, 1
  s_cbranch_scc0 L_bpc_159
  s_branch L_end
L_end:
  s_endpgm
.section .rodata,"a"
.p2align 6
.amdhsa_kernel interleave_layers__memory_aug_recurrent_mem_tr__glu_gated_geglu__prompt_kernel
  .amdhsa_next_free_vgpr 512
  .amdhsa_next_free_sgpr 102
  .amdhsa_accum_offset 256
  .amdhsa_group_segment_fixed_size 0
  .amdhsa_kernarg_size 112
  .amdhsa_user_sgpr_count 2
  .amdhsa_user_sgpr_kernarg_segment_ptr 1
  .amdhsa_system_sgpr_workgroup_id_x 1
.end_amdhsa_kernel
```
